```python
import torch

def _softmax(x, axis=-1):
    return torch.softmax(x, dim=axis)

def _gelu(x):
    return torch.nn.functional.gelu(x, approximate='tanh')

def _silu(x):
    return torch.nn.functional.silu(x)

def _sigmoid(x):
    return torch.sigmoid(x)

def _layernorm(x, axis=-1, eps=1e-05):
    m = x.mean(dim=axis, keepdim=True)
    v = x.var(dim=axis, keepdim=True, unbiased=False)
    return (x - m) / torch.sqrt(v + eps)

def _scatter_add(tgt, idx, src, axis=0):
    return tgt.clone().index_add_(axis, idx, src)

def _segment_sum(src, seg, n):
    out = torch.zeros((n,) + src.shape[1:], dtype=src.dtype)
    return out.index_add_(0, seg, src)

def _pad(x, pw):
    flat = tuple((v for pair in reversed(pw) for v in pair))
    return torch.nn.functional.pad(x, flat)
kernel_name = 'parallel_sum__memory_aug_recurrent_mem_tr__dense_activation_relu__prompt'

def setup_inputs():

    _w = lambda a: (lambda t: t.to(torch.bfloat16) if t.is_floating_point() else t)(torch.as_tensor(a))

    def _A_setup():
        B, S, Dm = (1, 2048, 576)
        H, Dh = (32, 128)
        M, seg = (8, 32)
        seg = min(seg, S)
        S = S // seg * seg
        return {'x': _w((lambda *s: torch.randn(*s, dtype=torch.bfloat16) * 0.05)(B, S, Dm)), 'mem0': _w((lambda *s: torch.randn(*s, dtype=torch.bfloat16) * 1.6)(B, M, Dm)), 'Wq': _w((lambda *s: torch.randn(*s, dtype=torch.bfloat16) * 0.8)(Dm, H, Dh) * Dm ** (-0.5)), 'Wk': _w((lambda *s: torch.randn(*s, dtype=torch.bfloat16) * 0.8)(Dm, H, Dh) * Dm ** (-0.5)), 'Wv': _w((lambda *s: torch.randn(*s, dtype=torch.bfloat16) * 1.6)(Dm, H, Dh) * Dm ** (-0.5)), 'Wo': _w((lambda *s: torch.randn(*s, dtype=torch.bfloat16) * 1.6)(H, Dh, Dm) * (H * Dh) ** (-0.5)), 'seg_len': seg}
    _A_in = _A_setup()

    def _B_setup():
        B, S, D, Dff = (1, 2048, 576, 4608)
        return {'x': _w((lambda *s: torch.randn(*s, dtype=torch.bfloat16) * 0.05)(B, S, D)), 'w1': _w((lambda *s: torch.randn(*s, dtype=torch.bfloat16) * 0.05)(D, Dff)), 'w2': _w((lambda *s: torch.randn(*s, dtype=torch.bfloat16) * 0.05)(Dff, D))}
    _B_in = _B_setup()
    return {'A_x': _A_in['x'], 'A_mem0': _A_in['mem0'], 'A_Wq': _A_in['Wq'], 'A_Wk': _A_in['Wk'], 'A_Wv': _A_in['Wv'], 'A_Wo': _A_in['Wo'], 'A_seg_len': _A_in['seg_len'], 'B_x': _B_in['x'], 'B_w1': _B_in['w1'], 'B_w2': _B_in['w2']}

def reference(A_x, A_mem0, A_Wq, A_Wk, A_Wv, A_Wo, A_seg_len, B_x, B_w1, B_w2):

    def _A_ref(x, mem0, Wq, Wk, Wv, Wo, seg_len):
        B, S, Dm = x.shape
        H, Dh = (Wq.shape[1], Wq.shape[2])
        M = mem0.shape[1]
        scale = Dh ** (-0.5)
        n_seg = S // seg_len
        L = M + seg_len
        idx = torch.arange(L)
        mask = (idx[:, None] < M) | (idx[:, None] >= idx[None, :])
        mem = mem0
        outs = []
        for s in range(n_seg):
            xs = x[:, s * seg_len:(s + 1) * seg_len, :].clone()
            h = torch.concatenate([mem, xs], axis=1)
            q = torch.einsum('btd,dhe->bhte', h, Wq)
            k = torch.einsum('btd,dhe->bhte', h, Wk)
            v = torch.einsum('btd,dhe->bhte', h, Wv)
            scores = torch.einsum('bhqe,bhke->bhqk', q, k) * scale
            scores = torch.where(mask[None, None], scores, -1000000000.0)
            p = _softmax(scores, axis=-1)
            o = torch.einsum('bhqk,bhke->bhqe', p, v)
            o = torch.einsum('bhte,hed->btd', o, Wo)
            mem = o[:, :M, :].clone()
            outs.append(o[:, M:, :])
        return torch.concatenate(outs, axis=1)

    def _B_ref(x, w1, w2):
        h = torch.einsum('bsd,df->bsf', x, w1)
        zero = torch.zeros_like(h)
        h = torch.maximum(h, zero)
        return torch.einsum('bsf,fd->bsd', h, w2)
    x = A_x
    xn = _layernorm(x, axis=-1)
    return x + _A_ref(xn, A_mem0, A_Wq, A_Wk, A_Wv, A_Wo, A_seg_len) + _B_ref(xn, B_w1, B_w2)
```

```asm
; @launch grid=(256,1,1) block=(256,1,1) lds=163840
.amdgcn_target "amdgcn-amd-amdhsa--gfx950"
.text
.globl parallel_sum__memory_aug_recurrent_mem_tr__dense_activation_relu__prompt_kernel
.p2align 8
.type parallel_sum__memory_aug_recurrent_mem_tr__dense_activation_relu__prompt_kernel,@function
parallel_sum__memory_aug_recurrent_mem_tr__dense_activation_relu__prompt_kernel:
 s_cmp_ge_u32 s2, 256
 s_cbranch_scc1 L_exit
 s_load_dwordx2 s[4:5], s[0:1], 96
 s_mov_b32 s6, 0x10000000
 s_mov_b32 s7, 0x20000
 s_load_dwordx2 s[8:9], s[0:1], 88
 s_mov_b32 s10, 0x100
 s_mov_b32 s11, 0x20000
 s_getreg_b32 s12, hwreg(HW_REG_XCC_ID)
 s_and_b32 s12, s12, 7
 v_lshrrev_b32 v2, 6, v0
 v_and_b32 v1, 63, v0
 v_readfirstlane_b32 s14, v2
 s_mov_b32 s15, 0x20000
 s_mov_b32 s32, 0
 s_waitcnt lgkmcnt(0)
 s_and_b32 s5, s5, 0xffff
 s_and_b32 s9, s9, 0xffff
 s_cmp_lg_u32 s14, 0
 s_cbranch_scc1 L_tk_wait
 s_lshl_b32 s33, s12, 2
 v_mov_b32 v2, 1
 v_mov_b32 v3, 0
 s_mov_b64 exec, 1
 buffer_atomic_add v2, v3, s[8:11], s33 offen sc0 sc1
 s_waitcnt vmcnt(0)
 v_readfirstlane_b32 s13, v2
 s_mov_b64 exec, -1
 s_cmp_lt_u32 s13, 32
 s_cbranch_scc1 L_tk_ok
 v_lshlrev_b32 v3, 2, v1
 v_and_b32 v3, 31, v3
L_ov_poll:
 buffer_load_dword v2, v3, s[8:11], 0 offen sc1
 s_waitcnt vmcnt(0)
 s_mov_b32 s33, 0
 v_readlane_b32 s40, v2, 0
 v_readlane_b32 s41, v2, 1
 v_readlane_b32 s42, v2, 2
 v_readlane_b32 s43, v2, 3
 v_readlane_b32 s44, v2, 4
 v_readlane_b32 s45, v2, 5
 v_readlane_b32 s46, v2, 6
 v_readlane_b32 s47, v2, 7
 s_add_u32 s33, s33, s40
 s_add_u32 s33, s33, s41
 s_add_u32 s33, s33, s42
 s_add_u32 s33, s33, s43
 s_add_u32 s33, s33, s44
 s_add_u32 s33, s33, s45
 s_add_u32 s33, s33, s46
 s_add_u32 s33, s33, s47
 s_cmp_eq_u32 s33, 256
 s_cbranch_scc1 L_ov_go
 s_cmp_eq_u32 s15, 0
 s_cbranch_scc1 L_ov_go
 s_sub_u32 s15, s15, 1
 s_branch L_ov_poll
L_ov_go:
 s_sub_u32 s33, s13, 32
 s_sub_u32 s34, s40, 32
 s_max_i32 s34, s34, 0
 s_cmp_gt_u32 s12, 0
 s_cselect_b32 s34, s34, 0
 s_add_u32 s33, s33, s34
 s_sub_u32 s34, s41, 32
 s_max_i32 s34, s34, 0
 s_cmp_gt_u32 s12, 1
 s_cselect_b32 s34, s34, 0
 s_add_u32 s33, s33, s34
 s_sub_u32 s34, s42, 32
 s_max_i32 s34, s34, 0
 s_cmp_gt_u32 s12, 2
 s_cselect_b32 s34, s34, 0
 s_add_u32 s33, s33, s34
 s_sub_u32 s34, s43, 32
 s_max_i32 s34, s34, 0
 s_cmp_gt_u32 s12, 3
 s_cselect_b32 s34, s34, 0
 s_add_u32 s33, s33, s34
 s_sub_u32 s34, s44, 32
 s_max_i32 s34, s34, 0
 s_cmp_gt_u32 s12, 4
 s_cselect_b32 s34, s34, 0
 s_add_u32 s33, s33, s34
 s_sub_u32 s34, s45, 32
 s_max_i32 s34, s34, 0
 s_cmp_gt_u32 s12, 5
 s_cselect_b32 s34, s34, 0
 s_add_u32 s33, s33, s34
 s_sub_u32 s34, s46, 32
 s_max_i32 s34, s34, 0
 s_cmp_gt_u32 s12, 6
 s_cselect_b32 s34, s34, 0
 s_add_u32 s33, s33, s34
 s_sub_u32 s34, s47, 32
 s_max_i32 s34, s34, 0
 s_cmp_gt_u32 s12, 7
 s_cselect_b32 s34, s34, 0
 s_add_u32 s33, s33, s34
 s_mov_b32 s32, 1
 s_mov_b32 s35, 0
 s_mov_b32 s36, 7
 s_mov_b32 s37, 31
 s_min_u32 s34, s40, 32
 s_sub_u32 s38, 32, s34
 s_cmp_eq_u32 s35, 0
 s_cbranch_scc0 L_hn1
 s_cmp_lt_u32 s33, s38
 s_cselect_b32 s35, 1, 0
 s_add_u32 s39, s34, s33
 s_cmp_eq_u32 s35, 1
 s_cselect_b32 s36, 0, s36
 s_cselect_b32 s37, s39, s37
 s_sub_u32 s33, s33, s38
L_hn1:
 s_min_u32 s34, s41, 32
 s_sub_u32 s38, 32, s34
 s_cmp_eq_u32 s35, 0
 s_cbranch_scc0 L_hn2
 s_cmp_lt_u32 s33, s38
 s_cselect_b32 s35, 1, 0
 s_add_u32 s39, s34, s33
 s_cmp_eq_u32 s35, 1
 s_cselect_b32 s36, 1, s36
 s_cselect_b32 s37, s39, s37
 s_sub_u32 s33, s33, s38
L_hn2:
 s_min_u32 s34, s42, 32
 s_sub_u32 s38, 32, s34
 s_cmp_eq_u32 s35, 0
 s_cbranch_scc0 L_hn3
 s_cmp_lt_u32 s33, s38
 s_cselect_b32 s35, 1, 0
 s_add_u32 s39, s34, s33
 s_cmp_eq_u32 s35, 1
 s_cselect_b32 s36, 2, s36
 s_cselect_b32 s37, s39, s37
 s_sub_u32 s33, s33, s38
L_hn3:
 s_min_u32 s34, s43, 32
 s_sub_u32 s38, 32, s34
 s_cmp_eq_u32 s35, 0
 s_cbranch_scc0 L_hn4
 s_cmp_lt_u32 s33, s38
 s_cselect_b32 s35, 1, 0
 s_add_u32 s39, s34, s33
 s_cmp_eq_u32 s35, 1
 s_cselect_b32 s36, 3, s36
 s_cselect_b32 s37, s39, s37
 s_sub_u32 s33, s33, s38
L_hn4:
 s_min_u32 s34, s44, 32
 s_sub_u32 s38, 32, s34
 s_cmp_eq_u32 s35, 0
 s_cbranch_scc0 L_hn5
 s_cmp_lt_u32 s33, s38
 s_cselect_b32 s35, 1, 0
 s_add_u32 s39, s34, s33
 s_cmp_eq_u32 s35, 1
 s_cselect_b32 s36, 4, s36
 s_cselect_b32 s37, s39, s37
 s_sub_u32 s33, s33, s38
L_hn5:
 s_min_u32 s34, s45, 32
 s_sub_u32 s38, 32, s34
 s_cmp_eq_u32 s35, 0
 s_cbranch_scc0 L_hn6
 s_cmp_lt_u32 s33, s38
 s_cselect_b32 s35, 1, 0
 s_add_u32 s39, s34, s33
 s_cmp_eq_u32 s35, 1
 s_cselect_b32 s36, 5, s36
 s_cselect_b32 s37, s39, s37
 s_sub_u32 s33, s33, s38
L_hn6:
 s_min_u32 s34, s46, 32
 s_sub_u32 s38, 32, s34
 s_cmp_eq_u32 s35, 0
 s_cbranch_scc0 L_hn7
 s_cmp_lt_u32 s33, s38
 s_cselect_b32 s35, 1, 0
 s_add_u32 s39, s34, s33
 s_cmp_eq_u32 s35, 1
 s_cselect_b32 s36, 6, s36
 s_cselect_b32 s37, s39, s37
 s_sub_u32 s33, s33, s38
L_hn7:
 s_min_u32 s34, s47, 32
 s_sub_u32 s38, 32, s34
 s_cmp_eq_u32 s35, 0
 s_cbranch_scc0 L_hn8
 s_cmp_lt_u32 s33, s38
 s_cselect_b32 s35, 1, 0
 s_add_u32 s39, s34, s33
 s_cmp_eq_u32 s35, 1
 s_cselect_b32 s36, 7, s36
 s_cselect_b32 s37, s39, s37
 s_sub_u32 s33, s33, s38
L_hn8:
 s_mov_b32 s12, s36
 s_mov_b32 s13, s37
L_tk_ok:
 s_lshl_b32 s33, s12, 5
 s_or_b32 s33, s33, s13
 s_lshl_b32 s34, s32, 8
 s_or_b32 s33, s33, s34
 v_mov_b32 v2, s33
 v_mov_b32 v3, 0
 ds_write_b32 v3, v2
 s_waitcnt lgkmcnt(0)
L_tk_wait:
 s_barrier
 v_mov_b32 v3, 0
 ds_read_b32 v2, v3
 s_waitcnt lgkmcnt(0)
 v_readfirstlane_b32 s33, v2
 s_and_b32 s13, s33, 31
 s_bfe_u32 s12, s33, 0x30005
 s_bfe_u32 s32, s33, 0x10008
 s_barrier
 s_lshl_b32 s33, s12, 2
 s_lshr_b32 s33, 0x43210765, s33
 s_and_b32 s12, s33, 7
 s_lshl_b32 s33, s12, 5
 s_add_u32 s33, s33, s13
 s_lshl_b32 s33, s33, 5
 v_mov_b32 v2, 0
 v_mov_b32 v3, 0
 v_mov_b32 v4, 0
 v_mov_b32 v5, 0
 v_lshlrev_b32 v6, 4, v1
 s_mov_b64 exec, 3
 buffer_store_dwordx4 v[2:5], v6, s[4:7], s33 offen sc1
 s_mov_b64 exec, -1
 s_cmp_eq_u32 s12, 0
 s_cbranch_scc1 L_chain
 s_sub_u32 s38, s12, 1
 s_mul_i32 s39, s13, 7
 s_add_u32 s39, s39, s38
 s_cmp_ge_u32 s39, 128
 s_cbranch_scc1 L_noln
 s_load_dwordx2 s[16:17], s[0:1], 0
 s_mov_b32 s18, 0x240000
 s_mov_b32 s19, 0x20000
 v_lshrrev_b32 v2, 4, v1
 v_and_b32 v3, 15, v1
 s_lshl_b32 s33, s14, 2
 v_add_u32 v2, s33, v2
 s_lshl_b32 s34, s39, 4
 v_add_u32 v4, s34, v2
 v_mul_u32_u24 v4, 1152, v4
 v_lshl_add_u32 v4, v3, 4, v4
 s_waitcnt lgkmcnt(0)
 s_and_b32 s17, s17, 0xffff
 buffer_load_dwordx4 v[8:11], v4, s[16:19], 0 offen offset:0
 buffer_load_dwordx4 v[12:15], v4, s[16:19], 0 offen offset:256
 buffer_load_dwordx4 v[16:19], v4, s[16:19], 0 offen offset:512
 buffer_load_dwordx4 v[20:23], v4, s[16:19], 0 offen offset:768
 buffer_load_dwordx4 v[24:27], v4, s[16:19], 0 offen offset:1024
 v_lshrrev_b32 v5, 2, v3
 v_lshlrev_b32 v5, 10, v5
 v_and_b32 v6, 3, v3
 v_lshl_add_u32 v5, v6, 8, v5
 v_lshl_add_u32 v5, v2, 4, v5
 s_mul_i32 s34, s39, 18432
 s_add_u32 s34, s34, 1048576
 v_cmp_gt_u32 vcc, 8, v3
 s_nop 1
 v_cndmask_b32 v7, 0, 1.0, vcc
 s_waitcnt vmcnt(4)
 v_lshlrev_b32 v30, 16, v8
 v_and_b32 v31, 0xffff0000, v8
 v_lshlrev_b32 v32, 16, v9
 v_and_b32 v33, 0xffff0000, v9
 v_lshlrev_b32 v34, 16, v10
 v_and_b32 v35, 0xffff0000, v10
 v_lshlrev_b32 v36, 16, v11
 v_and_b32 v37, 0xffff0000, v11
 s_waitcnt vmcnt(3)
 v_lshlrev_b32 v38, 16, v12
 v_and_b32 v39, 0xffff0000, v12
 v_lshlrev_b32 v40, 16, v13
 v_and_b32 v41, 0xffff0000, v13
 v_lshlrev_b32 v42, 16, v14
 v_and_b32 v43, 0xffff0000, v14
 v_lshlrev_b32 v44, 16, v15
 v_and_b32 v45, 0xffff0000, v15
 s_waitcnt vmcnt(2)
 v_lshlrev_b32 v46, 16, v16
 v_and_b32 v47, 0xffff0000, v16
 v_lshlrev_b32 v48, 16, v17
 v_and_b32 v49, 0xffff0000, v17
 v_lshlrev_b32 v50, 16, v18
 v_and_b32 v51, 0xffff0000, v18
 v_lshlrev_b32 v52, 16, v19
 v_and_b32 v53, 0xffff0000, v19
 s_waitcnt vmcnt(1)
 v_lshlrev_b32 v54, 16, v20
 v_and_b32 v55, 0xffff0000, v20
 v_lshlrev_b32 v56, 16, v21
 v_and_b32 v57, 0xffff0000, v21
 v_lshlrev_b32 v58, 16, v22
 v_and_b32 v59, 0xffff0000, v22
 v_lshlrev_b32 v60, 16, v23
 v_and_b32 v61, 0xffff0000, v23
 s_waitcnt vmcnt(0)
 v_lshlrev_b32 v62, 16, v24
 v_and_b32 v63, 0xffff0000, v24
 v_lshlrev_b32 v64, 16, v25
 v_and_b32 v65, 0xffff0000, v25
 v_lshlrev_b32 v66, 16, v26
 v_and_b32 v67, 0xffff0000, v26
 v_lshlrev_b32 v68, 16, v27
 v_and_b32 v69, 0xffff0000, v27
 v_add_f32 v72, v30, v34
 v_add_f32 v73, v31, v35
 v_add_f32 v74, v32, v36
 v_add_f32 v75, v33, v37
 v_add_f32 v72, v72, v38
 v_add_f32 v73, v73, v39
 v_add_f32 v74, v74, v40
 v_add_f32 v75, v75, v41
 v_add_f32 v72, v72, v42
 v_add_f32 v73, v73, v43
 v_add_f32 v74, v74, v44
 v_add_f32 v75, v75, v45
 v_add_f32 v72, v72, v46
 v_add_f32 v73, v73, v47
 v_add_f32 v74, v74, v48
 v_add_f32 v75, v75, v49
 v_add_f32 v72, v72, v50
 v_add_f32 v73, v73, v51
 v_add_f32 v74, v74, v52
 v_add_f32 v75, v75, v53
 v_add_f32 v72, v72, v54
 v_add_f32 v73, v73, v55
 v_add_f32 v74, v74, v56
 v_add_f32 v75, v75, v57
 v_add_f32 v72, v72, v58
 v_add_f32 v73, v73, v59
 v_add_f32 v74, v74, v60
 v_add_f32 v75, v75, v61
 v_add_f32 v72, v72, v73
 v_add_f32 v74, v74, v75
 v_add_f32 v72, v72, v74
 v_add_f32 v73, v62, v63
 v_add_f32 v73, v73, v64
 v_add_f32 v73, v73, v65
 v_add_f32 v73, v73, v66
 v_add_f32 v73, v73, v67
 v_add_f32 v73, v73, v68
 v_add_f32 v73, v73, v69
 v_fmac_f32 v72, v73, v7
 s_nop 1
 v_add_f32_dpp v72, v72, v72 row_ror:8 row_mask:0xf bank_mask:0xf
 s_nop 1
 v_add_f32_dpp v72, v72, v72 row_ror:4 row_mask:0xf bank_mask:0xf
 s_nop 1
 v_add_f32_dpp v72, v72, v72 row_ror:2 row_mask:0xf bank_mask:0xf
 s_nop 1
 v_add_f32_dpp v72, v72, v72 row_ror:1 row_mask:0xf bank_mask:0xf
 v_mov_b32 v76, v72
 v_mul_f32 v76, 0.001736111111111111, v76
 v_sub_f32 v30, v30, v76
 v_sub_f32 v31, v31, v76
 v_sub_f32 v32, v32, v76
 v_sub_f32 v33, v33, v76
 v_sub_f32 v34, v34, v76
 v_sub_f32 v35, v35, v76
 v_sub_f32 v36, v36, v76
 v_sub_f32 v37, v37, v76
 v_sub_f32 v38, v38, v76
 v_sub_f32 v39, v39, v76
 v_sub_f32 v40, v40, v76
 v_sub_f32 v41, v41, v76
 v_sub_f32 v42, v42, v76
 v_sub_f32 v43, v43, v76
 v_sub_f32 v44, v44, v76
 v_sub_f32 v45, v45, v76
 v_sub_f32 v46, v46, v76
 v_sub_f32 v47, v47, v76
 v_sub_f32 v48, v48, v76
 v_sub_f32 v49, v49, v76
 v_sub_f32 v50, v50, v76
 v_sub_f32 v51, v51, v76
 v_sub_f32 v52, v52, v76
 v_sub_f32 v53, v53, v76
 v_sub_f32 v54, v54, v76
 v_sub_f32 v55, v55, v76
 v_sub_f32 v56, v56, v76
 v_sub_f32 v57, v57, v76
 v_sub_f32 v58, v58, v76
 v_sub_f32 v59, v59, v76
 v_sub_f32 v60, v60, v76
 v_sub_f32 v61, v61, v76
 v_sub_f32 v62, v62, v76
 v_sub_f32 v63, v63, v76
 v_sub_f32 v64, v64, v76
 v_sub_f32 v65, v65, v76
 v_sub_f32 v66, v66, v76
 v_sub_f32 v67, v67, v76
 v_sub_f32 v68, v68, v76
 v_sub_f32 v69, v69, v76
 v_mul_f32 v80, v30, v30
 v_mul_f32 v81, v31, v31
 v_mul_f32 v82, v32, v32
 v_mul_f32 v83, v33, v33
 v_mul_f32 v84, v34, v34
 v_mul_f32 v85, v35, v35
 v_mul_f32 v86, v36, v36
 v_mul_f32 v87, v37, v37
 v_mul_f32 v88, v38, v38
 v_mul_f32 v89, v39, v39
 v_mul_f32 v90, v40, v40
 v_mul_f32 v91, v41, v41
 v_mul_f32 v92, v42, v42
 v_mul_f32 v93, v43, v43
 v_mul_f32 v94, v44, v44
 v_mul_f32 v95, v45, v45
 v_mul_f32 v96, v46, v46
 v_mul_f32 v97, v47, v47
 v_mul_f32 v98, v48, v48
 v_mul_f32 v99, v49, v49
 v_mul_f32 v100, v50, v50
 v_mul_f32 v101, v51, v51
 v_mul_f32 v102, v52, v52
 v_mul_f32 v103, v53, v53
 v_mul_f32 v104, v54, v54
 v_mul_f32 v105, v55, v55
 v_mul_f32 v106, v56, v56
 v_mul_f32 v107, v57, v57
 v_mul_f32 v108, v58, v58
 v_mul_f32 v109, v59, v59
 v_mul_f32 v110, v60, v60
 v_mul_f32 v111, v61, v61
 v_mul_f32 v112, v62, v62
 v_mul_f32 v113, v63, v63
 v_mul_f32 v114, v64, v64
 v_mul_f32 v115, v65, v65
 v_mul_f32 v116, v66, v66
 v_mul_f32 v117, v67, v67
 v_mul_f32 v118, v68, v68
 v_mul_f32 v119, v69, v69
 v_add_f32 v72, v80, v84
 v_add_f32 v73, v81, v85
 v_add_f32 v74, v82, v86
 v_add_f32 v75, v83, v87
 v_add_f32 v72, v72, v88
 v_add_f32 v73, v73, v89
 v_add_f32 v74, v74, v90
 v_add_f32 v75, v75, v91
 v_add_f32 v72, v72, v92
 v_add_f32 v73, v73, v93
 v_add_f32 v74, v74, v94
 v_add_f32 v75, v75, v95
 v_add_f32 v72, v72, v96
 v_add_f32 v73, v73, v97
 v_add_f32 v74, v74, v98
 v_add_f32 v75, v75, v99
 v_add_f32 v72, v72, v100
 v_add_f32 v73, v73, v101
 v_add_f32 v74, v74, v102
 v_add_f32 v75, v75, v103
 v_add_f32 v72, v72, v104
 v_add_f32 v73, v73, v105
 v_add_f32 v74, v74, v106
 v_add_f32 v75, v75, v107
 v_add_f32 v72, v72, v108
 v_add_f32 v73, v73, v109
 v_add_f32 v74, v74, v110
 v_add_f32 v75, v75, v111
 v_add_f32 v72, v72, v73
 v_add_f32 v74, v74, v75
 v_add_f32 v72, v72, v74
 v_add_f32 v73, v112, v113
 v_add_f32 v73, v73, v114
 v_add_f32 v73, v73, v115
 v_add_f32 v73, v73, v116
 v_add_f32 v73, v73, v117
 v_add_f32 v73, v73, v118
 v_add_f32 v73, v73, v119
 v_fmac_f32 v72, v73, v7
 s_nop 1
 v_add_f32_dpp v72, v72, v72 row_ror:8 row_mask:0xf bank_mask:0xf
 s_nop 1
 v_add_f32_dpp v72, v72, v72 row_ror:4 row_mask:0xf bank_mask:0xf
 s_nop 1
 v_add_f32_dpp v72, v72, v72 row_ror:2 row_mask:0xf bank_mask:0xf
 s_nop 1
 v_add_f32_dpp v72, v72, v72 row_ror:1 row_mask:0xf bank_mask:0xf
 v_mov_b32 v77, v72
 v_mov_b32 v78, 0x3727c5ac
 v_fmac_f32 v78, 0.001736111111111111, v77
 v_rsq_f32 v78, v78
 s_nop 0
 v_mul_f32 v30, v30, v78
 v_mul_f32 v31, v31, v78
 v_mul_f32 v32, v32, v78
 v_mul_f32 v33, v33, v78
 v_mul_f32 v34, v34, v78
 v_mul_f32 v35, v35, v78
 v_mul_f32 v36, v36, v78
 v_mul_f32 v37, v37, v78
 v_mul_f32 v38, v38, v78
 v_mul_f32 v39, v39, v78
 v_mul_f32 v40, v40, v78
 v_mul_f32 v41, v41, v78
 v_mul_f32 v42, v42, v78
 v_mul_f32 v43, v43, v78
 v_mul_f32 v44, v44, v78
 v_mul_f32 v45, v45, v78
 v_mul_f32 v46, v46, v78
 v_mul_f32 v47, v47, v78
 v_mul_f32 v48, v48, v78
 v_mul_f32 v49, v49, v78
 v_mul_f32 v50, v50, v78
 v_mul_f32 v51, v51, v78
 v_mul_f32 v52, v52, v78
 v_mul_f32 v53, v53, v78
 v_mul_f32 v54, v54, v78
 v_mul_f32 v55, v55, v78
 v_mul_f32 v56, v56, v78
 v_mul_f32 v57, v57, v78
 v_mul_f32 v58, v58, v78
 v_mul_f32 v59, v59, v78
 v_mul_f32 v60, v60, v78
 v_mul_f32 v61, v61, v78
 v_mul_f32 v62, v62, v78
 v_mul_f32 v63, v63, v78
 v_mul_f32 v64, v64, v78
 v_mul_f32 v65, v65, v78
 v_mul_f32 v66, v66, v78
 v_mul_f32 v67, v67, v78
 v_mul_f32 v68, v68, v78
 v_mul_f32 v69, v69, v78
 v_cvt_pk_bf16_f32 v8, v30, v31
 v_cvt_pk_bf16_f32 v9, v32, v33
 v_cvt_pk_bf16_f32 v10, v34, v35
 v_cvt_pk_bf16_f32 v11, v36, v37
 v_cvt_pk_bf16_f32 v12, v38, v39
 v_cvt_pk_bf16_f32 v13, v40, v41
 v_cvt_pk_bf16_f32 v14, v42, v43
 v_cvt_pk_bf16_f32 v15, v44, v45
 v_cvt_pk_bf16_f32 v16, v46, v47
 v_cvt_pk_bf16_f32 v17, v48, v49
 v_cvt_pk_bf16_f32 v18, v50, v51
 v_cvt_pk_bf16_f32 v19, v52, v53
 v_cvt_pk_bf16_f32 v20, v54, v55
 v_cvt_pk_bf16_f32 v21, v56, v57
 v_cvt_pk_bf16_f32 v22, v58, v59
 v_cvt_pk_bf16_f32 v23, v60, v61
 v_cvt_pk_bf16_f32 v24, v62, v63
 v_cvt_pk_bf16_f32 v25, v64, v65
 v_cvt_pk_bf16_f32 v26, v66, v67
 v_cvt_pk_bf16_f32 v27, v68, v69
 s_add_u32 s35, s34, 0
 buffer_store_dwordx4 v[8:11], v5, s[4:7], s35 offen sc1
 s_add_u32 s35, s34, 4096
 buffer_store_dwordx4 v[12:15], v5, s[4:7], s35 offen sc1
 s_add_u32 s35, s34, 8192
 buffer_store_dwordx4 v[16:19], v5, s[4:7], s35 offen sc1
 s_add_u32 s35, s34, 12288
 buffer_store_dwordx4 v[20:23], v5, s[4:7], s35 offen sc1
 s_add_u32 s35, s34, 16384
 s_mov_b32 s36, 0x00ff00ff
 s_mov_b32 exec_lo, s36
 s_mov_b32 exec_hi, s36
 buffer_store_dwordx4 v[24:27], v5, s[4:7], s35 offen sc1
 s_mov_b64 exec, -1
L_noln:
 s_waitcnt vmcnt(0)
 s_barrier
 s_cmp_lg_u32 s14, 0
 s_cbranch_scc1 L_ga9
 s_lshl_b32 s33, s12, 2
 s_add_u32 s33, s33, 32
 v_mov_b32 v2, 1
 v_mov_b32 v3, 0
 s_mov_b64 exec, 1
 buffer_atomic_add v2, v3, s[8:11], s33 offen sc1
 s_mov_b64 exec, -1
L_ga9:
 s_cmp_lt_u32 s13, 12
 s_cbranch_scc1 L_ffn
 s_sub_u32 s39, s13, 12
 s_cmp_lt_u32 s38, 4
 s_cselect_b32 s33, 4, 3
 s_cselect_b32 s34, 0, 60
 s_cselect_b32 s35, 48, 76
 s_cmp_lt_u32 s39, 16
 s_cselect_b32 s34, s34, s35
 s_mul_i32 s39, s39, s33
 s_add_u32 s39, s39, s38
 s_add_u32 s39, s39, s34
 s_cmp_ge_u32 s39, 128
 s_cbranch_scc1 L_spare
 s_cmp_lt_u32 s39, 64
 s_cbranch_scc1 L_shadow
 s_sub_u32 s39, s39, 64
 s_and_b32 s40, s39, 31
 s_lshr_b32 s41, s39, 5
 s_load_dwordx2 s[16:17], s[0:1], 24
 s_mov_b32 s18, 0x480000
 s_mov_b32 s19, 0x20000
 s_load_dwordx2 s[20:21], s[0:1], 32
 s_mov_b32 s22, 0x480000
 s_mov_b32 s23, 0x20000
 s_lshl_b32 s42, s40, 8
 s_mov_b32 s43, s42
 s_waitcnt lgkmcnt(0)
 s_and_b32 s17, s17, 0xffff
 s_and_b32 s21, s21, 0xffff
 v_lshrrev_b32 v2, 4, v1
 v_and_b32 v3, 15, v1
 v_lshlrev_b32 v4, 1, v2
 v_xor_b32 v5, v3, v4
 v_xor_b32 v6, 8, v5
 v_mul_u32_u24 v2, 8192, v2
 v_lshl_add_u32 v5, v5, 4, v2
 v_lshl_add_u32 v6, v6, 4, v2
 v_lshrrev_b32 v7, 4, v1
 v_bfe_u32 v8, v1, 2, 2
 v_and_b32 v9, 3, v1
 v_and_b32 v10, 1, v7
 v_lshl_or_b32 v10, v10, 2, v8
 v_lshlrev_b32 v10, 1, v10
 v_lshrrev_b32 v11, 1, v9
 s_lshl_b32 s33, s14, 2
 v_add_u32 v11, s33, v11
 v_add_u32 v12, 2, v11
 v_xor_b32 v11, v11, v10
 v_xor_b32 v12, v12, v10
 v_lshl_add_u32 v13, v7, 3, v8
 v_lshlrev_b32 v13, 8, v13
 v_and_b32 v9, 1, v9
 v_lshl_add_u32 v13, v9, 3, v13
 v_lshl_add_u32 v11, v11, 4, v13
 v_lshl_add_u32 v12, v12, 4, v13
 v_add_u32 v14, 73728, v11
 v_add_u32 v15, 73728, v12
 v_add_u32 v18, 65536, v11
 v_add_u32 v19, 65536, v12
 v_add_u32 v20, 65536, v14
 v_add_u32 v21, 65536, v15
 s_mul_i32 s33, s14, 18432
 s_add_u32 s33, s33, 0
 s_mul_i32 s34, s14, 589824
 s_add_u32 s34, s34, s42
 s_add_u32 s34, s34, 0
 s_bitcmp1_b32 s14, 0
 s_cselect_b64 vcc, -1, 0
 v_cndmask_b32 v16, v5, v6, vcc
 v_cndmask_b32 v17, v6, v5, vcc
 s_mov_b32 m0, s33
 s_nop 0
 buffer_load_dwordx4 v16, s[16:19], s34 offen lds
 s_add_u32 s33, s33, 1024
 s_add_u32 s34, s34, 32768
 s_mov_b32 m0, s33
 s_nop 0
 buffer_load_dwordx4 v16, s[16:19], s34 offen lds
 s_add_u32 s33, s33, 1024
 s_add_u32 s34, s34, 32768
 s_mov_b32 m0, s33
 s_nop 0
 buffer_load_dwordx4 v17, s[16:19], s34 offen lds
 s_add_u32 s33, s33, 1024
 s_add_u32 s34, s34, 32768
 s_mov_b32 m0, s33
 s_nop 0
 buffer_load_dwordx4 v17, s[16:19], s34 offen lds
 s_add_u32 s33, s33, 1024
 s_add_u32 s34, s34, 32768
 s_mov_b32 m0, s33
 s_nop 0
 buffer_load_dwordx4 v16, s[16:19], s34 offen lds
 s_add_u32 s33, s33, 1024
 s_add_u32 s34, s34, 32768
 s_mov_b32 m0, s33
 s_nop 0
 buffer_load_dwordx4 v16, s[16:19], s34 offen lds
 s_add_u32 s33, s33, 1024
 s_add_u32 s34, s34, 32768
 s_mov_b32 m0, s33
 s_nop 0
 buffer_load_dwordx4 v17, s[16:19], s34 offen lds
 s_add_u32 s33, s33, 1024
 s_add_u32 s34, s34, 32768
 s_mov_b32 m0, s33
 s_nop 0
 buffer_load_dwordx4 v17, s[16:19], s34 offen lds
 s_add_u32 s33, s33, 1024
 s_add_u32 s34, s34, 32768
 s_mov_b32 m0, s33
 s_nop 0
 buffer_load_dwordx4 v16, s[16:19], s34 offen lds
 s_add_u32 s33, s33, 1024
 s_add_u32 s34, s34, 32768
 s_mov_b32 m0, s33
 s_nop 0
 buffer_load_dwordx4 v16, s[16:19], s34 offen lds
 s_add_u32 s33, s33, 1024
 s_add_u32 s34, s34, 32768
 s_mov_b32 m0, s33
 s_nop 0
 buffer_load_dwordx4 v17, s[16:19], s34 offen lds
 s_add_u32 s33, s33, 1024
 s_add_u32 s34, s34, 32768
 s_mov_b32 m0, s33
 s_nop 0
 buffer_load_dwordx4 v17, s[16:19], s34 offen lds
 s_add_u32 s33, s33, 1024
 s_add_u32 s34, s34, 32768
 s_mov_b32 m0, s33
 s_nop 0
 buffer_load_dwordx4 v16, s[16:19], s34 offen lds
 s_add_u32 s33, s33, 1024
 s_add_u32 s34, s34, 32768
 s_mov_b32 m0, s33
 s_nop 0
 buffer_load_dwordx4 v16, s[16:19], s34 offen lds
 s_add_u32 s33, s33, 1024
 s_add_u32 s34, s34, 32768
 s_mov_b32 m0, s33
 s_nop 0
 buffer_load_dwordx4 v17, s[16:19], s34 offen lds
 s_add_u32 s33, s33, 1024
 s_add_u32 s34, s34, 32768
 s_mov_b32 m0, s33
 s_nop 0
 buffer_load_dwordx4 v17, s[16:19], s34 offen lds
 s_add_u32 s33, s33, 1024
 s_add_u32 s34, s34, 32768
 s_mov_b32 m0, s33
 s_nop 0
 buffer_load_dwordx4 v16, s[16:19], s34 offen lds
 s_add_u32 s33, s33, 1024
 s_add_u32 s34, s34, 32768
 s_mov_b32 m0, s33
 s_nop 0
 buffer_load_dwordx4 v16, s[16:19], s34 offen lds
 s_mul_i32 s33, s14, 18432
 s_add_u32 s33, s33, 73728
 s_mul_i32 s34, s14, 589824
 s_add_u32 s34, s34, s42
 s_add_u32 s34, s34, 2359296
 s_bitcmp1_b32 s14, 0
 s_cselect_b64 vcc, -1, 0
 v_cndmask_b32 v16, v5, v6, vcc
 v_cndmask_b32 v17, v6, v5, vcc
 s_mov_b32 m0, s33
 s_nop 0
 buffer_load_dwordx4 v16, s[16:19], s34 offen lds
 s_add_u32 s33, s33, 1024
 s_add_u32 s34, s34, 32768
 s_mov_b32 m0, s33
 s_nop 0
 buffer_load_dwordx4 v16, s[16:19], s34 offen lds
 s_add_u32 s33, s33, 1024
 s_add_u32 s34, s34, 32768
 s_mov_b32 m0, s33
 s_nop 0
 buffer_load_dwordx4 v17, s[16:19], s34 offen lds
 s_add_u32 s33, s33, 1024
 s_add_u32 s34, s34, 32768
 s_mov_b32 m0, s33
 s_nop 0
 buffer_load_dwordx4 v17, s[16:19], s34 offen lds
 s_add_u32 s33, s33, 1024
 s_add_u32 s34, s34, 32768
 s_mov_b32 m0, s33
 s_nop 0
 buffer_load_dwordx4 v16, s[16:19], s34 offen lds
 s_add_u32 s33, s33, 1024
 s_add_u32 s34, s34, 32768
 s_mov_b32 m0, s33
 s_nop 0
 buffer_load_dwordx4 v16, s[16:19], s34 offen lds
 s_add_u32 s33, s33, 1024
 s_add_u32 s34, s34, 32768
 s_mov_b32 m0, s33
 s_nop 0
 buffer_load_dwordx4 v17, s[16:19], s34 offen lds
 s_add_u32 s33, s33, 1024
 s_add_u32 s34, s34, 32768
 s_mov_b32 m0, s33
 s_nop 0
 buffer_load_dwordx4 v17, s[16:19], s34 offen lds
 s_add_u32 s33, s33, 1024
 s_add_u32 s34, s34, 32768
 s_mov_b32 m0, s33
 s_nop 0
 buffer_load_dwordx4 v16, s[16:19], s34 offen lds
 s_add_u32 s33, s33, 1024
 s_add_u32 s34, s34, 32768
 s_mov_b32 m0, s33
 s_nop 0
 buffer_load_dwordx4 v16, s[16:19], s34 offen lds
 s_add_u32 s33, s33, 1024
 s_add_u32 s34, s34, 32768
 s_mov_b32 m0, s33
 s_nop 0
 buffer_load_dwordx4 v17, s[16:19], s34 offen lds
 s_add_u32 s33, s33, 1024
 s_add_u32 s34, s34, 32768
 s_mov_b32 m0, s33
 s_nop 0
 buffer_load_dwordx4 v17, s[16:19], s34 offen lds
 s_add_u32 s33, s33, 1024
 s_add_u32 s34, s34, 32768
 s_mov_b32 m0, s33
 s_nop 0
 buffer_load_dwordx4 v16, s[16:19], s34 offen lds
 s_add_u32 s33, s33, 1024
 s_add_u32 s34, s34, 32768
 s_mov_b32 m0, s33
 s_nop 0
 buffer_load_dwordx4 v16, s[16:19], s34 offen lds
 s_add_u32 s33, s33, 1024
 s_add_u32 s34, s34, 32768
 s_mov_b32 m0, s33
 s_nop 0
 buffer_load_dwordx4 v17, s[16:19], s34 offen lds
 s_add_u32 s33, s33, 1024
 s_add_u32 s34, s34, 32768
 s_mov_b32 m0, s33
 s_nop 0
 buffer_load_dwordx4 v17, s[16:19], s34 offen lds
 s_add_u32 s33, s33, 1024
 s_add_u32 s34, s34, 32768
 s_mov_b32 m0, s33
 s_nop 0
 buffer_load_dwordx4 v16, s[16:19], s34 offen lds
 s_add_u32 s33, s33, 1024
 s_add_u32 s34, s34, 32768
 s_mov_b32 m0, s33
 s_nop 0
 buffer_load_dwordx4 v16, s[16:19], s34 offen lds
 s_waitcnt vmcnt(18)
 s_barrier
 ds_read_b64_tr_b16 a[0:1], v11 offset:0
 ds_read_b64_tr_b16 a[2:3], v11 offset:1024
 ds_read_b64_tr_b16 a[4:5], v12 offset:0
 ds_read_b64_tr_b16 a[6:7], v12 offset:1024
 ds_read_b64_tr_b16 a[16:17], v11 offset:8192
 ds_read_b64_tr_b16 a[18:19], v11 offset:9216
 ds_read_b64_tr_b16 a[20:21], v12 offset:8192
 ds_read_b64_tr_b16 a[22:23], v12 offset:9216
 ds_read_b64_tr_b16 a[32:33], v11 offset:16384
 ds_read_b64_tr_b16 a[34:35], v11 offset:17408
 ds_read_b64_tr_b16 a[36:37], v12 offset:16384
 ds_read_b64_tr_b16 a[38:39], v12 offset:17408
 ds_read_b64_tr_b16 a[48:49], v11 offset:24576
 ds_read_b64_tr_b16 a[50:51], v11 offset:25600
 ds_read_b64_tr_b16 a[52:53], v12 offset:24576
 ds_read_b64_tr_b16 a[54:55], v12 offset:25600
 ds_read_b64_tr_b16 a[64:65], v11 offset:32768
 ds_read_b64_tr_b16 a[66:67], v11 offset:33792
 ds_read_b64_tr_b16 a[68:69], v12 offset:32768
 ds_read_b64_tr_b16 a[70:71], v12 offset:33792
 ds_read_b64_tr_b16 a[80:81], v11 offset:40960
 ds_read_b64_tr_b16 a[82:83], v11 offset:41984
 ds_read_b64_tr_b16 a[84:85], v12 offset:40960
 ds_read_b64_tr_b16 a[86:87], v12 offset:41984
 ds_read_b64_tr_b16 a[96:97], v11 offset:49152
 ds_read_b64_tr_b16 a[98:99], v11 offset:50176
 ds_read_b64_tr_b16 a[100:101], v12 offset:49152
 ds_read_b64_tr_b16 a[102:103], v12 offset:50176
 ds_read_b64_tr_b16 a[112:113], v11 offset:57344
 ds_read_b64_tr_b16 a[114:115], v11 offset:58368
 ds_read_b64_tr_b16 a[116:117], v12 offset:57344
 ds_read_b64_tr_b16 a[118:119], v12 offset:58368
 ds_read_b64_tr_b16 a[128:129], v18 offset:0
 ds_read_b64_tr_b16 a[130:131], v18 offset:1024
 ds_read_b64_tr_b16 a[132:133], v19 offset:0
 ds_read_b64_tr_b16 a[134:135], v19 offset:1024
 s_waitcnt lgkmcnt(0)
 s_barrier
 s_mul_i32 s33, s14, 18432
 s_add_u32 s33, s33, 0
 s_mul_i32 s34, s14, 589824
 s_add_u32 s34, s34, s43
 s_add_u32 s34, s34, 0
 s_bitcmp1_b32 s14, 0
 s_cselect_b64 vcc, -1, 0
 v_cndmask_b32 v16, v5, v6, vcc
 v_cndmask_b32 v17, v6, v5, vcc
 s_mov_b32 m0, s33
 s_nop 0
 buffer_load_dwordx4 v16, s[20:23], s34 offen lds
 s_add_u32 s33, s33, 1024
 s_add_u32 s34, s34, 32768
 s_mov_b32 m0, s33
 s_nop 0
 buffer_load_dwordx4 v16, s[20:23], s34 offen lds
 s_add_u32 s33, s33, 1024
 s_add_u32 s34, s34, 32768
 s_mov_b32 m0, s33
 s_nop 0
 buffer_load_dwordx4 v17, s[20:23], s34 offen lds
 s_add_u32 s33, s33, 1024
 s_add_u32 s34, s34, 32768
 s_mov_b32 m0, s33
 s_nop 0
 buffer_load_dwordx4 v17, s[20:23], s34 offen lds
 s_add_u32 s33, s33, 1024
 s_add_u32 s34, s34, 32768
 s_mov_b32 m0, s33
 s_nop 0
 buffer_load_dwordx4 v16, s[20:23], s34 offen lds
 s_add_u32 s33, s33, 1024
 s_add_u32 s34, s34, 32768
 s_mov_b32 m0, s33
 s_nop 0
 buffer_load_dwordx4 v16, s[20:23], s34 offen lds
 s_add_u32 s33, s33, 1024
 s_add_u32 s34, s34, 32768
 s_mov_b32 m0, s33
 s_nop 0
 buffer_load_dwordx4 v17, s[20:23], s34 offen lds
 s_add_u32 s33, s33, 1024
 s_add_u32 s34, s34, 32768
 s_mov_b32 m0, s33
 s_nop 0
 buffer_load_dwordx4 v17, s[20:23], s34 offen lds
 s_add_u32 s33, s33, 1024
 s_add_u32 s34, s34, 32768
 s_mov_b32 m0, s33
 s_nop 0
 buffer_load_dwordx4 v16, s[20:23], s34 offen lds
 s_add_u32 s33, s33, 1024
 s_add_u32 s34, s34, 32768
 s_mov_b32 m0, s33
 s_nop 0
 buffer_load_dwordx4 v16, s[20:23], s34 offen lds
 s_add_u32 s33, s33, 1024
 s_add_u32 s34, s34, 32768
 s_mov_b32 m0, s33
 s_nop 0
 buffer_load_dwordx4 v17, s[20:23], s34 offen lds
 s_add_u32 s33, s33, 1024
 s_add_u32 s34, s34, 32768
 s_mov_b32 m0, s33
 s_nop 0
 buffer_load_dwordx4 v17, s[20:23], s34 offen lds
 s_add_u32 s33, s33, 1024
 s_add_u32 s34, s34, 32768
 s_mov_b32 m0, s33
 s_nop 0
 buffer_load_dwordx4 v16, s[20:23], s34 offen lds
 s_add_u32 s33, s33, 1024
 s_add_u32 s34, s34, 32768
 s_mov_b32 m0, s33
 s_nop 0
 buffer_load_dwordx4 v16, s[20:23], s34 offen lds
 s_add_u32 s33, s33, 1024
 s_add_u32 s34, s34, 32768
 s_mov_b32 m0, s33
 s_nop 0
 buffer_load_dwordx4 v17, s[20:23], s34 offen lds
 s_add_u32 s33, s33, 1024
 s_add_u32 s34, s34, 32768
 s_mov_b32 m0, s33
 s_nop 0
 buffer_load_dwordx4 v17, s[20:23], s34 offen lds
 s_add_u32 s33, s33, 1024
 s_add_u32 s34, s34, 32768
 s_mov_b32 m0, s33
 s_nop 0
 buffer_load_dwordx4 v16, s[20:23], s34 offen lds
 s_add_u32 s33, s33, 1024
 s_add_u32 s34, s34, 32768
 s_mov_b32 m0, s33
 s_nop 0
 buffer_load_dwordx4 v16, s[20:23], s34 offen lds
 s_waitcnt vmcnt(18)
 s_barrier
 ds_read_b64_tr_b16 a[144:145], v14 offset:0
 ds_read_b64_tr_b16 a[146:147], v14 offset:1024
 ds_read_b64_tr_b16 a[148:149], v15 offset:0
 ds_read_b64_tr_b16 a[150:151], v15 offset:1024
 ds_read_b64_tr_b16 a[160:161], v14 offset:8192
 ds_read_b64_tr_b16 a[162:163], v14 offset:9216
 ds_read_b64_tr_b16 a[164:165], v15 offset:8192
 ds_read_b64_tr_b16 a[166:167], v15 offset:9216
 ds_read_b64_tr_b16 a[176:177], v14 offset:16384
 ds_read_b64_tr_b16 a[178:179], v14 offset:17408
 ds_read_b64_tr_b16 a[180:181], v15 offset:16384
 ds_read_b64_tr_b16 a[182:183], v15 offset:17408
 ds_read_b64_tr_b16 a[192:193], v14 offset:24576
 ds_read_b64_tr_b16 a[194:195], v14 offset:25600
 ds_read_b64_tr_b16 a[196:197], v15 offset:24576
 ds_read_b64_tr_b16 a[198:199], v15 offset:25600
 ds_read_b64_tr_b16 a[208:209], v14 offset:32768
 ds_read_b64_tr_b16 a[210:211], v14 offset:33792
 ds_read_b64_tr_b16 a[212:213], v15 offset:32768
 ds_read_b64_tr_b16 a[214:215], v15 offset:33792
 ds_read_b64_tr_b16 a[224:225], v14 offset:40960
 ds_read_b64_tr_b16 a[226:227], v14 offset:41984
 ds_read_b64_tr_b16 a[228:229], v15 offset:40960
 ds_read_b64_tr_b16 a[230:231], v15 offset:41984
 ds_read_b64_tr_b16 a[240:241], v14 offset:49152
 ds_read_b64_tr_b16 a[242:243], v14 offset:50176
 ds_read_b64_tr_b16 a[244:245], v15 offset:49152
 ds_read_b64_tr_b16 a[246:247], v15 offset:50176
 ds_read_b64_tr_b16 v[224:225], v14 offset:57344
 ds_read_b64_tr_b16 v[226:227], v14 offset:58368
 ds_read_b64_tr_b16 v[228:229], v15 offset:57344
 ds_read_b64_tr_b16 v[230:231], v15 offset:58368
 ds_read_b64_tr_b16 v[240:241], v20 offset:0
 ds_read_b64_tr_b16 v[242:243], v20 offset:1024
 ds_read_b64_tr_b16 v[244:245], v21 offset:0
 ds_read_b64_tr_b16 v[246:247], v21 offset:1024
 s_waitcnt lgkmcnt(0)
 s_barrier
 s_mul_i32 s33, s14, 18432
 s_add_u32 s33, s33, 73728
 s_mul_i32 s34, s14, 589824
 s_add_u32 s34, s34, s43
 s_add_u32 s34, s34, 2359296
 s_bitcmp1_b32 s14, 0
 s_cselect_b64 vcc, -1, 0
 v_cndmask_b32 v16, v5, v6, vcc
 v_cndmask_b32 v17, v6, v5, vcc
 s_mov_b32 m0, s33
 s_nop 0
 buffer_load_dwordx4 v16, s[20:23], s34 offen lds
 s_add_u32 s33, s33, 1024
 s_add_u32 s34, s34, 32768
 s_mov_b32 m0, s33
 s_nop 0
 buffer_load_dwordx4 v16, s[20:23], s34 offen lds
 s_add_u32 s33, s33, 1024
 s_add_u32 s34, s34, 32768
 s_mov_b32 m0, s33
 s_nop 0
 buffer_load_dwordx4 v17, s[20:23], s34 offen lds
 s_add_u32 s33, s33, 1024
 s_add_u32 s34, s34, 32768
 s_mov_b32 m0, s33
 s_nop 0
 buffer_load_dwordx4 v17, s[20:23], s34 offen lds
 s_add_u32 s33, s33, 1024
 s_add_u32 s34, s34, 32768
 s_mov_b32 m0, s33
 s_nop 0
 buffer_load_dwordx4 v16, s[20:23], s34 offen lds
 s_add_u32 s33, s33, 1024
 s_add_u32 s34, s34, 32768
 s_mov_b32 m0, s33
 s_nop 0
 buffer_load_dwordx4 v16, s[20:23], s34 offen lds
 s_add_u32 s33, s33, 1024
 s_add_u32 s34, s34, 32768
 s_mov_b32 m0, s33
 s_nop 0
 buffer_load_dwordx4 v17, s[20:23], s34 offen lds
 s_add_u32 s33, s33, 1024
 s_add_u32 s34, s34, 32768
 s_mov_b32 m0, s33
 s_nop 0
 buffer_load_dwordx4 v17, s[20:23], s34 offen lds
 s_add_u32 s33, s33, 1024
 s_add_u32 s34, s34, 32768
 s_mov_b32 m0, s33
 s_nop 0
 buffer_load_dwordx4 v16, s[20:23], s34 offen lds
 s_add_u32 s33, s33, 1024
 s_add_u32 s34, s34, 32768
 s_mov_b32 m0, s33
 s_nop 0
 buffer_load_dwordx4 v16, s[20:23], s34 offen lds
 s_add_u32 s33, s33, 1024
 s_add_u32 s34, s34, 32768
 s_mov_b32 m0, s33
 s_nop 0
 buffer_load_dwordx4 v17, s[20:23], s34 offen lds
 s_add_u32 s33, s33, 1024
 s_add_u32 s34, s34, 32768
 s_mov_b32 m0, s33
 s_nop 0
 buffer_load_dwordx4 v17, s[20:23], s34 offen lds
 s_add_u32 s33, s33, 1024
 s_add_u32 s34, s34, 32768
 s_mov_b32 m0, s33
 s_nop 0
 buffer_load_dwordx4 v16, s[20:23], s34 offen lds
 s_add_u32 s33, s33, 1024
 s_add_u32 s34, s34, 32768
 s_mov_b32 m0, s33
 s_nop 0
 buffer_load_dwordx4 v16, s[20:23], s34 offen lds
 s_add_u32 s33, s33, 1024
 s_add_u32 s34, s34, 32768
 s_mov_b32 m0, s33
 s_nop 0
 buffer_load_dwordx4 v17, s[20:23], s34 offen lds
 s_add_u32 s33, s33, 1024
 s_add_u32 s34, s34, 32768
 s_mov_b32 m0, s33
 s_nop 0
 buffer_load_dwordx4 v17, s[20:23], s34 offen lds
 s_add_u32 s33, s33, 1024
 s_add_u32 s34, s34, 32768
 s_mov_b32 m0, s33
 s_nop 0
 buffer_load_dwordx4 v16, s[20:23], s34 offen lds
 s_add_u32 s33, s33, 1024
 s_add_u32 s34, s34, 32768
 s_mov_b32 m0, s33
 s_nop 0
 buffer_load_dwordx4 v16, s[20:23], s34 offen lds
 s_waitcnt vmcnt(18)
 s_barrier
 ds_read_b64_tr_b16 a[8:9], v11 offset:0
 ds_read_b64_tr_b16 a[10:11], v11 offset:1024
 ds_read_b64_tr_b16 a[12:13], v12 offset:0
 ds_read_b64_tr_b16 a[14:15], v12 offset:1024
 ds_read_b64_tr_b16 a[24:25], v11 offset:8192
 ds_read_b64_tr_b16 a[26:27], v11 offset:9216
 ds_read_b64_tr_b16 a[28:29], v12 offset:8192
 ds_read_b64_tr_b16 a[30:31], v12 offset:9216
 ds_read_b64_tr_b16 a[40:41], v11 offset:16384
 ds_read_b64_tr_b16 a[42:43], v11 offset:17408
 ds_read_b64_tr_b16 a[44:45], v12 offset:16384
 ds_read_b64_tr_b16 a[46:47], v12 offset:17408
 ds_read_b64_tr_b16 a[56:57], v11 offset:24576
 ds_read_b64_tr_b16 a[58:59], v11 offset:25600
 ds_read_b64_tr_b16 a[60:61], v12 offset:24576
 ds_read_b64_tr_b16 a[62:63], v12 offset:25600
 ds_read_b64_tr_b16 a[72:73], v11 offset:32768
 ds_read_b64_tr_b16 a[74:75], v11 offset:33792
 ds_read_b64_tr_b16 a[76:77], v12 offset:32768
 ds_read_b64_tr_b16 a[78:79], v12 offset:33792
 ds_read_b64_tr_b16 a[88:89], v11 offset:40960
 ds_read_b64_tr_b16 a[90:91], v11 offset:41984
 ds_read_b64_tr_b16 a[92:93], v12 offset:40960
 ds_read_b64_tr_b16 a[94:95], v12 offset:41984
 ds_read_b64_tr_b16 a[104:105], v11 offset:49152
 ds_read_b64_tr_b16 a[106:107], v11 offset:50176
 ds_read_b64_tr_b16 a[108:109], v12 offset:49152
 ds_read_b64_tr_b16 a[110:111], v12 offset:50176
 ds_read_b64_tr_b16 a[120:121], v11 offset:57344
 ds_read_b64_tr_b16 a[122:123], v11 offset:58368
 ds_read_b64_tr_b16 a[124:125], v12 offset:57344
 ds_read_b64_tr_b16 a[126:127], v12 offset:58368
 ds_read_b64_tr_b16 a[136:137], v18 offset:0
 ds_read_b64_tr_b16 a[138:139], v18 offset:1024
 ds_read_b64_tr_b16 a[140:141], v19 offset:0
 ds_read_b64_tr_b16 a[142:143], v19 offset:1024
 s_waitcnt vmcnt(0)
 s_barrier
 ds_read_b64_tr_b16 a[152:153], v14 offset:0
 ds_read_b64_tr_b16 a[154:155], v14 offset:1024
 ds_read_b64_tr_b16 a[156:157], v15 offset:0
 ds_read_b64_tr_b16 a[158:159], v15 offset:1024
 ds_read_b64_tr_b16 a[168:169], v14 offset:8192
 ds_read_b64_tr_b16 a[170:171], v14 offset:9216
 ds_read_b64_tr_b16 a[172:173], v15 offset:8192
 ds_read_b64_tr_b16 a[174:175], v15 offset:9216
 ds_read_b64_tr_b16 a[184:185], v14 offset:16384
 ds_read_b64_tr_b16 a[186:187], v14 offset:17408
 ds_read_b64_tr_b16 a[188:189], v15 offset:16384
 ds_read_b64_tr_b16 a[190:191], v15 offset:17408
 ds_read_b64_tr_b16 a[200:201], v14 offset:24576
 ds_read_b64_tr_b16 a[202:203], v14 offset:25600
 ds_read_b64_tr_b16 a[204:205], v15 offset:24576
 ds_read_b64_tr_b16 a[206:207], v15 offset:25600
 ds_read_b64_tr_b16 a[216:217], v14 offset:32768
 ds_read_b64_tr_b16 a[218:219], v14 offset:33792
 ds_read_b64_tr_b16 a[220:221], v15 offset:32768
 ds_read_b64_tr_b16 a[222:223], v15 offset:33792
 ds_read_b64_tr_b16 a[232:233], v14 offset:40960
 ds_read_b64_tr_b16 a[234:235], v14 offset:41984
 ds_read_b64_tr_b16 a[236:237], v15 offset:40960
 ds_read_b64_tr_b16 a[238:239], v15 offset:41984
 ds_read_b64_tr_b16 a[248:249], v14 offset:49152
 ds_read_b64_tr_b16 a[250:251], v14 offset:50176
 ds_read_b64_tr_b16 a[252:253], v15 offset:49152
 ds_read_b64_tr_b16 a[254:255], v15 offset:50176
 ds_read_b64_tr_b16 v[232:233], v14 offset:57344
 ds_read_b64_tr_b16 v[234:235], v14 offset:58368
 ds_read_b64_tr_b16 v[236:237], v15 offset:57344
 ds_read_b64_tr_b16 v[238:239], v15 offset:58368
 ds_read_b64_tr_b16 v[248:249], v20 offset:0
 ds_read_b64_tr_b16 v[250:251], v20 offset:1024
 ds_read_b64_tr_b16 v[252:253], v21 offset:0
 ds_read_b64_tr_b16 v[254:255], v21 offset:1024
 s_waitcnt lgkmcnt(0)
 s_barrier
 s_cmp_lg_u32 s14, 0
 s_cbranch_scc1 L_gw10
 v_lshlrev_b32 v3, 2, v1
 v_and_b32 v3, 31, v3
poll11:
 buffer_load_dword v2, v3, s[8:11], 0 offen offset:32 sc1
 s_waitcnt vmcnt(0)
 v_cmp_le_u32 vcc, 32, v2
 s_cmp_eq_u64 vcc, exec
 s_cbranch_scc1 polld12
 s_cmp_eq_u32 s15, 0
 s_cbranch_scc1 polld12
 s_sub_u32 s15, s15, 1
 s_sleep 4
 s_branch poll11
polld12:
L_gw10:
 s_barrier
 v_lshlrev_b32 v2, 4, v1
 s_mov_b32 s44, 0
 s_mov_b32 s45, 0
 s_lshl_b32 s48, s44, 1
 s_add_u32 s48, s48, s41
 s_min_u32 s48, s48, 63
 s_mul_i32 s48, s48, 36864
 s_mul_i32 s49, s14, 9216
 s_add_u32 s48, s48, s49
 s_add_u32 s48, s48, 1048576
 s_add_u32 s49, s49, s45
 s_mov_b32 m0, s49
 s_nop 0
 buffer_load_dwordx4 v2, s[4:7], s48 offen offset:0 lds
 buffer_load_dwordx4 v2, s[4:7], s48 offen offset:1024 lds
 buffer_load_dwordx4 v2, s[4:7], s48 offen offset:2048 lds
 buffer_load_dwordx4 v2, s[4:7], s48 offen offset:3072 lds
 s_add_u32 s49, s49, 4096
 s_add_u32 s48, s48, 4096
 s_mov_b32 m0, s49
 s_nop 0
 buffer_load_dwordx4 v2, s[4:7], s48 offen offset:0 lds
 buffer_load_dwordx4 v2, s[4:7], s48 offen offset:1024 lds
 buffer_load_dwordx4 v2, s[4:7], s48 offen offset:2048 lds
 buffer_load_dwordx4 v2, s[4:7], s48 offen offset:3072 lds
 s_add_u32 s49, s49, 4096
 s_add_u32 s48, s48, 4096
 s_mov_b32 m0, s49
 s_nop 0
 buffer_load_dwordx4 v2, s[4:7], s48 offen offset:0 lds
 s_mov_b32 s44, 1
 s_mov_b32 s45, 36864
 s_lshl_b32 s48, s44, 1
 s_add_u32 s48, s48, s41
 s_min_u32 s48, s48, 63
 s_mul_i32 s48, s48, 36864
 s_mul_i32 s49, s14, 9216
 s_add_u32 s48, s48, s49
 s_add_u32 s48, s48, 1048576
 s_add_u32 s49, s49, s45
 s_mov_b32 m0, s49
 s_nop 0
 buffer_load_dwordx4 v2, s[4:7], s48 offen offset:0 lds
 buffer_load_dwordx4 v2, s[4:7], s48 offen offset:1024 lds
 buffer_load_dwordx4 v2, s[4:7], s48 offen offset:2048 lds
 buffer_load_dwordx4 v2, s[4:7], s48 offen offset:3072 lds
 s_add_u32 s49, s49, 4096
 s_add_u32 s48, s48, 4096
 s_mov_b32 m0, s49
 s_nop 0
 buffer_load_dwordx4 v2, s[4:7], s48 offen offset:0 lds
 buffer_load_dwordx4 v2, s[4:7], s48 offen offset:1024 lds
 buffer_load_dwordx4 v2, s[4:7], s48 offen offset:2048 lds
 buffer_load_dwordx4 v2, s[4:7], s48 offen offset:3072 lds
 s_add_u32 s49, s49, 4096
 s_add_u32 s48, s48, 4096
 s_mov_b32 m0, s49
 s_nop 0
 buffer_load_dwordx4 v2, s[4:7], s48 offen offset:0 lds
 s_mov_b32 s44, 0
 s_mov_b32 s45, 0
 s_waitcnt vmcnt(9)
L_ws13:
 s_waitcnt vmcnt(13)
 s_barrier
 s_cmp_lg_u32 s14, 0
 s_cbranch_scc1 L_wsf14
 s_cmp_lt_u32 s44, 2
 s_cbranch_scc1 L_wsf14
 s_sub_u32 s47, s44, 1
 s_lshl_b32 s48, s41, 7
 s_lshl_b32 s49, s40, 2
 s_add_u32 s48, s48, s49
 s_add_u32 s48, s48, 0
 v_mov_b32 v4, s47
 v_mov_b32 v5, 0
 s_mov_b64 exec, 1
 buffer_store_dword v4, v5, s[4:7], s48 offen sc1
 s_mov_b64 exec, -1
L_wsf14:
 s_add_u32 s50, s44, 2
 s_add_u32 s51, s45, 73728
 s_cmp_ge_u32 s51, 110592
 s_cselect_b32 s47, 110592, 0
 s_sub_u32 s51, s51, s47
 s_lshl_b32 s48, s50, 1
 s_add_u32 s48, s48, s41
 s_min_u32 s48, s48, 63
 s_mul_i32 s48, s48, 36864
 s_mul_i32 s49, s14, 9216
 s_add_u32 s48, s48, s49
 s_add_u32 s48, s48, 1048576
 s_add_u32 s49, s49, s51
 s_mov_b32 m0, s49
 s_nop 0
 buffer_load_dwordx4 v2, s[4:7], s48 offen offset:0 lds
 buffer_load_dwordx4 v2, s[4:7], s48 offen offset:1024 lds
 buffer_load_dwordx4 v2, s[4:7], s48 offen offset:2048 lds
 buffer_load_dwordx4 v2, s[4:7], s48 offen offset:3072 lds
 s_add_u32 s49, s49, 4096
 s_add_u32 s48, s48, 4096
 s_mov_b32 m0, s49
 s_nop 0
 buffer_load_dwordx4 v2, s[4:7], s48 offen offset:0 lds
 buffer_load_dwordx4 v2, s[4:7], s48 offen offset:1024 lds
 buffer_load_dwordx4 v2, s[4:7], s48 offen offset:2048 lds
 buffer_load_dwordx4 v2, s[4:7], s48 offen offset:3072 lds
 s_add_u32 s49, s49, 4096
 s_add_u32 s48, s48, 4096
 s_mov_b32 m0, s49
 s_nop 0
 buffer_load_dwordx4 v2, s[4:7], s48 offen offset:0 lds
 v_add_u32 v3, s45, v2
 ds_read_b128 v[96:99], v3 offset:0
 ds_read_b128 v[100:103], v3 offset:18432
 ds_read_b128 v[104:107], v3 offset:1024
 ds_read_b128 v[108:111], v3 offset:19456
 ds_read_b128 v[112:115], v3 offset:2048
 ds_read_b128 v[116:119], v3 offset:20480
 s_waitcnt lgkmcnt(5)
 v_mfma_f32_16x16x32_bf16 v[128:131], a[0:3], v[96:99], 0
 s_waitcnt lgkmcnt(4)
 v_mfma_f32_16x16x32_bf16 v[132:135], a[0:3], v[100:103], 0
 v_mfma_f32_16x16x32_bf16 v[136:139], a[4:7], v[96:99], 0
 v_mfma_f32_16x16x32_bf16 v[140:143], a[4:7], v[100:103], 0
 ds_read_b128 v[120:123], v3 offset:3072
 ds_read_b128 v[124:127], v3 offset:21504
 v_mfma_f32_16x16x32_bf16 v[144:147], v[96:99], a[8:11], 0
 v_mfma_f32_16x16x32_bf16 v[148:151], v[100:103], a[8:11], 0
 v_mfma_f32_16x16x32_bf16 v[152:155], v[96:99], a[12:15], 0
 v_mfma_f32_16x16x32_bf16 v[156:159], v[100:103], a[12:15], 0
 s_waitcnt lgkmcnt(5)
 v_mfma_f32_16x16x32_bf16 v[128:131], a[16:19], v[104:107], v[128:131]
 s_waitcnt lgkmcnt(4)
 v_mfma_f32_16x16x32_bf16 v[132:135], a[16:19], v[108:111], v[132:135]
 v_mfma_f32_16x16x32_bf16 v[136:139], a[20:23], v[104:107], v[136:139]
 v_mfma_f32_16x16x32_bf16 v[140:143], a[20:23], v[108:111], v[140:143]
 ds_read_b128 v[96:99], v3 offset:4096
 ds_read_b128 v[100:103], v3 offset:22528
 v_mfma_f32_16x16x32_bf16 v[144:147], v[104:107], a[24:27], v[144:147]
 v_mfma_f32_16x16x32_bf16 v[148:151], v[108:111], a[24:27], v[148:151]
 v_mfma_f32_16x16x32_bf16 v[152:155], v[104:107], a[28:31], v[152:155]
 v_mfma_f32_16x16x32_bf16 v[156:159], v[108:111], a[28:31], v[156:159]
 s_waitcnt lgkmcnt(5)
 v_mfma_f32_16x16x32_bf16 v[128:131], a[32:35], v[112:115], v[128:131]
 s_waitcnt lgkmcnt(4)
 v_mfma_f32_16x16x32_bf16 v[132:135], a[32:35], v[116:119], v[132:135]
 v_mfma_f32_16x16x32_bf16 v[136:139], a[36:39], v[112:115], v[136:139]
 v_mfma_f32_16x16x32_bf16 v[140:143], a[36:39], v[116:119], v[140:143]
 ds_read_b128 v[104:107], v3 offset:5120
 ds_read_b128 v[108:111], v3 offset:23552
 v_mfma_f32_16x16x32_bf16 v[144:147], v[112:115], a[40:43], v[144:147]
 v_mfma_f32_16x16x32_bf16 v[148:151], v[116:119], a[40:43], v[148:151]
 v_mfma_f32_16x16x32_bf16 v[152:155], v[112:115], a[44:47], v[152:155]
 v_mfma_f32_16x16x32_bf16 v[156:159], v[116:119], a[44:47], v[156:159]
 s_waitcnt lgkmcnt(5)
 v_mfma_f32_16x16x32_bf16 v[128:131], a[48:51], v[120:123], v[128:131]
 s_waitcnt lgkmcnt(4)
 v_mfma_f32_16x16x32_bf16 v[132:135], a[48:51], v[124:127], v[132:135]
 v_mfma_f32_16x16x32_bf16 v[136:139], a[52:55], v[120:123], v[136:139]
 v_mfma_f32_16x16x32_bf16 v[140:143], a[52:55], v[124:127], v[140:143]
 ds_read_b128 v[112:115], v3 offset:6144
 ds_read_b128 v[116:119], v3 offset:24576
 v_mfma_f32_16x16x32_bf16 v[144:147], v[120:123], a[56:59], v[144:147]
 v_mfma_f32_16x16x32_bf16 v[148:151], v[124:127], a[56:59], v[148:151]
 v_mfma_f32_16x16x32_bf16 v[152:155], v[120:123], a[60:63], v[152:155]
 v_mfma_f32_16x16x32_bf16 v[156:159], v[124:127], a[60:63], v[156:159]
 s_waitcnt lgkmcnt(5)
 v_mfma_f32_16x16x32_bf16 v[128:131], a[64:67], v[96:99], v[128:131]
 s_waitcnt lgkmcnt(4)
 v_mfma_f32_16x16x32_bf16 v[132:135], a[64:67], v[100:103], v[132:135]
 v_mfma_f32_16x16x32_bf16 v[136:139], a[68:71], v[96:99], v[136:139]
 v_mfma_f32_16x16x32_bf16 v[140:143], a[68:71], v[100:103], v[140:143]
 ds_read_b128 v[120:123], v3 offset:7168
 ds_read_b128 v[124:127], v3 offset:25600
 v_mfma_f32_16x16x32_bf16 v[144:147], v[96:99], a[72:75], v[144:147]
 v_mfma_f32_16x16x32_bf16 v[148:151], v[100:103], a[72:75], v[148:151]
 v_mfma_f32_16x16x32_bf16 v[152:155], v[96:99], a[76:79], v[152:155]
 v_mfma_f32_16x16x32_bf16 v[156:159], v[100:103], a[76:79], v[156:159]
 s_waitcnt lgkmcnt(5)
 v_mfma_f32_16x16x32_bf16 v[128:131], a[80:83], v[104:107], v[128:131]
 s_waitcnt lgkmcnt(4)
 v_mfma_f32_16x16x32_bf16 v[132:135], a[80:83], v[108:111], v[132:135]
 v_mfma_f32_16x16x32_bf16 v[136:139], a[84:87], v[104:107], v[136:139]
 v_mfma_f32_16x16x32_bf16 v[140:143], a[84:87], v[108:111], v[140:143]
 ds_read_b128 v[96:99], v3 offset:8192
 ds_read_b128 v[100:103], v3 offset:26624
 v_mfma_f32_16x16x32_bf16 v[144:147], v[104:107], a[88:91], v[144:147]
 v_mfma_f32_16x16x32_bf16 v[148:151], v[108:111], a[88:91], v[148:151]
 v_mfma_f32_16x16x32_bf16 v[152:155], v[104:107], a[92:95], v[152:155]
 v_mfma_f32_16x16x32_bf16 v[156:159], v[108:111], a[92:95], v[156:159]
 s_waitcnt lgkmcnt(5)
 v_mfma_f32_16x16x32_bf16 v[128:131], a[96:99], v[112:115], v[128:131]
 s_waitcnt lgkmcnt(4)
 v_mfma_f32_16x16x32_bf16 v[132:135], a[96:99], v[116:119], v[132:135]
 v_mfma_f32_16x16x32_bf16 v[136:139], a[100:103], v[112:115], v[136:139]
 v_mfma_f32_16x16x32_bf16 v[140:143], a[100:103], v[116:119], v[140:143]
 ds_read_b128 v[104:107], v3 offset:9216
 ds_read_b128 v[108:111], v3 offset:27648
 v_mfma_f32_16x16x32_bf16 v[144:147], v[112:115], a[104:107], v[144:147]
 v_mfma_f32_16x16x32_bf16 v[148:151], v[116:119], a[104:107], v[148:151]
 v_mfma_f32_16x16x32_bf16 v[152:155], v[112:115], a[108:111], v[152:155]
 v_mfma_f32_16x16x32_bf16 v[156:159], v[116:119], a[108:111], v[156:159]
 s_waitcnt lgkmcnt(5)
 v_mfma_f32_16x16x32_bf16 v[128:131], a[112:115], v[120:123], v[128:131]
 s_waitcnt lgkmcnt(4)
 v_mfma_f32_16x16x32_bf16 v[132:135], a[112:115], v[124:127], v[132:135]
 v_mfma_f32_16x16x32_bf16 v[136:139], a[116:119], v[120:123], v[136:139]
 v_mfma_f32_16x16x32_bf16 v[140:143], a[116:119], v[124:127], v[140:143]
 ds_read_b128 v[112:115], v3 offset:10240
 ds_read_b128 v[116:119], v3 offset:28672
 v_mfma_f32_16x16x32_bf16 v[144:147], v[120:123], a[120:123], v[144:147]
 v_mfma_f32_16x16x32_bf16 v[148:151], v[124:127], a[120:123], v[148:151]
 v_mfma_f32_16x16x32_bf16 v[152:155], v[120:123], a[124:127], v[152:155]
 v_mfma_f32_16x16x32_bf16 v[156:159], v[124:127], a[124:127], v[156:159]
 s_waitcnt lgkmcnt(5)
 v_mfma_f32_16x16x32_bf16 v[128:131], a[128:131], v[96:99], v[128:131]
 s_waitcnt lgkmcnt(4)
 v_mfma_f32_16x16x32_bf16 v[132:135], a[128:131], v[100:103], v[132:135]
 v_mfma_f32_16x16x32_bf16 v[136:139], a[132:135], v[96:99], v[136:139]
 v_mfma_f32_16x16x32_bf16 v[140:143], a[132:135], v[100:103], v[140:143]
 ds_read_b128 v[120:123], v3 offset:11264
 ds_read_b128 v[124:127], v3 offset:29696
 v_mfma_f32_16x16x32_bf16 v[144:147], v[96:99], a[136:139], v[144:147]
 v_mfma_f32_16x16x32_bf16 v[148:151], v[100:103], a[136:139], v[148:151]
 v_mfma_f32_16x16x32_bf16 v[152:155], v[96:99], a[140:143], v[152:155]
 v_mfma_f32_16x16x32_bf16 v[156:159], v[100:103], a[140:143], v[156:159]
 s_waitcnt lgkmcnt(5)
 v_mfma_f32_16x16x32_bf16 v[128:131], a[144:147], v[104:107], v[128:131]
 s_waitcnt lgkmcnt(4)
 v_mfma_f32_16x16x32_bf16 v[132:135], a[144:147], v[108:111], v[132:135]
 v_mfma_f32_16x16x32_bf16 v[136:139], a[148:151], v[104:107], v[136:139]
 v_mfma_f32_16x16x32_bf16 v[140:143], a[148:151], v[108:111], v[140:143]
 ds_read_b128 v[96:99], v3 offset:12288
 ds_read_b128 v[100:103], v3 offset:30720
 v_mfma_f32_16x16x32_bf16 v[144:147], v[104:107], a[152:155], v[144:147]
 v_mfma_f32_16x16x32_bf16 v[148:151], v[108:111], a[152:155], v[148:151]
 v_mfma_f32_16x16x32_bf16 v[152:155], v[104:107], a[156:159], v[152:155]
 v_mfma_f32_16x16x32_bf16 v[156:159], v[108:111], a[156:159], v[156:159]
 s_waitcnt lgkmcnt(5)
 v_mfma_f32_16x16x32_bf16 v[128:131], a[160:163], v[112:115], v[128:131]
 s_waitcnt lgkmcnt(4)
 v_mfma_f32_16x16x32_bf16 v[132:135], a[160:163], v[116:119], v[132:135]
 v_mfma_f32_16x16x32_bf16 v[136:139], a[164:167], v[112:115], v[136:139]
 v_mfma_f32_16x16x32_bf16 v[140:143], a[164:167], v[116:119], v[140:143]
 ds_read_b128 v[104:107], v3 offset:13312
 ds_read_b128 v[108:111], v3 offset:31744
 v_mfma_f32_16x16x32_bf16 v[144:147], v[112:115], a[168:171], v[144:147]
 v_mfma_f32_16x16x32_bf16 v[148:151], v[116:119], a[168:171], v[148:151]
 v_mfma_f32_16x16x32_bf16 v[152:155], v[112:115], a[172:175], v[152:155]
 v_mfma_f32_16x16x32_bf16 v[156:159], v[116:119], a[172:175], v[156:159]
 s_waitcnt lgkmcnt(5)
 v_mfma_f32_16x16x32_bf16 v[128:131], a[176:179], v[120:123], v[128:131]
 s_waitcnt lgkmcnt(4)
 v_mfma_f32_16x16x32_bf16 v[132:135], a[176:179], v[124:127], v[132:135]
 v_mfma_f32_16x16x32_bf16 v[136:139], a[180:183], v[120:123], v[136:139]
 v_mfma_f32_16x16x32_bf16 v[140:143], a[180:183], v[124:127], v[140:143]
 ds_read_b128 v[112:115], v3 offset:14336
 ds_read_b128 v[116:119], v3 offset:32768
 v_mfma_f32_16x16x32_bf16 v[144:147], v[120:123], a[184:187], v[144:147]
 v_mfma_f32_16x16x32_bf16 v[148:151], v[124:127], a[184:187], v[148:151]
 v_mfma_f32_16x16x32_bf16 v[152:155], v[120:123], a[188:191], v[152:155]
 v_mfma_f32_16x16x32_bf16 v[156:159], v[124:127], a[188:191], v[156:159]
 s_waitcnt lgkmcnt(5)
 v_mfma_f32_16x16x32_bf16 v[128:131], a[192:195], v[96:99], v[128:131]
 s_waitcnt lgkmcnt(4)
 v_mfma_f32_16x16x32_bf16 v[132:135], a[192:195], v[100:103], v[132:135]
 v_mfma_f32_16x16x32_bf16 v[136:139], a[196:199], v[96:99], v[136:139]
 v_mfma_f32_16x16x32_bf16 v[140:143], a[196:199], v[100:103], v[140:143]
 ds_read_b128 v[120:123], v3 offset:15360
 ds_read_b128 v[124:127], v3 offset:33792
 v_mfma_f32_16x16x32_bf16 v[144:147], v[96:99], a[200:203], v[144:147]
 v_mfma_f32_16x16x32_bf16 v[148:151], v[100:103], a[200:203], v[148:151]
 v_mfma_f32_16x16x32_bf16 v[152:155], v[96:99], a[204:207], v[152:155]
 v_mfma_f32_16x16x32_bf16 v[156:159], v[100:103], a[204:207], v[156:159]
 s_waitcnt lgkmcnt(5)
 v_mfma_f32_16x16x32_bf16 v[128:131], a[208:211], v[104:107], v[128:131]
 s_waitcnt lgkmcnt(4)
 v_mfma_f32_16x16x32_bf16 v[132:135], a[208:211], v[108:111], v[132:135]
 v_mfma_f32_16x16x32_bf16 v[136:139], a[212:215], v[104:107], v[136:139]
 v_mfma_f32_16x16x32_bf16 v[140:143], a[212:215], v[108:111], v[140:143]
 ds_read_b128 v[96:99], v3 offset:16384
 ds_read_b128 v[100:103], v3 offset:34816
 v_mfma_f32_16x16x32_bf16 v[144:147], v[104:107], a[216:219], v[144:147]
 v_mfma_f32_16x16x32_bf16 v[148:151], v[108:111], a[216:219], v[148:151]
 v_mfma_f32_16x16x32_bf16 v[152:155], v[104:107], a[220:223], v[152:155]
 v_mfma_f32_16x16x32_bf16 v[156:159], v[108:111], a[220:223], v[156:159]
 s_waitcnt lgkmcnt(5)
 v_mfma_f32_16x16x32_bf16 v[128:131], a[224:227], v[112:115], v[128:131]
 s_waitcnt lgkmcnt(4)
 v_mfma_f32_16x16x32_bf16 v[132:135], a[224:227], v[116:119], v[132:135]
 v_mfma_f32_16x16x32_bf16 v[136:139], a[228:231], v[112:115], v[136:139]
 v_mfma_f32_16x16x32_bf16 v[140:143], a[228:231], v[116:119], v[140:143]
 ds_read_b128 v[104:107], v3 offset:17408
 ds_read_b128 v[108:111], v3 offset:35840
 v_mfma_f32_16x16x32_bf16 v[144:147], v[112:115], a[232:235], v[144:147]
 v_mfma_f32_16x16x32_bf16 v[148:151], v[116:119], a[232:235], v[148:151]
 v_mfma_f32_16x16x32_bf16 v[152:155], v[112:115], a[236:239], v[152:155]
 v_mfma_f32_16x16x32_bf16 v[156:159], v[116:119], a[236:239], v[156:159]
 s_waitcnt lgkmcnt(5)
 v_mfma_f32_16x16x32_bf16 v[128:131], a[240:243], v[120:123], v[128:131]
 s_waitcnt lgkmcnt(4)
 v_mfma_f32_16x16x32_bf16 v[132:135], a[240:243], v[124:127], v[132:135]
 v_mfma_f32_16x16x32_bf16 v[136:139], a[244:247], v[120:123], v[136:139]
 v_mfma_f32_16x16x32_bf16 v[140:143], a[244:247], v[124:127], v[140:143]
 v_mfma_f32_16x16x32_bf16 v[144:147], v[120:123], a[248:251], v[144:147]
 v_mfma_f32_16x16x32_bf16 v[148:151], v[124:127], a[248:251], v[148:151]
 v_mfma_f32_16x16x32_bf16 v[152:155], v[120:123], a[252:255], v[152:155]
 v_mfma_f32_16x16x32_bf16 v[156:159], v[124:127], a[252:255], v[156:159]
 s_waitcnt lgkmcnt(3)
 v_mfma_f32_16x16x32_bf16 v[128:131], v[224:227], v[96:99], v[128:131]
 s_waitcnt lgkmcnt(2)
 v_mfma_f32_16x16x32_bf16 v[132:135], v[224:227], v[100:103], v[132:135]
 v_mfma_f32_16x16x32_bf16 v[136:139], v[228:231], v[96:99], v[136:139]
 v_mfma_f32_16x16x32_bf16 v[140:143], v[228:231], v[100:103], v[140:143]
 v_mfma_f32_16x16x32_bf16 v[144:147], v[96:99], v[232:235], v[144:147]
 v_mfma_f32_16x16x32_bf16 v[148:151], v[100:103], v[232:235], v[148:151]
 v_mfma_f32_16x16x32_bf16 v[152:155], v[96:99], v[236:239], v[152:155]
 v_mfma_f32_16x16x32_bf16 v[156:159], v[100:103], v[236:239], v[156:159]
 s_waitcnt lgkmcnt(1)
 v_mfma_f32_16x16x32_bf16 v[128:131], v[240:243], v[104:107], v[128:131]
 s_waitcnt lgkmcnt(0)
 v_mfma_f32_16x16x32_bf16 v[132:135], v[240:243], v[108:111], v[132:135]
 v_mfma_f32_16x16x32_bf16 v[136:139], v[244:247], v[104:107], v[136:139]
 v_mfma_f32_16x16x32_bf16 v[140:143], v[244:247], v[108:111], v[140:143]
 v_mfma_f32_16x16x32_bf16 v[144:147], v[104:107], v[248:251], v[144:147]
 v_mfma_f32_16x16x32_bf16 v[148:151], v[108:111], v[248:251], v[148:151]
 v_mfma_f32_16x16x32_bf16 v[152:155], v[104:107], v[252:255], v[152:155]
 v_mfma_f32_16x16x32_bf16 v[156:159], v[108:111], v[252:255], v[156:159]
 s_lshl_b32 s46, s44, 1
 s_add_u32 s46, s46, s41
 v_cvt_pk_bf16_f32 v80, v128, v129
 v_cvt_pk_bf16_f32 v81, v130, v131
 v_cvt_pk_bf16_f32 v82, v136, v137
 v_cvt_pk_bf16_f32 v83, v138, v139
 v_cvt_pk_bf16_f32 v84, v132, v133
 v_cvt_pk_bf16_f32 v85, v134, v135
 v_cvt_pk_bf16_f32 v86, v140, v141
 v_cvt_pk_bf16_f32 v87, v142, v143
 v_cvt_pk_bf16_f32 v88, v144, v145
 v_cvt_pk_bf16_f32 v89, v146, v147
 v_cvt_pk_bf16_f32 v90, v148, v149
 v_cvt_pk_bf16_f32 v91, v150, v151
 v_cvt_pk_bf16_f32 v92, v152, v153
 v_cvt_pk_bf16_f32 v93, v154, v155
 v_cvt_pk_bf16_f32 v94, v156, v157
 v_cvt_pk_bf16_f32 v95, v158, v159
 s_cmp_lg_u32 s44, 4
 s_cbranch_scc1 L_arm15
 s_add_u32 s47, s41, 58
 s_lshl_b32 s47, s47, 5
 s_add_u32 s47, s47, s40
 s_lshl_b32 s47, s47, 2
 s_add_u32 s47, s47, s14
 s_lshl_b32 s47, s47, 11
 s_add_u32 s47, s47, 37748736
 v_mov_b32 v96, -1
 v_mov_b32 v97, -1
 v_mov_b32 v98, -1
 v_mov_b32 v99, -1
 buffer_store_dwordx4 v[96:99], v2, s[4:7], s47 offen offset:0 sc1
 buffer_store_dwordx4 v[96:99], v2, s[4:7], s47 offen offset:1024 sc1
 s_add_u32 s47, s47, 524288
 buffer_store_dwordx4 v[96:99], v2, s[4:7], s47 offen offset:0 sc1
 buffer_store_dwordx4 v[96:99], v2, s[4:7], s47 offen offset:1024 sc1
 s_add_u32 s47, s47, 524288
 buffer_store_dwordx4 v[96:99], v2, s[4:7], s47 offen offset:0 sc1
 buffer_store_dwordx4 v[96:99], v2, s[4:7], s47 offen offset:1024 sc1
 s_add_u32 s47, s47, 524288
L_arm15:
 s_lshl_b32 s47, s46, 5
 s_add_u32 s47, s47, s40
 s_lshl_b32 s47, s47, 2
 s_add_u32 s47, s47, s14
 s_lshl_b32 s47, s47, 11
 s_add_u32 s48, s47, 4194304
 s_add_u32 s49, s47, 20971520
 buffer_store_dwordx4 v[80:83], v2, s[4:7], s48 offen offset:0 sc1
 buffer_store_dwordx4 v[84:87], v2, s[4:7], s48 offen offset:1024 sc1
 buffer_store_dwordx4 v[88:91], v2, s[4:7], s49 offen offset:0 sc1
 buffer_store_dwordx4 v[92:95], v2, s[4:7], s49 offen offset:1024 sc1
 s_add_u32 s45, s45, 36864
 s_cmp_ge_u32 s45, 110592
 s_cselect_b32 s45, 0, s45
 s_add_u32 s44, s44, 1
 s_cmp_lt_u32 s44, 32
 s_cbranch_scc1 L_ws13
 s_waitcnt vmcnt(0)
 s_barrier
 s_cmp_lg_u32 s14, 0
 s_cbranch_scc1 L_wsf16
 s_mov_b32 s47, 32
 s_lshl_b32 s48, s41, 7
 s_lshl_b32 s49, s40, 2
 s_add_u32 s48, s48, s49
 s_add_u32 s48, s48, 0
 v_mov_b32 v4, s47
 v_mov_b32 v5, 0
 s_mov_b64 exec, 1
 buffer_store_dword v4, v5, s[4:7], s48 offen sc1
 s_mov_b64 exec, -1
L_wsf16:
 s_lshl_b32 s64, s41, 5
 s_add_u32 s64, s64, s40
 s_branch L_fin
L_ffn:
 s_lshr_b32 s39, s13, 2
 s_mul_i32 s39, s39, 7
 s_add_u32 s39, s39, s38
 s_cmp_ge_u32 s39, 18
 s_cbranch_scc1 L_spare
 s_and_b32 s52, s13, 3
 s_lshl_b32 s39, s39, 2
 s_add_u32 s52, s52, s39
 s_mul_i32 s41, s52, 3641
 s_lshr_b32 s41, s41, 16
 s_mul_i32 s40, s41, 18
 s_sub_u32 s40, s52, s40
 s_load_dwordx2 s[16:17], s[0:1], 64
 s_mov_b32 s18, 0x510000
 s_mov_b32 s19, 0x20000
 s_lshl_b32 s42, s40, 9
 s_add_u32 s43, s42, 256
 s_waitcnt lgkmcnt(0)
 s_and_b32 s17, s17, 0xffff
 v_lshrrev_b32 v2, 4, v1
 v_and_b32 v3, 15, v1
 v_lshlrev_b32 v4, 1, v2
 v_xor_b32 v5, v3, v4
 v_xor_b32 v6, 8, v5
 v_mul_u32_u24 v2, 9216, v2
 v_lshl_add_u32 v5, v5, 4, v2
 v_lshl_add_u32 v6, v6, 4, v2
 v_lshrrev_b32 v7, 4, v1
 v_bfe_u32 v8, v1, 2, 2
 v_and_b32 v9, 3, v1
 v_and_b32 v10, 1, v7
 v_lshl_or_b32 v10, v10, 2, v8
 v_lshlrev_b32 v10, 1, v10
 v_lshrrev_b32 v11, 1, v9
 s_lshl_b32 s33, s14, 2
 v_add_u32 v11, s33, v11
 v_add_u32 v12, 2, v11
 v_xor_b32 v11, v11, v10
 v_xor_b32 v12, v12, v10
 v_lshl_add_u32 v13, v7, 3, v8
 v_lshlrev_b32 v13, 8, v13
 v_and_b32 v9, 1, v9
 v_lshl_add_u32 v13, v9, 3, v13
 v_lshl_add_u32 v11, v11, 4, v13
 v_lshl_add_u32 v12, v12, 4, v13
 v_add_u32 v14, 73728, v11
 v_add_u32 v15, 73728, v12
 v_add_u32 v18, 65536, v11
 v_add_u32 v19, 65536, v12
 v_add_u32 v20, 65536, v14
 v_add_u32 v21, 65536, v15
 s_mul_i32 s33, s14, 18432
 s_add_u32 s33, s33, 0
 s_mul_i32 s34, s14, 663552
 s_add_u32 s34, s34, s42
 s_add_u32 s34, s34, 0
 s_bitcmp1_b32 s14, 0
 s_cselect_b64 vcc, -1, 0
 v_cndmask_b32 v16, v5, v6, vcc
 v_cndmask_b32 v17, v6, v5, vcc
 s_mov_b32 m0, s33
 s_nop 0
 buffer_load_dwordx4 v16, s[16:19], s34 offen lds
 s_add_u32 s33, s33, 1024
 s_add_u32 s34, s34, 36864
 s_mov_b32 m0, s33
 s_nop 0
 buffer_load_dwordx4 v16, s[16:19], s34 offen lds
 s_add_u32 s33, s33, 1024
 s_add_u32 s34, s34, 36864
 s_mov_b32 m0, s33
 s_nop 0
 buffer_load_dwordx4 v17, s[16:19], s34 offen lds
 s_add_u32 s33, s33, 1024
 s_add_u32 s34, s34, 36864
 s_mov_b32 m0, s33
 s_nop 0
 buffer_load_dwordx4 v17, s[16:19], s34 offen lds
 s_add_u32 s33, s33, 1024
 s_add_u32 s34, s34, 36864
 s_mov_b32 m0, s33
 s_nop 0
 buffer_load_dwordx4 v16, s[16:19], s34 offen lds
 s_add_u32 s33, s33, 1024
 s_add_u32 s34, s34, 36864
 s_mov_b32 m0, s33
 s_nop 0
 buffer_load_dwordx4 v16, s[16:19], s34 offen lds
 s_add_u32 s33, s33, 1024
 s_add_u32 s34, s34, 36864
 s_mov_b32 m0, s33
 s_nop 0
 buffer_load_dwordx4 v17, s[16:19], s34 offen lds
 s_add_u32 s33, s33, 1024
 s_add_u32 s34, s34, 36864
 s_mov_b32 m0, s33
 s_nop 0
 buffer_load_dwordx4 v17, s[16:19], s34 offen lds
 s_add_u32 s33, s33, 1024
 s_add_u32 s34, s34, 36864
 s_mov_b32 m0, s33
 s_nop 0
 buffer_load_dwordx4 v16, s[16:19], s34 offen lds
 s_add_u32 s33, s33, 1024
 s_add_u32 s34, s34, 36864
 s_mov_b32 m0, s33
 s_nop 0
 buffer_load_dwordx4 v16, s[16:19], s34 offen lds
 s_add_u32 s33, s33, 1024
 s_add_u32 s34, s34, 36864
 s_mov_b32 m0, s33
 s_nop 0
 buffer_load_dwordx4 v17, s[16:19], s34 offen lds
 s_add_u32 s33, s33, 1024
 s_add_u32 s34, s34, 36864
 s_mov_b32 m0, s33
 s_nop 0
 buffer_load_dwordx4 v17, s[16:19], s34 offen lds
 s_add_u32 s33, s33, 1024
 s_add_u32 s34, s34, 36864
 s_mov_b32 m0, s33
 s_nop 0
 buffer_load_dwordx4 v16, s[16:19], s34 offen lds
 s_add_u32 s33, s33, 1024
 s_add_u32 s34, s34, 36864
 s_mov_b32 m0, s33
 s_nop 0
 buffer_load_dwordx4 v16, s[16:19], s34 offen lds
 s_add_u32 s33, s33, 1024
 s_add_u32 s34, s34, 36864
 s_mov_b32 m0, s33
 s_nop 0
 buffer_load_dwordx4 v17, s[16:19], s34 offen lds
 s_add_u32 s33, s33, 1024
 s_add_u32 s34, s34, 36864
 s_mov_b32 m0, s33
 s_nop 0
 buffer_load_dwordx4 v17, s[16:19], s34 offen lds
 s_add_u32 s33, s33, 1024
 s_add_u32 s34, s34, 36864
 s_mov_b32 m0, s33
 s_nop 0
 buffer_load_dwordx4 v16, s[16:19], s34 offen lds
 s_add_u32 s33, s33, 1024
 s_add_u32 s34, s34, 36864
 s_mov_b32 m0, s33
 s_nop 0
 buffer_load_dwordx4 v16, s[16:19], s34 offen lds
 s_mul_i32 s33, s14, 18432
 s_add_u32 s33, s33, 73728
 s_mul_i32 s34, s14, 663552
 s_add_u32 s34, s34, s42
 s_add_u32 s34, s34, 2654208
 s_bitcmp1_b32 s14, 0
 s_cselect_b64 vcc, -1, 0
 v_cndmask_b32 v16, v5, v6, vcc
 v_cndmask_b32 v17, v6, v5, vcc
 s_mov_b32 m0, s33
 s_nop 0
 buffer_load_dwordx4 v16, s[16:19], s34 offen lds
 s_add_u32 s33, s33, 1024
 s_add_u32 s34, s34, 36864
 s_mov_b32 m0, s33
 s_nop 0
 buffer_load_dwordx4 v16, s[16:19], s34 offen lds
 s_add_u32 s33, s33, 1024
 s_add_u32 s34, s34, 36864
 s_mov_b32 m0, s33
 s_nop 0
 buffer_load_dwordx4 v17, s[16:19], s34 offen lds
 s_add_u32 s33, s33, 1024
 s_add_u32 s34, s34, 36864
 s_mov_b32 m0, s33
 s_nop 0
 buffer_load_dwordx4 v17, s[16:19], s34 offen lds
 s_add_u32 s33, s33, 1024
 s_add_u32 s34, s34, 36864
 s_mov_b32 m0, s33
 s_nop 0
 buffer_load_dwordx4 v16, s[16:19], s34 offen lds
 s_add_u32 s33, s33, 1024
 s_add_u32 s34, s34, 36864
 s_mov_b32 m0, s33
 s_nop 0
 buffer_load_dwordx4 v16, s[16:19], s34 offen lds
 s_add_u32 s33, s33, 1024
 s_add_u32 s34, s34, 36864
 s_mov_b32 m0, s33
 s_nop 0
 buffer_load_dwordx4 v17, s[16:19], s34 offen lds
 s_add_u32 s33, s33, 1024
 s_add_u32 s34, s34, 36864
 s_mov_b32 m0, s33
 s_nop 0
 buffer_load_dwordx4 v17, s[16:19], s34 offen lds
 s_add_u32 s33, s33, 1024
 s_add_u32 s34, s34, 36864
 s_mov_b32 m0, s33
 s_nop 0
 buffer_load_dwordx4 v16, s[16:19], s34 offen lds
 s_add_u32 s33, s33, 1024
 s_add_u32 s34, s34, 36864
 s_mov_b32 m0, s33
 s_nop 0
 buffer_load_dwordx4 v16, s[16:19], s34 offen lds
 s_add_u32 s33, s33, 1024
 s_add_u32 s34, s34, 36864
 s_mov_b32 m0, s33
 s_nop 0
 buffer_load_dwordx4 v17, s[16:19], s34 offen lds
 s_add_u32 s33, s33, 1024
 s_add_u32 s34, s34, 36864
 s_mov_b32 m0, s33
 s_nop 0
 buffer_load_dwordx4 v17, s[16:19], s34 offen lds
 s_add_u32 s33, s33, 1024
 s_add_u32 s34, s34, 36864
 s_mov_b32 m0, s33
 s_nop 0
 buffer_load_dwordx4 v16, s[16:19], s34 offen lds
 s_add_u32 s33, s33, 1024
 s_add_u32 s34, s34, 36864
 s_mov_b32 m0, s33
 s_nop 0
 buffer_load_dwordx4 v16, s[16:19], s34 offen lds
 s_add_u32 s33, s33, 1024
 s_add_u32 s34, s34, 36864
 s_mov_b32 m0, s33
 s_nop 0
 buffer_load_dwordx4 v17, s[16:19], s34 offen lds
 s_add_u32 s33, s33, 1024
 s_add_u32 s34, s34, 36864
 s_mov_b32 m0, s33
 s_nop 0
 buffer_load_dwordx4 v17, s[16:19], s34 offen lds
 s_add_u32 s33, s33, 1024
 s_add_u32 s34, s34, 36864
 s_mov_b32 m0, s33
 s_nop 0
 buffer_load_dwordx4 v16, s[16:19], s34 offen lds
 s_add_u32 s33, s33, 1024
 s_add_u32 s34, s34, 36864
 s_mov_b32 m0, s33
 s_nop 0
 buffer_load_dwordx4 v16, s[16:19], s34 offen lds
 s_waitcnt vmcnt(18)
 s_barrier
 ds_read_b64_tr_b16 a[0:1], v11 offset:0
 ds_read_b64_tr_b16 a[2:3], v11 offset:1024
 ds_read_b64_tr_b16 a[4:5], v12 offset:0
 ds_read_b64_tr_b16 a[6:7], v12 offset:1024
 ds_read_b64_tr_b16 a[16:17], v11 offset:8192
 ds_read_b64_tr_b16 a[18:19], v11 offset:9216
 ds_read_b64_tr_b16 a[20:21], v12 offset:8192
 ds_read_b64_tr_b16 a[22:23], v12 offset:9216
 ds_read_b64_tr_b16 a[32:33], v11 offset:16384
 ds_read_b64_tr_b16 a[34:35], v11 offset:17408
 ds_read_b64_tr_b16 a[36:37], v12 offset:16384
 ds_read_b64_tr_b16 a[38:39], v12 offset:17408
 ds_read_b64_tr_b16 a[48:49], v11 offset:24576
 ds_read_b64_tr_b16 a[50:51], v11 offset:25600
 ds_read_b64_tr_b16 a[52:53], v12 offset:24576
 ds_read_b64_tr_b16 a[54:55], v12 offset:25600
 ds_read_b64_tr_b16 a[64:65], v11 offset:32768
 ds_read_b64_tr_b16 a[66:67], v11 offset:33792
 ds_read_b64_tr_b16 a[68:69], v12 offset:32768
 ds_read_b64_tr_b16 a[70:71], v12 offset:33792
 ds_read_b64_tr_b16 a[80:81], v11 offset:40960
 ds_read_b64_tr_b16 a[82:83], v11 offset:41984
 ds_read_b64_tr_b16 a[84:85], v12 offset:40960
 ds_read_b64_tr_b16 a[86:87], v12 offset:41984
 ds_read_b64_tr_b16 a[96:97], v11 offset:49152
 ds_read_b64_tr_b16 a[98:99], v11 offset:50176
 ds_read_b64_tr_b16 a[100:101], v12 offset:49152
 ds_read_b64_tr_b16 a[102:103], v12 offset:50176
 ds_read_b64_tr_b16 a[112:113], v11 offset:57344
 ds_read_b64_tr_b16 a[114:115], v11 offset:58368
 ds_read_b64_tr_b16 a[116:117], v12 offset:57344
 ds_read_b64_tr_b16 a[118:119], v12 offset:58368
 ds_read_b64_tr_b16 a[128:129], v18 offset:0
 ds_read_b64_tr_b16 a[130:131], v18 offset:1024
 ds_read_b64_tr_b16 a[132:133], v19 offset:0
 ds_read_b64_tr_b16 a[134:135], v19 offset:1024
 s_waitcnt lgkmcnt(0)
 s_barrier
 s_mul_i32 s33, s14, 18432
 s_add_u32 s33, s33, 0
 s_mul_i32 s34, s14, 663552
 s_add_u32 s34, s34, s43
 s_add_u32 s34, s34, 0
 s_bitcmp1_b32 s14, 0
 s_cselect_b64 vcc, -1, 0
 v_cndmask_b32 v16, v5, v6, vcc
 v_cndmask_b32 v17, v6, v5, vcc
 s_mov_b32 m0, s33
 s_nop 0
 buffer_load_dwordx4 v16, s[16:19], s34 offen lds
 s_add_u32 s33, s33, 1024
 s_add_u32 s34, s34, 36864
 s_mov_b32 m0, s33
 s_nop 0
 buffer_load_dwordx4 v16, s[16:19], s34 offen lds
 s_add_u32 s33, s33, 1024
 s_add_u32 s34, s34, 36864
 s_mov_b32 m0, s33
 s_nop 0
 buffer_load_dwordx4 v17, s[16:19], s34 offen lds
 s_add_u32 s33, s33, 1024
 s_add_u32 s34, s34, 36864
 s_mov_b32 m0, s33
 s_nop 0
 buffer_load_dwordx4 v17, s[16:19], s34 offen lds
 s_add_u32 s33, s33, 1024
 s_add_u32 s34, s34, 36864
 s_mov_b32 m0, s33
 s_nop 0
 buffer_load_dwordx4 v16, s[16:19], s34 offen lds
 s_add_u32 s33, s33, 1024
 s_add_u32 s34, s34, 36864
 s_mov_b32 m0, s33
 s_nop 0
 buffer_load_dwordx4 v16, s[16:19], s34 offen lds
 s_add_u32 s33, s33, 1024
 s_add_u32 s34, s34, 36864
 s_mov_b32 m0, s33
 s_nop 0
 buffer_load_dwordx4 v17, s[16:19], s34 offen lds
 s_add_u32 s33, s33, 1024
 s_add_u32 s34, s34, 36864
 s_mov_b32 m0, s33
 s_nop 0
 buffer_load_dwordx4 v17, s[16:19], s34 offen lds
 s_add_u32 s33, s33, 1024
 s_add_u32 s34, s34, 36864
 s_mov_b32 m0, s33
 s_nop 0
 buffer_load_dwordx4 v16, s[16:19], s34 offen lds
 s_add_u32 s33, s33, 1024
 s_add_u32 s34, s34, 36864
 s_mov_b32 m0, s33
 s_nop 0
 buffer_load_dwordx4 v16, s[16:19], s34 offen lds
 s_add_u32 s33, s33, 1024
 s_add_u32 s34, s34, 36864
 s_mov_b32 m0, s33
 s_nop 0
 buffer_load_dwordx4 v17, s[16:19], s34 offen lds
 s_add_u32 s33, s33, 1024
 s_add_u32 s34, s34, 36864
 s_mov_b32 m0, s33
 s_nop 0
 buffer_load_dwordx4 v17, s[16:19], s34 offen lds
 s_add_u32 s33, s33, 1024
 s_add_u32 s34, s34, 36864
 s_mov_b32 m0, s33
 s_nop 0
 buffer_load_dwordx4 v16, s[16:19], s34 offen lds
 s_add_u32 s33, s33, 1024
 s_add_u32 s34, s34, 36864
 s_mov_b32 m0, s33
 s_nop 0
 buffer_load_dwordx4 v16, s[16:19], s34 offen lds
 s_add_u32 s33, s33, 1024
 s_add_u32 s34, s34, 36864
 s_mov_b32 m0, s33
 s_nop 0
 buffer_load_dwordx4 v17, s[16:19], s34 offen lds
 s_add_u32 s33, s33, 1024
 s_add_u32 s34, s34, 36864
 s_mov_b32 m0, s33
 s_nop 0
 buffer_load_dwordx4 v17, s[16:19], s34 offen lds
 s_add_u32 s33, s33, 1024
 s_add_u32 s34, s34, 36864
 s_mov_b32 m0, s33
 s_nop 0
 buffer_load_dwordx4 v16, s[16:19], s34 offen lds
 s_add_u32 s33, s33, 1024
 s_add_u32 s34, s34, 36864
 s_mov_b32 m0, s33
 s_nop 0
 buffer_load_dwordx4 v16, s[16:19], s34 offen lds
 s_waitcnt vmcnt(18)
 s_barrier
 ds_read_b64_tr_b16 a[144:145], v14 offset:0
 ds_read_b64_tr_b16 a[146:147], v14 offset:1024
 ds_read_b64_tr_b16 a[148:149], v15 offset:0
 ds_read_b64_tr_b16 a[150:151], v15 offset:1024
 ds_read_b64_tr_b16 a[160:161], v14 offset:8192
 ds_read_b64_tr_b16 a[162:163], v14 offset:9216
 ds_read_b64_tr_b16 a[164:165], v15 offset:8192
 ds_read_b64_tr_b16 a[166:167], v15 offset:9216
 ds_read_b64_tr_b16 a[176:177], v14 offset:16384
 ds_read_b64_tr_b16 a[178:179], v14 offset:17408
 ds_read_b64_tr_b16 a[180:181], v15 offset:16384
 ds_read_b64_tr_b16 a[182:183], v15 offset:17408
 ds_read_b64_tr_b16 a[192:193], v14 offset:24576
 ds_read_b64_tr_b16 a[194:195], v14 offset:25600
 ds_read_b64_tr_b16 a[196:197], v15 offset:24576
 ds_read_b64_tr_b16 a[198:199], v15 offset:25600
 ds_read_b64_tr_b16 a[208:209], v14 offset:32768
 ds_read_b64_tr_b16 a[210:211], v14 offset:33792
 ds_read_b64_tr_b16 a[212:213], v15 offset:32768
 ds_read_b64_tr_b16 a[214:215], v15 offset:33792
 ds_read_b64_tr_b16 a[224:225], v14 offset:40960
 ds_read_b64_tr_b16 a[226:227], v14 offset:41984
 ds_read_b64_tr_b16 a[228:229], v15 offset:40960
 ds_read_b64_tr_b16 a[230:231], v15 offset:41984
 ds_read_b64_tr_b16 a[240:241], v14 offset:49152
 ds_read_b64_tr_b16 a[242:243], v14 offset:50176
 ds_read_b64_tr_b16 a[244:245], v15 offset:49152
 ds_read_b64_tr_b16 a[246:247], v15 offset:50176
 ds_read_b64_tr_b16 v[224:225], v14 offset:57344
 ds_read_b64_tr_b16 v[226:227], v14 offset:58368
 ds_read_b64_tr_b16 v[228:229], v15 offset:57344
 ds_read_b64_tr_b16 v[230:231], v15 offset:58368
 ds_read_b64_tr_b16 v[240:241], v20 offset:0
 ds_read_b64_tr_b16 v[242:243], v20 offset:1024
 ds_read_b64_tr_b16 v[244:245], v21 offset:0
 ds_read_b64_tr_b16 v[246:247], v21 offset:1024
 s_waitcnt lgkmcnt(0)
 s_barrier
 s_mul_i32 s33, s14, 18432
 s_add_u32 s33, s33, 73728
 s_mul_i32 s34, s14, 663552
 s_add_u32 s34, s34, s43
 s_add_u32 s34, s34, 2654208
 s_bitcmp1_b32 s14, 0
 s_cselect_b64 vcc, -1, 0
 v_cndmask_b32 v16, v5, v6, vcc
 v_cndmask_b32 v17, v6, v5, vcc
 s_mov_b32 m0, s33
 s_nop 0
 buffer_load_dwordx4 v16, s[16:19], s34 offen lds
 s_add_u32 s33, s33, 1024
 s_add_u32 s34, s34, 36864
 s_mov_b32 m0, s33
 s_nop 0
 buffer_load_dwordx4 v16, s[16:19], s34 offen lds
 s_add_u32 s33, s33, 1024
 s_add_u32 s34, s34, 36864
 s_mov_b32 m0, s33
 s_nop 0
 buffer_load_dwordx4 v17, s[16:19], s34 offen lds
 s_add_u32 s33, s33, 1024
 s_add_u32 s34, s34, 36864
 s_mov_b32 m0, s33
 s_nop 0
 buffer_load_dwordx4 v17, s[16:19], s34 offen lds
 s_add_u32 s33, s33, 1024
 s_add_u32 s34, s34, 36864
 s_mov_b32 m0, s33
 s_nop 0
 buffer_load_dwordx4 v16, s[16:19], s34 offen lds
 s_add_u32 s33, s33, 1024
 s_add_u32 s34, s34, 36864
 s_mov_b32 m0, s33
 s_nop 0
 buffer_load_dwordx4 v16, s[16:19], s34 offen lds
 s_add_u32 s33, s33, 1024
 s_add_u32 s34, s34, 36864
 s_mov_b32 m0, s33
 s_nop 0
 buffer_load_dwordx4 v17, s[16:19], s34 offen lds
 s_add_u32 s33, s33, 1024
 s_add_u32 s34, s34, 36864
 s_mov_b32 m0, s33
 s_nop 0
 buffer_load_dwordx4 v17, s[16:19], s34 offen lds
 s_add_u32 s33, s33, 1024
 s_add_u32 s34, s34, 36864
 s_mov_b32 m0, s33
 s_nop 0
 buffer_load_dwordx4 v16, s[16:19], s34 offen lds
 s_add_u32 s33, s33, 1024
 s_add_u32 s34, s34, 36864
 s_mov_b32 m0, s33
 s_nop 0
 buffer_load_dwordx4 v16, s[16:19], s34 offen lds
 s_add_u32 s33, s33, 1024
 s_add_u32 s34, s34, 36864
 s_mov_b32 m0, s33
 s_nop 0
 buffer_load_dwordx4 v17, s[16:19], s34 offen lds
 s_add_u32 s33, s33, 1024
 s_add_u32 s34, s34, 36864
 s_mov_b32 m0, s33
 s_nop 0
 buffer_load_dwordx4 v17, s[16:19], s34 offen lds
 s_add_u32 s33, s33, 1024
 s_add_u32 s34, s34, 36864
 s_mov_b32 m0, s33
 s_nop 0
 buffer_load_dwordx4 v16, s[16:19], s34 offen lds
 s_add_u32 s33, s33, 1024
 s_add_u32 s34, s34, 36864
 s_mov_b32 m0, s33
 s_nop 0
 buffer_load_dwordx4 v16, s[16:19], s34 offen lds
 s_add_u32 s33, s33, 1024
 s_add_u32 s34, s34, 36864
 s_mov_b32 m0, s33
 s_nop 0
 buffer_load_dwordx4 v17, s[16:19], s34 offen lds
 s_add_u32 s33, s33, 1024
 s_add_u32 s34, s34, 36864
 s_mov_b32 m0, s33
 s_nop 0
 buffer_load_dwordx4 v17, s[16:19], s34 offen lds
 s_add_u32 s33, s33, 1024
 s_add_u32 s34, s34, 36864
 s_mov_b32 m0, s33
 s_nop 0
 buffer_load_dwordx4 v16, s[16:19], s34 offen lds
 s_add_u32 s33, s33, 1024
 s_add_u32 s34, s34, 36864
 s_mov_b32 m0, s33
 s_nop 0
 buffer_load_dwordx4 v16, s[16:19], s34 offen lds
 s_waitcnt vmcnt(18)
 s_barrier
 ds_read_b64_tr_b16 a[8:9], v11 offset:0
 ds_read_b64_tr_b16 a[10:11], v11 offset:1024
 ds_read_b64_tr_b16 a[12:13], v12 offset:0
 ds_read_b64_tr_b16 a[14:15], v12 offset:1024
 ds_read_b64_tr_b16 a[24:25], v11 offset:8192
 ds_read_b64_tr_b16 a[26:27], v11 offset:9216
 ds_read_b64_tr_b16 a[28:29], v12 offset:8192
 ds_read_b64_tr_b16 a[30:31], v12 offset:9216
 ds_read_b64_tr_b16 a[40:41], v11 offset:16384
 ds_read_b64_tr_b16 a[42:43], v11 offset:17408
 ds_read_b64_tr_b16 a[44:45], v12 offset:16384
 ds_read_b64_tr_b16 a[46:47], v12 offset:17408
 ds_read_b64_tr_b16 a[56:57], v11 offset:24576
 ds_read_b64_tr_b16 a[58:59], v11 offset:25600
 ds_read_b64_tr_b16 a[60:61], v12 offset:24576
 ds_read_b64_tr_b16 a[62:63], v12 offset:25600
 ds_read_b64_tr_b16 a[72:73], v11 offset:32768
 ds_read_b64_tr_b16 a[74:75], v11 offset:33792
 ds_read_b64_tr_b16 a[76:77], v12 offset:32768
 ds_read_b64_tr_b16 a[78:79], v12 offset:33792
 ds_read_b64_tr_b16 a[88:89], v11 offset:40960
 ds_read_b64_tr_b16 a[90:91], v11 offset:41984
 ds_read_b64_tr_b16 a[92:93], v12 offset:40960
 ds_read_b64_tr_b16 a[94:95], v12 offset:41984
 ds_read_b64_tr_b16 a[104:105], v11 offset:49152
 ds_read_b64_tr_b16 a[106:107], v11 offset:50176
 ds_read_b64_tr_b16 a[108:109], v12 offset:49152
 ds_read_b64_tr_b16 a[110:111], v12 offset:50176
 ds_read_b64_tr_b16 a[120:121], v11 offset:57344
 ds_read_b64_tr_b16 a[122:123], v11 offset:58368
 ds_read_b64_tr_b16 a[124:125], v12 offset:57344
 ds_read_b64_tr_b16 a[126:127], v12 offset:58368
 ds_read_b64_tr_b16 a[136:137], v18 offset:0
 ds_read_b64_tr_b16 a[138:139], v18 offset:1024
 ds_read_b64_tr_b16 a[140:141], v19 offset:0
 ds_read_b64_tr_b16 a[142:143], v19 offset:1024
 s_waitcnt vmcnt(0)
 s_barrier
 ds_read_b64_tr_b16 a[152:153], v14 offset:0
 ds_read_b64_tr_b16 a[154:155], v14 offset:1024
 ds_read_b64_tr_b16 a[156:157], v15 offset:0
 ds_read_b64_tr_b16 a[158:159], v15 offset:1024
 ds_read_b64_tr_b16 a[168:169], v14 offset:8192
 ds_read_b64_tr_b16 a[170:171], v14 offset:9216
 ds_read_b64_tr_b16 a[172:173], v15 offset:8192
 ds_read_b64_tr_b16 a[174:175], v15 offset:9216
 ds_read_b64_tr_b16 a[184:185], v14 offset:16384
 ds_read_b64_tr_b16 a[186:187], v14 offset:17408
 ds_read_b64_tr_b16 a[188:189], v15 offset:16384
 ds_read_b64_tr_b16 a[190:191], v15 offset:17408
 ds_read_b64_tr_b16 a[200:201], v14 offset:24576
 ds_read_b64_tr_b16 a[202:203], v14 offset:25600
 ds_read_b64_tr_b16 a[204:205], v15 offset:24576
 ds_read_b64_tr_b16 a[206:207], v15 offset:25600
 ds_read_b64_tr_b16 a[216:217], v14 offset:32768
 ds_read_b64_tr_b16 a[218:219], v14 offset:33792
 ds_read_b64_tr_b16 a[220:221], v15 offset:32768
 ds_read_b64_tr_b16 a[222:223], v15 offset:33792
 ds_read_b64_tr_b16 a[232:233], v14 offset:40960
 ds_read_b64_tr_b16 a[234:235], v14 offset:41984
 ds_read_b64_tr_b16 a[236:237], v15 offset:40960
 ds_read_b64_tr_b16 a[238:239], v15 offset:41984
 ds_read_b64_tr_b16 a[248:249], v14 offset:49152
 ds_read_b64_tr_b16 a[250:251], v14 offset:50176
 ds_read_b64_tr_b16 a[252:253], v15 offset:49152
 ds_read_b64_tr_b16 a[254:255], v15 offset:50176
 ds_read_b64_tr_b16 v[232:233], v14 offset:57344
 ds_read_b64_tr_b16 v[234:235], v14 offset:58368
 ds_read_b64_tr_b16 v[236:237], v15 offset:57344
 ds_read_b64_tr_b16 v[238:239], v15 offset:58368
 ds_read_b64_tr_b16 v[248:249], v20 offset:0
 ds_read_b64_tr_b16 v[250:251], v20 offset:1024
 ds_read_b64_tr_b16 v[252:253], v21 offset:0
 ds_read_b64_tr_b16 v[254:255], v21 offset:1024
 s_waitcnt lgkmcnt(0)
 s_barrier
 s_cmp_lg_u32 s14, 0
 s_cbranch_scc1 L_gw17
 v_lshlrev_b32 v3, 2, v1
 v_and_b32 v3, 31, v3
poll18:
 buffer_load_dword v2, v3, s[8:11], 0 offen offset:32 sc1
 s_waitcnt vmcnt(0)
 v_cmp_le_u32 vcc, 32, v2
 s_cmp_eq_u64 vcc, exec
 s_cbranch_scc1 polld19
 s_cmp_eq_u32 s15, 0
 s_cbranch_scc1 polld19
 s_sub_u32 s15, s15, 1
 s_sleep 4
 s_branch poll18
polld19:
L_gw17:
 s_barrier
 v_lshlrev_b32 v2, 4, v1
 s_mov_b32 s44, 0
 s_mov_b32 s45, 0
 s_lshr_b32 s48, s44, 3
 s_lshl_b32 s48, s48, 5
 s_and_b32 s47, s44, 7
 s_add_u32 s48, s48, s47
 s_lshl_b32 s47, s41, 3
 s_add_u32 s48, s48, s47
 s_min_u32 s48, s48, 63
 s_mul_i32 s48, s48, 36864
 s_mul_i32 s49, s14, 9216
 s_add_u32 s48, s48, s49
 s_add_u32 s48, s48, 1048576
 s_add_u32 s49, s49, s45
 s_mov_b32 m0, s49
 s_nop 0
 buffer_load_dwordx4 v2, s[4:7], s48 offen offset:0 lds
 buffer_load_dwordx4 v2, s[4:7], s48 offen offset:1024 lds
 buffer_load_dwordx4 v2, s[4:7], s48 offen offset:2048 lds
 buffer_load_dwordx4 v2, s[4:7], s48 offen offset:3072 lds
 s_add_u32 s49, s49, 4096
 s_add_u32 s48, s48, 4096
 s_mov_b32 m0, s49
 s_nop 0
 buffer_load_dwordx4 v2, s[4:7], s48 offen offset:0 lds
 buffer_load_dwordx4 v2, s[4:7], s48 offen offset:1024 lds
 buffer_load_dwordx4 v2, s[4:7], s48 offen offset:2048 lds
 buffer_load_dwordx4 v2, s[4:7], s48 offen offset:3072 lds
 s_add_u32 s49, s49, 4096
 s_add_u32 s48, s48, 4096
 s_mov_b32 m0, s49
 s_nop 0
 buffer_load_dwordx4 v2, s[4:7], s48 offen offset:0 lds
 s_mov_b32 s44, 1
 s_mov_b32 s45, 36864
 s_lshr_b32 s48, s44, 3
 s_lshl_b32 s48, s48, 5
 s_and_b32 s47, s44, 7
 s_add_u32 s48, s48, s47
 s_lshl_b32 s47, s41, 3
 s_add_u32 s48, s48, s47
 s_min_u32 s48, s48, 63
 s_mul_i32 s48, s48, 36864
 s_mul_i32 s49, s14, 9216
 s_add_u32 s48, s48, s49
 s_add_u32 s48, s48, 1048576
 s_add_u32 s49, s49, s45
 s_mov_b32 m0, s49
 s_nop 0
 buffer_load_dwordx4 v2, s[4:7], s48 offen offset:0 lds
 buffer_load_dwordx4 v2, s[4:7], s48 offen offset:1024 lds
 buffer_load_dwordx4 v2, s[4:7], s48 offen offset:2048 lds
 buffer_load_dwordx4 v2, s[4:7], s48 offen offset:3072 lds
 s_add_u32 s49, s49, 4096
 s_add_u32 s48, s48, 4096
 s_mov_b32 m0, s49
 s_nop 0
 buffer_load_dwordx4 v2, s[4:7], s48 offen offset:0 lds
 buffer_load_dwordx4 v2, s[4:7], s48 offen offset:1024 lds
 buffer_load_dwordx4 v2, s[4:7], s48 offen offset:2048 lds
 buffer_load_dwordx4 v2, s[4:7], s48 offen offset:3072 lds
 s_add_u32 s49, s49, 4096
 s_add_u32 s48, s48, 4096
 s_mov_b32 m0, s49
 s_nop 0
 buffer_load_dwordx4 v2, s[4:7], s48 offen offset:0 lds
 s_mov_b32 s44, 0
 s_mov_b32 s45, 0
 s_waitcnt vmcnt(9)
L_ws20:
 s_waitcnt vmcnt(13)
 s_barrier
 s_cmp_lg_u32 s14, 0
 s_cbranch_scc1 L_wsf21
 s_cmp_lt_u32 s44, 2
 s_cbranch_scc1 L_wsf21
 s_sub_u32 s47, s44, 1
 s_lshl_b32 s48, s41, 7
 s_lshl_b32 s49, s40, 2
 s_add_u32 s48, s48, s49
 s_add_u32 s48, s48, 512
 v_mov_b32 v4, s47
 v_mov_b32 v5, 0
 s_mov_b64 exec, 1
 buffer_store_dword v4, v5, s[4:7], s48 offen sc1
 s_mov_b64 exec, -1
L_wsf21:
 s_add_u32 s50, s44, 2
 s_add_u32 s51, s45, 73728
 s_cmp_ge_u32 s51, 110592
 s_cselect_b32 s47, 110592, 0
 s_sub_u32 s51, s51, s47
 s_lshr_b32 s48, s50, 3
 s_lshl_b32 s48, s48, 5
 s_and_b32 s47, s50, 7
 s_add_u32 s48, s48, s47
 s_lshl_b32 s47, s41, 3
 s_add_u32 s48, s48, s47
 s_min_u32 s48, s48, 63
 s_mul_i32 s48, s48, 36864
 s_mul_i32 s49, s14, 9216
 s_add_u32 s48, s48, s49
 s_add_u32 s48, s48, 1048576
 s_add_u32 s49, s49, s51
 s_mov_b32 m0, s49
 s_nop 0
 buffer_load_dwordx4 v2, s[4:7], s48 offen offset:0 lds
 buffer_load_dwordx4 v2, s[4:7], s48 offen offset:1024 lds
 buffer_load_dwordx4 v2, s[4:7], s48 offen offset:2048 lds
 buffer_load_dwordx4 v2, s[4:7], s48 offen offset:3072 lds
 s_add_u32 s49, s49, 4096
 s_add_u32 s48, s48, 4096
 s_mov_b32 m0, s49
 s_nop 0
 buffer_load_dwordx4 v2, s[4:7], s48 offen offset:0 lds
 buffer_load_dwordx4 v2, s[4:7], s48 offen offset:1024 lds
 buffer_load_dwordx4 v2, s[4:7], s48 offen offset:2048 lds
 buffer_load_dwordx4 v2, s[4:7], s48 offen offset:3072 lds
 s_add_u32 s49, s49, 4096
 s_add_u32 s48, s48, 4096
 s_mov_b32 m0, s49
 s_nop 0
 buffer_load_dwordx4 v2, s[4:7], s48 offen offset:0 lds
 v_add_u32 v3, s45, v2
 ds_read_b128 v[96:99], v3 offset:0
 ds_read_b128 v[100:103], v3 offset:18432
 ds_read_b128 v[104:107], v3 offset:1024
 ds_read_b128 v[108:111], v3 offset:19456
 ds_read_b128 v[112:115], v3 offset:2048
 ds_read_b128 v[116:119], v3 offset:20480
 s_waitcnt lgkmcnt(5)
 v_mfma_f32_16x16x32_bf16 v[128:131], a[0:3], v[96:99], 0
 s_waitcnt lgkmcnt(4)
 v_mfma_f32_16x16x32_bf16 v[132:135], a[0:3], v[100:103], 0
 v_mfma_f32_16x16x32_bf16 v[136:139], a[4:7], v[96:99], 0
 v_mfma_f32_16x16x32_bf16 v[140:143], a[4:7], v[100:103], 0
 ds_read_b128 v[120:123], v3 offset:3072
 ds_read_b128 v[124:127], v3 offset:21504
 v_mfma_f32_16x16x32_bf16 v[144:147], a[8:11], v[96:99], 0
 v_mfma_f32_16x16x32_bf16 v[148:151], a[8:11], v[100:103], 0
 v_mfma_f32_16x16x32_bf16 v[152:155], a[12:15], v[96:99], 0
 v_mfma_f32_16x16x32_bf16 v[156:159], a[12:15], v[100:103], 0
 s_waitcnt lgkmcnt(5)
 v_mfma_f32_16x16x32_bf16 v[128:131], a[16:19], v[104:107], v[128:131]
 s_waitcnt lgkmcnt(4)
 v_mfma_f32_16x16x32_bf16 v[132:135], a[16:19], v[108:111], v[132:135]
 v_mfma_f32_16x16x32_bf16 v[136:139], a[20:23], v[104:107], v[136:139]
 v_mfma_f32_16x16x32_bf16 v[140:143], a[20:23], v[108:111], v[140:143]
 ds_read_b128 v[96:99], v3 offset:4096
 ds_read_b128 v[100:103], v3 offset:22528
 v_mfma_f32_16x16x32_bf16 v[144:147], a[24:27], v[104:107], v[144:147]
 v_mfma_f32_16x16x32_bf16 v[148:151], a[24:27], v[108:111], v[148:151]
 v_mfma_f32_16x16x32_bf16 v[152:155], a[28:31], v[104:107], v[152:155]
 v_mfma_f32_16x16x32_bf16 v[156:159], a[28:31], v[108:111], v[156:159]
 s_waitcnt lgkmcnt(5)
 v_mfma_f32_16x16x32_bf16 v[128:131], a[32:35], v[112:115], v[128:131]
 s_waitcnt lgkmcnt(4)
 v_mfma_f32_16x16x32_bf16 v[132:135], a[32:35], v[116:119], v[132:135]
 v_mfma_f32_16x16x32_bf16 v[136:139], a[36:39], v[112:115], v[136:139]
 v_mfma_f32_16x16x32_bf16 v[140:143], a[36:39], v[116:119], v[140:143]
 ds_read_b128 v[104:107], v3 offset:5120
 ds_read_b128 v[108:111], v3 offset:23552
 v_mfma_f32_16x16x32_bf16 v[144:147], a[40:43], v[112:115], v[144:147]
 v_mfma_f32_16x16x32_bf16 v[148:151], a[40:43], v[116:119], v[148:151]
 v_mfma_f32_16x16x32_bf16 v[152:155], a[44:47], v[112:115], v[152:155]
 v_mfma_f32_16x16x32_bf16 v[156:159], a[44:47], v[116:119], v[156:159]
 s_waitcnt lgkmcnt(5)
 v_mfma_f32_16x16x32_bf16 v[128:131], a[48:51], v[120:123], v[128:131]
 s_waitcnt lgkmcnt(4)
 v_mfma_f32_16x16x32_bf16 v[132:135], a[48:51], v[124:127], v[132:135]
 v_mfma_f32_16x16x32_bf16 v[136:139], a[52:55], v[120:123], v[136:139]
 v_mfma_f32_16x16x32_bf16 v[140:143], a[52:55], v[124:127], v[140:143]
 ds_read_b128 v[112:115], v3 offset:6144
 ds_read_b128 v[116:119], v3 offset:24576
 v_mfma_f32_16x16x32_bf16 v[144:147], a[56:59], v[120:123], v[144:147]
 v_mfma_f32_16x16x32_bf16 v[148:151], a[56:59], v[124:127], v[148:151]
 v_mfma_f32_16x16x32_bf16 v[152:155], a[60:63], v[120:123], v[152:155]
 v_mfma_f32_16x16x32_bf16 v[156:159], a[60:63], v[124:127], v[156:159]
 s_waitcnt lgkmcnt(5)
 v_mfma_f32_16x16x32_bf16 v[128:131], a[64:67], v[96:99], v[128:131]
 s_waitcnt lgkmcnt(4)
 v_mfma_f32_16x16x32_bf16 v[132:135], a[64:67], v[100:103], v[132:135]
 v_mfma_f32_16x16x32_bf16 v[136:139], a[68:71], v[96:99], v[136:139]
 v_mfma_f32_16x16x32_bf16 v[140:143], a[68:71], v[100:103], v[140:143]
 ds_read_b128 v[120:123], v3 offset:7168
 ds_read_b128 v[124:127], v3 offset:25600
 v_mfma_f32_16x16x32_bf16 v[144:147], a[72:75], v[96:99], v[144:147]
 v_mfma_f32_16x16x32_bf16 v[148:151], a[72:75], v[100:103], v[148:151]
 v_mfma_f32_16x16x32_bf16 v[152:155], a[76:79], v[96:99], v[152:155]
 v_mfma_f32_16x16x32_bf16 v[156:159], a[76:79], v[100:103], v[156:159]
 s_waitcnt lgkmcnt(5)
 v_mfma_f32_16x16x32_bf16 v[128:131], a[80:83], v[104:107], v[128:131]
 s_waitcnt lgkmcnt(4)
 v_mfma_f32_16x16x32_bf16 v[132:135], a[80:83], v[108:111], v[132:135]
 v_mfma_f32_16x16x32_bf16 v[136:139], a[84:87], v[104:107], v[136:139]
 v_mfma_f32_16x16x32_bf16 v[140:143], a[84:87], v[108:111], v[140:143]
 ds_read_b128 v[96:99], v3 offset:8192
 ds_read_b128 v[100:103], v3 offset:26624
 v_mfma_f32_16x16x32_bf16 v[144:147], a[88:91], v[104:107], v[144:147]
 v_mfma_f32_16x16x32_bf16 v[148:151], a[88:91], v[108:111], v[148:151]
 v_mfma_f32_16x16x32_bf16 v[152:155], a[92:95], v[104:107], v[152:155]
 v_mfma_f32_16x16x32_bf16 v[156:159], a[92:95], v[108:111], v[156:159]
 s_waitcnt lgkmcnt(5)
 v_mfma_f32_16x16x32_bf16 v[128:131], a[96:99], v[112:115], v[128:131]
 s_waitcnt lgkmcnt(4)
 v_mfma_f32_16x16x32_bf16 v[132:135], a[96:99], v[116:119], v[132:135]
 v_mfma_f32_16x16x32_bf16 v[136:139], a[100:103], v[112:115], v[136:139]
 v_mfma_f32_16x16x32_bf16 v[140:143], a[100:103], v[116:119], v[140:143]
 ds_read_b128 v[104:107], v3 offset:9216
 ds_read_b128 v[108:111], v3 offset:27648
 v_mfma_f32_16x16x32_bf16 v[144:147], a[104:107], v[112:115], v[144:147]
 v_mfma_f32_16x16x32_bf16 v[148:151], a[104:107], v[116:119], v[148:151]
 v_mfma_f32_16x16x32_bf16 v[152:155], a[108:111], v[112:115], v[152:155]
 v_mfma_f32_16x16x32_bf16 v[156:159], a[108:111], v[116:119], v[156:159]
 s_waitcnt lgkmcnt(5)
 v_mfma_f32_16x16x32_bf16 v[128:131], a[112:115], v[120:123], v[128:131]
 s_waitcnt lgkmcnt(4)
 v_mfma_f32_16x16x32_bf16 v[132:135], a[112:115], v[124:127], v[132:135]
 v_mfma_f32_16x16x32_bf16 v[136:139], a[116:119], v[120:123], v[136:139]
 v_mfma_f32_16x16x32_bf16 v[140:143], a[116:119], v[124:127], v[140:143]
 ds_read_b128 v[112:115], v3 offset:10240
 ds_read_b128 v[116:119], v3 offset:28672
 v_mfma_f32_16x16x32_bf16 v[144:147], a[120:123], v[120:123], v[144:147]
 v_mfma_f32_16x16x32_bf16 v[148:151], a[120:123], v[124:127], v[148:151]
 v_mfma_f32_16x16x32_bf16 v[152:155], a[124:127], v[120:123], v[152:155]
 v_mfma_f32_16x16x32_bf16 v[156:159], a[124:127], v[124:127], v[156:159]
 s_waitcnt lgkmcnt(5)
 v_mfma_f32_16x16x32_bf16 v[128:131], a[128:131], v[96:99], v[128:131]
 s_waitcnt lgkmcnt(4)
 v_mfma_f32_16x16x32_bf16 v[132:135], a[128:131], v[100:103], v[132:135]
 v_mfma_f32_16x16x32_bf16 v[136:139], a[132:135], v[96:99], v[136:139]
 v_mfma_f32_16x16x32_bf16 v[140:143], a[132:135], v[100:103], v[140:143]
 ds_read_b128 v[120:123], v3 offset:11264
 ds_read_b128 v[124:127], v3 offset:29696
 v_mfma_f32_16x16x32_bf16 v[144:147], a[136:139], v[96:99], v[144:147]
 v_mfma_f32_16x16x32_bf16 v[148:151], a[136:139], v[100:103], v[148:151]
 v_mfma_f32_16x16x32_bf16 v[152:155], a[140:143], v[96:99], v[152:155]
 v_mfma_f32_16x16x32_bf16 v[156:159], a[140:143], v[100:103], v[156:159]
 s_waitcnt lgkmcnt(5)
 v_mfma_f32_16x16x32_bf16 v[128:131], a[144:147], v[104:107], v[128:131]
 s_waitcnt lgkmcnt(4)
 v_mfma_f32_16x16x32_bf16 v[132:135], a[144:147], v[108:111], v[132:135]
 v_mfma_f32_16x16x32_bf16 v[136:139], a[148:151], v[104:107], v[136:139]
 v_mfma_f32_16x16x32_bf16 v[140:143], a[148:151], v[108:111], v[140:143]
 ds_read_b128 v[96:99], v3 offset:12288
 ds_read_b128 v[100:103], v3 offset:30720
 v_mfma_f32_16x16x32_bf16 v[144:147], a[152:155], v[104:107], v[144:147]
 v_mfma_f32_16x16x32_bf16 v[148:151], a[152:155], v[108:111], v[148:151]
 v_mfma_f32_16x16x32_bf16 v[152:155], a[156:159], v[104:107], v[152:155]
 v_mfma_f32_16x16x32_bf16 v[156:159], a[156:159], v[108:111], v[156:159]
 s_waitcnt lgkmcnt(5)
 v_mfma_f32_16x16x32_bf16 v[128:131], a[160:163], v[112:115], v[128:131]
 s_waitcnt lgkmcnt(4)
 v_mfma_f32_16x16x32_bf16 v[132:135], a[160:163], v[116:119], v[132:135]
 v_mfma_f32_16x16x32_bf16 v[136:139], a[164:167], v[112:115], v[136:139]
 v_mfma_f32_16x16x32_bf16 v[140:143], a[164:167], v[116:119], v[140:143]
 ds_read_b128 v[104:107], v3 offset:13312
 ds_read_b128 v[108:111], v3 offset:31744
 v_mfma_f32_16x16x32_bf16 v[144:147], a[168:171], v[112:115], v[144:147]
 v_mfma_f32_16x16x32_bf16 v[148:151], a[168:171], v[116:119], v[148:151]
 v_mfma_f32_16x16x32_bf16 v[152:155], a[172:175], v[112:115], v[152:155]
 v_mfma_f32_16x16x32_bf16 v[156:159], a[172:175], v[116:119], v[156:159]
 s_waitcnt lgkmcnt(5)
 v_mfma_f32_16x16x32_bf16 v[128:131], a[176:179], v[120:123], v[128:131]
 s_waitcnt lgkmcnt(4)
 v_mfma_f32_16x16x32_bf16 v[132:135], a[176:179], v[124:127], v[132:135]
 v_mfma_f32_16x16x32_bf16 v[136:139], a[180:183], v[120:123], v[136:139]
 v_mfma_f32_16x16x32_bf16 v[140:143], a[180:183], v[124:127], v[140:143]
 ds_read_b128 v[112:115], v3 offset:14336
 ds_read_b128 v[116:119], v3 offset:32768
 v_mfma_f32_16x16x32_bf16 v[144:147], a[184:187], v[120:123], v[144:147]
 v_mfma_f32_16x16x32_bf16 v[148:151], a[184:187], v[124:127], v[148:151]
 v_mfma_f32_16x16x32_bf16 v[152:155], a[188:191], v[120:123], v[152:155]
 v_mfma_f32_16x16x32_bf16 v[156:159], a[188:191], v[124:127], v[156:159]
 s_waitcnt lgkmcnt(5)
 v_mfma_f32_16x16x32_bf16 v[128:131], a[192:195], v[96:99], v[128:131]
 s_waitcnt lgkmcnt(4)
 v_mfma_f32_16x16x32_bf16 v[132:135], a[192:195], v[100:103], v[132:135]
 v_mfma_f32_16x16x32_bf16 v[136:139], a[196:199], v[96:99], v[136:139]
 v_mfma_f32_16x16x32_bf16 v[140:143], a[196:199], v[100:103], v[140:143]
 ds_read_b128 v[120:123], v3 offset:15360
 ds_read_b128 v[124:127], v3 offset:33792
 v_mfma_f32_16x16x32_bf16 v[144:147], a[200:203], v[96:99], v[144:147]
 v_mfma_f32_16x16x32_bf16 v[148:151], a[200:203], v[100:103], v[148:151]
 v_mfma_f32_16x16x32_bf16 v[152:155], a[204:207], v[96:99], v[152:155]
 v_mfma_f32_16x16x32_bf16 v[156:159], a[204:207], v[100:103], v[156:159]
 s_waitcnt lgkmcnt(5)
 v_mfma_f32_16x16x32_bf16 v[128:131], a[208:211], v[104:107], v[128:131]
 s_waitcnt lgkmcnt(4)
 v_mfma_f32_16x16x32_bf16 v[132:135], a[208:211], v[108:111], v[132:135]
 v_mfma_f32_16x16x32_bf16 v[136:139], a[212:215], v[104:107], v[136:139]
 v_mfma_f32_16x16x32_bf16 v[140:143], a[212:215], v[108:111], v[140:143]
 ds_read_b128 v[96:99], v3 offset:16384
 ds_read_b128 v[100:103], v3 offset:34816
 v_mfma_f32_16x16x32_bf16 v[144:147], a[216:219], v[104:107], v[144:147]
 v_mfma_f32_16x16x32_bf16 v[148:151], a[216:219], v[108:111], v[148:151]
 v_mfma_f32_16x16x32_bf16 v[152:155], a[220:223], v[104:107], v[152:155]
 v_mfma_f32_16x16x32_bf16 v[156:159], a[220:223], v[108:111], v[156:159]
 s_waitcnt lgkmcnt(5)
 v_mfma_f32_16x16x32_bf16 v[128:131], a[224:227], v[112:115], v[128:131]
 s_waitcnt lgkmcnt(4)
 v_mfma_f32_16x16x32_bf16 v[132:135], a[224:227], v[116:119], v[132:135]
 v_mfma_f32_16x16x32_bf16 v[136:139], a[228:231], v[112:115], v[136:139]
 v_mfma_f32_16x16x32_bf16 v[140:143], a[228:231], v[116:119], v[140:143]
 ds_read_b128 v[104:107], v3 offset:17408
 ds_read_b128 v[108:111], v3 offset:35840
 v_mfma_f32_16x16x32_bf16 v[144:147], a[232:235], v[112:115], v[144:147]
 v_mfma_f32_16x16x32_bf16 v[148:151], a[232:235], v[116:119], v[148:151]
 v_mfma_f32_16x16x32_bf16 v[152:155], a[236:239], v[112:115], v[152:155]
 v_mfma_f32_16x16x32_bf16 v[156:159], a[236:239], v[116:119], v[156:159]
 s_waitcnt lgkmcnt(5)
 v_mfma_f32_16x16x32_bf16 v[128:131], a[240:243], v[120:123], v[128:131]
 s_waitcnt lgkmcnt(4)
 v_mfma_f32_16x16x32_bf16 v[132:135], a[240:243], v[124:127], v[132:135]
 v_mfma_f32_16x16x32_bf16 v[136:139], a[244:247], v[120:123], v[136:139]
 v_mfma_f32_16x16x32_bf16 v[140:143], a[244:247], v[124:127], v[140:143]
 v_mfma_f32_16x16x32_bf16 v[144:147], a[248:251], v[120:123], v[144:147]
 v_mfma_f32_16x16x32_bf16 v[148:151], a[248:251], v[124:127], v[148:151]
 v_mfma_f32_16x16x32_bf16 v[152:155], a[252:255], v[120:123], v[152:155]
 v_mfma_f32_16x16x32_bf16 v[156:159], a[252:255], v[124:127], v[156:159]
 s_waitcnt lgkmcnt(3)
 v_mfma_f32_16x16x32_bf16 v[128:131], v[224:227], v[96:99], v[128:131]
 s_waitcnt lgkmcnt(2)
 v_mfma_f32_16x16x32_bf16 v[132:135], v[224:227], v[100:103], v[132:135]
 v_mfma_f32_16x16x32_bf16 v[136:139], v[228:231], v[96:99], v[136:139]
 v_mfma_f32_16x16x32_bf16 v[140:143], v[228:231], v[100:103], v[140:143]
 v_mfma_f32_16x16x32_bf16 v[144:147], v[232:235], v[96:99], v[144:147]
 v_mfma_f32_16x16x32_bf16 v[148:151], v[232:235], v[100:103], v[148:151]
 v_mfma_f32_16x16x32_bf16 v[152:155], v[236:239], v[96:99], v[152:155]
 v_mfma_f32_16x16x32_bf16 v[156:159], v[236:239], v[100:103], v[156:159]
 s_waitcnt lgkmcnt(1)
 v_mfma_f32_16x16x32_bf16 v[128:131], v[240:243], v[104:107], v[128:131]
 s_waitcnt lgkmcnt(0)
 v_mfma_f32_16x16x32_bf16 v[132:135], v[240:243], v[108:111], v[132:135]
 v_mfma_f32_16x16x32_bf16 v[136:139], v[244:247], v[104:107], v[136:139]
 v_mfma_f32_16x16x32_bf16 v[140:143], v[244:247], v[108:111], v[140:143]
 v_mfma_f32_16x16x32_bf16 v[144:147], v[248:251], v[104:107], v[144:147]
 v_mfma_f32_16x16x32_bf16 v[148:151], v[248:251], v[108:111], v[148:151]
 v_mfma_f32_16x16x32_bf16 v[152:155], v[252:255], v[104:107], v[152:155]
 v_mfma_f32_16x16x32_bf16 v[156:159], v[252:255], v[108:111], v[156:159]
 s_lshr_b32 s46, s44, 3
 s_lshl_b32 s46, s46, 5
 s_and_b32 s47, s44, 7
 s_add_u32 s46, s46, s47
 s_lshl_b32 s47, s41, 3
 s_add_u32 s46, s46, s47
 v_max_f32 v128, 0, v128
 v_max_f32 v129, 0, v129
 v_max_f32 v130, 0, v130
 v_max_f32 v131, 0, v131
 v_max_f32 v136, 0, v136
 v_max_f32 v137, 0, v137
 v_max_f32 v138, 0, v138
 v_max_f32 v139, 0, v139
 v_cvt_pk_bf16_f32 v80, v128, v129
 v_cvt_pk_bf16_f32 v81, v130, v131
 v_cvt_pk_bf16_f32 v82, v136, v137
 v_cvt_pk_bf16_f32 v83, v138, v139
 v_max_f32 v132, 0, v132
 v_max_f32 v133, 0, v133
 v_max_f32 v134, 0, v134
 v_max_f32 v135, 0, v135
 v_max_f32 v140, 0, v140
 v_max_f32 v141, 0, v141
 v_max_f32 v142, 0, v142
 v_max_f32 v143, 0, v143
 v_cvt_pk_bf16_f32 v84, v132, v133
 v_cvt_pk_bf16_f32 v85, v134, v135
 v_cvt_pk_bf16_f32 v86, v140, v141
 v_cvt_pk_bf16_f32 v87, v142, v143
 v_max_f32 v144, 0, v144
 v_max_f32 v145, 0, v145
 v_max_f32 v146, 0, v146
 v_max_f32 v147, 0, v147
 v_max_f32 v152, 0, v152
 v_max_f32 v153, 0, v153
 v_max_f32 v154, 0, v154
 v_max_f32 v155, 0, v155
 v_cvt_pk_bf16_f32 v88, v144, v145
 v_cvt_pk_bf16_f32 v89, v146, v147
 v_cvt_pk_bf16_f32 v90, v152, v153
 v_cvt_pk_bf16_f32 v91, v154, v155
 v_max_f32 v148, 0, v148
 v_max_f32 v149, 0, v149
 v_max_f32 v150, 0, v150
 v_max_f32 v151, 0, v151
 v_max_f32 v156, 0, v156
 v_max_f32 v157, 0, v157
 v_max_f32 v158, 0, v158
 v_max_f32 v159, 0, v159
 v_cvt_pk_bf16_f32 v92, v148, v149
 v_cvt_pk_bf16_f32 v93, v150, v151
 v_cvt_pk_bf16_f32 v94, v156, v157
 v_cvt_pk_bf16_f32 v95, v158, v159
 s_mul_i32 s47, s46, 288
 s_lshl_b32 s48, s40, 3
 s_add_u32 s47, s47, s48
 s_add_u32 s47, s47, s14
 s_lshl_b32 s47, s47, 10
 s_add_u32 s47, s47, 54525952
 s_add_u32 s48, s47, 0
 buffer_store_dwordx4 v[80:83], v2, s[4:7], s48 offen sc1
 s_add_u32 s48, s47, 147456
 buffer_store_dwordx4 v[84:87], v2, s[4:7], s48 offen sc1
 s_add_u32 s48, s47, 4096
 buffer_store_dwordx4 v[88:91], v2, s[4:7], s48 offen sc1
 s_add_u32 s48, s47, 151552
 buffer_store_dwordx4 v[92:95], v2, s[4:7], s48 offen sc1
 s_add_u32 s45, s45, 36864
 s_cmp_ge_u32 s45, 110592
 s_cselect_b32 s45, 0, s45
 s_add_u32 s44, s44, 1
 s_cmp_lt_u32 s44, 16
 s_cbranch_scc1 L_ws20
 s_waitcnt vmcnt(0)
 s_barrier
 s_cmp_lg_u32 s14, 0
 s_cbranch_scc1 L_wsf22
 s_mov_b32 s47, 16
 s_lshl_b32 s48, s41, 7
 s_lshl_b32 s49, s40, 2
 s_add_u32 s48, s48, s49
 s_add_u32 s48, s48, 512
 v_mov_b32 v4, s47
 v_mov_b32 v5, 0
 s_mov_b64 exec, 1
 buffer_store_dword v4, v5, s[4:7], s48 offen sc1
 s_mov_b64 exec, -1
L_wsf22:
 s_cmp_ge_u32 s52, 64
 s_cbranch_scc1 L_f2x23
 s_load_dwordx2 s[16:17], s[0:1], 72
 s_mov_b32 s18, 0x510000
 s_mov_b32 s19, 0x20000
 s_and_b32 s53, s52, 3
 s_bfe_u32 s54, s52, 0x10002
 s_lshr_b32 s55, s52, 3
 v_lshlrev_b32 v2, 4, v1
 s_mul_i32 s33, s14, 576
 s_add_u32 s33, s33, 0
 v_add_u32 v13, s33, v1
 v_mul_u32_u24 v14, 3641, v13
 v_lshrrev_b32 v14, 16, v14
 v_mul_u32_u24 v15, 18, v14
 v_sub_u32 v15, v13, v15
 v_mul_u32_u24 v14, 1152, v14
 v_lshl_add_u32 v4, v15, 4, v14
 s_mul_i32 s33, s14, 576
 s_add_u32 s33, s33, 64
 v_add_u32 v13, s33, v1
 v_mul_u32_u24 v14, 3641, v13
 v_lshrrev_b32 v14, 16, v14
 v_mul_u32_u24 v15, 18, v14
 v_sub_u32 v15, v13, v15
 v_mul_u32_u24 v14, 1152, v14
 v_lshl_add_u32 v5, v15, 4, v14
 s_mul_i32 s33, s14, 576
 s_add_u32 s33, s33, 128
 v_add_u32 v13, s33, v1
 v_mul_u32_u24 v14, 3641, v13
 v_lshrrev_b32 v14, 16, v14
 v_mul_u32_u24 v15, 18, v14
 v_sub_u32 v15, v13, v15
 v_mul_u32_u24 v14, 1152, v14
 v_lshl_add_u32 v6, v15, 4, v14
 s_mul_i32 s33, s14, 576
 s_add_u32 s33, s33, 192
 v_add_u32 v13, s33, v1
 v_mul_u32_u24 v14, 3641, v13
 v_lshrrev_b32 v14, 16, v14
 v_mul_u32_u24 v15, 18, v14
 v_sub_u32 v15, v13, v15
 v_mul_u32_u24 v14, 1152, v14
 v_lshl_add_u32 v7, v15, 4, v14
 s_mul_i32 s33, s14, 576
 s_add_u32 s33, s33, 256
 v_add_u32 v13, s33, v1
 v_mul_u32_u24 v14, 3641, v13
 v_lshrrev_b32 v14, 16, v14
 v_mul_u32_u24 v15, 18, v14
 v_sub_u32 v15, v13, v15
 v_mul_u32_u24 v14, 1152, v14
 v_lshl_add_u32 v8, v15, 4, v14
 s_mul_i32 s33, s14, 576
 s_add_u32 s33, s33, 320
 v_add_u32 v13, s33, v1
 v_mul_u32_u24 v14, 3641, v13
 v_lshrrev_b32 v14, 16, v14
 v_mul_u32_u24 v15, 18, v14
 v_sub_u32 v15, v13, v15
 v_mul_u32_u24 v14, 1152, v14
 v_lshl_add_u32 v9, v15, 4, v14
 s_mul_i32 s33, s14, 576
 s_add_u32 s33, s33, 384
 v_add_u32 v13, s33, v1
 v_mul_u32_u24 v14, 3641, v13
 v_lshrrev_b32 v14, 16, v14
 v_mul_u32_u24 v15, 18, v14
 v_sub_u32 v15, v13, v15
 v_mul_u32_u24 v14, 1152, v14
 v_lshl_add_u32 v10, v15, 4, v14
 s_mul_i32 s33, s14, 576
 s_add_u32 s33, s33, 448
 v_add_u32 v13, s33, v1
 v_mul_u32_u24 v14, 3641, v13
 v_lshrrev_b32 v14, 16, v14
 v_mul_u32_u24 v15, 18, v14
 v_sub_u32 v15, v13, v15
 v_mul_u32_u24 v14, 1152, v14
 v_lshl_add_u32 v11, v15, 4, v14
 s_mul_i32 s33, s14, 576
 s_add_u32 s33, s33, 512
 v_add_u32 v13, s33, v1
 v_mul_u32_u24 v14, 3641, v13
 v_lshrrev_b32 v14, 16, v14
 v_mul_u32_u24 v15, 18, v14
 v_sub_u32 v15, v13, v15
 v_mul_u32_u24 v14, 1152, v14
 v_lshl_add_u32 v12, v15, 4, v14
 v_lshrrev_b32 v13, 4, v1
 v_bfe_u32 v14, v1, 2, 2
 v_lshl_add_u32 v13, v13, 2, v14
 v_mul_u32_u24 v13, 288, v13
 v_and_b32 v14, 3, v1
 v_lshl_add_u32 v13, v14, 3, v13
 s_waitcnt lgkmcnt(0)
 s_and_b32 s17, s17, 0xffff
 s_mul_i32 s56, s54, 2654208
 s_mul_i32 s33, s53, 288
 s_add_u32 s56, s56, s33
 s_mov_b32 s59, 0
 s_mul_i32 s33, s14, 9216
 s_add_u32 s33, s33, s59
 s_mov_b32 m0, s33
 s_nop 0
 buffer_load_dwordx4 v4, s[16:19], s56 offen lds
 s_add_u32 s33, s33, 1024
 s_mov_b32 m0, s33
 s_nop 0
 buffer_load_dwordx4 v5, s[16:19], s56 offen lds
 s_add_u32 s33, s33, 1024
 s_mov_b32 m0, s33
 s_nop 0
 buffer_load_dwordx4 v6, s[16:19], s56 offen lds
 s_add_u32 s33, s33, 1024
 s_mov_b32 m0, s33
 s_nop 0
 buffer_load_dwordx4 v7, s[16:19], s56 offen lds
 s_add_u32 s33, s33, 1024
 s_mov_b32 m0, s33
 s_nop 0
 buffer_load_dwordx4 v8, s[16:19], s56 offen lds
 s_add_u32 s33, s33, 1024
 s_mov_b32 m0, s33
 s_nop 0
 buffer_load_dwordx4 v9, s[16:19], s56 offen lds
 s_add_u32 s33, s33, 1024
 s_mov_b32 m0, s33
 s_nop 0
 buffer_load_dwordx4 v10, s[16:19], s56 offen lds
 s_add_u32 s33, s33, 1024
 s_mov_b32 m0, s33
 s_nop 0
 buffer_load_dwordx4 v11, s[16:19], s56 offen lds
 s_add_u32 s33, s33, 1024
 s_mov_b32 m0, s33
 s_nop 0
 buffer_load_dwordx4 v12, s[16:19], s56 offen lds
 s_add_u32 s56, s56, 147456
 s_mov_b32 s59, 36864
 s_mul_i32 s33, s14, 9216
 s_add_u32 s33, s33, s59
 s_mov_b32 m0, s33
 s_nop 0
 buffer_load_dwordx4 v4, s[16:19], s56 offen lds
 s_add_u32 s33, s33, 1024
 s_mov_b32 m0, s33
 s_nop 0
 buffer_load_dwordx4 v5, s[16:19], s56 offen lds
 s_add_u32 s33, s33, 1024
 s_mov_b32 m0, s33
 s_nop 0
 buffer_load_dwordx4 v6, s[16:19], s56 offen lds
 s_add_u32 s33, s33, 1024
 s_mov_b32 m0, s33
 s_nop 0
 buffer_load_dwordx4 v7, s[16:19], s56 offen lds
 s_add_u32 s33, s33, 1024
 s_mov_b32 m0, s33
 s_nop 0
 buffer_load_dwordx4 v8, s[16:19], s56 offen lds
 s_add_u32 s33, s33, 1024
 s_mov_b32 m0, s33
 s_nop 0
 buffer_load_dwordx4 v9, s[16:19], s56 offen lds
 s_add_u32 s33, s33, 1024
 s_mov_b32 m0, s33
 s_nop 0
 buffer_load_dwordx4 v10, s[16:19], s56 offen lds
 s_add_u32 s33, s33, 1024
 s_mov_b32 m0, s33
 s_nop 0
 buffer_load_dwordx4 v11, s[16:19], s56 offen lds
 s_add_u32 s33, s33, 1024
 s_mov_b32 m0, s33
 s_nop 0
 buffer_load_dwordx4 v12, s[16:19], s56 offen lds
 s_add_u32 s56, s56, 147456
 s_cmp_lg_u32 s14, 0
 s_cbranch_scc1 L_f2w24
 s_and_b32 s33, s55, 3
 s_lshl_b32 s33, s33, 7
 s_mul_i32 s34, s54, 36
 s_add_u32 s33, s33, s34
 s_add_u32 s33, s33, 512
 s_lshr_b32 s34, s55, 2
 s_add_u32 s34, s34, 1
 s_lshl_b32 s34, s34, 3
 v_lshlrev_b32 v15, 2, v1
 s_mov_b64 exec, 0x1ff
poll25:
 buffer_load_dword v14, v15, s[4:7], s33 offen sc1
 s_waitcnt vmcnt(0)
 v_cmp_le_u32 vcc, s34, v14
 s_cmp_eq_u64 vcc, exec
 s_cbranch_scc1 polld26
 s_cmp_eq_u32 s15, 0
 s_cbranch_scc1 polld26
 s_sub_u32 s15, s15, 1
 s_branch poll25
polld26:
 s_mov_b64 exec, -1
L_f2w24:
 s_barrier
 s_lshl_b32 s33, s55, 4
 s_lshl_b32 s34, s14, 2
 s_add_u32 s33, s33, s34
 s_mul_i32 s33, s33, 144
 s_mul_i32 s34, s54, 72
 s_add_u32 s33, s33, s34
 s_lshl_b32 s33, s33, 10
 s_add_u32 s60, s33, 54525952
 s_add_u32 s61, s60, 147456
 s_add_u32 s62, s60, 294912
 s_add_u32 s63, s60, 442368
 buffer_load_dwordx4 v[16:19], v2, s[4:7], s60 offen offset:0 sc1
 buffer_load_dwordx4 v[20:23], v2, s[4:7], s61 offen offset:0 sc1
 buffer_load_dwordx4 v[24:27], v2, s[4:7], s62 offen offset:0 sc1
 buffer_load_dwordx4 v[28:31], v2, s[4:7], s63 offen offset:0 sc1
 buffer_load_dwordx4 v[32:35], v2, s[4:7], s60 offen offset:1024 sc1
 buffer_load_dwordx4 v[36:39], v2, s[4:7], s61 offen offset:1024 sc1
 buffer_load_dwordx4 v[40:43], v2, s[4:7], s62 offen offset:1024 sc1
 buffer_load_dwordx4 v[44:47], v2, s[4:7], s63 offen offset:1024 sc1
 buffer_load_dwordx4 v[48:51], v2, s[4:7], s60 offen offset:2048 sc1
 buffer_load_dwordx4 v[52:55], v2, s[4:7], s61 offen offset:2048 sc1
 buffer_load_dwordx4 v[56:59], v2, s[4:7], s62 offen offset:2048 sc1
 buffer_load_dwordx4 v[60:63], v2, s[4:7], s63 offen offset:2048 sc1
 buffer_load_dwordx4 v[64:67], v2, s[4:7], s60 offen offset:3072 sc1
 buffer_load_dwordx4 v[68:71], v2, s[4:7], s61 offen offset:3072 sc1
 buffer_load_dwordx4 v[72:75], v2, s[4:7], s62 offen offset:3072 sc1
 buffer_load_dwordx4 v[76:79], v2, s[4:7], s63 offen offset:3072 sc1
 s_add_u32 s60, s60, 4096
 s_add_u32 s61, s61, 4096
 s_add_u32 s62, s62, 4096
 s_add_u32 s63, s63, 4096
 v_accvgpr_write_b32 a0, 0
 v_accvgpr_write_b32 a1, 0
 v_accvgpr_write_b32 a2, 0
 v_accvgpr_write_b32 a3, 0
 v_accvgpr_write_b32 a4, 0
 v_accvgpr_write_b32 a5, 0
 v_accvgpr_write_b32 a6, 0
 v_accvgpr_write_b32 a7, 0
 v_accvgpr_write_b32 a8, 0
 v_accvgpr_write_b32 a9, 0
 v_accvgpr_write_b32 a10, 0
 v_accvgpr_write_b32 a11, 0
 v_accvgpr_write_b32 a12, 0
 v_accvgpr_write_b32 a13, 0
 v_accvgpr_write_b32 a14, 0
 v_accvgpr_write_b32 a15, 0
 v_accvgpr_write_b32 a16, 0
 v_accvgpr_write_b32 a17, 0
 v_accvgpr_write_b32 a18, 0
 v_accvgpr_write_b32 a19, 0
 v_accvgpr_write_b32 a20, 0
 v_accvgpr_write_b32 a21, 0
 v_accvgpr_write_b32 a22, 0
 v_accvgpr_write_b32 a23, 0
 v_accvgpr_write_b32 a24, 0
 v_accvgpr_write_b32 a25, 0
 v_accvgpr_write_b32 a26, 0
 v_accvgpr_write_b32 a27, 0
 v_accvgpr_write_b32 a28, 0
 v_accvgpr_write_b32 a29, 0
 v_accvgpr_write_b32 a30, 0
 v_accvgpr_write_b32 a31, 0
 v_accvgpr_write_b32 a32, 0
 v_accvgpr_write_b32 a33, 0
 v_accvgpr_write_b32 a34, 0
 v_accvgpr_write_b32 a35, 0
 v_accvgpr_write_b32 a36, 0
 v_accvgpr_write_b32 a37, 0
 v_accvgpr_write_b32 a38, 0
 v_accvgpr_write_b32 a39, 0
 v_accvgpr_write_b32 a40, 0
 v_accvgpr_write_b32 a41, 0
 v_accvgpr_write_b32 a42, 0
 v_accvgpr_write_b32 a43, 0
 v_accvgpr_write_b32 a44, 0
 v_accvgpr_write_b32 a45, 0
 v_accvgpr_write_b32 a46, 0
 v_accvgpr_write_b32 a47, 0
 v_accvgpr_write_b32 a48, 0
 v_accvgpr_write_b32 a49, 0
 v_accvgpr_write_b32 a50, 0
 v_accvgpr_write_b32 a51, 0
 v_accvgpr_write_b32 a52, 0
 v_accvgpr_write_b32 a53, 0
 v_accvgpr_write_b32 a54, 0
 v_accvgpr_write_b32 a55, 0
 v_accvgpr_write_b32 a56, 0
 v_accvgpr_write_b32 a57, 0
 v_accvgpr_write_b32 a58, 0
 v_accvgpr_write_b32 a59, 0
 v_accvgpr_write_b32 a60, 0
 v_accvgpr_write_b32 a61, 0
 v_accvgpr_write_b32 a62, 0
 v_accvgpr_write_b32 a63, 0
 v_accvgpr_write_b32 a64, 0
 v_accvgpr_write_b32 a65, 0
 v_accvgpr_write_b32 a66, 0
 v_accvgpr_write_b32 a67, 0
 v_accvgpr_write_b32 a68, 0
 v_accvgpr_write_b32 a69, 0
 v_accvgpr_write_b32 a70, 0
 v_accvgpr_write_b32 a71, 0
 v_accvgpr_write_b32 a72, 0
 v_accvgpr_write_b32 a73, 0
 v_accvgpr_write_b32 a74, 0
 v_accvgpr_write_b32 a75, 0
 v_accvgpr_write_b32 a76, 0
 v_accvgpr_write_b32 a77, 0
 v_accvgpr_write_b32 a78, 0
 v_accvgpr_write_b32 a79, 0
 v_accvgpr_write_b32 a80, 0
 v_accvgpr_write_b32 a81, 0
 v_accvgpr_write_b32 a82, 0
 v_accvgpr_write_b32 a83, 0
 v_accvgpr_write_b32 a84, 0
 v_accvgpr_write_b32 a85, 0
 v_accvgpr_write_b32 a86, 0
 v_accvgpr_write_b32 a87, 0
 v_accvgpr_write_b32 a88, 0
 v_accvgpr_write_b32 a89, 0
 v_accvgpr_write_b32 a90, 0
 v_accvgpr_write_b32 a91, 0
 v_accvgpr_write_b32 a92, 0
 v_accvgpr_write_b32 a93, 0
 v_accvgpr_write_b32 a94, 0
 v_accvgpr_write_b32 a95, 0
 v_accvgpr_write_b32 a96, 0
 v_accvgpr_write_b32 a97, 0
 v_accvgpr_write_b32 a98, 0
 v_accvgpr_write_b32 a99, 0
 v_accvgpr_write_b32 a100, 0
 v_accvgpr_write_b32 a101, 0
 v_accvgpr_write_b32 a102, 0
 v_accvgpr_write_b32 a103, 0
 v_accvgpr_write_b32 a104, 0
 v_accvgpr_write_b32 a105, 0
 v_accvgpr_write_b32 a106, 0
 v_accvgpr_write_b32 a107, 0
 v_accvgpr_write_b32 a108, 0
 v_accvgpr_write_b32 a109, 0
 v_accvgpr_write_b32 a110, 0
 v_accvgpr_write_b32 a111, 0
 v_accvgpr_write_b32 a112, 0
 v_accvgpr_write_b32 a113, 0
 v_accvgpr_write_b32 a114, 0
 v_accvgpr_write_b32 a115, 0
 v_accvgpr_write_b32 a116, 0
 v_accvgpr_write_b32 a117, 0
 v_accvgpr_write_b32 a118, 0
 v_accvgpr_write_b32 a119, 0
 v_accvgpr_write_b32 a120, 0
 v_accvgpr_write_b32 a121, 0
 v_accvgpr_write_b32 a122, 0
 v_accvgpr_write_b32 a123, 0
 v_accvgpr_write_b32 a124, 0
 v_accvgpr_write_b32 a125, 0
 v_accvgpr_write_b32 a126, 0
 v_accvgpr_write_b32 a127, 0
 v_accvgpr_write_b32 a128, 0
 v_accvgpr_write_b32 a129, 0
 v_accvgpr_write_b32 a130, 0
 v_accvgpr_write_b32 a131, 0
 v_accvgpr_write_b32 a132, 0
 v_accvgpr_write_b32 a133, 0
 v_accvgpr_write_b32 a134, 0
 v_accvgpr_write_b32 a135, 0
 v_accvgpr_write_b32 a136, 0
 v_accvgpr_write_b32 a137, 0
 v_accvgpr_write_b32 a138, 0
 v_accvgpr_write_b32 a139, 0
 v_accvgpr_write_b32 a140, 0
 v_accvgpr_write_b32 a141, 0
 v_accvgpr_write_b32 a142, 0
 v_accvgpr_write_b32 a143, 0
 s_mov_b32 s58, 0
 s_mov_b32 s57, 0
 s_waitcnt vmcnt(25)
L_f227:
 s_waitcnt vmcnt(41)
 s_barrier
 s_add_u32 s59, s57, 73728
 s_cmp_ge_u32 s59, 147456
 s_cselect_b32 s33, 147456, 0
 s_sub_u32 s59, s59, s33
 s_mul_i32 s33, s14, 9216
 s_add_u32 s33, s33, s59
 s_mov_b32 m0, s33
 s_nop 0
 buffer_load_dwordx4 v4, s[16:19], s56 offen lds
 s_add_u32 s33, s33, 1024
 s_mov_b32 m0, s33
 s_nop 0
 buffer_load_dwordx4 v5, s[16:19], s56 offen lds
 s_add_u32 s33, s33, 1024
 s_mov_b32 m0, s33
 s_nop 0
 buffer_load_dwordx4 v6, s[16:19], s56 offen lds
 s_add_u32 s33, s33, 1024
 s_mov_b32 m0, s33
 s_nop 0
 buffer_load_dwordx4 v7, s[16:19], s56 offen lds
 s_add_u32 s33, s33, 1024
 s_mov_b32 m0, s33
 s_nop 0
 buffer_load_dwordx4 v8, s[16:19], s56 offen lds
 s_add_u32 s33, s33, 1024
 s_mov_b32 m0, s33
 s_nop 0
 buffer_load_dwordx4 v9, s[16:19], s56 offen lds
 s_add_u32 s33, s33, 1024
 s_mov_b32 m0, s33
 s_nop 0
 buffer_load_dwordx4 v10, s[16:19], s56 offen lds
 s_add_u32 s33, s33, 1024
 s_mov_b32 m0, s33
 s_nop 0
 buffer_load_dwordx4 v11, s[16:19], s56 offen lds
 s_add_u32 s33, s33, 1024
 s_mov_b32 m0, s33
 s_nop 0
 buffer_load_dwordx4 v12, s[16:19], s56 offen lds
 s_add_u32 s56, s56, 147456
 v_add_u32 v3, s57, v13
 ds_read_b64_tr_b16 v[80:81], v3 offset:0
 ds_read_b64_tr_b16 v[82:83], v3 offset:4608
 ds_read_b64_tr_b16 v[84:85], v3 offset:32
 ds_read_b64_tr_b16 v[86:87], v3 offset:4640
 ds_read_b64_tr_b16 v[88:89], v3 offset:64
 ds_read_b64_tr_b16 v[90:91], v3 offset:4672
 s_waitcnt vmcnt(24) lgkmcnt(4)
 v_mfma_f32_16x16x32_bf16 a[0:3], v[80:83], v[16:19], a[0:3]
 ds_read_b64_tr_b16 v[92:93], v3 offset:96
 ds_read_b64_tr_b16 v[94:95], v3 offset:4704
 s_waitcnt vmcnt(23)
 v_mfma_f32_16x16x32_bf16 a[4:7], v[80:83], v[20:23], a[4:7]
 s_waitcnt vmcnt(22)
 v_mfma_f32_16x16x32_bf16 a[8:11], v[80:83], v[24:27], a[8:11]
 s_waitcnt vmcnt(21)
 v_mfma_f32_16x16x32_bf16 a[12:15], v[80:83], v[28:31], a[12:15]
 s_waitcnt lgkmcnt(4)
 v_mfma_f32_16x16x32_bf16 a[16:19], v[84:87], v[16:19], a[16:19]
 ds_read_b64_tr_b16 v[80:81], v3 offset:128
 ds_read_b64_tr_b16 v[82:83], v3 offset:4736
 v_mfma_f32_16x16x32_bf16 a[20:23], v[84:87], v[20:23], a[20:23]
 v_mfma_f32_16x16x32_bf16 a[24:27], v[84:87], v[24:27], a[24:27]
 v_mfma_f32_16x16x32_bf16 a[28:31], v[84:87], v[28:31], a[28:31]
 s_waitcnt lgkmcnt(4)
 v_mfma_f32_16x16x32_bf16 a[32:35], v[88:91], v[16:19], a[32:35]
 ds_read_b64_tr_b16 v[84:85], v3 offset:160
 ds_read_b64_tr_b16 v[86:87], v3 offset:4768
 v_mfma_f32_16x16x32_bf16 a[36:39], v[88:91], v[20:23], a[36:39]
 v_mfma_f32_16x16x32_bf16 a[40:43], v[88:91], v[24:27], a[40:43]
 v_mfma_f32_16x16x32_bf16 a[44:47], v[88:91], v[28:31], a[44:47]
 s_waitcnt lgkmcnt(4)
 v_mfma_f32_16x16x32_bf16 a[48:51], v[92:95], v[16:19], a[48:51]
 ds_read_b64_tr_b16 v[88:89], v3 offset:192
 ds_read_b64_tr_b16 v[90:91], v3 offset:4800
 v_mfma_f32_16x16x32_bf16 a[52:55], v[92:95], v[20:23], a[52:55]
 v_mfma_f32_16x16x32_bf16 a[56:59], v[92:95], v[24:27], a[56:59]
 v_mfma_f32_16x16x32_bf16 a[60:63], v[92:95], v[28:31], a[60:63]
 s_waitcnt lgkmcnt(4)
 v_mfma_f32_16x16x32_bf16 a[64:67], v[80:83], v[16:19], a[64:67]
 ds_read_b64_tr_b16 v[92:93], v3 offset:224
 ds_read_b64_tr_b16 v[94:95], v3 offset:4832
 v_mfma_f32_16x16x32_bf16 a[68:71], v[80:83], v[20:23], a[68:71]
 v_mfma_f32_16x16x32_bf16 a[72:75], v[80:83], v[24:27], a[72:75]
 v_mfma_f32_16x16x32_bf16 a[76:79], v[80:83], v[28:31], a[76:79]
 s_waitcnt lgkmcnt(4)
 v_mfma_f32_16x16x32_bf16 a[80:83], v[84:87], v[16:19], a[80:83]
 ds_read_b64_tr_b16 v[80:81], v3 offset:256
 ds_read_b64_tr_b16 v[82:83], v3 offset:4864
 v_mfma_f32_16x16x32_bf16 a[84:87], v[84:87], v[20:23], a[84:87]
 v_mfma_f32_16x16x32_bf16 a[88:91], v[84:87], v[24:27], a[88:91]
 v_mfma_f32_16x16x32_bf16 a[92:95], v[84:87], v[28:31], a[92:95]
 s_waitcnt lgkmcnt(4)
 v_mfma_f32_16x16x32_bf16 a[96:99], v[88:91], v[16:19], a[96:99]
 ds_read_b64_tr_b16 v[84:85], v3 offset:9216
 ds_read_b64_tr_b16 v[86:87], v3 offset:13824
 v_mfma_f32_16x16x32_bf16 a[100:103], v[88:91], v[20:23], a[100:103]
 v_mfma_f32_16x16x32_bf16 a[104:107], v[88:91], v[24:27], a[104:107]
 v_mfma_f32_16x16x32_bf16 a[108:111], v[88:91], v[28:31], a[108:111]
 s_waitcnt lgkmcnt(4)
 v_mfma_f32_16x16x32_bf16 a[112:115], v[92:95], v[16:19], a[112:115]
 ds_read_b64_tr_b16 v[88:89], v3 offset:9248
 ds_read_b64_tr_b16 v[90:91], v3 offset:13856
 v_mfma_f32_16x16x32_bf16 a[116:119], v[92:95], v[20:23], a[116:119]
 v_mfma_f32_16x16x32_bf16 a[120:123], v[92:95], v[24:27], a[120:123]
 v_mfma_f32_16x16x32_bf16 a[124:127], v[92:95], v[28:31], a[124:127]
 s_waitcnt lgkmcnt(4)
 v_mfma_f32_16x16x32_bf16 a[128:131], v[80:83], v[16:19], a[128:131]
 ds_read_b64_tr_b16 v[92:93], v3 offset:9280
 ds_read_b64_tr_b16 v[94:95], v3 offset:13888
 v_mfma_f32_16x16x32_bf16 a[132:135], v[80:83], v[20:23], a[132:135]
 v_mfma_f32_16x16x32_bf16 a[136:139], v[80:83], v[24:27], a[136:139]
 v_mfma_f32_16x16x32_bf16 a[140:143], v[80:83], v[28:31], a[140:143]
 buffer_load_dwordx4 v[16:19], v2, s[4:7], s60 offen offset:0 sc1
 buffer_load_dwordx4 v[20:23], v2, s[4:7], s61 offen offset:0 sc1
 buffer_load_dwordx4 v[24:27], v2, s[4:7], s62 offen offset:0 sc1
 buffer_load_dwordx4 v[28:31], v2, s[4:7], s63 offen offset:0 sc1
 s_waitcnt vmcnt(24) lgkmcnt(4)
 v_mfma_f32_16x16x32_bf16 a[0:3], v[84:87], v[32:35], a[0:3]
 ds_read_b64_tr_b16 v[80:81], v3 offset:9312
 ds_read_b64_tr_b16 v[82:83], v3 offset:13920
 s_waitcnt vmcnt(23)
 v_mfma_f32_16x16x32_bf16 a[4:7], v[84:87], v[36:39], a[4:7]
 s_waitcnt vmcnt(22)
 v_mfma_f32_16x16x32_bf16 a[8:11], v[84:87], v[40:43], a[8:11]
 s_waitcnt vmcnt(21)
 v_mfma_f32_16x16x32_bf16 a[12:15], v[84:87], v[44:47], a[12:15]
 s_waitcnt lgkmcnt(4)
 v_mfma_f32_16x16x32_bf16 a[16:19], v[88:91], v[32:35], a[16:19]
 ds_read_b64_tr_b16 v[84:85], v3 offset:9344
 ds_read_b64_tr_b16 v[86:87], v3 offset:13952
 v_mfma_f32_16x16x32_bf16 a[20:23], v[88:91], v[36:39], a[20:23]
 v_mfma_f32_16x16x32_bf16 a[24:27], v[88:91], v[40:43], a[24:27]
 v_mfma_f32_16x16x32_bf16 a[28:31], v[88:91], v[44:47], a[28:31]
 s_waitcnt lgkmcnt(4)
 v_mfma_f32_16x16x32_bf16 a[32:35], v[92:95], v[32:35], a[32:35]
 ds_read_b64_tr_b16 v[88:89], v3 offset:9376
 ds_read_b64_tr_b16 v[90:91], v3 offset:13984
 v_mfma_f32_16x16x32_bf16 a[36:39], v[92:95], v[36:39], a[36:39]
 v_mfma_f32_16x16x32_bf16 a[40:43], v[92:95], v[40:43], a[40:43]
 v_mfma_f32_16x16x32_bf16 a[44:47], v[92:95], v[44:47], a[44:47]
 s_waitcnt lgkmcnt(4)
 v_mfma_f32_16x16x32_bf16 a[48:51], v[80:83], v[32:35], a[48:51]
 ds_read_b64_tr_b16 v[92:93], v3 offset:9408
 ds_read_b64_tr_b16 v[94:95], v3 offset:14016
 v_mfma_f32_16x16x32_bf16 a[52:55], v[80:83], v[36:39], a[52:55]
 v_mfma_f32_16x16x32_bf16 a[56:59], v[80:83], v[40:43], a[56:59]
 v_mfma_f32_16x16x32_bf16 a[60:63], v[80:83], v[44:47], a[60:63]
 s_waitcnt lgkmcnt(4)
 v_mfma_f32_16x16x32_bf16 a[64:67], v[84:87], v[32:35], a[64:67]
 ds_read_b64_tr_b16 v[80:81], v3 offset:9440
 ds_read_b64_tr_b16 v[82:83], v3 offset:14048
 v_mfma_f32_16x16x32_bf16 a[68:71], v[84:87], v[36:39], a[68:71]
 v_mfma_f32_16x16x32_bf16 a[72:75], v[84:87], v[40:43], a[72:75]
 v_mfma_f32_16x16x32_bf16 a[76:79], v[84:87], v[44:47], a[76:79]
 s_waitcnt lgkmcnt(4)
 v_mfma_f32_16x16x32_bf16 a[80:83], v[88:91], v[32:35], a[80:83]
 ds_read_b64_tr_b16 v[84:85], v3 offset:9472
 ds_read_b64_tr_b16 v[86:87], v3 offset:14080
 v_mfma_f32_16x16x32_bf16 a[84:87], v[88:91], v[36:39], a[84:87]
 v_mfma_f32_16x16x32_bf16 a[88:91], v[88:91], v[40:43], a[88:91]
 v_mfma_f32_16x16x32_bf16 a[92:95], v[88:91], v[44:47], a[92:95]
 s_waitcnt lgkmcnt(4)
 v_mfma_f32_16x16x32_bf16 a[96:99], v[92:95], v[32:35], a[96:99]
 ds_read_b64_tr_b16 v[88:89], v3 offset:18432
 ds_read_b64_tr_b16 v[90:91], v3 offset:23040
 v_mfma_f32_16x16x32_bf16 a[100:103], v[92:95], v[36:39], a[100:103]
 v_mfma_f32_16x16x32_bf16 a[104:107], v[92:95], v[40:43], a[104:107]
 v_mfma_f32_16x16x32_bf16 a[108:111], v[92:95], v[44:47], a[108:111]
 s_waitcnt lgkmcnt(4)
 v_mfma_f32_16x16x32_bf16 a[112:115], v[80:83], v[32:35], a[112:115]
 ds_read_b64_tr_b16 v[92:93], v3 offset:18464
 ds_read_b64_tr_b16 v[94:95], v3 offset:23072
 v_mfma_f32_16x16x32_bf16 a[116:119], v[80:83], v[36:39], a[116:119]
 v_mfma_f32_16x16x32_bf16 a[120:123], v[80:83], v[40:43], a[120:123]
 v_mfma_f32_16x16x32_bf16 a[124:127], v[80:83], v[44:47], a[124:127]
 s_waitcnt lgkmcnt(4)
 v_mfma_f32_16x16x32_bf16 a[128:131], v[84:87], v[32:35], a[128:131]
 ds_read_b64_tr_b16 v[80:81], v3 offset:18496
 ds_read_b64_tr_b16 v[82:83], v3 offset:23104
 v_mfma_f32_16x16x32_bf16 a[132:135], v[84:87], v[36:39], a[132:135]
 v_mfma_f32_16x16x32_bf16 a[136:139], v[84:87], v[40:43], a[136:139]
 v_mfma_f32_16x16x32_bf16 a[140:143], v[84:87], v[44:47], a[140:143]
 buffer_load_dwordx4 v[32:35], v2, s[4:7], s60 offen offset:1024 sc1
 buffer_load_dwordx4 v[36:39], v2, s[4:7], s61 offen offset:1024 sc1
 buffer_load_dwordx4 v[40:43], v2, s[4:7], s62 offen offset:1024 sc1
 buffer_load_dwordx4 v[44:47], v2, s[4:7], s63 offen offset:1024 sc1
 s_waitcnt vmcnt(24) lgkmcnt(4)
 v_mfma_f32_16x16x32_bf16 a[0:3], v[88:91], v[48:51], a[0:3]
 ds_read_b64_tr_b16 v[84:85], v3 offset:18528
 ds_read_b64_tr_b16 v[86:87], v3 offset:23136
 s_waitcnt vmcnt(23)
 v_mfma_f32_16x16x32_bf16 a[4:7], v[88:91], v[52:55], a[4:7]
 s_waitcnt vmcnt(22)
 v_mfma_f32_16x16x32_bf16 a[8:11], v[88:91], v[56:59], a[8:11]
 s_waitcnt vmcnt(21)
 v_mfma_f32_16x16x32_bf16 a[12:15], v[88:91], v[60:63], a[12:15]
 s_waitcnt lgkmcnt(4)
 v_mfma_f32_16x16x32_bf16 a[16:19], v[92:95], v[48:51], a[16:19]
 ds_read_b64_tr_b16 v[88:89], v3 offset:18560
 ds_read_b64_tr_b16 v[90:91], v3 offset:23168
 v_mfma_f32_16x16x32_bf16 a[20:23], v[92:95], v[52:55], a[20:23]
 v_mfma_f32_16x16x32_bf16 a[24:27], v[92:95], v[56:59], a[24:27]
 v_mfma_f32_16x16x32_bf16 a[28:31], v[92:95], v[60:63], a[28:31]
 s_waitcnt lgkmcnt(4)
 v_mfma_f32_16x16x32_bf16 a[32:35], v[80:83], v[48:51], a[32:35]
 ds_read_b64_tr_b16 v[92:93], v3 offset:18592
 ds_read_b64_tr_b16 v[94:95], v3 offset:23200
 v_mfma_f32_16x16x32_bf16 a[36:39], v[80:83], v[52:55], a[36:39]
 v_mfma_f32_16x16x32_bf16 a[40:43], v[80:83], v[56:59], a[40:43]
 v_mfma_f32_16x16x32_bf16 a[44:47], v[80:83], v[60:63], a[44:47]
 s_waitcnt lgkmcnt(4)
 v_mfma_f32_16x16x32_bf16 a[48:51], v[84:87], v[48:51], a[48:51]
 ds_read_b64_tr_b16 v[80:81], v3 offset:18624
 ds_read_b64_tr_b16 v[82:83], v3 offset:23232
 v_mfma_f32_16x16x32_bf16 a[52:55], v[84:87], v[52:55], a[52:55]
 v_mfma_f32_16x16x32_bf16 a[56:59], v[84:87], v[56:59], a[56:59]
 v_mfma_f32_16x16x32_bf16 a[60:63], v[84:87], v[60:63], a[60:63]
 s_waitcnt lgkmcnt(4)
 v_mfma_f32_16x16x32_bf16 a[64:67], v[88:91], v[48:51], a[64:67]
 ds_read_b64_tr_b16 v[84:85], v3 offset:18656
 ds_read_b64_tr_b16 v[86:87], v3 offset:23264
 v_mfma_f32_16x16x32_bf16 a[68:71], v[88:91], v[52:55], a[68:71]
 v_mfma_f32_16x16x32_bf16 a[72:75], v[88:91], v[56:59], a[72:75]
 v_mfma_f32_16x16x32_bf16 a[76:79], v[88:91], v[60:63], a[76:79]
 s_waitcnt lgkmcnt(4)
 v_mfma_f32_16x16x32_bf16 a[80:83], v[92:95], v[48:51], a[80:83]
 ds_read_b64_tr_b16 v[88:89], v3 offset:18688
 ds_read_b64_tr_b16 v[90:91], v3 offset:23296
 v_mfma_f32_16x16x32_bf16 a[84:87], v[92:95], v[52:55], a[84:87]
 v_mfma_f32_16x16x32_bf16 a[88:91], v[92:95], v[56:59], a[88:91]
 v_mfma_f32_16x16x32_bf16 a[92:95], v[92:95], v[60:63], a[92:95]
 s_waitcnt lgkmcnt(4)
 v_mfma_f32_16x16x32_bf16 a[96:99], v[80:83], v[48:51], a[96:99]
 ds_read_b64_tr_b16 v[92:93], v3 offset:27648
 ds_read_b64_tr_b16 v[94:95], v3 offset:32256
 v_mfma_f32_16x16x32_bf16 a[100:103], v[80:83], v[52:55], a[100:103]
 v_mfma_f32_16x16x32_bf16 a[104:107], v[80:83], v[56:59], a[104:107]
 v_mfma_f32_16x16x32_bf16 a[108:111], v[80:83], v[60:63], a[108:111]
 s_waitcnt lgkmcnt(4)
 v_mfma_f32_16x16x32_bf16 a[112:115], v[84:87], v[48:51], a[112:115]
 ds_read_b64_tr_b16 v[80:81], v3 offset:27680
 ds_read_b64_tr_b16 v[82:83], v3 offset:32288
 v_mfma_f32_16x16x32_bf16 a[116:119], v[84:87], v[52:55], a[116:119]
 v_mfma_f32_16x16x32_bf16 a[120:123], v[84:87], v[56:59], a[120:123]
 v_mfma_f32_16x16x32_bf16 a[124:127], v[84:87], v[60:63], a[124:127]
 s_waitcnt lgkmcnt(4)
 v_mfma_f32_16x16x32_bf16 a[128:131], v[88:91], v[48:51], a[128:131]
 ds_read_b64_tr_b16 v[84:85], v3 offset:27712
 ds_read_b64_tr_b16 v[86:87], v3 offset:32320
 v_mfma_f32_16x16x32_bf16 a[132:135], v[88:91], v[52:55], a[132:135]
 v_mfma_f32_16x16x32_bf16 a[136:139], v[88:91], v[56:59], a[136:139]
 v_mfma_f32_16x16x32_bf16 a[140:143], v[88:91], v[60:63], a[140:143]
 buffer_load_dwordx4 v[48:51], v2, s[4:7], s60 offen offset:2048 sc1
 buffer_load_dwordx4 v[52:55], v2, s[4:7], s61 offen offset:2048 sc1
 buffer_load_dwordx4 v[56:59], v2, s[4:7], s62 offen offset:2048 sc1
 buffer_load_dwordx4 v[60:63], v2, s[4:7], s63 offen offset:2048 sc1
 s_waitcnt vmcnt(24) lgkmcnt(4)
 v_mfma_f32_16x16x32_bf16 a[0:3], v[92:95], v[64:67], a[0:3]
 ds_read_b64_tr_b16 v[88:89], v3 offset:27744
 ds_read_b64_tr_b16 v[90:91], v3 offset:32352
 s_waitcnt vmcnt(23)
 v_mfma_f32_16x16x32_bf16 a[4:7], v[92:95], v[68:71], a[4:7]
 s_waitcnt vmcnt(22)
 v_mfma_f32_16x16x32_bf16 a[8:11], v[92:95], v[72:75], a[8:11]
 s_waitcnt vmcnt(21)
 v_mfma_f32_16x16x32_bf16 a[12:15], v[92:95], v[76:79], a[12:15]
 s_waitcnt lgkmcnt(4)
 v_mfma_f32_16x16x32_bf16 a[16:19], v[80:83], v[64:67], a[16:19]
 ds_read_b64_tr_b16 v[92:93], v3 offset:27776
 ds_read_b64_tr_b16 v[94:95], v3 offset:32384
 v_mfma_f32_16x16x32_bf16 a[20:23], v[80:83], v[68:71], a[20:23]
 v_mfma_f32_16x16x32_bf16 a[24:27], v[80:83], v[72:75], a[24:27]
 v_mfma_f32_16x16x32_bf16 a[28:31], v[80:83], v[76:79], a[28:31]
 s_waitcnt lgkmcnt(4)
 v_mfma_f32_16x16x32_bf16 a[32:35], v[84:87], v[64:67], a[32:35]
 ds_read_b64_tr_b16 v[80:81], v3 offset:27808
 ds_read_b64_tr_b16 v[82:83], v3 offset:32416
 v_mfma_f32_16x16x32_bf16 a[36:39], v[84:87], v[68:71], a[36:39]
 v_mfma_f32_16x16x32_bf16 a[40:43], v[84:87], v[72:75], a[40:43]
 v_mfma_f32_16x16x32_bf16 a[44:47], v[84:87], v[76:79], a[44:47]
 s_waitcnt lgkmcnt(4)
 v_mfma_f32_16x16x32_bf16 a[48:51], v[88:91], v[64:67], a[48:51]
 ds_read_b64_tr_b16 v[84:85], v3 offset:27840
 ds_read_b64_tr_b16 v[86:87], v3 offset:32448
 v_mfma_f32_16x16x32_bf16 a[52:55], v[88:91], v[68:71], a[52:55]
 v_mfma_f32_16x16x32_bf16 a[56:59], v[88:91], v[72:75], a[56:59]
 v_mfma_f32_16x16x32_bf16 a[60:63], v[88:91], v[76:79], a[60:63]
 s_waitcnt lgkmcnt(4)
 v_mfma_f32_16x16x32_bf16 a[64:67], v[92:95], v[64:67], a[64:67]
 ds_read_b64_tr_b16 v[88:89], v3 offset:27872
 ds_read_b64_tr_b16 v[90:91], v3 offset:32480
 v_mfma_f32_16x16x32_bf16 a[68:71], v[92:95], v[68:71], a[68:71]
 v_mfma_f32_16x16x32_bf16 a[72:75], v[92:95], v[72:75], a[72:75]
 v_mfma_f32_16x16x32_bf16 a[76:79], v[92:95], v[76:79], a[76:79]
 s_waitcnt lgkmcnt(4)
 v_mfma_f32_16x16x32_bf16 a[80:83], v[80:83], v[64:67], a[80:83]
 ds_read_b64_tr_b16 v[92:93], v3 offset:27904
 ds_read_b64_tr_b16 v[94:95], v3 offset:32512
 v_mfma_f32_16x16x32_bf16 a[84:87], v[80:83], v[68:71], a[84:87]
 v_mfma_f32_16x16x32_bf16 a[88:91], v[80:83], v[72:75], a[88:91]
 v_mfma_f32_16x16x32_bf16 a[92:95], v[80:83], v[76:79], a[92:95]
 s_waitcnt lgkmcnt(4)
 v_mfma_f32_16x16x32_bf16 a[96:99], v[84:87], v[64:67], a[96:99]
 v_mfma_f32_16x16x32_bf16 a[100:103], v[84:87], v[68:71], a[100:103]
 v_mfma_f32_16x16x32_bf16 a[104:107], v[84:87], v[72:75], a[104:107]
 v_mfma_f32_16x16x32_bf16 a[108:111], v[84:87], v[76:79], a[108:111]
 s_waitcnt lgkmcnt(2)
 v_mfma_f32_16x16x32_bf16 a[112:115], v[88:91], v[64:67], a[112:115]
 v_mfma_f32_16x16x32_bf16 a[116:119], v[88:91], v[68:71], a[116:119]
 v_mfma_f32_16x16x32_bf16 a[120:123], v[88:91], v[72:75], a[120:123]
 v_mfma_f32_16x16x32_bf16 a[124:127], v[88:91], v[76:79], a[124:127]
 s_waitcnt lgkmcnt(0)
 v_mfma_f32_16x16x32_bf16 a[128:131], v[92:95], v[64:67], a[128:131]
 v_mfma_f32_16x16x32_bf16 a[132:135], v[92:95], v[68:71], a[132:135]
 v_mfma_f32_16x16x32_bf16 a[136:139], v[92:95], v[72:75], a[136:139]
 v_mfma_f32_16x16x32_bf16 a[140:143], v[92:95], v[76:79], a[140:143]
 buffer_load_dwordx4 v[64:67], v2, s[4:7], s60 offen offset:3072 sc1
 buffer_load_dwordx4 v[68:71], v2, s[4:7], s61 offen offset:3072 sc1
 buffer_load_dwordx4 v[72:75], v2, s[4:7], s62 offen offset:3072 sc1
 buffer_load_dwordx4 v[76:79], v2, s[4:7], s63 offen offset:3072 sc1
 s_add_u32 s60, s60, 4096
 s_add_u32 s61, s61, 4096
 s_add_u32 s62, s62, 4096
 s_add_u32 s63, s63, 4096
 s_add_u32 s57, s57, 36864
 s_cmp_ge_u32 s57, 147456
 s_cselect_b32 s57, 0, s57
 s_add_u32 s58, s58, 1
 s_cmp_lt_u32 s58, 18
 s_cbranch_scc1 L_f227
 v_and_b32 v14, 15, v1
 v_mul_u32_u24 v14, 2304, v14
 v_lshrrev_b32 v15, 4, v1
 v_lshl_add_u32 v14, v15, 4, v14
 s_mul_i32 s33, s54, 4718592
 s_lshl_b32 s34, s55, 8
 s_lshl_b32 s59, s14, 6
 s_add_u32 s34, s34, s59
 s_mul_i32 s34, s34, 2304
 s_add_u32 s33, s33, s34
 s_mul_i32 s34, s53, 576
 s_add_u32 s33, s33, s34
 s_add_u32 s33, s33, 73400320
 buffer_store_dwordx4 a[0:3], v14, s[4:7], s33 offen offset:0 sc1
 buffer_store_dwordx4 a[16:19], v14, s[4:7], s33 offen offset:64 sc1
 buffer_store_dwordx4 a[32:35], v14, s[4:7], s33 offen offset:128 sc1
 buffer_store_dwordx4 a[48:51], v14, s[4:7], s33 offen offset:192 sc1
 buffer_store_dwordx4 a[64:67], v14, s[4:7], s33 offen offset:256 sc1
 buffer_store_dwordx4 a[80:83], v14, s[4:7], s33 offen offset:320 sc1
 buffer_store_dwordx4 a[96:99], v14, s[4:7], s33 offen offset:384 sc1
 buffer_store_dwordx4 a[112:115], v14, s[4:7], s33 offen offset:448 sc1
 buffer_store_dwordx4 a[128:131], v14, s[4:7], s33 offen offset:512 sc1
 s_add_u32 s33, s33, 36864
 buffer_store_dwordx4 a[4:7], v14, s[4:7], s33 offen offset:0 sc1
 buffer_store_dwordx4 a[20:23], v14, s[4:7], s33 offen offset:64 sc1
 buffer_store_dwordx4 a[36:39], v14, s[4:7], s33 offen offset:128 sc1
 buffer_store_dwordx4 a[52:55], v14, s[4:7], s33 offen offset:192 sc1
 buffer_store_dwordx4 a[68:71], v14, s[4:7], s33 offen offset:256 sc1
 buffer_store_dwordx4 a[84:87], v14, s[4:7], s33 offen offset:320 sc1
 buffer_store_dwordx4 a[100:103], v14, s[4:7], s33 offen offset:384 sc1
 buffer_store_dwordx4 a[116:119], v14, s[4:7], s33 offen offset:448 sc1
 buffer_store_dwordx4 a[132:135], v14, s[4:7], s33 offen offset:512 sc1
 s_add_u32 s33, s33, 36864
 buffer_store_dwordx4 a[8:11], v14, s[4:7], s33 offen offset:0 sc1
 buffer_store_dwordx4 a[24:27], v14, s[4:7], s33 offen offset:64 sc1
 buffer_store_dwordx4 a[40:43], v14, s[4:7], s33 offen offset:128 sc1
 buffer_store_dwordx4 a[56:59], v14, s[4:7], s33 offen offset:192 sc1
 buffer_store_dwordx4 a[72:75], v14, s[4:7], s33 offen offset:256 sc1
 buffer_store_dwordx4 a[88:91], v14, s[4:7], s33 offen offset:320 sc1
 buffer_store_dwordx4 a[104:107], v14, s[4:7], s33 offen offset:384 sc1
 buffer_store_dwordx4 a[120:123], v14, s[4:7], s33 offen offset:448 sc1
 buffer_store_dwordx4 a[136:139], v14, s[4:7], s33 offen offset:512 sc1
 s_add_u32 s33, s33, 36864
 buffer_store_dwordx4 a[12:15], v14, s[4:7], s33 offen offset:0 sc1
 buffer_store_dwordx4 a[28:31], v14, s[4:7], s33 offen offset:64 sc1
 buffer_store_dwordx4 a[44:47], v14, s[4:7], s33 offen offset:128 sc1
 buffer_store_dwordx4 a[60:63], v14, s[4:7], s33 offen offset:192 sc1
 buffer_store_dwordx4 a[76:79], v14, s[4:7], s33 offen offset:256 sc1
 buffer_store_dwordx4 a[92:95], v14, s[4:7], s33 offen offset:320 sc1
 buffer_store_dwordx4 a[108:111], v14, s[4:7], s33 offen offset:384 sc1
 buffer_store_dwordx4 a[124:127], v14, s[4:7], s33 offen offset:448 sc1
 buffer_store_dwordx4 a[140:143], v14, s[4:7], s33 offen offset:512 sc1
 s_add_u32 s33, s33, 36864
 s_waitcnt vmcnt(0)
 s_barrier
 s_cmp_lg_u32 s14, 0
 s_cbranch_scc1 L_f2f28
 s_lshl_b32 s33, s52, 2
 s_add_u32 s33, s33, 1536
 v_mov_b32 v14, 1
 v_mov_b32 v15, 0
 s_mov_b64 exec, 1
 buffer_store_dword v14, v15, s[4:7], s33 offen sc1
 s_mov_b64 exec, -1
L_f2f28:
L_f2x23:
 s_add_u32 s64, s52, 64
 s_branch L_fin
L_shadow:
 s_and_b32 s40, s39, 31
 s_lshr_b32 s41, s39, 5
 s_load_dwordx2 s[16:17], s[0:1], 16
 s_mov_b32 s18, 0x480000
 s_mov_b32 s19, 0x20000
 s_load_dwordx2 s[20:21], s[0:1], 40
 s_mov_b32 s22, 0x480000
 s_mov_b32 s23, 0x20000
 s_lshl_b32 s42, s40, 8
 v_lshrrev_b32 v2, 4, v1
 v_and_b32 v3, 15, v1
 v_lshlrev_b32 v4, 1, v2
 v_xor_b32 v5, v3, v4
 v_xor_b32 v6, 8, v5
 v_mul_u32_u24 v2, 8192, v2
 v_lshl_add_u32 v5, v5, 4, v2
 v_lshl_add_u32 v6, v6, 4, v2
 v_lshrrev_b32 v7, 4, v1
 v_bfe_u32 v8, v1, 2, 2
 v_and_b32 v9, 3, v1
 v_and_b32 v10, 1, v7
 v_lshl_or_b32 v10, v10, 2, v8
 v_lshlrev_b32 v10, 1, v10
 v_lshrrev_b32 v11, 1, v9
 s_lshl_b32 s33, s14, 2
 v_add_u32 v11, s33, v11
 v_add_u32 v12, 2, v11
 v_xor_b32 v11, v11, v10
 v_xor_b32 v12, v12, v10
 v_lshl_add_u32 v13, v7, 3, v8
 v_lshlrev_b32 v13, 8, v13
 v_and_b32 v9, 1, v9
 v_lshl_add_u32 v13, v9, 3, v13
 v_lshl_add_u32 v11, v11, 4, v13
 v_lshl_add_u32 v12, v12, 4, v13
 v_add_u32 v14, 73728, v11
 v_add_u32 v15, 73728, v12
 v_add_u32 v18, 65536, v11
 v_add_u32 v19, 65536, v12
 v_add_u32 v20, 65536, v14
 v_add_u32 v21, 65536, v15
 s_waitcnt lgkmcnt(0)
 s_and_b32 s17, s17, 0xffff
 s_and_b32 s21, s21, 0xffff
 s_bitcmp1_b32 s14, 0
 s_cselect_b64 vcc, -1, 0
 v_cndmask_b32 v16, v5, v6, vcc
 v_cndmask_b32 v17, v6, v5, vcc
 s_mul_i32 s33, s14, 18432
 s_add_u32 s33, s33, 0
 s_mul_i32 s34, s14, 589824
 s_add_u32 s34, s34, s42
 s_add_u32 s34, s34, 0
 s_mov_b32 m0, s33
 s_nop 0
 buffer_load_dwordx4 v16, s[16:19], s34 offen lds
 s_add_u32 s33, s33, 1024
 s_add_u32 s34, s34, 32768
 s_mov_b32 m0, s33
 s_nop 0
 buffer_load_dwordx4 v16, s[16:19], s34 offen lds
 s_add_u32 s33, s33, 1024
 s_add_u32 s34, s34, 32768
 s_mov_b32 m0, s33
 s_nop 0
 buffer_load_dwordx4 v17, s[16:19], s34 offen lds
 s_add_u32 s33, s33, 1024
 s_add_u32 s34, s34, 32768
 s_mov_b32 m0, s33
 s_nop 0
 buffer_load_dwordx4 v17, s[16:19], s34 offen lds
 s_add_u32 s33, s33, 1024
 s_add_u32 s34, s34, 32768
 s_mov_b32 m0, s33
 s_nop 0
 buffer_load_dwordx4 v16, s[16:19], s34 offen lds
 s_add_u32 s33, s33, 1024
 s_add_u32 s34, s34, 32768
 s_mov_b32 m0, s33
 s_nop 0
 buffer_load_dwordx4 v16, s[16:19], s34 offen lds
 s_add_u32 s33, s33, 1024
 s_add_u32 s34, s34, 32768
 s_mov_b32 m0, s33
 s_nop 0
 buffer_load_dwordx4 v17, s[16:19], s34 offen lds
 s_add_u32 s33, s33, 1024
 s_add_u32 s34, s34, 32768
 s_mov_b32 m0, s33
 s_nop 0
 buffer_load_dwordx4 v17, s[16:19], s34 offen lds
 s_add_u32 s33, s33, 1024
 s_add_u32 s34, s34, 32768
 s_mov_b32 m0, s33
 s_nop 0
 buffer_load_dwordx4 v16, s[16:19], s34 offen lds
 s_add_u32 s33, s33, 1024
 s_add_u32 s34, s34, 32768
 s_mov_b32 m0, s33
 s_nop 0
 buffer_load_dwordx4 v16, s[16:19], s34 offen lds
 s_add_u32 s33, s33, 1024
 s_add_u32 s34, s34, 32768
 s_mov_b32 m0, s33
 s_nop 0
 buffer_load_dwordx4 v17, s[16:19], s34 offen lds
 s_add_u32 s33, s33, 1024
 s_add_u32 s34, s34, 32768
 s_mov_b32 m0, s33
 s_nop 0
 buffer_load_dwordx4 v17, s[16:19], s34 offen lds
 s_add_u32 s33, s33, 1024
 s_add_u32 s34, s34, 32768
 s_mov_b32 m0, s33
 s_nop 0
 buffer_load_dwordx4 v16, s[16:19], s34 offen lds
 s_add_u32 s33, s33, 1024
 s_add_u32 s34, s34, 32768
 s_mov_b32 m0, s33
 s_nop 0
 buffer_load_dwordx4 v16, s[16:19], s34 offen lds
 s_add_u32 s33, s33, 1024
 s_add_u32 s34, s34, 32768
 s_mov_b32 m0, s33
 s_nop 0
 buffer_load_dwordx4 v17, s[16:19], s34 offen lds
 s_add_u32 s33, s33, 1024
 s_add_u32 s34, s34, 32768
 s_mov_b32 m0, s33
 s_nop 0
 buffer_load_dwordx4 v17, s[16:19], s34 offen lds
 s_add_u32 s33, s33, 1024
 s_add_u32 s34, s34, 32768
 s_mov_b32 m0, s33
 s_nop 0
 buffer_load_dwordx4 v16, s[16:19], s34 offen lds
 s_add_u32 s33, s33, 1024
 s_add_u32 s34, s34, 32768
 s_mov_b32 m0, s33
 s_nop 0
 buffer_load_dwordx4 v16, s[16:19], s34 offen lds
 s_mul_i32 s33, s14, 18432
 s_add_u32 s33, s33, 73728
 s_mul_i32 s34, s14, 589824
 s_add_u32 s34, s34, s42
 s_add_u32 s34, s34, 2359296
 s_mov_b32 m0, s33
 s_nop 0
 buffer_load_dwordx4 v16, s[16:19], s34 offen lds
 s_add_u32 s33, s33, 1024
 s_add_u32 s34, s34, 32768
 s_mov_b32 m0, s33
 s_nop 0
 buffer_load_dwordx4 v16, s[16:19], s34 offen lds
 s_add_u32 s33, s33, 1024
 s_add_u32 s34, s34, 32768
 s_mov_b32 m0, s33
 s_nop 0
 buffer_load_dwordx4 v17, s[16:19], s34 offen lds
 s_add_u32 s33, s33, 1024
 s_add_u32 s34, s34, 32768
 s_mov_b32 m0, s33
 s_nop 0
 buffer_load_dwordx4 v17, s[16:19], s34 offen lds
 s_add_u32 s33, s33, 1024
 s_add_u32 s34, s34, 32768
 s_mov_b32 m0, s33
 s_nop 0
 buffer_load_dwordx4 v16, s[16:19], s34 offen lds
 s_add_u32 s33, s33, 1024
 s_add_u32 s34, s34, 32768
 s_mov_b32 m0, s33
 s_nop 0
 buffer_load_dwordx4 v16, s[16:19], s34 offen lds
 s_add_u32 s33, s33, 1024
 s_add_u32 s34, s34, 32768
 s_mov_b32 m0, s33
 s_nop 0
 buffer_load_dwordx4 v17, s[16:19], s34 offen lds
 s_add_u32 s33, s33, 1024
 s_add_u32 s34, s34, 32768
 s_mov_b32 m0, s33
 s_nop 0
 buffer_load_dwordx4 v17, s[16:19], s34 offen lds
 s_add_u32 s33, s33, 1024
 s_add_u32 s34, s34, 32768
 s_mov_b32 m0, s33
 s_nop 0
 buffer_load_dwordx4 v16, s[16:19], s34 offen lds
 s_add_u32 s33, s33, 1024
 s_add_u32 s34, s34, 32768
 s_mov_b32 m0, s33
 s_nop 0
 buffer_load_dwordx4 v16, s[16:19], s34 offen lds
 s_add_u32 s33, s33, 1024
 s_add_u32 s34, s34, 32768
 s_mov_b32 m0, s33
 s_nop 0
 buffer_load_dwordx4 v17, s[16:19], s34 offen lds
 s_add_u32 s33, s33, 1024
 s_add_u32 s34, s34, 32768
 s_mov_b32 m0, s33
 s_nop 0
 buffer_load_dwordx4 v17, s[16:19], s34 offen lds
 s_add_u32 s33, s33, 1024
 s_add_u32 s34, s34, 32768
 s_mov_b32 m0, s33
 s_nop 0
 buffer_load_dwordx4 v16, s[16:19], s34 offen lds
 s_add_u32 s33, s33, 1024
 s_add_u32 s34, s34, 32768
 s_mov_b32 m0, s33
 s_nop 0
 buffer_load_dwordx4 v16, s[16:19], s34 offen lds
 s_add_u32 s33, s33, 1024
 s_add_u32 s34, s34, 32768
 s_mov_b32 m0, s33
 s_nop 0
 buffer_load_dwordx4 v17, s[16:19], s34 offen lds
 s_add_u32 s33, s33, 1024
 s_add_u32 s34, s34, 32768
 s_mov_b32 m0, s33
 s_nop 0
 buffer_load_dwordx4 v17, s[16:19], s34 offen lds
 s_add_u32 s33, s33, 1024
 s_add_u32 s34, s34, 32768
 s_mov_b32 m0, s33
 s_nop 0
 buffer_load_dwordx4 v16, s[16:19], s34 offen lds
 s_add_u32 s33, s33, 1024
 s_add_u32 s34, s34, 32768
 s_mov_b32 m0, s33
 s_nop 0
 buffer_load_dwordx4 v16, s[16:19], s34 offen lds
 v_lshlrev_b32 v22, 4, v1
 v_lshrrev_b32 v23, 4, v1
 v_bfe_u32 v24, v1, 2, 2
 v_lshl_add_u32 v23, v23, 2, v24
 v_mul_u32_u24 v23, 1152, v23
 v_and_b32 v24, 3, v1
 v_lshl_add_u32 v23, v24, 4, v23
 s_mul_i32 s33, s14, 9
 s_lshr_b32 s43, s33, 1
 s_lshl_b32 s33, s43, 6
 v_add_u32 v23, s33, v23
 v_add_u32 v24, 73728, v23
 s_waitcnt vmcnt(18)
 s_barrier
 ds_read_b64_tr_b16 a[0:1], v11 offset:0
 ds_read_b64_tr_b16 a[2:3], v11 offset:1024
 ds_read_b64_tr_b16 a[4:5], v12 offset:0
 ds_read_b64_tr_b16 a[6:7], v12 offset:1024
 ds_read_b64_tr_b16 a[8:9], v11 offset:8192
 ds_read_b64_tr_b16 a[10:11], v11 offset:9216
 ds_read_b64_tr_b16 a[12:13], v12 offset:8192
 ds_read_b64_tr_b16 a[14:15], v12 offset:9216
 ds_read_b64_tr_b16 a[16:17], v11 offset:16384
 ds_read_b64_tr_b16 a[18:19], v11 offset:17408
 ds_read_b64_tr_b16 a[20:21], v12 offset:16384
 ds_read_b64_tr_b16 a[22:23], v12 offset:17408
 ds_read_b64_tr_b16 a[24:25], v11 offset:24576
 ds_read_b64_tr_b16 a[26:27], v11 offset:25600
 ds_read_b64_tr_b16 a[28:29], v12 offset:24576
 ds_read_b64_tr_b16 a[30:31], v12 offset:25600
 ds_read_b64_tr_b16 a[32:33], v11 offset:32768
 ds_read_b64_tr_b16 a[34:35], v11 offset:33792
 ds_read_b64_tr_b16 a[36:37], v12 offset:32768
 ds_read_b64_tr_b16 a[38:39], v12 offset:33792
 ds_read_b64_tr_b16 a[40:41], v11 offset:40960
 ds_read_b64_tr_b16 a[42:43], v11 offset:41984
 ds_read_b64_tr_b16 a[44:45], v12 offset:40960
 ds_read_b64_tr_b16 a[46:47], v12 offset:41984
 ds_read_b64_tr_b16 a[48:49], v11 offset:49152
 ds_read_b64_tr_b16 a[50:51], v11 offset:50176
 ds_read_b64_tr_b16 a[52:53], v12 offset:49152
 ds_read_b64_tr_b16 a[54:55], v12 offset:50176
 ds_read_b64_tr_b16 a[56:57], v11 offset:57344
 ds_read_b64_tr_b16 a[58:59], v11 offset:58368
 ds_read_b64_tr_b16 a[60:61], v12 offset:57344
 ds_read_b64_tr_b16 a[62:63], v12 offset:58368
 ds_read_b64_tr_b16 a[64:65], v18 offset:0
 ds_read_b64_tr_b16 a[66:67], v18 offset:1024
 ds_read_b64_tr_b16 a[68:69], v19 offset:0
 ds_read_b64_tr_b16 a[70:71], v19 offset:1024
 s_waitcnt lgkmcnt(0)
 s_barrier
 s_mul_i32 s33, s14, 18432
 s_mul_i32 s34, s40, 147456
 s_add_u32 s34, s34, s33
 s_add_u32 s34, s34, 0
 s_add_u32 s33, s33, 0
 s_mov_b32 m0, s33
 s_nop 0
 buffer_load_dwordx4 v22, s[20:23], s34 offen lds
 s_add_u32 s33, s33, 1024
 s_add_u32 s34, s34, 1024
 s_mov_b32 m0, s33
 s_nop 0
 buffer_load_dwordx4 v22, s[20:23], s34 offen lds
 s_add_u32 s33, s33, 1024
 s_add_u32 s34, s34, 1024
 s_mov_b32 m0, s33
 s_nop 0
 buffer_load_dwordx4 v22, s[20:23], s34 offen lds
 s_add_u32 s33, s33, 1024
 s_add_u32 s34, s34, 1024
 s_mov_b32 m0, s33
 s_nop 0
 buffer_load_dwordx4 v22, s[20:23], s34 offen lds
 s_add_u32 s33, s33, 1024
 s_add_u32 s34, s34, 1024
 s_mov_b32 m0, s33
 s_nop 0
 buffer_load_dwordx4 v22, s[20:23], s34 offen lds
 s_add_u32 s33, s33, 1024
 s_add_u32 s34, s34, 1024
 s_mov_b32 m0, s33
 s_nop 0
 buffer_load_dwordx4 v22, s[20:23], s34 offen lds
 s_add_u32 s33, s33, 1024
 s_add_u32 s34, s34, 1024
 s_mov_b32 m0, s33
 s_nop 0
 buffer_load_dwordx4 v22, s[20:23], s34 offen lds
 s_add_u32 s33, s33, 1024
 s_add_u32 s34, s34, 1024
 s_mov_b32 m0, s33
 s_nop 0
 buffer_load_dwordx4 v22, s[20:23], s34 offen lds
 s_add_u32 s33, s33, 1024
 s_add_u32 s34, s34, 1024
 s_mov_b32 m0, s33
 s_nop 0
 buffer_load_dwordx4 v22, s[20:23], s34 offen lds
 s_add_u32 s33, s33, 1024
 s_add_u32 s34, s34, 1024
 s_mov_b32 m0, s33
 s_nop 0
 buffer_load_dwordx4 v22, s[20:23], s34 offen lds
 s_add_u32 s33, s33, 1024
 s_add_u32 s34, s34, 1024
 s_mov_b32 m0, s33
 s_nop 0
 buffer_load_dwordx4 v22, s[20:23], s34 offen lds
 s_add_u32 s33, s33, 1024
 s_add_u32 s34, s34, 1024
 s_mov_b32 m0, s33
 s_nop 0
 buffer_load_dwordx4 v22, s[20:23], s34 offen lds
 s_add_u32 s33, s33, 1024
 s_add_u32 s34, s34, 1024
 s_mov_b32 m0, s33
 s_nop 0
 buffer_load_dwordx4 v22, s[20:23], s34 offen lds
 s_add_u32 s33, s33, 1024
 s_add_u32 s34, s34, 1024
 s_mov_b32 m0, s33
 s_nop 0
 buffer_load_dwordx4 v22, s[20:23], s34 offen lds
 s_add_u32 s33, s33, 1024
 s_add_u32 s34, s34, 1024
 s_mov_b32 m0, s33
 s_nop 0
 buffer_load_dwordx4 v22, s[20:23], s34 offen lds
 s_add_u32 s33, s33, 1024
 s_add_u32 s34, s34, 1024
 s_mov_b32 m0, s33
 s_nop 0
 buffer_load_dwordx4 v22, s[20:23], s34 offen lds
 s_add_u32 s33, s33, 1024
 s_add_u32 s34, s34, 1024
 s_mov_b32 m0, s33
 s_nop 0
 buffer_load_dwordx4 v22, s[20:23], s34 offen lds
 s_add_u32 s33, s33, 1024
 s_add_u32 s34, s34, 1024
 s_mov_b32 m0, s33
 s_nop 0
 buffer_load_dwordx4 v22, s[20:23], s34 offen lds
 s_waitcnt vmcnt(18)
 s_barrier
 ds_read_b64_tr_b16 a[72:73], v14 offset:0
 ds_read_b64_tr_b16 a[74:75], v14 offset:1024
 ds_read_b64_tr_b16 a[76:77], v15 offset:0
 ds_read_b64_tr_b16 a[78:79], v15 offset:1024
 ds_read_b64_tr_b16 a[80:81], v14 offset:8192
 ds_read_b64_tr_b16 a[82:83], v14 offset:9216
 ds_read_b64_tr_b16 a[84:85], v15 offset:8192
 ds_read_b64_tr_b16 a[86:87], v15 offset:9216
 ds_read_b64_tr_b16 a[88:89], v14 offset:16384
 ds_read_b64_tr_b16 a[90:91], v14 offset:17408
 ds_read_b64_tr_b16 a[92:93], v15 offset:16384
 ds_read_b64_tr_b16 a[94:95], v15 offset:17408
 ds_read_b64_tr_b16 a[96:97], v14 offset:24576
 ds_read_b64_tr_b16 a[98:99], v14 offset:25600
 ds_read_b64_tr_b16 a[100:101], v15 offset:24576
 ds_read_b64_tr_b16 a[102:103], v15 offset:25600
 ds_read_b64_tr_b16 a[104:105], v14 offset:32768
 ds_read_b64_tr_b16 a[106:107], v14 offset:33792
 ds_read_b64_tr_b16 a[108:109], v15 offset:32768
 ds_read_b64_tr_b16 a[110:111], v15 offset:33792
 ds_read_b64_tr_b16 a[112:113], v14 offset:40960
 ds_read_b64_tr_b16 a[114:115], v14 offset:41984
 ds_read_b64_tr_b16 a[116:117], v15 offset:40960
 ds_read_b64_tr_b16 a[118:119], v15 offset:41984
 ds_read_b64_tr_b16 a[120:121], v14 offset:49152
 ds_read_b64_tr_b16 a[122:123], v14 offset:50176
 ds_read_b64_tr_b16 a[124:125], v15 offset:49152
 ds_read_b64_tr_b16 a[126:127], v15 offset:50176
 ds_read_b64_tr_b16 a[128:129], v14 offset:57344
 ds_read_b64_tr_b16 a[130:131], v14 offset:58368
 ds_read_b64_tr_b16 a[132:133], v15 offset:57344
 ds_read_b64_tr_b16 a[134:135], v15 offset:58368
 ds_read_b64_tr_b16 a[136:137], v20 offset:0
 ds_read_b64_tr_b16 a[138:139], v20 offset:1024
 ds_read_b64_tr_b16 a[140:141], v21 offset:0
 ds_read_b64_tr_b16 a[142:143], v21 offset:1024
 s_waitcnt lgkmcnt(0)
 s_barrier
 s_mul_i32 s33, s14, 18432
 s_mul_i32 s34, s40, 147456
 s_add_u32 s34, s34, s33
 s_add_u32 s34, s34, 73728
 s_add_u32 s33, s33, 73728
 s_mov_b32 m0, s33
 s_nop 0
 buffer_load_dwordx4 v22, s[20:23], s34 offen lds
 s_add_u32 s33, s33, 1024
 s_add_u32 s34, s34, 1024
 s_mov_b32 m0, s33
 s_nop 0
 buffer_load_dwordx4 v22, s[20:23], s34 offen lds
 s_add_u32 s33, s33, 1024
 s_add_u32 s34, s34, 1024
 s_mov_b32 m0, s33
 s_nop 0
 buffer_load_dwordx4 v22, s[20:23], s34 offen lds
 s_add_u32 s33, s33, 1024
 s_add_u32 s34, s34, 1024
 s_mov_b32 m0, s33
 s_nop 0
 buffer_load_dwordx4 v22, s[20:23], s34 offen lds
 s_add_u32 s33, s33, 1024
 s_add_u32 s34, s34, 1024
 s_mov_b32 m0, s33
 s_nop 0
 buffer_load_dwordx4 v22, s[20:23], s34 offen lds
 s_add_u32 s33, s33, 1024
 s_add_u32 s34, s34, 1024
 s_mov_b32 m0, s33
 s_nop 0
 buffer_load_dwordx4 v22, s[20:23], s34 offen lds
 s_add_u32 s33, s33, 1024
 s_add_u32 s34, s34, 1024
 s_mov_b32 m0, s33
 s_nop 0
 buffer_load_dwordx4 v22, s[20:23], s34 offen lds
 s_add_u32 s33, s33, 1024
 s_add_u32 s34, s34, 1024
 s_mov_b32 m0, s33
 s_nop 0
 buffer_load_dwordx4 v22, s[20:23], s34 offen lds
 s_add_u32 s33, s33, 1024
 s_add_u32 s34, s34, 1024
 s_mov_b32 m0, s33
 s_nop 0
 buffer_load_dwordx4 v22, s[20:23], s34 offen lds
 s_add_u32 s33, s33, 1024
 s_add_u32 s34, s34, 1024
 s_mov_b32 m0, s33
 s_nop 0
 buffer_load_dwordx4 v22, s[20:23], s34 offen lds
 s_add_u32 s33, s33, 1024
 s_add_u32 s34, s34, 1024
 s_mov_b32 m0, s33
 s_nop 0
 buffer_load_dwordx4 v22, s[20:23], s34 offen lds
 s_add_u32 s33, s33, 1024
 s_add_u32 s34, s34, 1024
 s_mov_b32 m0, s33
 s_nop 0
 buffer_load_dwordx4 v22, s[20:23], s34 offen lds
 s_add_u32 s33, s33, 1024
 s_add_u32 s34, s34, 1024
 s_mov_b32 m0, s33
 s_nop 0
 buffer_load_dwordx4 v22, s[20:23], s34 offen lds
 s_add_u32 s33, s33, 1024
 s_add_u32 s34, s34, 1024
 s_mov_b32 m0, s33
 s_nop 0
 buffer_load_dwordx4 v22, s[20:23], s34 offen lds
 s_add_u32 s33, s33, 1024
 s_add_u32 s34, s34, 1024
 s_mov_b32 m0, s33
 s_nop 0
 buffer_load_dwordx4 v22, s[20:23], s34 offen lds
 s_add_u32 s33, s33, 1024
 s_add_u32 s34, s34, 1024
 s_mov_b32 m0, s33
 s_nop 0
 buffer_load_dwordx4 v22, s[20:23], s34 offen lds
 s_add_u32 s33, s33, 1024
 s_add_u32 s34, s34, 1024
 s_mov_b32 m0, s33
 s_nop 0
 buffer_load_dwordx4 v22, s[20:23], s34 offen lds
 s_add_u32 s33, s33, 1024
 s_add_u32 s34, s34, 1024
 s_mov_b32 m0, s33
 s_nop 0
 buffer_load_dwordx4 v22, s[20:23], s34 offen lds
 s_waitcnt vmcnt(18)
 s_barrier
 ds_read_b64_tr_b16 a[144:145], v23 offset:0
 ds_read_b64_tr_b16 a[146:147], v23 offset:18432
 ds_read_b64_tr_b16 a[160:161], v23 offset:8
 ds_read_b64_tr_b16 a[162:163], v23 offset:18440
 ds_read_b64_tr_b16 a[176:177], v23 offset:64
 ds_read_b64_tr_b16 a[178:179], v23 offset:18496
 ds_read_b64_tr_b16 a[192:193], v23 offset:72
 ds_read_b64_tr_b16 a[194:195], v23 offset:18504
 ds_read_b64_tr_b16 a[208:209], v23 offset:128
 ds_read_b64_tr_b16 a[210:211], v23 offset:18560
 ds_read_b64_tr_b16 a[224:225], v23 offset:136
 ds_read_b64_tr_b16 a[226:227], v23 offset:18568
 ds_read_b64_tr_b16 a[240:241], v23 offset:192
 ds_read_b64_tr_b16 a[242:243], v23 offset:18624
 ds_read_b64_tr_b16 v[208:209], v23 offset:200
 ds_read_b64_tr_b16 v[210:211], v23 offset:18632
 ds_read_b64_tr_b16 v[224:225], v23 offset:256
 ds_read_b64_tr_b16 v[226:227], v23 offset:18688
 ds_read_b64_tr_b16 v[240:241], v23 offset:264
 ds_read_b64_tr_b16 v[242:243], v23 offset:18696
 ds_read_b64_tr_b16 a[148:149], v23 offset:36864
 ds_read_b64_tr_b16 a[150:151], v23 offset:55296
 ds_read_b64_tr_b16 a[164:165], v23 offset:36872
 ds_read_b64_tr_b16 a[166:167], v23 offset:55304
 ds_read_b64_tr_b16 a[180:181], v23 offset:36928
 ds_read_b64_tr_b16 a[182:183], v23 offset:55360
 ds_read_b64_tr_b16 a[196:197], v23 offset:36936
 ds_read_b64_tr_b16 a[198:199], v23 offset:55368
 ds_read_b64_tr_b16 a[212:213], v23 offset:36992
 ds_read_b64_tr_b16 a[214:215], v23 offset:55424
 ds_read_b64_tr_b16 a[228:229], v23 offset:37000
 ds_read_b64_tr_b16 a[230:231], v23 offset:55432
 ds_read_b64_tr_b16 a[244:245], v23 offset:37056
 ds_read_b64_tr_b16 a[246:247], v23 offset:55488
 ds_read_b64_tr_b16 v[212:213], v23 offset:37064
 ds_read_b64_tr_b16 v[214:215], v23 offset:55496
 ds_read_b64_tr_b16 v[228:229], v23 offset:37120
 ds_read_b64_tr_b16 v[230:231], v23 offset:55552
 ds_read_b64_tr_b16 v[244:245], v23 offset:37128
 ds_read_b64_tr_b16 v[246:247], v23 offset:55560
 s_waitcnt vmcnt(0)
 s_waitcnt lgkmcnt(0)
 s_barrier
 ds_read_b64_tr_b16 a[152:153], v24 offset:0
 ds_read_b64_tr_b16 a[154:155], v24 offset:18432
 ds_read_b64_tr_b16 a[168:169], v24 offset:8
 ds_read_b64_tr_b16 a[170:171], v24 offset:18440
 ds_read_b64_tr_b16 a[184:185], v24 offset:64
 ds_read_b64_tr_b16 a[186:187], v24 offset:18496
 ds_read_b64_tr_b16 a[200:201], v24 offset:72
 ds_read_b64_tr_b16 a[202:203], v24 offset:18504
 ds_read_b64_tr_b16 a[216:217], v24 offset:128
 ds_read_b64_tr_b16 a[218:219], v24 offset:18560
 ds_read_b64_tr_b16 a[232:233], v24 offset:136
 ds_read_b64_tr_b16 a[234:235], v24 offset:18568
 ds_read_b64_tr_b16 a[248:249], v24 offset:192
 ds_read_b64_tr_b16 a[250:251], v24 offset:18624
 ds_read_b64_tr_b16 v[216:217], v24 offset:200
 ds_read_b64_tr_b16 v[218:219], v24 offset:18632
 ds_read_b64_tr_b16 v[232:233], v24 offset:256
 ds_read_b64_tr_b16 v[234:235], v24 offset:18688
 ds_read_b64_tr_b16 v[248:249], v24 offset:264
 ds_read_b64_tr_b16 v[250:251], v24 offset:18696
 ds_read_b64_tr_b16 a[156:157], v24 offset:36864
 ds_read_b64_tr_b16 a[158:159], v24 offset:55296
 ds_read_b64_tr_b16 a[172:173], v24 offset:36872
 ds_read_b64_tr_b16 a[174:175], v24 offset:55304
 ds_read_b64_tr_b16 a[188:189], v24 offset:36928
 ds_read_b64_tr_b16 a[190:191], v24 offset:55360
 ds_read_b64_tr_b16 a[204:205], v24 offset:36936
 ds_read_b64_tr_b16 a[206:207], v24 offset:55368
 ds_read_b64_tr_b16 a[220:221], v24 offset:36992
 ds_read_b64_tr_b16 a[222:223], v24 offset:55424
 ds_read_b64_tr_b16 a[236:237], v24 offset:37000
 ds_read_b64_tr_b16 a[238:239], v24 offset:55432
 ds_read_b64_tr_b16 a[252:253], v24 offset:37056
 ds_read_b64_tr_b16 a[254:255], v24 offset:55488
 ds_read_b64_tr_b16 v[220:221], v24 offset:37064
 ds_read_b64_tr_b16 v[222:223], v24 offset:55496
 ds_read_b64_tr_b16 v[236:237], v24 offset:37120
 ds_read_b64_tr_b16 v[238:239], v24 offset:55552
 ds_read_b64_tr_b16 v[252:253], v24 offset:37128
 ds_read_b64_tr_b16 v[254:255], v24 offset:55560
 s_waitcnt lgkmcnt(0)
 s_barrier
 s_cmp_lg_u32 s14, 0
 s_cbranch_scc1 L_gw29
 v_lshlrev_b32 v3, 2, v1
 v_and_b32 v3, 31, v3
poll30:
 buffer_load_dword v2, v3, s[8:11], 0 offen offset:32 sc1
 s_waitcnt vmcnt(0)
 v_cmp_le_u32 vcc, 32, v2
 s_cmp_eq_u64 vcc, exec
 s_cbranch_scc1 polld31
 s_cmp_eq_u32 s15, 0
 s_cbranch_scc1 polld31
 s_sub_u32 s15, s15, 1
 s_sleep 4
 s_branch poll30
polld31:
L_gw29:
 s_barrier
 v_lshlrev_b32 v2, 4, v1
 s_and_b32 s55, s14, 1
 s_lshr_b32 s56, s14, 1
 s_mov_b32 s44, 0
 s_mov_b32 s45, 0
 s_lshl_b32 s48, s44, 1
 s_add_u32 s48, s48, s41
 s_min_u32 s48, s48, 63
 s_mul_i32 s48, s48, 36864
 s_mul_i32 s49, s14, 9216
 s_add_u32 s48, s48, s49
 s_add_u32 s48, s48, 1048576
 s_add_u32 s49, s49, s45
 s_mov_b32 m0, s49
 s_nop 0
 buffer_load_dwordx4 v2, s[4:7], s48 offen offset:0 lds
 buffer_load_dwordx4 v2, s[4:7], s48 offen offset:1024 lds
 buffer_load_dwordx4 v2, s[4:7], s48 offen offset:2048 lds
 buffer_load_dwordx4 v2, s[4:7], s48 offen offset:3072 lds
 s_add_u32 s49, s49, 4096
 s_add_u32 s48, s48, 4096
 s_mov_b32 m0, s49
 s_nop 0
 buffer_load_dwordx4 v2, s[4:7], s48 offen offset:0 lds
 buffer_load_dwordx4 v2, s[4:7], s48 offen offset:1024 lds
 buffer_load_dwordx4 v2, s[4:7], s48 offen offset:2048 lds
 buffer_load_dwordx4 v2, s[4:7], s48 offen offset:3072 lds
 s_add_u32 s49, s49, 4096
 s_add_u32 s48, s48, 4096
 s_mov_b32 m0, s49
 s_nop 0
 buffer_load_dwordx4 v2, s[4:7], s48 offen offset:0 lds
 s_mov_b32 s44, 1
 s_mov_b32 s45, 36864
 s_lshl_b32 s48, s44, 1
 s_add_u32 s48, s48, s41
 s_min_u32 s48, s48, 63
 s_mul_i32 s48, s48, 36864
 s_mul_i32 s49, s14, 9216
 s_add_u32 s48, s48, s49
 s_add_u32 s48, s48, 1048576
 s_add_u32 s49, s49, s45
 s_mov_b32 m0, s49
 s_nop 0
 buffer_load_dwordx4 v2, s[4:7], s48 offen offset:0 lds
 buffer_load_dwordx4 v2, s[4:7], s48 offen offset:1024 lds
 buffer_load_dwordx4 v2, s[4:7], s48 offen offset:2048 lds
 buffer_load_dwordx4 v2, s[4:7], s48 offen offset:3072 lds
 s_add_u32 s49, s49, 4096
 s_add_u32 s48, s48, 4096
 s_mov_b32 m0, s49
 s_nop 0
 buffer_load_dwordx4 v2, s[4:7], s48 offen offset:0 lds
 buffer_load_dwordx4 v2, s[4:7], s48 offen offset:1024 lds
 buffer_load_dwordx4 v2, s[4:7], s48 offen offset:2048 lds
 buffer_load_dwordx4 v2, s[4:7], s48 offen offset:3072 lds
 s_add_u32 s49, s49, 4096
 s_add_u32 s48, s48, 4096
 s_mov_b32 m0, s49
 s_nop 0
 buffer_load_dwordx4 v2, s[4:7], s48 offen offset:0 lds
 s_mov_b32 s44, 0
 s_mov_b32 s45, 0
 s_waitcnt vmcnt(9)
L_sq32:
 s_waitcnt vmcnt(11)
 s_barrier
 v_add_u32 v3, s45, v2
 ds_read_b128 v[16:19], v3 offset:0
 ds_read_b128 v[20:23], v3 offset:18432
 ds_read_b128 v[24:27], v3 offset:1024
 ds_read_b128 v[28:31], v3 offset:19456
 ds_read_b128 v[32:35], v3 offset:2048
 ds_read_b128 v[36:39], v3 offset:20480
 s_add_u32 s50, s44, 2
 s_add_u32 s51, s45, 73728
 s_cmp_ge_u32 s51, 110592
 s_cselect_b32 s47, 110592, 0
 s_sub_u32 s51, s51, s47
 s_waitcnt lgkmcnt(5)
 v_mfma_f32_16x16x32_bf16 v[48:51], a[0:3], v[16:19], 0
 s_waitcnt lgkmcnt(4)
 v_mfma_f32_16x16x32_bf16 v[52:55], a[0:3], v[20:23], 0
 ds_read_b128 v[40:43], v3 offset:3072
 ds_read_b128 v[44:47], v3 offset:21504
 v_mfma_f32_16x16x32_bf16 v[56:59], a[4:7], v[16:19], 0
 v_mfma_f32_16x16x32_bf16 v[60:63], a[4:7], v[20:23], 0
 s_lshl_b32 s48, s50, 1
 s_add_u32 s48, s48, s41
 s_min_u32 s48, s48, 63
 s_mul_i32 s48, s48, 36864
 s_mul_i32 s49, s14, 9216
 s_add_u32 s48, s48, s49
 s_add_u32 s48, s48, 1048576
 s_add_u32 s49, s49, s51
 s_mov_b32 m0, s49
 s_nop 0
 buffer_load_dwordx4 v2, s[4:7], s48 offen offset:0 lds
 s_waitcnt lgkmcnt(5)
 v_mfma_f32_16x16x32_bf16 v[48:51], a[8:11], v[24:27], v[48:51]
 s_waitcnt lgkmcnt(4)
 v_mfma_f32_16x16x32_bf16 v[52:55], a[8:11], v[28:31], v[52:55]
 ds_read_b128 v[16:19], v3 offset:4096
 ds_read_b128 v[20:23], v3 offset:22528
 v_mfma_f32_16x16x32_bf16 v[56:59], a[12:15], v[24:27], v[56:59]
 v_mfma_f32_16x16x32_bf16 v[60:63], a[12:15], v[28:31], v[60:63]
 s_waitcnt lgkmcnt(5)
 v_mfma_f32_16x16x32_bf16 v[48:51], a[16:19], v[32:35], v[48:51]
 s_waitcnt lgkmcnt(4)
 v_mfma_f32_16x16x32_bf16 v[52:55], a[16:19], v[36:39], v[52:55]
 ds_read_b128 v[24:27], v3 offset:5120
 ds_read_b128 v[28:31], v3 offset:23552
 v_mfma_f32_16x16x32_bf16 v[56:59], a[20:23], v[32:35], v[56:59]
 v_mfma_f32_16x16x32_bf16 v[60:63], a[20:23], v[36:39], v[60:63]
 buffer_load_dwordx4 v2, s[4:7], s48 offen offset:1024 lds
 s_waitcnt lgkmcnt(5)
 v_mfma_f32_16x16x32_bf16 v[48:51], a[24:27], v[40:43], v[48:51]
 s_waitcnt lgkmcnt(4)
 v_mfma_f32_16x16x32_bf16 v[52:55], a[24:27], v[44:47], v[52:55]
 ds_read_b128 v[32:35], v3 offset:6144
 ds_read_b128 v[36:39], v3 offset:24576
 v_mfma_f32_16x16x32_bf16 v[56:59], a[28:31], v[40:43], v[56:59]
 v_mfma_f32_16x16x32_bf16 v[60:63], a[28:31], v[44:47], v[60:63]
 s_waitcnt lgkmcnt(5)
 v_mfma_f32_16x16x32_bf16 v[48:51], a[32:35], v[16:19], v[48:51]
 s_waitcnt lgkmcnt(4)
 v_mfma_f32_16x16x32_bf16 v[52:55], a[32:35], v[20:23], v[52:55]
 ds_read_b128 v[40:43], v3 offset:7168
 ds_read_b128 v[44:47], v3 offset:25600
 v_mfma_f32_16x16x32_bf16 v[56:59], a[36:39], v[16:19], v[56:59]
 v_mfma_f32_16x16x32_bf16 v[60:63], a[36:39], v[20:23], v[60:63]
 buffer_load_dwordx4 v2, s[4:7], s48 offen offset:2048 lds
 s_waitcnt lgkmcnt(5)
 v_mfma_f32_16x16x32_bf16 v[48:51], a[40:43], v[24:27], v[48:51]
 s_waitcnt lgkmcnt(4)
 v_mfma_f32_16x16x32_bf16 v[52:55], a[40:43], v[28:31], v[52:55]
 ds_read_b128 v[16:19], v3 offset:8192
 ds_read_b128 v[20:23], v3 offset:26624
 v_mfma_f32_16x16x32_bf16 v[56:59], a[44:47], v[24:27], v[56:59]
 v_mfma_f32_16x16x32_bf16 v[60:63], a[44:47], v[28:31], v[60:63]
 s_waitcnt lgkmcnt(5)
 v_mfma_f32_16x16x32_bf16 v[48:51], a[48:51], v[32:35], v[48:51]
 s_waitcnt lgkmcnt(4)
 v_mfma_f32_16x16x32_bf16 v[52:55], a[48:51], v[36:39], v[52:55]
 ds_read_b128 v[24:27], v3 offset:9216
 ds_read_b128 v[28:31], v3 offset:27648
 v_mfma_f32_16x16x32_bf16 v[56:59], a[52:55], v[32:35], v[56:59]
 v_mfma_f32_16x16x32_bf16 v[60:63], a[52:55], v[36:39], v[60:63]
 buffer_load_dwordx4 v2, s[4:7], s48 offen offset:3072 lds
 s_waitcnt lgkmcnt(5)
 v_mfma_f32_16x16x32_bf16 v[48:51], a[56:59], v[40:43], v[48:51]
 s_waitcnt lgkmcnt(4)
 v_mfma_f32_16x16x32_bf16 v[52:55], a[56:59], v[44:47], v[52:55]
 ds_read_b128 v[32:35], v3 offset:10240
 ds_read_b128 v[36:39], v3 offset:28672
 v_mfma_f32_16x16x32_bf16 v[56:59], a[60:63], v[40:43], v[56:59]
 v_mfma_f32_16x16x32_bf16 v[60:63], a[60:63], v[44:47], v[60:63]
 s_waitcnt lgkmcnt(5)
 v_mfma_f32_16x16x32_bf16 v[48:51], a[64:67], v[16:19], v[48:51]
 s_waitcnt lgkmcnt(4)
 v_mfma_f32_16x16x32_bf16 v[52:55], a[64:67], v[20:23], v[52:55]
 ds_read_b128 v[40:43], v3 offset:11264
 ds_read_b128 v[44:47], v3 offset:29696
 v_mfma_f32_16x16x32_bf16 v[56:59], a[68:71], v[16:19], v[56:59]
 v_mfma_f32_16x16x32_bf16 v[60:63], a[68:71], v[20:23], v[60:63]
 s_add_u32 s49, s49, 4096
 s_add_u32 s48, s48, 4096
 s_mov_b32 m0, s49
 s_nop 0
 buffer_load_dwordx4 v2, s[4:7], s48 offen offset:0 lds
 s_waitcnt lgkmcnt(5)
 v_mfma_f32_16x16x32_bf16 v[48:51], a[72:75], v[24:27], v[48:51]
 s_waitcnt lgkmcnt(4)
 v_mfma_f32_16x16x32_bf16 v[52:55], a[72:75], v[28:31], v[52:55]
 ds_read_b128 v[16:19], v3 offset:12288
 ds_read_b128 v[20:23], v3 offset:30720
 v_mfma_f32_16x16x32_bf16 v[56:59], a[76:79], v[24:27], v[56:59]
 v_mfma_f32_16x16x32_bf16 v[60:63], a[76:79], v[28:31], v[60:63]
 s_waitcnt lgkmcnt(5)
 v_mfma_f32_16x16x32_bf16 v[48:51], a[80:83], v[32:35], v[48:51]
 s_waitcnt lgkmcnt(4)
 v_mfma_f32_16x16x32_bf16 v[52:55], a[80:83], v[36:39], v[52:55]
 ds_read_b128 v[24:27], v3 offset:13312
 ds_read_b128 v[28:31], v3 offset:31744
 v_mfma_f32_16x16x32_bf16 v[56:59], a[84:87], v[32:35], v[56:59]
 v_mfma_f32_16x16x32_bf16 v[60:63], a[84:87], v[36:39], v[60:63]
 buffer_load_dwordx4 v2, s[4:7], s48 offen offset:1024 lds
 s_waitcnt lgkmcnt(5)
 v_mfma_f32_16x16x32_bf16 v[48:51], a[88:91], v[40:43], v[48:51]
 s_waitcnt lgkmcnt(4)
 v_mfma_f32_16x16x32_bf16 v[52:55], a[88:91], v[44:47], v[52:55]
 ds_read_b128 v[32:35], v3 offset:14336
 ds_read_b128 v[36:39], v3 offset:32768
 v_mfma_f32_16x16x32_bf16 v[56:59], a[92:95], v[40:43], v[56:59]
 v_mfma_f32_16x16x32_bf16 v[60:63], a[92:95], v[44:47], v[60:63]
 s_waitcnt lgkmcnt(5)
 v_mfma_f32_16x16x32_bf16 v[48:51], a[96:99], v[16:19], v[48:51]
 s_waitcnt lgkmcnt(4)
 v_mfma_f32_16x16x32_bf16 v[52:55], a[96:99], v[20:23], v[52:55]
 ds_read_b128 v[40:43], v3 offset:15360
 ds_read_b128 v[44:47], v3 offset:33792
 v_mfma_f32_16x16x32_bf16 v[56:59], a[100:103], v[16:19], v[56:59]
 v_mfma_f32_16x16x32_bf16 v[60:63], a[100:103], v[20:23], v[60:63]
 buffer_load_dwordx4 v2, s[4:7], s48 offen offset:2048 lds
 s_waitcnt lgkmcnt(5)
 v_mfma_f32_16x16x32_bf16 v[48:51], a[104:107], v[24:27], v[48:51]
 s_waitcnt lgkmcnt(4)
 v_mfma_f32_16x16x32_bf16 v[52:55], a[104:107], v[28:31], v[52:55]
 ds_read_b128 v[16:19], v3 offset:16384
 ds_read_b128 v[20:23], v3 offset:34816
 v_mfma_f32_16x16x32_bf16 v[56:59], a[108:111], v[24:27], v[56:59]
 v_mfma_f32_16x16x32_bf16 v[60:63], a[108:111], v[28:31], v[60:63]
 s_waitcnt lgkmcnt(5)
 v_mfma_f32_16x16x32_bf16 v[48:51], a[112:115], v[32:35], v[48:51]
 s_waitcnt lgkmcnt(4)
 v_mfma_f32_16x16x32_bf16 v[52:55], a[112:115], v[36:39], v[52:55]
 ds_read_b128 v[24:27], v3 offset:17408
 ds_read_b128 v[28:31], v3 offset:35840
 v_mfma_f32_16x16x32_bf16 v[56:59], a[116:119], v[32:35], v[56:59]
 v_mfma_f32_16x16x32_bf16 v[60:63], a[116:119], v[36:39], v[60:63]
 buffer_load_dwordx4 v2, s[4:7], s48 offen offset:3072 lds
 s_waitcnt lgkmcnt(5)
 v_mfma_f32_16x16x32_bf16 v[48:51], a[120:123], v[40:43], v[48:51]
 s_waitcnt lgkmcnt(4)
 v_mfma_f32_16x16x32_bf16 v[52:55], a[120:123], v[44:47], v[52:55]
 v_mfma_f32_16x16x32_bf16 v[56:59], a[124:127], v[40:43], v[56:59]
 v_mfma_f32_16x16x32_bf16 v[60:63], a[124:127], v[44:47], v[60:63]
 s_waitcnt lgkmcnt(3)
 v_mfma_f32_16x16x32_bf16 v[48:51], a[128:131], v[16:19], v[48:51]
 s_waitcnt lgkmcnt(2)
 v_mfma_f32_16x16x32_bf16 v[52:55], a[128:131], v[20:23], v[52:55]
 v_mfma_f32_16x16x32_bf16 v[56:59], a[132:135], v[16:19], v[56:59]
 v_mfma_f32_16x16x32_bf16 v[60:63], a[132:135], v[20:23], v[60:63]
 s_add_u32 s49, s49, 4096
 s_add_u32 s48, s48, 4096
 s_mov_b32 m0, s49
 s_nop 0
 buffer_load_dwordx4 v2, s[4:7], s48 offen offset:0 lds
 s_waitcnt lgkmcnt(1)
 v_mfma_f32_16x16x32_bf16 v[48:51], a[136:139], v[24:27], v[48:51]
 s_waitcnt lgkmcnt(0)
 v_mfma_f32_16x16x32_bf16 v[52:55], a[136:139], v[28:31], v[52:55]
 v_mfma_f32_16x16x32_bf16 v[56:59], a[140:143], v[24:27], v[56:59]
 v_mfma_f32_16x16x32_bf16 v[60:63], a[140:143], v[28:31], v[60:63]
 s_lshl_b32 s47, s44, 1
 s_add_u32 s47, s47, s41
 s_lshl_b32 s47, s47, 5
 s_add_u32 s47, s47, s40
 s_lshl_b32 s47, s47, 13
 s_lshl_b32 s48, s14, 10
 s_add_u32 s47, s47, s48
 s_add_u32 s47, s47, 161480704
 s_add_u32 s48, s47, 4096
 v_cvt_pk_bf16_f32 v64, v48, v49
 v_cvt_pk_bf16_f32 v65, v50, v51
 v_cvt_pk_bf16_f32 v66, v56, v57
 v_cvt_pk_bf16_f32 v67, v58, v59
 buffer_store_dwordx4 v[64:67], v2, s[4:7], s47 offen
 v_cvt_pk_bf16_f32 v68, v52, v53
 v_cvt_pk_bf16_f32 v69, v54, v55
 v_cvt_pk_bf16_f32 v70, v60, v61
 v_cvt_pk_bf16_f32 v71, v62, v63
 buffer_store_dwordx4 v[68:71], v2, s[4:7], s48 offen
 s_add_u32 s45, s45, 36864
 s_cmp_ge_u32 s45, 110592
 s_cselect_b32 s45, 0, s45
 s_add_u32 s44, s44, 1
 s_cmp_lt_u32 s44, 32
 s_cbranch_scc1 L_sq32
 s_waitcnt vmcnt(0)
 s_barrier
 v_add_u32 v3, 8192, v2
 s_lshl_b32 s33, s55, 12
 v_add_u32 v4, s33, v3
 s_lshl_b32 s33, s56, 12
 v_add_u32 v5, s33, v3
 v_add_u32 v7, s33, v2
 s_lshl_b32 s33, s55, 12
 s_lshl_b32 s34, s56, 11
 s_add_u32 s33, s33, s34
 s_add_u32 s33, s33, 0
 v_add_u32 v6, s33, v2
 v_and_b32 v48, 15, v1
 s_lshl_b32 s33, s55, 4
 v_add_u32 v48, s33, v48
 v_lshrrev_b32 v49, 4, v1
 v_lshlrev_b32 v49, 2, v49
 v_mov_b32 v50, 0xff800000
 v_mov_b32 v52, 0
 v_add_u32 v51, 0, v49
 v_cmp_le_u32 vcc, v51, v48
 s_nop 1
 v_cndmask_b32 v8, v50, v52, vcc
 v_add_u32 v51, 1, v49
 v_cmp_le_u32 vcc, v51, v48
 s_nop 1
 v_cndmask_b32 v9, v50, v52, vcc
 v_add_u32 v51, 2, v49
 v_cmp_le_u32 vcc, v51, v48
 s_nop 1
 v_cndmask_b32 v10, v50, v52, vcc
 v_add_u32 v51, 3, v49
 v_cmp_le_u32 vcc, v51, v48
 s_nop 1
 v_cndmask_b32 v11, v50, v52, vcc
 v_add_u32 v51, 16, v49
 v_cmp_le_u32 vcc, v51, v48
 s_nop 1
 v_cndmask_b32 v12, v50, v52, vcc
 v_add_u32 v51, 17, v49
 v_cmp_le_u32 vcc, v51, v48
 s_nop 1
 v_cndmask_b32 v13, v50, v52, vcc
 v_add_u32 v51, 18, v49
 v_cmp_le_u32 vcc, v51, v48
 s_nop 1
 v_cndmask_b32 v14, v50, v52, vcc
 v_add_u32 v51, 19, v49
 v_cmp_le_u32 vcc, v51, v48
 s_nop 1
 v_cndmask_b32 v15, v50, v52, vcc
 v_mov_b32 v0, 0
 s_lshl_b32 s59, s40, 7
 s_add_u32 s59, s59, 4096
 s_mov_b32 s44, 0
 s_mov_b32 s45, 8192
 s_mov_b32 s53, 0
 s_mov_b32 s54, 0
 s_mov_b32 s57, 0
 s_mov_b32 s46, s41
 s_min_u32 s34, s44, 31
 s_cmp_gt_u32 s53, s34
 s_cbranch_scc1 L_kvok33
 s_add_u32 s34, s34, 1
 s_lshl_b32 s33, s41, 7
 s_lshl_b32 s35, s40, 2
 s_add_u32 s33, s33, s35
 s_add_u32 s33, s33, 0
poll34:
 buffer_load_dword v62, v0, s[4:7], s33 offen sc1
 s_waitcnt vmcnt(0)
 v_cmp_le_u32 vcc, s34, v62
 s_cmp_eq_u64 vcc, exec
 s_cbranch_scc1 polld35
 s_cmp_eq_u32 s15, 0
 s_cbranch_scc1 polld35
 s_sub_u32 s15, s15, 1
 s_sleep 2
 s_branch poll34
polld35:
 v_readfirstlane_b32 s53, v62
L_kvok33:
 s_lshl_b32 s50, s46, 5
 s_add_u32 s50, s50, s40
 s_lshl_b32 s50, s50, 13
 s_lshl_b32 s51, s14, 11
 s_add_u32 s50, s50, s51
 s_add_u32 s51, s51, s45
 s_add_u32 m0, s51, 0
 s_add_u32 s52, s50, 161480704
 buffer_load_dwordx4 v2, s[4:7], s52 offen offset:0 lds
 buffer_load_dwordx4 v2, s[4:7], s52 offen offset:1024 lds
 s_add_u32 m0, s51, 8192
 s_add_u32 s52, s50, 4194304
 buffer_load_dwordx4 v2, s[4:7], s52 offen offset:0 lds
 buffer_load_dwordx4 v2, s[4:7], s52 offen offset:1024 lds
 s_add_u32 m0, s51, 16384
 s_add_u32 s52, s50, 20971520
 buffer_load_dwordx4 v2, s[4:7], s52 offen offset:0 lds
 buffer_load_dwordx4 v2, s[4:7], s52 offen offset:1024 lds
 s_waitcnt vmcnt(0)
L_sh36:
 s_waitcnt vmcnt(9)
 s_barrier
 ds_read_b128 v[16:19], v4 offset:0
 ds_read_b128 v[64:67], v3 offset:8192
 ds_read_b128 v[68:71], v3 offset:9216
 ds_read_b128 v[20:23], v4 offset:1024
 ds_read_b128 v[72:75], v3 offset:10240
 ds_read_b128 v[76:79], v3 offset:11264
 ds_read_b128 v[24:27], v4 offset:2048
 ds_read_b128 v[80:83], v3 offset:12288
 ds_read_b128 v[84:87], v3 offset:13312
 ds_read_b128 v[28:31], v4 offset:3072
 ds_read_b128 v[88:91], v3 offset:14336
 ds_read_b128 v[92:95], v3 offset:15360
 s_add_u32 s58, s46, 2
 s_add_u32 s33, s41, 62
 s_min_u32 s58, s58, s33
 s_waitcnt lgkmcnt(10)
 v_mfma_f32_16x16x32_bf16 v[48:51], v[64:67], v[16:19], v[8:11]
 s_waitcnt lgkmcnt(9)
 v_mfma_f32_16x16x32_bf16 v[52:55], v[68:71], v[16:19], v[12:15]
 s_waitcnt lgkmcnt(7)
 v_mfma_f32_16x16x32_bf16 v[48:51], v[72:75], v[20:23], v[48:51]
 s_waitcnt lgkmcnt(6)
 v_mfma_f32_16x16x32_bf16 v[52:55], v[76:79], v[20:23], v[52:55]
 s_cmp_eq_u32 s57, 0
 s_cbranch_scc1 L_late38
 ds_read_b128 v[96:99], v3 offset:24576
 ds_read_b128 v[100:103], v3 offset:26624
 ds_read_b128 v[104:107], v3 offset:28672
 ds_read_b128 v[108:111], v3 offset:30720
 ds_read_b128 v[128:131], v5 offset:25600
 ds_read_b128 v[132:135], v5 offset:27648
L_late38:
 s_waitcnt lgkmcnt(4)
 v_mfma_f32_16x16x32_bf16 v[48:51], v[80:83], v[24:27], v[48:51]
 s_waitcnt lgkmcnt(3)
 v_mfma_f32_16x16x32_bf16 v[52:55], v[84:87], v[24:27], v[52:55]
 s_waitcnt lgkmcnt(1)
 v_mfma_f32_16x16x32_bf16 v[48:51], v[88:91], v[28:31], v[48:51]
 s_waitcnt lgkmcnt(0)
 v_mfma_f32_16x16x32_bf16 v[52:55], v[92:95], v[28:31], v[52:55]
 ds_read_b128 v[112:115], v5 offset:16384
 ds_read_b128 v[116:119], v5 offset:17408
 ds_read_b128 v[120:123], v5 offset:18432
 ds_read_b128 v[124:127], v5 offset:19456
 s_add_u32 s37, s44, 1
 s_min_u32 s34, s37, 31
 s_cmp_gt_u32 s53, s34
 s_cbranch_scc1 L_kvok40
 s_add_u32 s34, s34, 1
 s_lshl_b32 s33, s41, 7
 s_lshl_b32 s35, s40, 2
 s_add_u32 s33, s33, s35
 s_add_u32 s33, s33, 0
poll41:
 buffer_load_dword v62, v0, s[4:7], s33 offen sc1
 s_waitcnt vmcnt(0)
 v_cmp_le_u32 vcc, s34, v62
 s_cmp_eq_u64 vcc, exec
 s_cbranch_scc1 polld42
 s_cmp_eq_u32 s15, 0
 s_cbranch_scc1 polld42
 s_sub_u32 s15, s15, 1
 s_sleep 2
 s_branch poll41
polld42:
 v_readfirstlane_b32 s53, v62
L_kvok40:
 s_cmp_lg_u32 s14, 0
 s_cbranch_scc1 L_nofl43
 buffer_load_dword v1, v0, s[4:7], s59 offen sc1
L_nofl43:
 s_xor_b32 s36, s45, 32768
 s_lshl_b32 s50, s58, 5
 s_add_u32 s50, s50, s40
 s_lshl_b32 s50, s50, 13
 s_lshl_b32 s51, s14, 11
 s_add_u32 s50, s50, s51
 s_add_u32 s51, s51, s36
 s_add_u32 m0, s51, 0
 s_add_u32 s52, s50, 161480704
 buffer_load_dwordx4 v2, s[4:7], s52 offen offset:0 lds
 buffer_load_dwordx4 v2, s[4:7], s52 offen offset:1024 lds
 s_add_u32 m0, s51, 8192
 s_add_u32 s52, s50, 4194304
 buffer_load_dwordx4 v2, s[4:7], s52 offen offset:0 lds
 buffer_load_dwordx4 v2, s[4:7], s52 offen offset:1024 lds
 s_add_u32 m0, s51, 16384
 s_add_u32 s52, s50, 20971520
 buffer_load_dwordx4 v2, s[4:7], s52 offen offset:0 lds
 buffer_load_dwordx4 v2, s[4:7], s52 offen offset:1024 lds
 s_cmp_lg_u32 s57, 0
 s_cbranch_scc1 L_chok37
 s_cmp_ge_u32 s46, 58
 s_cbranch_scc1 L_dp44
 s_cmp_gt_u32 s54, s46
 s_cbranch_scc1 L_chok39
 s_add_u32 s34, s46, 1
poll45:
 buffer_load_dword v60, v0, s[4:7], s59 offen sc1
 s_waitcnt vmcnt(0)
 v_cmp_le_u32 vcc, s34, v60
 s_cmp_eq_u64 vcc, exec
 s_cbranch_scc1 polld46
 s_cmp_eq_u32 s15, 0
 s_cbranch_scc1 polld46
 s_sub_u32 s15, s15, 1
 s_sleep 1
 s_branch poll45
polld46:
 v_readfirstlane_b32 s54, v60
L_chok39:
 s_lshl_b32 s47, s46, 5
 s_add_u32 s47, s47, s40
 s_lshl_b32 s47, s47, 13
 s_add_u32 s47, s47, 37748736
 s_add_u32 s48, s47, 4096
 buffer_load_dwordx4 v[96:99], v2, s[4:7], s47 offen offset:0
 buffer_load_dwordx4 v[100:103], v2, s[4:7], s47 offen offset:2048
 buffer_load_dwordx4 v[104:107], v2, s[4:7], s48 offen offset:0
 buffer_load_dwordx4 v[108:111], v2, s[4:7], s48 offen offset:2048
 buffer_load_dwordx4 v[128:131], v7, s[4:7], s47 offen offset:1024
 buffer_load_dwordx4 v[132:135], v7, s[4:7], s47 offen offset:3072
 s_waitcnt vmcnt(0)
L_chok37:
 v_mfma_f32_16x16x32_bf16 v[56:59], v[96:99], v[16:19], 0
 v_mfma_f32_16x16x32_bf16 v[56:59], v[100:103], v[20:23], v[56:59]
 v_mfma_f32_16x16x32_bf16 v[56:59], v[104:107], v[24:27], v[56:59]
 v_mfma_f32_16x16x32_bf16 v[56:59], v[108:111], v[28:31], v[56:59]
 v_max3_f32 v60, v48, v49, v50
 v_max3_f32 v61, v51, v52, v53
 v_max3_f32 v60, v60, v54, v55
 s_mov_b32 s34, 0x3e0293ee
 s_mov_b32 s35, s34
 s_nop 2
 v_max3_f32 v61, v61, v56, v57
 v_max3_f32 v60, v60, v58, v59
 v_max_f32 v60, v60, v61
 v_mov_b32 v61, v60
 s_nop 1
 v_permlane32_swap_b32 v60, v61
 v_max_f32 v60, v60, v61
 v_mov_b32 v61, v60
 s_nop 1
 v_permlane16_swap_b32 v60, v61
 v_max_f32 v60, v60, v61
 v_mul_f32 v60, s34, v60
 v_pk_fma_f32 v[48:49], v[48:49], s[34:35], v[60:61] op_sel_hi:[1,1,0] neg_lo:[0,0,1] neg_hi:[0,0,1]
 v_pk_fma_f32 v[50:51], v[50:51], s[34:35], v[60:61] op_sel_hi:[1,1,0] neg_lo:[0,0,1] neg_hi:[0,0,1]
 v_pk_fma_f32 v[52:53], v[52:53], s[34:35], v[60:61] op_sel_hi:[1,1,0] neg_lo:[0,0,1] neg_hi:[0,0,1]
 v_pk_fma_f32 v[54:55], v[54:55], s[34:35], v[60:61] op_sel_hi:[1,1,0] neg_lo:[0,0,1] neg_hi:[0,0,1]
 v_pk_fma_f32 v[56:57], v[56:57], s[34:35], v[60:61] op_sel_hi:[1,1,0] neg_lo:[0,0,1] neg_hi:[0,0,1]
 v_pk_fma_f32 v[58:59], v[58:59], s[34:35], v[60:61] op_sel_hi:[1,1,0] neg_lo:[0,0,1] neg_hi:[0,0,1]
 v_exp_f32 v48, v48
 v_mov_b32 v40, 0x3f803f80
 v_exp_f32 v49, v49
 v_mov_b32 v41, 0x3f803f80
 v_exp_f32 v50, v50
 v_mov_b32 v42, 0x3f803f80
 v_exp_f32 v51, v51
 v_cvt_pk_bf16_f32 v32, v48, v49
 v_exp_f32 v52, v52
 v_mov_b32 v43, 0x3f803f80
 v_exp_f32 v53, v53
 v_cvt_pk_bf16_f32 v33, v50, v51
 v_exp_f32 v54, v54
 v_mov_b32 v44, 0x3f003f00
 v_exp_f32 v55, v55
 v_cvt_pk_bf16_f32 v34, v52, v53
 v_exp_f32 v56, v56
 v_mov_b32 v45, 0x3f003f00
 v_exp_f32 v57, v57
 v_cvt_pk_bf16_f32 v35, v54, v55
 v_exp_f32 v58, v58
 v_exp_f32 v59, v59
 v_cvt_pk_bf16_f32 v36, v56, v57
 v_cvt_pk_bf16_f32 v37, v58, v59
 v_mfma_f32_16x16x32_bf16 v[56:59], v[40:43], v[32:35], 0
 s_waitcnt lgkmcnt(3)
 v_mfma_f32_16x16x32_bf16 v[64:67], v[112:115], v[32:35], 0
 v_mfma_f32_16x16x16_bf16 v[56:59], v[44:45], v[36:37], v[56:59]
 s_waitcnt lgkmcnt(2)
 v_mfma_f32_16x16x32_bf16 v[68:71], v[116:119], v[32:35], 0
 s_waitcnt lgkmcnt(1)
 v_mfma_f32_16x16x32_bf16 v[72:75], v[120:123], v[32:35], 0
 s_waitcnt lgkmcnt(0)
 v_mfma_f32_16x16x32_bf16 v[76:79], v[124:127], v[32:35], 0
 v_mfma_f32_16x16x16_bf16 v[64:67], v[128:129], v[36:37], v[64:67]
 v_rcp_f32 v56, v56
 v_mfma_f32_16x16x16_bf16 v[68:71], v[130:131], v[36:37], v[68:71]
 v_mfma_f32_16x16x16_bf16 v[72:75], v[132:133], v[36:37], v[72:75]
 v_mfma_f32_16x16x16_bf16 v[76:79], v[134:135], v[36:37], v[76:79]
 v_pk_mul_f32 v[64:65], v[64:65], v[56:57] op_sel_hi:[1,0]
 v_pk_mul_f32 v[66:67], v[66:67], v[56:57] op_sel_hi:[1,0]
 v_pk_mul_f32 v[68:69], v[68:69], v[56:57] op_sel_hi:[1,0]
 v_pk_mul_f32 v[70:71], v[70:71], v[56:57] op_sel_hi:[1,0]
 v_cvt_pk_bf16_f32 v16, v64, v65
 v_cvt_pk_bf16_f32 v17, v66, v67
 v_cvt_pk_bf16_f32 v18, v68, v69
 v_cvt_pk_bf16_f32 v19, v70, v71
 ds_write_b128 v6, v[16:19] offset:0
 v_pk_mul_f32 v[72:73], v[72:73], v[56:57] op_sel_hi:[1,0]
 v_pk_mul_f32 v[74:75], v[74:75], v[56:57] op_sel_hi:[1,0]
 v_pk_mul_f32 v[76:77], v[76:77], v[56:57] op_sel_hi:[1,0]
 v_pk_mul_f32 v[78:79], v[78:79], v[56:57] op_sel_hi:[1,0]
 v_cvt_pk_bf16_f32 v20, v72, v73
 v_cvt_pk_bf16_f32 v21, v74, v75
 v_cvt_pk_bf16_f32 v22, v76, v77
 v_cvt_pk_bf16_f32 v23, v78, v79
 ds_write_b128 v6, v[20:23] offset:1024
 s_waitcnt vmcnt(6)
 v_mov_b32 v61, 73728
 s_cmp_lg_u32 s14, 0
 s_cbranch_scc1 L_nofl47
 v_max_u32 v1, s54, v1
 ds_write_b32 v61, v1
L_nofl47:
 s_lshl_b32 s47, s46, 5
 s_add_u32 s47, s47, s40
 s_mul_i32 s47, s47, 36864
 s_lshl_b32 s48, s43, 10
 s_add_u32 s47, s47, s48
 s_add_u32 s60, s47, 83886080
 s_waitcnt lgkmcnt(0)
 s_barrier
 s_cmp_lg_u32 s44, 4
 s_cbranch_scc1 L_arm48
 s_add_u32 s47, s41, 62
 s_lshl_b32 s47, s47, 5
 s_add_u32 s47, s47, s40
 s_mul_i32 s47, s47, 36864
 s_mul_i32 s48, s14, 9216
 s_add_u32 s47, s47, s48
 s_add_u32 s47, s47, 83886080
 v_mov_b32 v48, -1
 v_mov_b32 v49, -1
 v_mov_b32 v50, -1
 v_mov_b32 v51, -1
 buffer_store_dwordx4 v[48:51], v2, s[4:7], s47 offen offset:0 sc1
 buffer_store_dwordx4 v[48:51], v2, s[4:7], s47 offen offset:1024 sc1
 buffer_store_dwordx4 v[48:51], v2, s[4:7], s47 offen offset:2048 sc1
 buffer_store_dwordx4 v[48:51], v2, s[4:7], s47 offen offset:3072 sc1
 s_add_u32 s47, s47, 4096
 buffer_store_dwordx4 v[48:51], v2, s[4:7], s47 offen offset:0 sc1
 buffer_store_dwordx4 v[48:51], v2, s[4:7], s47 offen offset:1024 sc1
 buffer_store_dwordx4 v[48:51], v2, s[4:7], s47 offen offset:2048 sc1
 buffer_store_dwordx4 v[48:51], v2, s[4:7], s47 offen offset:3072 sc1
 s_add_u32 s47, s47, 4096
 buffer_store_dwordx4 v[48:51], v2, s[4:7], s47 offen offset:0 sc1
L_arm48:
 s_bitcmp1_b32 s14, 0
 s_cbranch_scc1 L_op49_odd
 ds_read_b128 v[16:19], v2 offset:0
 ds_read_b128 v[20:23], v2 offset:1024
 ds_read_b128 v[24:27], v2 offset:2048
 ds_read_b128 v[28:31], v2 offset:3072
 ds_read_b128 v[32:35], v2 offset:4096
 ds_read_b128 v[36:39], v2 offset:5120
 ds_read_b128 v[40:43], v2 offset:6144
 ds_read_b128 v[44:47], v2 offset:7168
 ds_read_b32 v1, v61
 s_cmp_lg_u32 s14, 0
 s_cbranch_scc1 L_shf50
 s_cmp_eq_u32 s44, 0
 s_cbranch_scc1 L_shf50
 s_mov_b32 s47, s44
 s_lshl_b32 s48, s41, 7
 s_lshl_b32 s49, s40, 2
 s_add_u32 s48, s48, s49
 s_add_u32 s48, s48, 2048
 v_mov_b32 v62, s47
 v_mov_b32 v63, 0
 s_mov_b64 exec, 1
 buffer_store_dword v62, v63, s[4:7], s48 offen sc1
 s_mov_b64 exec, -1
L_shf50:
 s_waitcnt lgkmcnt(0)
 v_readfirstlane_b32 s33, v1
 s_max_u32 s54, s54, s33
 s_cmp_gt_u32 s33, s58
 s_cselect_b32 s57, 1, 0
 s_cmp_eq_u32 s44, 31
 s_cselect_b32 s57, 0, s57
 s_cmp_eq_u32 s57, 0
 s_cbranch_scc1 L_noe51
 s_xor_b32 s36, s45, 32768
 s_lshl_b32 s50, s58, 5
 s_add_u32 s50, s50, s40
 s_lshl_b32 s50, s50, 13
 s_lshl_b32 s51, s14, 11
 s_add_u32 s50, s50, s51
 s_add_u32 s51, s51, s36
 s_add_u32 m0, s51, 24576
 s_add_u32 s52, s50, 37748736
 buffer_load_dwordx4 v2, s[4:7], s52 offen offset:0 lds
 buffer_load_dwordx4 v2, s[4:7], s52 offen offset:1024 lds
L_noe51:
 v_mfma_f32_16x16x32_bf16 v[136:139], a[144:147], v[16:19], 0
 v_mfma_f32_16x16x32_bf16 v[140:143], a[160:163], v[16:19], 0
 v_mfma_f32_16x16x32_bf16 v[136:139], a[148:151], v[20:23], v[136:139]
 v_mfma_f32_16x16x32_bf16 v[140:143], a[164:167], v[20:23], v[140:143]
 v_mfma_f32_16x16x32_bf16 v[136:139], a[152:155], v[24:27], v[136:139]
 v_mfma_f32_16x16x32_bf16 v[140:143], a[168:171], v[24:27], v[140:143]
 v_mfma_f32_16x16x32_bf16 v[136:139], a[156:159], v[28:31], v[136:139]
 v_mfma_f32_16x16x32_bf16 v[140:143], a[172:175], v[28:31], v[140:143]
 v_mfma_f32_16x16x32_bf16 v[144:147], a[144:147], v[32:35], 0
 v_mfma_f32_16x16x32_bf16 v[148:151], a[160:163], v[32:35], 0
 v_mfma_f32_16x16x32_bf16 v[144:147], a[148:151], v[36:39], v[144:147]
 v_cvt_pk_bf16_f32 v136, v136, v137
 v_cvt_pk_bf16_f32 v137, v138, v139
 v_mfma_f32_16x16x32_bf16 v[148:151], a[164:167], v[36:39], v[148:151]
 v_cvt_pk_bf16_f32 v138, v140, v141
 v_cvt_pk_bf16_f32 v139, v142, v143
 v_mfma_f32_16x16x32_bf16 v[144:147], a[152:155], v[40:43], v[144:147]
 s_add_u32 s48, s60, 0
 buffer_store_dwordx4 v[136:139], v2, s[4:7], s48 offen sc1
 v_mfma_f32_16x16x32_bf16 v[148:151], a[168:171], v[40:43], v[148:151]
 v_mfma_f32_16x16x32_bf16 v[144:147], a[156:159], v[44:47], v[144:147]
 v_mfma_f32_16x16x32_bf16 v[148:151], a[172:175], v[44:47], v[148:151]
 v_mfma_f32_16x16x32_bf16 v[152:155], a[176:179], v[16:19], 0
 v_mfma_f32_16x16x32_bf16 v[156:159], a[192:195], v[16:19], 0
 v_mfma_f32_16x16x32_bf16 v[152:155], a[180:183], v[20:23], v[152:155]
 v_cvt_pk_bf16_f32 v144, v144, v145
 v_cvt_pk_bf16_f32 v145, v146, v147
 v_mfma_f32_16x16x32_bf16 v[156:159], a[196:199], v[20:23], v[156:159]
 v_cvt_pk_bf16_f32 v146, v148, v149
 v_cvt_pk_bf16_f32 v147, v150, v151
 v_mfma_f32_16x16x32_bf16 v[152:155], a[184:187], v[24:27], v[152:155]
 s_add_u32 s48, s60, 18432
 buffer_store_dwordx4 v[144:147], v2, s[4:7], s48 offen sc1
 v_mfma_f32_16x16x32_bf16 v[156:159], a[200:203], v[24:27], v[156:159]
 v_mfma_f32_16x16x32_bf16 v[152:155], a[188:191], v[28:31], v[152:155]
 v_mfma_f32_16x16x32_bf16 v[156:159], a[204:207], v[28:31], v[156:159]
 v_mfma_f32_16x16x32_bf16 v[160:163], a[176:179], v[32:35], 0
 v_mfma_f32_16x16x32_bf16 v[164:167], a[192:195], v[32:35], 0
 v_mfma_f32_16x16x32_bf16 v[160:163], a[180:183], v[36:39], v[160:163]
 v_cvt_pk_bf16_f32 v152, v152, v153
 v_cvt_pk_bf16_f32 v153, v154, v155
 v_mfma_f32_16x16x32_bf16 v[164:167], a[196:199], v[36:39], v[164:167]
 v_cvt_pk_bf16_f32 v154, v156, v157
 v_cvt_pk_bf16_f32 v155, v158, v159
 v_mfma_f32_16x16x32_bf16 v[160:163], a[184:187], v[40:43], v[160:163]
 s_add_u32 s48, s60, 1024
 buffer_store_dwordx4 v[152:155], v2, s[4:7], s48 offen sc1
 v_mfma_f32_16x16x32_bf16 v[164:167], a[200:203], v[40:43], v[164:167]
 v_mfma_f32_16x16x32_bf16 v[160:163], a[188:191], v[44:47], v[160:163]
 v_mfma_f32_16x16x32_bf16 v[164:167], a[204:207], v[44:47], v[164:167]
 v_mfma_f32_16x16x32_bf16 v[168:171], a[208:211], v[16:19], 0
 v_mfma_f32_16x16x32_bf16 v[172:175], a[224:227], v[16:19], 0
 v_mfma_f32_16x16x32_bf16 v[168:171], a[212:215], v[20:23], v[168:171]
 v_cvt_pk_bf16_f32 v160, v160, v161
 v_cvt_pk_bf16_f32 v161, v162, v163
 v_mfma_f32_16x16x32_bf16 v[172:175], a[228:231], v[20:23], v[172:175]
 v_cvt_pk_bf16_f32 v162, v164, v165
 v_cvt_pk_bf16_f32 v163, v166, v167
 v_mfma_f32_16x16x32_bf16 v[168:171], a[216:219], v[24:27], v[168:171]
 s_add_u32 s48, s60, 19456
 buffer_store_dwordx4 v[160:163], v2, s[4:7], s48 offen sc1
 v_mfma_f32_16x16x32_bf16 v[172:175], a[232:235], v[24:27], v[172:175]
 v_mfma_f32_16x16x32_bf16 v[168:171], a[220:223], v[28:31], v[168:171]
 v_mfma_f32_16x16x32_bf16 v[172:175], a[236:239], v[28:31], v[172:175]
 v_mfma_f32_16x16x32_bf16 v[176:179], a[208:211], v[32:35], 0
 v_mfma_f32_16x16x32_bf16 v[180:183], a[224:227], v[32:35], 0
 v_mfma_f32_16x16x32_bf16 v[176:179], a[212:215], v[36:39], v[176:179]
 v_cvt_pk_bf16_f32 v168, v168, v169
 v_cvt_pk_bf16_f32 v169, v170, v171
 v_mfma_f32_16x16x32_bf16 v[180:183], a[228:231], v[36:39], v[180:183]
 v_cvt_pk_bf16_f32 v170, v172, v173
 v_cvt_pk_bf16_f32 v171, v174, v175
 v_mfma_f32_16x16x32_bf16 v[176:179], a[216:219], v[40:43], v[176:179]
 s_add_u32 s48, s60, 2048
 buffer_store_dwordx4 v[168:171], v2, s[4:7], s48 offen sc1
 v_mfma_f32_16x16x32_bf16 v[180:183], a[232:235], v[40:43], v[180:183]
 v_mfma_f32_16x16x32_bf16 v[176:179], a[220:223], v[44:47], v[176:179]
 v_mfma_f32_16x16x32_bf16 v[180:183], a[236:239], v[44:47], v[180:183]
 v_mfma_f32_16x16x32_bf16 v[184:187], a[240:243], v[16:19], 0
 v_mfma_f32_16x16x32_bf16 v[188:191], v[208:211], v[16:19], 0
 v_mfma_f32_16x16x32_bf16 v[184:187], a[244:247], v[20:23], v[184:187]
 v_cvt_pk_bf16_f32 v176, v176, v177
 v_cvt_pk_bf16_f32 v177, v178, v179
 v_mfma_f32_16x16x32_bf16 v[188:191], v[212:215], v[20:23], v[188:191]
 v_cvt_pk_bf16_f32 v178, v180, v181
 v_cvt_pk_bf16_f32 v179, v182, v183
 v_mfma_f32_16x16x32_bf16 v[184:187], a[248:251], v[24:27], v[184:187]
 s_add_u32 s48, s60, 20480
 buffer_store_dwordx4 v[176:179], v2, s[4:7], s48 offen sc1
 v_mfma_f32_16x16x32_bf16 v[188:191], v[216:219], v[24:27], v[188:191]
 v_mfma_f32_16x16x32_bf16 v[184:187], a[252:255], v[28:31], v[184:187]
 v_mfma_f32_16x16x32_bf16 v[188:191], v[220:223], v[28:31], v[188:191]
 v_mfma_f32_16x16x32_bf16 v[192:195], a[240:243], v[32:35], 0
 v_mfma_f32_16x16x32_bf16 v[196:199], v[208:211], v[32:35], 0
 v_mfma_f32_16x16x32_bf16 v[192:195], a[244:247], v[36:39], v[192:195]
 v_cvt_pk_bf16_f32 v184, v184, v185
 v_cvt_pk_bf16_f32 v185, v186, v187
 v_mfma_f32_16x16x32_bf16 v[196:199], v[212:215], v[36:39], v[196:199]
 v_cvt_pk_bf16_f32 v186, v188, v189
 v_cvt_pk_bf16_f32 v187, v190, v191
 v_mfma_f32_16x16x32_bf16 v[192:195], a[248:251], v[40:43], v[192:195]
 s_add_u32 s48, s60, 3072
 buffer_store_dwordx4 v[184:187], v2, s[4:7], s48 offen sc1
 v_mfma_f32_16x16x32_bf16 v[196:199], v[216:219], v[40:43], v[196:199]
 v_mfma_f32_16x16x32_bf16 v[192:195], a[252:255], v[44:47], v[192:195]
 v_mfma_f32_16x16x32_bf16 v[196:199], v[220:223], v[44:47], v[196:199]
 v_mfma_f32_16x16x32_bf16 v[200:203], v[224:227], v[16:19], 0
 v_mfma_f32_16x16x32_bf16 v[204:207], v[240:243], v[16:19], 0
 v_mfma_f32_16x16x32_bf16 v[200:203], v[228:231], v[20:23], v[200:203]
 v_cvt_pk_bf16_f32 v192, v192, v193
 v_cvt_pk_bf16_f32 v193, v194, v195
 v_mfma_f32_16x16x32_bf16 v[204:207], v[244:247], v[20:23], v[204:207]
 v_cvt_pk_bf16_f32 v194, v196, v197
 v_cvt_pk_bf16_f32 v195, v198, v199
 v_mfma_f32_16x16x32_bf16 v[200:203], v[232:235], v[24:27], v[200:203]
 s_add_u32 s48, s60, 21504
 buffer_store_dwordx4 v[192:195], v2, s[4:7], s48 offen sc1
 v_mfma_f32_16x16x32_bf16 v[204:207], v[248:251], v[24:27], v[204:207]
 v_mfma_f32_16x16x32_bf16 v[200:203], v[236:239], v[28:31], v[200:203]
 v_mfma_f32_16x16x32_bf16 v[204:207], v[252:255], v[28:31], v[204:207]
 s_nop 3
 v_cvt_pk_bf16_f32 v200, v200, v201
 v_cvt_pk_bf16_f32 v201, v202, v203
 s_nop 1
 v_cvt_pk_bf16_f32 v202, v204, v205
 v_cvt_pk_bf16_f32 v203, v206, v207
 s_add_u32 s48, s60, 4096
 buffer_store_dwordx4 v[200:203], v2, s[4:7], s48 offen sc1
 s_branch L_op49_join
L_op49_odd:
 ds_read_b128 v[32:35], v2 offset:4096
 ds_read_b128 v[36:39], v2 offset:5120
 ds_read_b128 v[40:43], v2 offset:6144
 ds_read_b128 v[44:47], v2 offset:7168
 ds_read_b128 v[16:19], v2 offset:0
 ds_read_b128 v[20:23], v2 offset:1024
 ds_read_b128 v[24:27], v2 offset:2048
 ds_read_b128 v[28:31], v2 offset:3072
 ds_read_b32 v1, v61
 s_waitcnt lgkmcnt(0)
 v_readfirstlane_b32 s33, v1
 s_max_u32 s54, s54, s33
 s_cmp_gt_u32 s33, s58
 s_cselect_b32 s57, 1, 0
 s_cmp_eq_u32 s44, 31
 s_cselect_b32 s57, 0, s57
 s_cmp_eq_u32 s57, 0
 s_cbranch_scc1 L_noe53
 s_xor_b32 s36, s45, 32768
 s_lshl_b32 s50, s58, 5
 s_add_u32 s50, s50, s40
 s_lshl_b32 s50, s50, 13
 s_lshl_b32 s51, s14, 11
 s_add_u32 s50, s50, s51
 s_add_u32 s51, s51, s36
 s_add_u32 m0, s51, 24576
 s_add_u32 s52, s50, 37748736
 buffer_load_dwordx4 v2, s[4:7], s52 offen offset:0 lds
 buffer_load_dwordx4 v2, s[4:7], s52 offen offset:1024 lds
L_noe53:
 v_mfma_f32_16x16x32_bf16 v[136:139], a[144:147], v[32:35], 0
 v_mfma_f32_16x16x32_bf16 v[140:143], a[160:163], v[32:35], 0
 v_mfma_f32_16x16x32_bf16 v[136:139], a[148:151], v[36:39], v[136:139]
 v_mfma_f32_16x16x32_bf16 v[140:143], a[164:167], v[36:39], v[140:143]
 v_mfma_f32_16x16x32_bf16 v[136:139], a[152:155], v[40:43], v[136:139]
 v_mfma_f32_16x16x32_bf16 v[140:143], a[168:171], v[40:43], v[140:143]
 v_mfma_f32_16x16x32_bf16 v[136:139], a[156:159], v[44:47], v[136:139]
 v_mfma_f32_16x16x32_bf16 v[140:143], a[172:175], v[44:47], v[140:143]
 v_mfma_f32_16x16x32_bf16 v[144:147], a[176:179], v[16:19], 0
 v_mfma_f32_16x16x32_bf16 v[148:151], a[192:195], v[16:19], 0
 v_mfma_f32_16x16x32_bf16 v[144:147], a[180:183], v[20:23], v[144:147]
 v_cvt_pk_bf16_f32 v136, v136, v137
 v_cvt_pk_bf16_f32 v137, v138, v139
 v_mfma_f32_16x16x32_bf16 v[148:151], a[196:199], v[20:23], v[148:151]
 v_cvt_pk_bf16_f32 v138, v140, v141
 v_cvt_pk_bf16_f32 v139, v142, v143
 v_mfma_f32_16x16x32_bf16 v[144:147], a[184:187], v[24:27], v[144:147]
 s_add_u32 s48, s60, 18432
 buffer_store_dwordx4 v[136:139], v2, s[4:7], s48 offen sc1
 v_mfma_f32_16x16x32_bf16 v[148:151], a[200:203], v[24:27], v[148:151]
 v_mfma_f32_16x16x32_bf16 v[144:147], a[188:191], v[28:31], v[144:147]
 v_mfma_f32_16x16x32_bf16 v[148:151], a[204:207], v[28:31], v[148:151]
 v_mfma_f32_16x16x32_bf16 v[152:155], a[176:179], v[32:35], 0
 v_mfma_f32_16x16x32_bf16 v[156:159], a[192:195], v[32:35], 0
 v_mfma_f32_16x16x32_bf16 v[152:155], a[180:183], v[36:39], v[152:155]
 v_cvt_pk_bf16_f32 v144, v144, v145
 v_cvt_pk_bf16_f32 v145, v146, v147
 v_mfma_f32_16x16x32_bf16 v[156:159], a[196:199], v[36:39], v[156:159]
 v_cvt_pk_bf16_f32 v146, v148, v149
 v_cvt_pk_bf16_f32 v147, v150, v151
 v_mfma_f32_16x16x32_bf16 v[152:155], a[184:187], v[40:43], v[152:155]
 s_add_u32 s48, s60, 1024
 buffer_store_dwordx4 v[144:147], v2, s[4:7], s48 offen sc1
 v_mfma_f32_16x16x32_bf16 v[156:159], a[200:203], v[40:43], v[156:159]
 v_mfma_f32_16x16x32_bf16 v[152:155], a[188:191], v[44:47], v[152:155]
 v_mfma_f32_16x16x32_bf16 v[156:159], a[204:207], v[44:47], v[156:159]
 v_mfma_f32_16x16x32_bf16 v[160:163], a[208:211], v[16:19], 0
 v_mfma_f32_16x16x32_bf16 v[164:167], a[224:227], v[16:19], 0
 v_mfma_f32_16x16x32_bf16 v[160:163], a[212:215], v[20:23], v[160:163]
 v_cvt_pk_bf16_f32 v152, v152, v153
 v_cvt_pk_bf16_f32 v153, v154, v155
 v_mfma_f32_16x16x32_bf16 v[164:167], a[228:231], v[20:23], v[164:167]
 v_cvt_pk_bf16_f32 v154, v156, v157
 v_cvt_pk_bf16_f32 v155, v158, v159
 v_mfma_f32_16x16x32_bf16 v[160:163], a[216:219], v[24:27], v[160:163]
 s_add_u32 s48, s60, 19456
 buffer_store_dwordx4 v[152:155], v2, s[4:7], s48 offen sc1
 v_mfma_f32_16x16x32_bf16 v[164:167], a[232:235], v[24:27], v[164:167]
 v_mfma_f32_16x16x32_bf16 v[160:163], a[220:223], v[28:31], v[160:163]
 v_mfma_f32_16x16x32_bf16 v[164:167], a[236:239], v[28:31], v[164:167]
 v_mfma_f32_16x16x32_bf16 v[168:171], a[208:211], v[32:35], 0
 v_mfma_f32_16x16x32_bf16 v[172:175], a[224:227], v[32:35], 0
 v_mfma_f32_16x16x32_bf16 v[168:171], a[212:215], v[36:39], v[168:171]
 v_cvt_pk_bf16_f32 v160, v160, v161
 v_cvt_pk_bf16_f32 v161, v162, v163
 v_mfma_f32_16x16x32_bf16 v[172:175], a[228:231], v[36:39], v[172:175]
 v_cvt_pk_bf16_f32 v162, v164, v165
 v_cvt_pk_bf16_f32 v163, v166, v167
 v_mfma_f32_16x16x32_bf16 v[168:171], a[216:219], v[40:43], v[168:171]
 s_add_u32 s48, s60, 2048
 buffer_store_dwordx4 v[160:163], v2, s[4:7], s48 offen sc1
 v_mfma_f32_16x16x32_bf16 v[172:175], a[232:235], v[40:43], v[172:175]
 v_mfma_f32_16x16x32_bf16 v[168:171], a[220:223], v[44:47], v[168:171]
 v_mfma_f32_16x16x32_bf16 v[172:175], a[236:239], v[44:47], v[172:175]
 v_mfma_f32_16x16x32_bf16 v[176:179], a[240:243], v[16:19], 0
 v_mfma_f32_16x16x32_bf16 v[180:183], v[208:211], v[16:19], 0
 v_mfma_f32_16x16x32_bf16 v[176:179], a[244:247], v[20:23], v[176:179]
 v_cvt_pk_bf16_f32 v168, v168, v169
 v_cvt_pk_bf16_f32 v169, v170, v171
 v_mfma_f32_16x16x32_bf16 v[180:183], v[212:215], v[20:23], v[180:183]
 v_cvt_pk_bf16_f32 v170, v172, v173
 v_cvt_pk_bf16_f32 v171, v174, v175
 v_mfma_f32_16x16x32_bf16 v[176:179], a[248:251], v[24:27], v[176:179]
 s_add_u32 s48, s60, 20480
 buffer_store_dwordx4 v[168:171], v2, s[4:7], s48 offen sc1
 v_mfma_f32_16x16x32_bf16 v[180:183], v[216:219], v[24:27], v[180:183]
 v_mfma_f32_16x16x32_bf16 v[176:179], a[252:255], v[28:31], v[176:179]
 v_mfma_f32_16x16x32_bf16 v[180:183], v[220:223], v[28:31], v[180:183]
 v_mfma_f32_16x16x32_bf16 v[184:187], a[240:243], v[32:35], 0
 v_mfma_f32_16x16x32_bf16 v[188:191], v[208:211], v[32:35], 0
 v_mfma_f32_16x16x32_bf16 v[184:187], a[244:247], v[36:39], v[184:187]
 v_cvt_pk_bf16_f32 v176, v176, v177
 v_cvt_pk_bf16_f32 v177, v178, v179
 v_mfma_f32_16x16x32_bf16 v[188:191], v[212:215], v[36:39], v[188:191]
 v_cvt_pk_bf16_f32 v178, v180, v181
 v_cvt_pk_bf16_f32 v179, v182, v183
 v_mfma_f32_16x16x32_bf16 v[184:187], a[248:251], v[40:43], v[184:187]
 s_add_u32 s48, s60, 3072
 buffer_store_dwordx4 v[176:179], v2, s[4:7], s48 offen sc1
 v_mfma_f32_16x16x32_bf16 v[188:191], v[216:219], v[40:43], v[188:191]
 v_mfma_f32_16x16x32_bf16 v[184:187], a[252:255], v[44:47], v[184:187]
 v_mfma_f32_16x16x32_bf16 v[188:191], v[220:223], v[44:47], v[188:191]
 v_mfma_f32_16x16x32_bf16 v[192:195], v[224:227], v[16:19], 0
 v_mfma_f32_16x16x32_bf16 v[196:199], v[240:243], v[16:19], 0
 v_mfma_f32_16x16x32_bf16 v[192:195], v[228:231], v[20:23], v[192:195]
 v_cvt_pk_bf16_f32 v184, v184, v185
 v_cvt_pk_bf16_f32 v185, v186, v187
 v_mfma_f32_16x16x32_bf16 v[196:199], v[244:247], v[20:23], v[196:199]
 v_cvt_pk_bf16_f32 v186, v188, v189
 v_cvt_pk_bf16_f32 v187, v190, v191
 v_mfma_f32_16x16x32_bf16 v[192:195], v[232:235], v[24:27], v[192:195]
 s_add_u32 s48, s60, 21504
 buffer_store_dwordx4 v[184:187], v2, s[4:7], s48 offen sc1
 v_mfma_f32_16x16x32_bf16 v[196:199], v[248:251], v[24:27], v[196:199]
 v_mfma_f32_16x16x32_bf16 v[192:195], v[236:239], v[28:31], v[192:195]
 v_mfma_f32_16x16x32_bf16 v[196:199], v[252:255], v[28:31], v[196:199]
 v_mfma_f32_16x16x32_bf16 v[200:203], v[224:227], v[32:35], 0
 v_mfma_f32_16x16x32_bf16 v[204:207], v[240:243], v[32:35], 0
 v_mfma_f32_16x16x32_bf16 v[200:203], v[228:231], v[36:39], v[200:203]
 v_cvt_pk_bf16_f32 v192, v192, v193
 v_cvt_pk_bf16_f32 v193, v194, v195
 v_mfma_f32_16x16x32_bf16 v[204:207], v[244:247], v[36:39], v[204:207]
 v_cvt_pk_bf16_f32 v194, v196, v197
 v_cvt_pk_bf16_f32 v195, v198, v199
 v_mfma_f32_16x16x32_bf16 v[200:203], v[232:235], v[40:43], v[200:203]
 s_add_u32 s48, s60, 4096
 buffer_store_dwordx4 v[192:195], v2, s[4:7], s48 offen sc1
 v_mfma_f32_16x16x32_bf16 v[204:207], v[248:251], v[40:43], v[204:207]
 v_mfma_f32_16x16x32_bf16 v[200:203], v[236:239], v[44:47], v[200:203]
 v_mfma_f32_16x16x32_bf16 v[204:207], v[252:255], v[44:47], v[204:207]
 s_nop 3
 v_cvt_pk_bf16_f32 v200, v200, v201
 v_cvt_pk_bf16_f32 v201, v202, v203
 s_nop 1
 v_cvt_pk_bf16_f32 v202, v204, v205
 v_cvt_pk_bf16_f32 v203, v206, v207
 s_add_u32 s48, s60, 22528
 buffer_store_dwordx4 v[200:203], v2, s[4:7], s48 offen sc1
L_op49_join:
 s_xor_b32 s45, s45, 32768
 v_xor_b32 v3, 32768, v3
 v_xor_b32 v4, 32768, v4
 v_xor_b32 v5, 32768, v5
 s_mov_b32 s46, s58
 s_add_u32 s44, s44, 1
 s_cmp_lt_u32 s44, 32
 s_cbranch_scc1 L_sh36
 s_branch L_dpx54
L_dp44:
L_dp356:
 s_lshl_b32 s47, s46, 5
 s_add_u32 s47, s47, s40
 s_lshl_b32 s47, s47, 13
 s_add_u32 s47, s47, 37748736
 s_add_u32 s48, s47, 4096
L_dpl55:
 buffer_load_dwordx4 v[96:99], v2, s[4:7], s47 offen offset:0 sc1
 buffer_load_dwordx4 v[100:103], v2, s[4:7], s47 offen offset:2048 sc1
 buffer_load_dwordx4 v[104:107], v2, s[4:7], s48 offen offset:0 sc1
 buffer_load_dwordx4 v[108:111], v2, s[4:7], s48 offen offset:2048 sc1
 buffer_load_dwordx4 v[128:131], v7, s[4:7], s47 offen offset:1024 sc1
 buffer_load_dwordx4 v[132:135], v7, s[4:7], s47 offen offset:3072 sc1
 s_waitcnt vmcnt(0)
 v_max3_u32 v60, v96, v97, v98
 v_max3_u32 v61, v99, v100, v101
 v_max3_u32 v60, v60, v102, v103
 v_max3_u32 v61, v61, v104, v105
 v_max3_u32 v60, v60, v106, v107
 v_max3_u32 v61, v61, v108, v109
 v_max3_u32 v60, v60, v110, v111
 v_max3_u32 v61, v61, v128, v129
 v_max3_u32 v60, v60, v130, v131
 v_max3_u32 v61, v61, v132, v133
 v_max3_u32 v60, v60, v134, v135
 v_max_u32 v60, v60, v61
 v_cmp_eq_u32 vcc, -1, v60
 s_cmp_eq_u64 vcc, 0
 s_cbranch_scc1 L_chok37
 s_cmp_eq_u32 s15, 0
 s_cbranch_scc1 L_chok37
 s_sub_u32 s15, s15, 1
 s_branch L_dpl55
L_dpx54:
 s_waitcnt vmcnt(0)
 s_barrier
 s_cmp_lg_u32 s14, 0
 s_cbranch_scc1 L_shf57
 s_mov_b32 s47, 32
 s_lshl_b32 s48, s41, 7
 s_lshl_b32 s49, s40, 2
 s_add_u32 s48, s48, s49
 s_add_u32 s48, s48, 2048
 v_mov_b32 v62, s47
 v_mov_b32 v63, 0
 s_mov_b64 exec, 1
 buffer_store_dword v62, v63, s[4:7], s48 offen sc1
 s_mov_b64 exec, -1
L_shf57:
 s_branch L_exit
L_spare:
 s_cmp_lt_u32 s13, 12
 s_cbranch_scc0 L_spare2
 s_sub_u32 s39, s39, 18
 s_lshl_b32 s39, s39, 2
 s_and_b32 s33, s13, 3
 s_add_u32 s64, s39, s33
 s_branch L_spare3
L_spare2:
 s_sub_u32 s64, s39, 116
L_spare3:
 s_add_u32 s64, s64, 136
 s_cmp_lg_u32 s14, 0
 s_cbranch_scc1 L_gw58
 v_lshlrev_b32 v3, 2, v1
 v_and_b32 v3, 31, v3
poll59:
 buffer_load_dword v2, v3, s[8:11], 0 offen offset:32 sc1
 s_waitcnt vmcnt(0)
 v_cmp_le_u32 vcc, 32, v2
 s_cmp_eq_u64 vcc, exec
 s_cbranch_scc1 polld60
 s_cmp_eq_u32 s15, 0
 s_cbranch_scc1 polld60
 s_sub_u32 s15, s15, 1
 s_sleep 4
 s_branch poll59
polld60:
L_gw58:
 s_barrier
L_fin:
 s_load_dwordx2 s[16:17], s[0:1], 0
 s_mov_b32 s18, 0x240000
 s_mov_b32 s19, 0x20000
 s_load_dwordx2 s[20:21], s[0:1], 80
 s_mov_b32 s22, 0x240000
 s_mov_b32 s23, 0x20000
 s_lshl_b32 s65, s64, 2
 s_add_u32 s65, s65, s14
 v_and_b32 v2, 15, v1
 v_lshrrev_b32 v3, 4, v1
 v_and_b32 v4, 1, v3
 v_mul_u32_u24 v4, 36864, v4
 v_lshrrev_b32 v5, 1, v3
 v_lshl_add_u32 v5, v5, 4, v2
 v_lshl_add_u32 v4, v5, 4, v4
 v_lshrrev_b32 v5, 1, v3
 v_lshrrev_b32 v6, 3, v2
 v_cmp_eq_u32 s[68:69], v5, v6
 v_and_b32 v5, 7, v2
 v_cmp_eq_u32 vcc, 0, v5
 v_mov_b32 v6, 0
 v_mov_b32 v7, 0x3f80
 v_cndmask_b32 v6, v6, v7, vcc
 v_cmp_eq_u32 vcc, 1, v5
 v_mov_b32 v7, 0x3f800000
 s_nop 0
 v_cndmask_b32 v6, v6, v7, vcc
 v_mov_b32 v7, 0
 v_cndmask_b32 v8, v7, v6, s[68:69]
 v_cmp_eq_u32 vcc, 2, v5
 v_mov_b32 v6, 0
 v_mov_b32 v7, 0x3f80
 v_cndmask_b32 v6, v6, v7, vcc
 v_cmp_eq_u32 vcc, 3, v5
 v_mov_b32 v7, 0x3f800000
 s_nop 0
 v_cndmask_b32 v6, v6, v7, vcc
 v_mov_b32 v7, 0
 v_cndmask_b32 v9, v7, v6, s[68:69]
 v_cmp_eq_u32 vcc, 4, v5
 v_mov_b32 v6, 0
 v_mov_b32 v7, 0x3f80
 v_cndmask_b32 v6, v6, v7, vcc
 v_cmp_eq_u32 vcc, 5, v5
 v_mov_b32 v7, 0x3f800000
 s_nop 0
 v_cndmask_b32 v6, v6, v7, vcc
 v_mov_b32 v7, 0
 v_cndmask_b32 v10, v7, v6, s[68:69]
 v_cmp_eq_u32 vcc, 6, v5
 v_mov_b32 v6, 0
 v_mov_b32 v7, 0x3f80
 v_cndmask_b32 v6, v6, v7, vcc
 v_cmp_eq_u32 vcc, 7, v5
 v_mov_b32 v7, 0x3f800000
 s_nop 0
 v_cndmask_b32 v6, v6, v7, vcc
 v_mov_b32 v7, 0
 v_cndmask_b32 v11, v7, v6, s[68:69]
 v_mul_u32_u24 v12, 2304, v2
 v_lshl_add_u32 v12, v3, 4, v12
 v_mul_u32_u24 v13, 1152, v2
 v_lshl_add_u32 v13, v3, 3, v13
 v_lshlrev_b32 v14, 2, v1
 s_waitcnt lgkmcnt(0)
 s_and_b32 s17, s17, 0xffff
 s_and_b32 s21, s21, 0xffff
 s_mov_b32 s67, -1
L_fin61:
 s_cmp_ge_u32 s65, 4608
 s_cbranch_scc1 L_finx62
 s_mul_i32 s66, s65, 58255
 s_lshr_b32 s66, s66, 22
 s_mul_i32 s33, s66, 72
 s_sub_u32 s70, s65, s33
 s_cmp_ge_u32 s70, 36
 s_cselect_b32 s71, 1, 0
 s_mul_i32 s33, s71, 36
 s_sub_u32 s70, s70, s33
 s_lshr_b32 s72, s70, 1
 s_and_b32 s73, s70, 1
 s_cmp_eq_u32 s67, s66
 s_cbranch_scc1 L_fok63
 s_cmp_lg_u32 s14, 0
 s_cbranch_scc1 L_fw64
 s_and_b32 s33, s66, 1
 s_lshl_b32 s33, s33, 7
 s_add_u32 s33, s33, 2048
 s_lshr_b32 s34, s66, 3
 s_lshl_b32 s34, s34, 5
 s_add_u32 s34, s34, 1408
 s_lshr_b32 s35, s66, 1
 s_add_u32 s35, s35, 1
 s_min_u32 s35, s35, 31
 v_cmp_gt_u32 vcc, 32, v1
 v_mov_b32 v15, s34
 v_mov_b32 v16, s33
 v_cndmask_b32 v15, v15, v16, vcc
 v_add_u32 v15, v15, v14
 v_mov_b32 v17, 1
 v_mov_b32 v16, s35
 v_cndmask_b32 v17, v17, v16, vcc
 s_mov_b32 exec_lo, -1
 s_mov_b32 exec_hi, 0xff
L_fp65:
 buffer_load_dword v16, v15, s[4:7], 0 offen sc1
 s_waitcnt vmcnt(0)
 v_cmp_le_u32 vcc, v17, v16
 s_cmp_eq_u64 vcc, exec
 s_cbranch_scc1 L_fpd66
 s_cmp_eq_u32 s15, 0
 s_cbranch_scc1 L_fpd66
 s_sub_u32 s15, s15, 1
 v_add_u32 v18, 1, v16
 v_cmp_le_u32 vcc, v17, v18
 s_cmp_eq_u64 vcc, exec
 s_cbranch_scc1 L_fps67
 s_sleep 24
L_fps67:
 s_sleep 2
 s_branch L_fp65
L_fpd66:
 s_mov_b64 exec, -1
L_fw64:
 s_barrier
 s_mov_b32 s67, s66
L_fok63:
 s_lshl_b32 s33, s66, 5
 s_lshl_b32 s34, s71, 4
 s_add_u32 s33, s33, s34
 s_lshl_b32 s34, s72, 5
 s_lshl_b32 s35, s73, 4
 s_add_u32 s34, s34, s35
 s_mul_i32 s35, s33, 2304
 s_lshl_b32 s36, s34, 2
 s_add_u32 s35, s35, s36
 s_add_u32 s35, s35, 73400320
 buffer_load_dwordx4 v[20:23], v12, s[4:7], s35 offen sc1
 s_add_u32 s35, s35, 4718592
 buffer_load_dwordx4 v[24:27], v12, s[4:7], s35 offen sc1
 s_mul_i32 s35, s33, 1152
 s_lshl_b32 s36, s34, 1
 s_add_u32 s35, s35, s36
 buffer_load_dwordx2 v[28:29], v13, s[16:19], s35 offen
L_fdl68:
 s_lshl_b32 s33, s66, 5
 s_mul_i32 s33, s33, 36864
 s_mul_i32 s34, s71, 18432
 s_add_u32 s33, s33, s34
 s_lshl_b32 s34, s72, 10
 s_add_u32 s33, s33, s34
 s_lshl_b32 s34, s73, 9
 s_add_u32 s33, s33, s34
 s_add_u32 s33, s33, 83886080
 buffer_load_dwordx4 v[32:35], v4, s[4:7], s33 offen sc1
 s_add_u32 s33, s33, 73728
 buffer_load_dwordx4 v[36:39], v4, s[4:7], s33 offen sc1
 s_add_u32 s33, s33, 73728
 buffer_load_dwordx4 v[40:43], v4, s[4:7], s33 offen sc1
 s_add_u32 s33, s33, 73728
 buffer_load_dwordx4 v[44:47], v4, s[4:7], s33 offen sc1
 s_add_u32 s33, s33, 73728
 buffer_load_dwordx4 v[48:51], v4, s[4:7], s33 offen sc1
 s_add_u32 s33, s33, 73728
 buffer_load_dwordx4 v[52:55], v4, s[4:7], s33 offen sc1
 s_add_u32 s33, s33, 73728
 buffer_load_dwordx4 v[56:59], v4, s[4:7], s33 offen sc1
 s_add_u32 s33, s33, 73728
 buffer_load_dwordx4 v[60:63], v4, s[4:7], s33 offen sc1
 s_add_u32 s33, s33, 73728
 buffer_load_dwordx4 v[64:67], v4, s[4:7], s33 offen sc1
 s_add_u32 s33, s33, 73728
 buffer_load_dwordx4 v[68:71], v4, s[4:7], s33 offen sc1
 s_add_u32 s33, s33, 73728
 buffer_load_dwordx4 v[72:75], v4, s[4:7], s33 offen sc1
 s_add_u32 s33, s33, 73728
 buffer_load_dwordx4 v[76:79], v4, s[4:7], s33 offen sc1
 s_add_u32 s33, s33, 73728
 buffer_load_dwordx4 v[80:83], v4, s[4:7], s33 offen sc1
 s_add_u32 s33, s33, 73728
 buffer_load_dwordx4 v[84:87], v4, s[4:7], s33 offen sc1
 s_add_u32 s33, s33, 73728
 buffer_load_dwordx4 v[88:91], v4, s[4:7], s33 offen sc1
 s_add_u32 s33, s33, 73728
 buffer_load_dwordx4 v[92:95], v4, s[4:7], s33 offen sc1
 s_cmp_lt_u32 s66, 62
 s_cbranch_scc1 L_fdk69
 s_waitcnt vmcnt(0)
 v_max3_u32 v18, v32, v33, v34
 v_max3_u32 v19, v35, v36, v37
 v_max3_u32 v18, v18, v38, v39
 v_max3_u32 v19, v19, v40, v41
 v_max3_u32 v18, v18, v42, v43
 v_max3_u32 v19, v19, v44, v45
 v_max3_u32 v18, v18, v46, v47
 v_max3_u32 v19, v19, v48, v49
 v_max3_u32 v18, v18, v50, v51
 v_max3_u32 v19, v19, v52, v53
 v_max3_u32 v18, v18, v54, v55
 v_max3_u32 v19, v19, v56, v57
 v_max3_u32 v18, v18, v58, v59
 v_max3_u32 v19, v19, v60, v61
 v_max3_u32 v18, v18, v62, v63
 v_max3_u32 v19, v19, v64, v65
 v_max3_u32 v18, v18, v66, v67
 v_max3_u32 v19, v19, v68, v69
 v_max3_u32 v18, v18, v70, v71
 v_max3_u32 v19, v19, v72, v73
 v_max3_u32 v18, v18, v74, v75
 v_max3_u32 v19, v19, v76, v77
 v_max3_u32 v18, v18, v78, v79
 v_max3_u32 v19, v19, v80, v81
 v_max3_u32 v18, v18, v82, v83
 v_max3_u32 v19, v19, v84, v85
 v_max3_u32 v18, v18, v86, v87
 v_max3_u32 v19, v19, v88, v89
 v_max3_u32 v18, v18, v90, v91
 v_max3_u32 v19, v19, v92, v93
 v_max3_u32 v18, v18, v94, v95
 v_max_u32 v18, v18, v19
 v_cmp_eq_u32 vcc, -1, v18
 s_cmp_eq_u64 vcc, 0
 s_cbranch_scc1 L_fdk69
 s_cmp_eq_u32 s15, 0
 s_cbranch_scc1 L_fdk69
 s_sub_u32 s15, s15, 1
 s_branch L_fdl68
L_fdk69:
 s_waitcnt vmcnt(15)
 v_mfma_f32_16x16x32_bf16 v[100:103], v[8:11], v[32:35], 0
 s_waitcnt vmcnt(14)
 v_mfma_f32_16x16x32_bf16 v[100:103], v[8:11], v[36:39], v[100:103]
 s_waitcnt vmcnt(13)
 v_mfma_f32_16x16x32_bf16 v[100:103], v[8:11], v[40:43], v[100:103]
 s_waitcnt vmcnt(12)
 v_mfma_f32_16x16x32_bf16 v[100:103], v[8:11], v[44:47], v[100:103]
 s_waitcnt vmcnt(11)
 v_mfma_f32_16x16x32_bf16 v[100:103], v[8:11], v[48:51], v[100:103]
 s_waitcnt vmcnt(10)
 v_mfma_f32_16x16x32_bf16 v[100:103], v[8:11], v[52:55], v[100:103]
 s_waitcnt vmcnt(9)
 v_mfma_f32_16x16x32_bf16 v[100:103], v[8:11], v[56:59], v[100:103]
 s_waitcnt vmcnt(8)
 v_mfma_f32_16x16x32_bf16 v[100:103], v[8:11], v[60:63], v[100:103]
 s_waitcnt vmcnt(7)
 v_mfma_f32_16x16x32_bf16 v[100:103], v[8:11], v[64:67], v[100:103]
 s_waitcnt vmcnt(6)
 v_mfma_f32_16x16x32_bf16 v[100:103], v[8:11], v[68:71], v[100:103]
 s_waitcnt vmcnt(5)
 v_mfma_f32_16x16x32_bf16 v[100:103], v[8:11], v[72:75], v[100:103]
 s_waitcnt vmcnt(4)
 v_mfma_f32_16x16x32_bf16 v[100:103], v[8:11], v[76:79], v[100:103]
 s_waitcnt vmcnt(3)
 v_mfma_f32_16x16x32_bf16 v[100:103], v[8:11], v[80:83], v[100:103]
 s_waitcnt vmcnt(2)
 v_mfma_f32_16x16x32_bf16 v[100:103], v[8:11], v[84:87], v[100:103]
 s_waitcnt vmcnt(1)
 v_mfma_f32_16x16x32_bf16 v[100:103], v[8:11], v[88:91], v[100:103]
 s_waitcnt vmcnt(0)
 v_mfma_f32_16x16x32_bf16 v[100:103], v[8:11], v[92:95], v[100:103]
 v_add_f32 v20, v20, v24
 v_add_f32 v21, v21, v25
 v_add_f32 v22, v22, v26
 v_add_f32 v23, v23, v27
 v_lshlrev_b32 v24, 16, v28
 v_and_b32 v25, 0xffff0000, v28
 v_lshlrev_b32 v26, 16, v29
 v_and_b32 v27, 0xffff0000, v29
 v_add_f32 v20, v20, v24
 v_add_f32 v21, v21, v25
 v_add_f32 v22, v22, v26
 v_add_f32 v23, v23, v27
 v_add_f32 v20, v20, v100
 v_add_f32 v21, v21, v101
 v_add_f32 v22, v22, v102
 v_add_f32 v23, v23, v103
 v_cvt_pk_bf16_f32 v20, v20, v21
 v_cvt_pk_bf16_f32 v21, v22, v23
 buffer_store_dwordx2 v[20:21], v13, s[20:23], s35 offen
 s_add_u32 s65, s65, 640
 s_branch L_fin61
L_finx62:
 s_branch L_exit
L_chain:
 s_mov_b32 s40, s13
 s_load_dwordx2 s[16:17], s[0:1], 16
 s_mov_b32 s18, 0x480000
 s_mov_b32 s19, 0x20000
 s_load_dwordx2 s[20:21], s[0:1], 24
 s_mov_b32 s22, 0x480000
 s_mov_b32 s23, 0x20000
 s_load_dwordx2 s[24:25], s[0:1], 32
 s_mov_b32 s26, 0x480000
 s_mov_b32 s27, 0x20000
 s_load_dwordx2 s[28:29], s[0:1], 40
 s_mov_b32 s30, 0x480000
 s_mov_b32 s31, 0x20000
 s_load_dwordx2 s[76:77], s[0:1], 8
 s_mov_b32 s78, 0x2400
 s_mov_b32 s79, 0x20000
 v_mov_b32 v79, v1
 v_lshlrev_b32 v0, 4, v79
 s_mul_i32 s33, s14, 36864
 s_add_u32 s33, s33, 16384
 v_add_u32 v1, s33, v0
 v_bfe_u32 v9, v79, 3, 1
 v_lshlrev_b32 v9, 12, v9
 v_and_b32 v10, 7, v79
 v_lshl_add_u32 v9, v10, 3, v9
 v_bfe_u32 v10, v79, 4, 1
 v_lshl_add_u32 v9, v10, 6, v9
 v_lshrrev_b32 v10, 5, v79
 v_lshl_add_u32 v3, v10, 13, v9
 v_lshl_add_u32 v2, v10, 2, v9
 v_bfe_u32 v9, v79, 2, 1
 v_lshlrev_b32 v9, 2, v9
 v_lshrrev_b32 v10, 4, v79
 v_add_u32 v9, v9, v10
 v_and_b32 v10, 3, v79
 v_lshlrev_b32 v10, 2, v10
 v_lshl_add_u32 v4, v9, 4, v10
 v_bfe_u32 v10, v79, 3, 1
 v_mul_u32_u24 v10, 0xaaaa, v10
 v_add_u32 v5, 0x4444, v10
 v_and_b32 v9, 7, v79
 v_bfe_u32 v10, v79, 4, 1
 v_lshlrev_b32 v10, 2, v10
 v_sub_u32 v9, v9, v10
 v_mov_b32 v11, 0
 v_mov_b32 v12, 0x3f80
 v_cmp_eq_u32 vcc, 0, v9
 s_nop 1
 v_cndmask_b32 v11, v11, v12, vcc
 v_mov_b32 v12, 0x3f800000
 v_cmp_eq_u32 vcc, 1, v9
 s_nop 1
 v_cndmask_b32 v6, v11, v12, vcc
 v_mov_b32 v11, 0
 v_mov_b32 v12, 0x3f80
 v_cmp_eq_u32 vcc, 2, v9
 s_nop 1
 v_cndmask_b32 v11, v11, v12, vcc
 v_mov_b32 v12, 0x3f800000
 v_cmp_eq_u32 vcc, 3, v9
 s_nop 1
 v_cndmask_b32 v7, v11, v12, vcc
 s_mov_b32 s54, 0x3e0293ee
 s_mov_b32 s55, s54
 s_mov_b32 s56, 0x00ff00ff
 s_mov_b32 s57, 0x00ff00ff
 s_mov_b32 s60, 0
 s_mov_b32 s61, -1
 s_mov_b32 s62, 0x110011
 s_mov_b32 s63, 0x110011
 s_mov_b32 s64, 0x11001100
 s_mov_b32 s65, 0x11001100
 s_mov_b32 s66, 0x220022
 s_mov_b32 s67, 0x220022
 s_mov_b32 s68, 0x22002200
 s_mov_b32 s69, 0x22002200
 s_mov_b32 s70, 0x3e803e80
 s_mov_b32 s71, 0x3e803e80
 s_mov_b32 s72, 0x3f803f80
 s_mov_b32 s73, 0x3f803f80
 s_lshl_b32 s33, s14, 11
 s_lshl_b32 s34, s40, 13
 s_add_u32 s58, s33, s34
 s_cmp_lt_u32 s40, 16
 s_cselect_b32 s33, 32, -16
 s_cselect_b32 s34, 16, 32
 s_cmp_eq_u32 s14, 1
 s_cselect_b32 s33, s34, s33
 s_cmp_eq_u32 s14, 2
 s_cselect_b32 s33, 64, s33
 s_add_u32 s53, s33, s40
 s_cmp_lt_u32 s40, 8
 s_cselect_b32 s52, 1, 0
 s_cmp_lt_u32 s14, 2
 s_cselect_b32 s52, 1, s52
 s_cmp_eq_u32 s14, 3
 s_cselect_b32 s52, 0, s52
 s_min_u32 s53, s53, 71
 s_lshl_b32 s33, s53, 7
 s_add_u32 s46, s33, 159383552
 s_lshl_b32 s33, s53, 12
 s_add_u32 s49, s33, 159449088
 s_lshl_b32 s33, s14, 14
 s_lshl_b32 s34, s40, 7
 s_add_u32 s33, s33, s34
 s_add_u32 s48, s33, 159449088
 s_lshl_b32 s33, s14, 13
 s_add_u32 s33, s33, s34
 s_add_u32 s59, s33, 159711232
 s_mov_b32 s50, 0
 s_mov_b32 s51, 0
 s_waitcnt lgkmcnt(0)
 s_and_b32 s17, s17, 0xffff
 s_and_b32 s21, s21, 0xffff
 s_and_b32 s25, s25, 0xffff
 s_and_b32 s29, s29, 0xffff
 s_and_b32 s77, s77, 0xffff
 v_and_b32 v72, 7, v79
 v_mul_u32_u24 v72, 1152, v72
 v_lshrrev_b32 v73, 3, v79
 v_lshl_add_u32 v72, v73, 4, v72
 v_mov_b32 v74, 0
 v_lshlrev_b32 v75, 7, v79
 v_and_b32 v8, 1, v79
 v_bfe_u32 v9, v79, 4, 1
 v_bfe_u32 v10, v79, 1, 1
 v_bfe_u32 v11, v79, 2, 1
 v_bfe_u32 v12, v79, 3, 1
 v_bfe_u32 v13, v79, 5, 1
 v_lshlrev_b32 v14, 5, v10
 v_lshl_add_u32 v14, v8, 4, v14
 s_lshl_b32 s33, s14, 6
 v_add_u32 v14, s33, v14
 v_lshl_add_u32 v16, v13, 1, v12
 v_lshl_add_u32 v16, v11, 4, v16
 v_lshl_add_u32 v16, v9, 5, v16
 v_mul_u32_u24 v17, 1152, v16
 v_add_u32 v21, v17, v14
 v_xor_b32 v10, v10, v9
 v_lshlrev_b32 v14, 5, v10
 v_lshl_add_u32 v14, v8, 4, v14
 s_lshl_b32 s33, s14, 6
 v_add_u32 v14, s33, v14
 v_lshl_add_u32 v15, v13, 1, v9
 v_lshl_add_u32 v16, v11, 2, v15
 v_lshl_add_u32 v16, v12, 3, v16
 v_lshl_add_u32 v20, v16, 13, v14
 v_lshl_add_u32 v16, v11, 4, v15
 v_lshl_add_u32 v16, v12, 5, v16
 v_lshl_add_u32 v16, v10, 6, v16
 v_mul_u32_u24 v17, 1152, v16
 v_lshlrev_b32 v18, 4, v8
 s_lshl_b32 s33, s14, 5
 s_add_u32 s33, s33, 1024
 v_add_u32 v18, s33, v18
 v_add_u32 v22, v17, v18
 v_bfe_u32 v8, v79, 1, 1
 v_bfe_u32 v9, v79, 2, 1
 v_bfe_u32 v12, v79, 3, 1
 v_bfe_u32 v11, v79, 4, 1
 v_bfe_u32 v14, v79, 5, 1
 v_and_b32 v18, 1, v79
 v_lshlrev_b32 v18, 3, v18
 s_mul_i32 s33, s14, 36864
 s_add_u32 s37, s33, 16384
 v_add_u32 v18, s37, v18
 v_lshl_add_u32 v15, v11, 2, v8
 v_lshl_add_u32 v15, v12, 3, v15
 v_lshl_add_u32 v15, v9, 4, v15
 v_lshl_add_u32 v15, v14, 6, v15
 v_lshl_add_u32 v16, v9, 1, v15
 v_xor_b32 v17, 2, v16
 v_lshl_add_u32 v23, v16, 4, v18
 v_lshl_add_u32 v24, v17, 4, v18
 v_lshl_add_u32 v15, v12, 1, v8
 v_lshl_add_u32 v15, v11, 2, v15
 v_lshl_add_u32 v15, v9, 3, v15
 v_lshl_add_u32 v15, v14, 6, v15
 v_lshl_add_u32 v25, v15, 4, v18
 v_add_u32 v26, 256, v25
 v_bfe_u32 v8, v79, 0, 1
 v_bfe_u32 v9, v79, 1, 1
 v_bfe_u32 v10, v79, 2, 1
 v_bfe_u32 v11, v79, 3, 1
 v_bfe_u32 v12, v79, 4, 1
 v_bfe_u32 v13, v79, 5, 1
 s_and_b32 s33, s14, 1
 s_lshr_b32 s34, s14, 1
 v_xor_b32 v14, v9, v12
 v_lshl_add_u32 v14, v14, 1, v8
 v_xor_b32 v15, v10, v13
 v_lshl_add_u32 v14, v15, 2, v14
 v_lshl_add_u32 v14, v11, 3, v14
 v_lshl_add_u32 v15, v13, 2, v12
 s_lshl_b32 s35, s33, 1
 s_lshl_b32 s36, s34, 5
 s_add_u32 s35, s35, s36
 v_add_u32 v15, s35, v15
 v_lshlrev_b32 v14, 4, v14
 v_lshl_add_u32 v20, v15, 13, v14
 v_xor_b32 v27, 0x80, v20
 v_lshl_add_u32 v14, v9, 1, v8
 v_xor_b32 v15, v10, v12
 v_lshl_add_u32 v14, v15, 2, v14
 v_xor_b32 v15, v11, v13
 v_lshl_add_u32 v14, v15, 3, v14
 v_lshl_add_u32 v15, v13, 4, v12
 s_lshl_b32 s35, s33, 1
 s_lshl_b32 s36, s34, 3
 s_add_u32 s35, s35, s36
 v_add_u32 v15, s35, v15
 v_mul_u32_u24 v15, 1152, v15
 v_lshl_add_u32 v21, v14, 4, v15
 v_lshlrev_b32 v16, 3, v8
 v_add_u32 v16, 16384, v16
 v_lshl_add_u32 v16, v10, 8, v16
 v_lshl_add_u32 v16, v12, 9, v16
 v_lshl_add_u32 v16, v9, 4, v16
 v_xor_b32 v14, s33, v12
 v_lshl_add_u32 v17, v14, 6, v16
 v_xor_b32 v14, s34, v11
 v_lshl_add_u32 v17, v14, 7, v17
 v_lshl_add_u32 v17, v11, 10, v17
 v_lshl_add_u32 v17, v13, 11, v17
 v_lshl_add_u32 v17, v10, 5, v17
 v_add_u32 v48, 0, v17
 v_add_u32 v49, 36864, v17
 v_add_u32 v50, 73728, v17
 v_add_u32 v51, 110592, v17
 v_subrev_u32 v60, 16384, v17
 v_xor_b32 v17, 32, v17
 v_add_u32 v52, 0, v17
 v_add_u32 v53, 36864, v17
 v_add_u32 v54, 73728, v17
 v_add_u32 v55, 110592, v17
 v_subrev_u32 v61, 16384, v17
 v_lshl_add_u32 v17, v11, 5, v16
 v_xor_b32 v14, s33, v10
 v_lshl_add_u32 v17, v14, 6, v17
 v_xor_b32 v14, s34, v12
 v_lshl_add_u32 v17, v14, 7, v17
 v_lshl_add_u32 v17, v13, 10, v17
 v_add_u32 v56, 0, v17
 v_add_u32 v57, 36864, v17
 v_add_u32 v58, 73728, v17
 v_add_u32 v59, 110592, v17
 v_subrev_u32 v62, 16384, v17
 s_lshl_b32 s35, s40, 8
 s_mul_i32 s36, s40, 147456
 s_cmp_eq_u32 s14, 1
 s_cbranch_scc1 L_wl72
 s_cmp_eq_u32 s14, 2
 s_cbranch_scc1 L_wl73
 s_cmp_eq_u32 s14, 3
 s_cbranch_scc1 L_wl74
L_wl71:
 s_add_u32 s53, s36, 0
 s_add_u32 m0, s37, 0
 s_add_u32 s38, s53, 0
 buffer_load_dwordx4 v21, s[28:31], s38 offen lds
 s_add_u32 m0, s37, 1024
 s_add_u32 s38, s53, 4608
 buffer_load_dwordx4 v21, s[28:31], s38 offen lds
 s_add_u32 m0, s37, 2048
 s_add_u32 s38, s53, 36864
 buffer_load_dwordx4 v21, s[28:31], s38 offen lds
 s_add_u32 m0, s37, 3072
 s_add_u32 s38, s53, 41472
 buffer_load_dwordx4 v21, s[28:31], s38 offen lds
 s_add_u32 s53, s36, 73728
 s_add_u32 m0, s37, 8192
 s_add_u32 s38, s53, 0
 buffer_load_dwordx4 v21, s[28:31], s38 offen lds
 s_add_u32 m0, s37, 9216
 s_add_u32 s38, s53, 4608
 buffer_load_dwordx4 v21, s[28:31], s38 offen lds
 s_add_u32 m0, s37, 10240
 s_add_u32 s38, s53, 36864
 buffer_load_dwordx4 v21, s[28:31], s38 offen lds
 s_add_u32 m0, s37, 11264
 s_add_u32 s38, s53, 41472
 buffer_load_dwordx4 v21, s[28:31], s38 offen lds
 s_add_u32 s53, s36, 256
 s_add_u32 m0, s37, 16384
 s_add_u32 s38, s53, 0
 buffer_load_dwordx4 v21, s[28:31], s38 offen lds
 s_add_u32 m0, s37, 17408
 s_add_u32 s38, s53, 4608
 buffer_load_dwordx4 v21, s[28:31], s38 offen lds
 s_add_u32 m0, s37, 18432
 s_add_u32 s38, s53, 36864
 buffer_load_dwordx4 v21, s[28:31], s38 offen lds
 s_add_u32 m0, s37, 19456
 s_add_u32 s38, s53, 41472
 buffer_load_dwordx4 v21, s[28:31], s38 offen lds
 s_add_u32 s53, s36, 73984
 s_add_u32 m0, s37, 4096
 s_add_u32 s38, s53, 0
 buffer_load_dwordx4 v21, s[28:31], s38 offen lds
 s_add_u32 m0, s37, 5120
 s_add_u32 s38, s53, 4608
 buffer_load_dwordx4 v21, s[28:31], s38 offen lds
 s_add_u32 m0, s37, 6144
 s_add_u32 s38, s53, 36864
 buffer_load_dwordx4 v21, s[28:31], s38 offen lds
 s_add_u32 m0, s37, 7168
 s_add_u32 s38, s53, 41472
 buffer_load_dwordx4 v21, s[28:31], s38 offen lds
 s_mov_b32 s53, s36
 s_add_u32 m0, s37, 12288
 s_add_u32 s38, s53, 0
 buffer_load_dwordx4 v22, s[28:31], s38 offen lds
 s_add_u32 m0, s37, 13312
 s_add_u32 s38, s53, 4608
 buffer_load_dwordx4 v22, s[28:31], s38 offen lds
 s_add_u32 m0, s37, 14336
 s_add_u32 s38, s53, 9216
 buffer_load_dwordx4 v22, s[28:31], s38 offen lds
 s_add_u32 m0, s37, 15360
 s_add_u32 s38, s53, 13824
 buffer_load_dwordx4 v22, s[28:31], s38 offen lds
 s_add_u32 s53, s35, 524288
 s_add_u32 m0, s37, 20480
 s_add_u32 s38, s53, 0
 buffer_load_dwordx4 v20, s[16:19], s38 offen lds
 s_add_u32 m0, s37, 21504
 s_add_u32 s38, s53, 65536
 buffer_load_dwordx4 v27, s[16:19], s38 offen lds
 s_add_u32 m0, s37, 22528
 s_add_u32 s38, s53, 131072
 buffer_load_dwordx4 v20, s[16:19], s38 offen lds
 s_add_u32 m0, s37, 23552
 s_add_u32 s38, s53, 196608
 buffer_load_dwordx4 v27, s[16:19], s38 offen lds
 s_add_u32 s53, s35, 524288
 s_add_u32 m0, s37, 24576
 s_add_u32 s38, s53, 0
 buffer_load_dwordx4 v20, s[24:27], s38 offen lds
 s_add_u32 m0, s37, 25600
 s_add_u32 s38, s53, 65536
 buffer_load_dwordx4 v27, s[24:27], s38 offen lds
 s_add_u32 m0, s37, 26624
 s_add_u32 s38, s53, 131072
 buffer_load_dwordx4 v20, s[24:27], s38 offen lds
 s_add_u32 m0, s37, 27648
 s_add_u32 s38, s53, 196608
 buffer_load_dwordx4 v27, s[24:27], s38 offen lds
 s_add_u32 s53, s35, 1572864
 s_add_u32 m0, s37, 28672
 s_add_u32 s38, s53, 0
 buffer_load_dwordx4 v20, s[16:19], s38 offen lds
 s_add_u32 m0, s37, 29696
 s_add_u32 s38, s53, 65536
 buffer_load_dwordx4 v27, s[16:19], s38 offen lds
 s_add_u32 m0, s37, 30720
 s_add_u32 s38, s53, 131072
 buffer_load_dwordx4 v20, s[16:19], s38 offen lds
 s_add_u32 m0, s37, 31744
 s_add_u32 s38, s53, 196608
 buffer_load_dwordx4 v27, s[16:19], s38 offen lds
 s_add_u32 s53, s35, 1572864
 s_add_u32 m0, s37, 32768
 s_add_u32 s38, s53, 0
 buffer_load_dwordx4 v20, s[20:23], s38 offen lds
 s_add_u32 m0, s37, 33792
 s_add_u32 s38, s53, 65536
 buffer_load_dwordx4 v27, s[20:23], s38 offen lds
 s_add_u32 m0, s37, 34816
 s_add_u32 s38, s53, 131072
 buffer_load_dwordx4 v20, s[20:23], s38 offen lds
 s_add_u32 m0, s37, 35840
 s_add_u32 s38, s53, 196608
 buffer_load_dwordx4 v27, s[20:23], s38 offen lds
 s_add_u32 s53, s35, 1572864
 s_mov_b32 m0, 0
 s_add_u32 s38, s53, 0
 buffer_load_dwordx4 v20, s[24:27], s38 offen lds
 s_mov_b32 m0, 1024
 s_add_u32 s38, s53, 65536
 buffer_load_dwordx4 v27, s[24:27], s38 offen lds
 s_mov_b32 m0, 2048
 s_add_u32 s38, s53, 131072
 buffer_load_dwordx4 v20, s[24:27], s38 offen lds
 s_mov_b32 m0, 3072
 s_add_u32 s38, s53, 196608
 buffer_load_dwordx4 v27, s[24:27], s38 offen lds
 s_cmp_eq_u32 s52, 0
 s_cbranch_scc1 L_np75
 v_mov_b32 v8, -1
 v_mov_b32 v9, -1
 v_mov_b32 v10, -1
 v_mov_b32 v11, -1
 s_add_u32 s33, s49, 0
 buffer_store_dwordx4 v[8:11], v0, s[4:7], s33 offen offset:0 sc1
 buffer_store_dwordx4 v[8:11], v0, s[4:7], s33 offen offset:1024 sc1
 buffer_store_dwordx4 v[8:11], v0, s[4:7], s33 offen offset:2048 sc1
 buffer_store_dwordx4 v[8:11], v0, s[4:7], s33 offen offset:3072 sc1
 s_add_u32 s33, s49, 294912
 buffer_store_dwordx4 v[8:11], v0, s[4:7], s33 offen offset:0 sc1
 buffer_store_dwordx4 v[8:11], v0, s[4:7], s33 offen offset:1024 sc1
 buffer_store_dwordx4 v[8:11], v0, s[4:7], s33 offen offset:2048 sc1
 buffer_store_dwordx4 v[8:11], v0, s[4:7], s33 offen offset:3072 sc1
 s_add_u32 s33, s46, 9216
 buffer_store_dword v8, v4, s[4:7], s33 offen sc1
 s_add_u32 s33, s46, 18432
 buffer_store_dword v8, v4, s[4:7], s33 offen sc1
L_np75:
 s_waitcnt vmcnt(36)
 s_lshl_b32 s53, s12, 2
 s_add_u32 s53, s53, 32
 v_mov_b32 v8, 1
 v_mov_b32 v9, 0
 s_mov_b64 exec, 1
 buffer_atomic_add v8, v9, s[8:11], s53 offen sc1
 s_mov_b64 exec, -1
 s_barrier
 ds_read_b64_tr_b16 v[176:177], v56 offset:0
 ds_read_b64_tr_b16 v[178:179], v57 offset:12288
 ds_read_b64_tr_b16 v[180:181], v58 offset:12288
 ds_read_b64_tr_b16 v[182:183], v59 offset:16384
 ds_read_b64_tr_b16 v[184:185], v56 offset:2048
 ds_read_b64_tr_b16 v[186:187], v57 offset:14336
 ds_read_b64_tr_b16 v[188:189], v58 offset:14336
 ds_read_b64_tr_b16 v[190:191], v59 offset:18432
 s_waitcnt lgkmcnt(0)
 s_waitcnt vmcnt(33)
 s_barrier
 s_add_u32 s53, s35, 2097152
 s_add_u32 m0, s37, 0
 s_add_u32 s38, s53, 0
 buffer_load_dwordx4 v20, s[24:27], s38 offen lds
 s_add_u32 m0, s37, 1024
 s_add_u32 s38, s53, 65536
 buffer_load_dwordx4 v27, s[24:27], s38 offen lds
 s_add_u32 m0, s37, 2048
 s_add_u32 s38, s53, 131072
 buffer_load_dwordx4 v20, s[24:27], s38 offen lds
 s_add_u32 m0, s37, 3072
 s_add_u32 s38, s53, 196608
 buffer_load_dwordx4 v27, s[24:27], s38 offen lds
 ds_read_b64_tr_b16 v[192:193], v56 offset:8192
 ds_read_b64_tr_b16 v[194:195], v57 offset:8192
 ds_read_b64_tr_b16 v[196:197], v58 offset:0
 ds_read_b64_tr_b16 v[198:199], v59 offset:12288
 ds_read_b64_tr_b16 v[200:201], v56 offset:10240
 ds_read_b64_tr_b16 v[202:203], v57 offset:10240
 ds_read_b64_tr_b16 v[204:205], v58 offset:2048
 ds_read_b64_tr_b16 v[206:207], v59 offset:14336
 s_waitcnt lgkmcnt(0)
 s_waitcnt vmcnt(33)
 s_barrier
 s_add_u32 s53, s35, 2621440
 s_add_u32 m0, s37, 8192
 s_add_u32 s38, s53, 0
 buffer_load_dwordx4 v20, s[16:19], s38 offen lds
 s_add_u32 m0, s37, 9216
 s_add_u32 s38, s53, 65536
 buffer_load_dwordx4 v27, s[16:19], s38 offen lds
 s_add_u32 m0, s37, 10240
 s_add_u32 s38, s53, 131072
 buffer_load_dwordx4 v20, s[16:19], s38 offen lds
 s_add_u32 m0, s37, 11264
 s_add_u32 s38, s53, 196608
 buffer_load_dwordx4 v27, s[16:19], s38 offen lds
 ds_read_b64_tr_b16 v[208:209], v56 offset:16384
 ds_read_b64_tr_b16 v[210:211], v57 offset:4096
 ds_read_b64_tr_b16 v[212:213], v58 offset:16384
 ds_read_b64_tr_b16 v[214:215], v59 offset:8192
 ds_read_b64_tr_b16 v[216:217], v56 offset:18432
 ds_read_b64_tr_b16 v[218:219], v57 offset:6144
 ds_read_b64_tr_b16 v[220:221], v58 offset:18432
 ds_read_b64_tr_b16 v[222:223], v59 offset:10240
 s_waitcnt lgkmcnt(0)
 s_waitcnt vmcnt(33)
 s_barrier
 s_add_u32 s53, s35, 3145728
 s_add_u32 m0, s37, 16384
 s_add_u32 s38, s53, 0
 buffer_load_dwordx4 v20, s[24:27], s38 offen lds
 s_add_u32 m0, s37, 17408
 s_add_u32 s38, s53, 65536
 buffer_load_dwordx4 v27, s[24:27], s38 offen lds
 s_add_u32 m0, s37, 18432
 s_add_u32 s38, s53, 131072
 buffer_load_dwordx4 v20, s[24:27], s38 offen lds
 s_add_u32 m0, s37, 19456
 s_add_u32 s38, s53, 196608
 buffer_load_dwordx4 v27, s[24:27], s38 offen lds
 ds_read_b64_tr_b16 v[224:225], v56 offset:4096
 ds_read_b64_tr_b16 v[226:227], v57 offset:16384
 ds_read_b64_tr_b16 v[228:229], v58 offset:8192
 ds_read_b64_tr_b16 v[230:231], v59 offset:0
 ds_read_b64_tr_b16 v[232:233], v56 offset:6144
 ds_read_b64_tr_b16 v[234:235], v57 offset:18432
 ds_read_b64_tr_b16 v[236:237], v58 offset:10240
 ds_read_b64_tr_b16 v[238:239], v59 offset:2048
 s_waitcnt lgkmcnt(0)
 s_waitcnt vmcnt(33)
 s_barrier
 s_add_u32 s53, s35, 3670016
 s_add_u32 m0, s37, 4096
 s_add_u32 s38, s53, 0
 buffer_load_dwordx4 v20, s[16:19], s38 offen lds
 s_add_u32 m0, s37, 5120
 s_add_u32 s38, s53, 65536
 buffer_load_dwordx4 v27, s[16:19], s38 offen lds
 s_add_u32 m0, s37, 6144
 s_add_u32 s38, s53, 131072
 buffer_load_dwordx4 v20, s[16:19], s38 offen lds
 s_add_u32 m0, s37, 7168
 s_add_u32 s38, s53, 196608
 buffer_load_dwordx4 v27, s[16:19], s38 offen lds
 ds_read_b64_tr_b16 v[240:241], v23 offset:12288
 ds_read_b64_tr_b16 v[242:243], v23 offset:12800
 ds_read_b64_tr_b16 v[244:245], v23 offset:14336
 ds_read_b64_tr_b16 v[246:247], v23 offset:14848
 ds_read_b64_tr_b16 v[248:249], v24 offset:12288
 ds_read_b64_tr_b16 v[250:251], v24 offset:12800
 ds_read_b64_tr_b16 v[252:253], v24 offset:14336
 ds_read_b64_tr_b16 v[254:255], v24 offset:14848
 s_waitcnt lgkmcnt(0)
 s_waitcnt vmcnt(33)
 s_barrier
 s_add_u32 s53, s35, 4194304
 s_add_u32 m0, s37, 12288
 s_add_u32 s38, s53, 0
 buffer_load_dwordx4 v20, s[16:19], s38 offen lds
 s_add_u32 m0, s37, 13312
 s_add_u32 s38, s53, 65536
 buffer_load_dwordx4 v27, s[16:19], s38 offen lds
 s_add_u32 m0, s37, 14336
 s_add_u32 s38, s53, 131072
 buffer_load_dwordx4 v20, s[16:19], s38 offen lds
 s_add_u32 m0, s37, 15360
 s_add_u32 s38, s53, 196608
 buffer_load_dwordx4 v27, s[16:19], s38 offen lds
 ds_read_b64_tr_b16 v[128:129], v48 offset:20480
 ds_read_b64_tr_b16 v[130:131], v49 offset:20480
 ds_read_b64_tr_b16 v[132:133], v50 offset:20480
 ds_read_b64_tr_b16 v[134:135], v51 offset:20480
 ds_read_b64_tr_b16 v[136:137], v52 offset:20480
 ds_read_b64_tr_b16 v[138:139], v53 offset:20480
 ds_read_b64_tr_b16 v[140:141], v54 offset:20480
 ds_read_b64_tr_b16 v[142:143], v55 offset:20480
 s_waitcnt lgkmcnt(0)
 s_waitcnt vmcnt(33)
 s_barrier
 s_add_u32 s53, s35, 4194304
 s_add_u32 m0, s37, 20480
 s_add_u32 s38, s53, 0
 buffer_load_dwordx4 v20, s[24:27], s38 offen lds
 s_add_u32 m0, s37, 21504
 s_add_u32 s38, s53, 65536
 buffer_load_dwordx4 v27, s[24:27], s38 offen lds
 s_add_u32 m0, s37, 22528
 s_add_u32 s38, s53, 131072
 buffer_load_dwordx4 v20, s[24:27], s38 offen lds
 s_add_u32 m0, s37, 23552
 s_add_u32 s38, s53, 196608
 buffer_load_dwordx4 v27, s[24:27], s38 offen lds
 ds_read_b64_tr_b16 v[160:161], v48 offset:24576
 ds_read_b64_tr_b16 v[162:163], v49 offset:24576
 ds_read_b64_tr_b16 v[164:165], v50 offset:24576
 ds_read_b64_tr_b16 v[166:167], v51 offset:24576
 ds_read_b64_tr_b16 v[168:169], v52 offset:24576
 ds_read_b64_tr_b16 v[170:171], v53 offset:24576
 ds_read_b64_tr_b16 v[172:173], v54 offset:24576
 ds_read_b64_tr_b16 v[174:175], v55 offset:24576
 s_waitcnt lgkmcnt(0)
 s_waitcnt vmcnt(33)
 s_barrier
 s_add_u32 s53, s35, 1048576
 s_add_u32 m0, s37, 24576
 s_add_u32 s38, s53, 0
 buffer_load_dwordx4 v20, s[16:19], s38 offen lds
 s_add_u32 m0, s37, 25600
 s_add_u32 s38, s53, 65536
 buffer_load_dwordx4 v27, s[16:19], s38 offen lds
 s_add_u32 m0, s37, 26624
 s_add_u32 s38, s53, 131072
 buffer_load_dwordx4 v20, s[16:19], s38 offen lds
 s_add_u32 m0, s37, 27648
 s_add_u32 s38, s53, 196608
 buffer_load_dwordx4 v27, s[16:19], s38 offen lds
 ds_read_b64_tr_b16 a[32:33], v48 offset:28672
 ds_read_b64_tr_b16 a[34:35], v49 offset:28672
 ds_read_b64_tr_b16 a[36:37], v50 offset:28672
 ds_read_b64_tr_b16 a[38:39], v51 offset:28672
 ds_read_b64_tr_b16 a[40:41], v52 offset:28672
 ds_read_b64_tr_b16 a[42:43], v53 offset:28672
 ds_read_b64_tr_b16 a[44:45], v54 offset:28672
 ds_read_b64_tr_b16 a[46:47], v55 offset:28672
 s_waitcnt lgkmcnt(0)
 s_waitcnt vmcnt(33)
 s_barrier
 s_add_u32 s53, s35, 2621440
 s_add_u32 m0, s37, 28672
 s_add_u32 s38, s53, 0
 buffer_load_dwordx4 v20, s[20:23], s38 offen lds
 s_add_u32 m0, s37, 29696
 s_add_u32 s38, s53, 65536
 buffer_load_dwordx4 v27, s[20:23], s38 offen lds
 s_add_u32 m0, s37, 30720
 s_add_u32 s38, s53, 131072
 buffer_load_dwordx4 v20, s[20:23], s38 offen lds
 s_add_u32 m0, s37, 31744
 s_add_u32 s38, s53, 196608
 buffer_load_dwordx4 v27, s[20:23], s38 offen lds
 ds_read_b64_tr_b16 a[48:49], v48 offset:32768
 ds_read_b64_tr_b16 a[50:51], v49 offset:32768
 ds_read_b64_tr_b16 a[52:53], v50 offset:32768
 ds_read_b64_tr_b16 a[54:55], v51 offset:32768
 ds_read_b64_tr_b16 a[56:57], v52 offset:32768
 ds_read_b64_tr_b16 a[58:59], v53 offset:32768
 ds_read_b64_tr_b16 a[60:61], v54 offset:32768
 ds_read_b64_tr_b16 a[62:63], v55 offset:32768
 s_waitcnt lgkmcnt(0)
 s_waitcnt vmcnt(33)
 s_barrier
 s_add_u32 s53, s35, 3145728
 s_add_u32 m0, s37, 32768
 s_add_u32 s38, s53, 0
 buffer_load_dwordx4 v20, s[20:23], s38 offen lds
 s_add_u32 m0, s37, 33792
 s_add_u32 s38, s53, 65536
 buffer_load_dwordx4 v27, s[20:23], s38 offen lds
 s_add_u32 m0, s37, 34816
 s_add_u32 s38, s53, 131072
 buffer_load_dwordx4 v20, s[20:23], s38 offen lds
 s_add_u32 m0, s37, 35840
 s_add_u32 s38, s53, 196608
 buffer_load_dwordx4 v27, s[20:23], s38 offen lds
 ds_read_b64_tr_b16 a[64:65], v60 offset:0
 ds_read_b64_tr_b16 a[66:67], v60 offset:4096
 ds_read_b64_tr_b16 a[68:69], v60 offset:8192
 ds_read_b64_tr_b16 a[70:71], v60 offset:12288
 ds_read_b64_tr_b16 a[72:73], v61 offset:0
 ds_read_b64_tr_b16 a[74:75], v61 offset:4096
 ds_read_b64_tr_b16 a[76:77], v61 offset:8192
 ds_read_b64_tr_b16 a[78:79], v61 offset:12288
 s_waitcnt lgkmcnt(0)
 s_waitcnt vmcnt(32)
 s_barrier
 s_add_u32 s53, s35, 3670016
 s_mov_b32 m0, 0
 s_add_u32 s38, s53, 0
 buffer_load_dwordx4 v20, s[24:27], s38 offen lds
 s_mov_b32 m0, 1024
 s_add_u32 s38, s53, 65536
 buffer_load_dwordx4 v27, s[24:27], s38 offen lds
 s_mov_b32 m0, 2048
 s_add_u32 s38, s53, 131072
 buffer_load_dwordx4 v20, s[24:27], s38 offen lds
 s_mov_b32 m0, 3072
 s_add_u32 s38, s53, 196608
 buffer_load_dwordx4 v27, s[24:27], s38 offen lds
 ds_read_b64_tr_b16 a[96:97], v48 offset:0
 ds_read_b64_tr_b16 a[98:99], v49 offset:12288
 ds_read_b64_tr_b16 a[100:101], v50 offset:12288
 ds_read_b64_tr_b16 a[102:103], v51 offset:16384
 ds_read_b64_tr_b16 a[104:105], v52 offset:0
 ds_read_b64_tr_b16 a[106:107], v53 offset:12288
 ds_read_b64_tr_b16 a[108:109], v54 offset:12288
 ds_read_b64_tr_b16 a[110:111], v55 offset:16384
 s_waitcnt lgkmcnt(0)
 s_waitcnt vmcnt(32)
 s_barrier
 s_lshl_b32 s38, s32, 16
 s_add_u32 s38, s38, 1
 v_mov_b32 v8, s38
 s_mov_b64 exec, 1
 buffer_atomic_add v8, v74, s[8:11], 0 offen offset:64 sc1
 s_mov_b64 exec, -1
 ds_read_b64_tr_b16 a[112:113], v48 offset:8192
 ds_read_b64_tr_b16 a[114:115], v49 offset:8192
 ds_read_b64_tr_b16 a[116:117], v50 offset:0
 ds_read_b64_tr_b16 a[118:119], v51 offset:12288
 ds_read_b64_tr_b16 a[120:121], v52 offset:8192
 ds_read_b64_tr_b16 a[122:123], v53 offset:8192
 ds_read_b64_tr_b16 a[124:125], v54 offset:0
 ds_read_b64_tr_b16 a[126:127], v55 offset:12288
 s_waitcnt lgkmcnt(0)
 s_waitcnt vmcnt(29)
 s_barrier
 ds_read_b64_tr_b16 a[176:177], v48 offset:16384
 ds_read_b64_tr_b16 a[178:179], v49 offset:4096
 ds_read_b64_tr_b16 a[180:181], v50 offset:16384
 ds_read_b64_tr_b16 a[182:183], v51 offset:8192
 ds_read_b64_tr_b16 a[184:185], v52 offset:16384
 ds_read_b64_tr_b16 a[186:187], v53 offset:4096
 ds_read_b64_tr_b16 a[188:189], v54 offset:16384
 ds_read_b64_tr_b16 a[190:191], v55 offset:8192
 s_waitcnt lgkmcnt(0)
 s_waitcnt vmcnt(25)
 s_barrier
 ds_read_b64_tr_b16 a[192:193], v48 offset:4096
 ds_read_b64_tr_b16 a[194:195], v49 offset:16384
 ds_read_b64_tr_b16 a[196:197], v50 offset:8192
 ds_read_b64_tr_b16 a[198:199], v51 offset:0
 ds_read_b64_tr_b16 a[200:201], v52 offset:4096
 ds_read_b64_tr_b16 a[202:203], v53 offset:16384
 ds_read_b64_tr_b16 a[204:205], v54 offset:8192
 ds_read_b64_tr_b16 a[206:207], v55 offset:0
 s_waitcnt lgkmcnt(0)
 s_waitcnt vmcnt(21)
 s_barrier
 s_add_u32 s53, s35, 2097152
 s_add_u32 m0, s37, 4096
 s_add_u32 s38, s53, 0
 buffer_load_dwordx4 v20, s[20:23], s38 offen lds
 s_add_u32 m0, s37, 5120
 s_add_u32 s38, s53, 65536
 buffer_load_dwordx4 v27, s[20:23], s38 offen lds
 s_add_u32 m0, s37, 6144
 s_add_u32 s38, s53, 131072
 buffer_load_dwordx4 v20, s[20:23], s38 offen lds
 s_add_u32 m0, s37, 7168
 s_add_u32 s38, s53, 196608
 buffer_load_dwordx4 v27, s[20:23], s38 offen lds
 ds_read_b64_tr_b16 a[208:209], v48 offset:12288
 ds_read_b64_tr_b16 a[210:211], v49 offset:0
 ds_read_b64_tr_b16 a[212:213], v50 offset:4096
 ds_read_b64_tr_b16 a[214:215], v51 offset:4096
 ds_read_b64_tr_b16 a[216:217], v52 offset:12288
 ds_read_b64_tr_b16 a[218:219], v53 offset:0
 ds_read_b64_tr_b16 a[220:221], v54 offset:4096
 ds_read_b64_tr_b16 a[222:223], v55 offset:4096
 s_waitcnt lgkmcnt(0)
 s_waitcnt vmcnt(21)
 s_barrier
 s_add_u32 s53, s35, 1048576
 s_add_u32 m0, s37, 12288
 s_add_u32 s38, s53, 0
 buffer_load_dwordx4 v20, s[20:23], s38 offen lds
 s_add_u32 m0, s37, 13312
 s_add_u32 s38, s53, 65536
 buffer_load_dwordx4 v27, s[20:23], s38 offen lds
 s_add_u32 m0, s37, 14336
 s_add_u32 s38, s53, 131072
 buffer_load_dwordx4 v20, s[20:23], s38 offen lds
 s_add_u32 m0, s37, 15360
 s_add_u32 s38, s53, 196608
 buffer_load_dwordx4 v27, s[20:23], s38 offen lds
 ds_read_b64_tr_b16 a[240:241], v48 offset:20480
 ds_read_b64_tr_b16 a[242:243], v49 offset:20480
 ds_read_b64_tr_b16 a[244:245], v50 offset:20480
 ds_read_b64_tr_b16 a[246:247], v51 offset:20480
 ds_read_b64_tr_b16 a[248:249], v52 offset:20480
 ds_read_b64_tr_b16 a[250:251], v53 offset:20480
 ds_read_b64_tr_b16 a[252:253], v54 offset:20480
 ds_read_b64_tr_b16 a[254:255], v55 offset:20480
 s_waitcnt lgkmcnt(0)
 s_waitcnt vmcnt(21)
 s_barrier
 s_add_u32 s53, s35, 3145728
 s_add_u32 m0, s37, 20480
 s_add_u32 s38, s53, 0
 buffer_load_dwordx4 v20, s[16:19], s38 offen lds
 s_add_u32 m0, s37, 21504
 s_add_u32 s38, s53, 65536
 buffer_load_dwordx4 v27, s[16:19], s38 offen lds
 s_add_u32 m0, s37, 22528
 s_add_u32 s38, s53, 131072
 buffer_load_dwordx4 v20, s[16:19], s38 offen lds
 s_add_u32 m0, s37, 23552
 s_add_u32 s38, s53, 196608
 buffer_load_dwordx4 v27, s[16:19], s38 offen lds
 ds_read_b64_tr_b16 v[32:33], v48 offset:24576
 ds_read_b64_tr_b16 v[34:35], v49 offset:24576
 ds_read_b64_tr_b16 v[36:37], v50 offset:24576
 ds_read_b64_tr_b16 v[38:39], v51 offset:24576
 ds_read_b64_tr_b16 v[40:41], v52 offset:24576
 ds_read_b64_tr_b16 v[42:43], v53 offset:24576
 ds_read_b64_tr_b16 v[44:45], v54 offset:24576
 ds_read_b64_tr_b16 v[46:47], v55 offset:24576
 s_waitcnt lgkmcnt(0)
 s_waitcnt vmcnt(21)
 s_barrier
 ds_write_b128 v1, v[32:35] offset:0
 ds_write_b128 v1, v[36:39] offset:1024
 ds_write_b128 v1, v[40:43] offset:2048
 ds_write_b128 v1, v[44:47] offset:3072
 s_add_u32 s53, s35, 0
 s_add_u32 m0, s37, 24576
 s_add_u32 s38, s53, 0
 buffer_load_dwordx4 v20, s[24:27], s38 offen lds
 s_add_u32 m0, s37, 25600
 s_add_u32 s38, s53, 65536
 buffer_load_dwordx4 v27, s[24:27], s38 offen lds
 s_add_u32 m0, s37, 26624
 s_add_u32 s38, s53, 131072
 buffer_load_dwordx4 v20, s[24:27], s38 offen lds
 s_add_u32 m0, s37, 27648
 s_add_u32 s38, s53, 196608
 buffer_load_dwordx4 v27, s[24:27], s38 offen lds
 ds_read_b64_tr_b16 a[128:129], v48 offset:28672
 ds_read_b64_tr_b16 a[130:131], v49 offset:28672
 ds_read_b64_tr_b16 a[132:133], v50 offset:28672
 ds_read_b64_tr_b16 a[134:135], v51 offset:28672
 ds_read_b64_tr_b16 a[136:137], v52 offset:28672
 ds_read_b64_tr_b16 a[138:139], v53 offset:28672
 ds_read_b64_tr_b16 a[140:141], v54 offset:28672
 ds_read_b64_tr_b16 a[142:143], v55 offset:28672
 s_waitcnt lgkmcnt(0)
 s_waitcnt vmcnt(21)
 s_barrier
 s_add_u32 s53, s35, 0
 s_add_u32 m0, s37, 28672
 s_add_u32 s38, s53, 0
 buffer_load_dwordx4 v20, s[20:23], s38 offen lds
 s_add_u32 m0, s37, 29696
 s_add_u32 s38, s53, 65536
 buffer_load_dwordx4 v27, s[20:23], s38 offen lds
 s_add_u32 m0, s37, 30720
 s_add_u32 s38, s53, 131072
 buffer_load_dwordx4 v20, s[20:23], s38 offen lds
 s_add_u32 m0, s37, 31744
 s_add_u32 s38, s53, 196608
 buffer_load_dwordx4 v27, s[20:23], s38 offen lds
 ds_read_b64_tr_b16 v[32:33], v48 offset:32768
 ds_read_b64_tr_b16 v[34:35], v49 offset:32768
 ds_read_b64_tr_b16 v[36:37], v50 offset:32768
 ds_read_b64_tr_b16 v[38:39], v51 offset:32768
 ds_read_b64_tr_b16 v[40:41], v52 offset:32768
 ds_read_b64_tr_b16 v[42:43], v53 offset:32768
 ds_read_b64_tr_b16 v[44:45], v54 offset:32768
 ds_read_b64_tr_b16 v[46:47], v55 offset:32768
 s_waitcnt lgkmcnt(0)
 s_waitcnt vmcnt(21)
 s_barrier
 ds_write_b128 v1, v[32:35] offset:8192
 ds_write_b128 v1, v[36:39] offset:9216
 ds_write_b128 v1, v[40:43] offset:10240
 ds_write_b128 v1, v[44:47] offset:11264
 s_add_u32 s53, s35, 1048576
 s_add_u32 m0, s37, 32768
 s_add_u32 s38, s53, 0
 buffer_load_dwordx4 v20, s[24:27], s38 offen lds
 s_add_u32 m0, s37, 33792
 s_add_u32 s38, s53, 65536
 buffer_load_dwordx4 v27, s[24:27], s38 offen lds
 s_add_u32 m0, s37, 34816
 s_add_u32 s38, s53, 131072
 buffer_load_dwordx4 v20, s[24:27], s38 offen lds
 s_add_u32 m0, s37, 35840
 s_add_u32 s38, s53, 196608
 buffer_load_dwordx4 v27, s[24:27], s38 offen lds
 ds_read_b64_tr_b16 v[32:33], v60 offset:0
 ds_read_b64_tr_b16 v[34:35], v60 offset:4096
 ds_read_b64_tr_b16 v[36:37], v60 offset:8192
 ds_read_b64_tr_b16 v[38:39], v60 offset:12288
 ds_read_b64_tr_b16 v[40:41], v61 offset:0
 ds_read_b64_tr_b16 v[42:43], v61 offset:4096
 ds_read_b64_tr_b16 v[44:45], v61 offset:8192
 ds_read_b64_tr_b16 v[46:47], v61 offset:12288
 s_waitcnt lgkmcnt(0)
 s_waitcnt vmcnt(20)
 s_barrier
 ds_write_b128 v1, v[32:35] offset:16384
 ds_write_b128 v1, v[36:39] offset:17408
 ds_write_b128 v1, v[40:43] offset:18432
 ds_write_b128 v1, v[44:47] offset:19456
 s_add_u32 s53, s35, 3670016
 s_mov_b32 m0, 0
 s_add_u32 s38, s53, 0
 buffer_load_dwordx4 v20, s[20:23], s38 offen lds
 s_mov_b32 m0, 1024
 s_add_u32 s38, s53, 65536
 buffer_load_dwordx4 v27, s[20:23], s38 offen lds
 s_mov_b32 m0, 2048
 s_add_u32 s38, s53, 131072
 buffer_load_dwordx4 v20, s[20:23], s38 offen lds
 s_mov_b32 m0, 3072
 s_add_u32 s38, s53, 196608
 buffer_load_dwordx4 v27, s[20:23], s38 offen lds
 ds_read_b64_tr_b16 v[32:33], v48 offset:4096
 ds_read_b64_tr_b16 v[34:35], v49 offset:8192
 ds_read_b64_tr_b16 v[36:37], v50 offset:12288
 ds_read_b64_tr_b16 v[38:39], v51 offset:16384
 ds_read_b64_tr_b16 v[40:41], v52 offset:4096
 ds_read_b64_tr_b16 v[42:43], v53 offset:8192
 ds_read_b64_tr_b16 v[44:45], v54 offset:12288
 ds_read_b64_tr_b16 v[46:47], v55 offset:16384
 s_waitcnt lgkmcnt(0)
 s_waitcnt vmcnt(20)
 s_barrier
 buffer_load_dword v71, v74, s[8:11], 0 offen offset:64 sc1
 ds_write_b128 v1, v[32:35] offset:4096
 ds_write_b128 v1, v[36:39] offset:5120
 ds_write_b128 v1, v[40:43] offset:6144
 ds_write_b128 v1, v[44:47] offset:7168
 ds_read_b64_tr_b16 a[0:1], v48 offset:12288
 ds_read_b64_tr_b16 a[2:3], v49 offset:4096
 ds_read_b64_tr_b16 a[4:5], v50 offset:0
 ds_read_b64_tr_b16 a[6:7], v51 offset:12288
 ds_read_b64_tr_b16 a[8:9], v52 offset:12288
 ds_read_b64_tr_b16 a[10:11], v53 offset:4096
 ds_read_b64_tr_b16 a[12:13], v54 offset:0
 ds_read_b64_tr_b16 a[14:15], v55 offset:12288
 s_waitcnt lgkmcnt(0)
 s_waitcnt vmcnt(17)
 s_barrier
 ds_read_b64_tr_b16 a[160:161], v48 offset:20480
 ds_read_b64_tr_b16 a[162:163], v49 offset:16384
 ds_read_b64_tr_b16 a[164:165], v50 offset:16384
 ds_read_b64_tr_b16 a[166:167], v51 offset:8192
 ds_read_b64_tr_b16 a[168:169], v52 offset:20480
 ds_read_b64_tr_b16 a[170:171], v53 offset:16384
 ds_read_b64_tr_b16 a[172:173], v54 offset:16384
 ds_read_b64_tr_b16 a[174:175], v55 offset:8192
 s_waitcnt lgkmcnt(0)
 s_waitcnt vmcnt(13)
 s_barrier
 s_add_u32 s53, s35, 2097152
 s_add_u32 m0, s37, 20480
 s_add_u32 s38, s53, 0
 buffer_load_dwordx4 v20, s[16:19], s38 offen lds
 s_add_u32 m0, s37, 21504
 s_add_u32 s38, s53, 65536
 buffer_load_dwordx4 v27, s[16:19], s38 offen lds
 s_add_u32 m0, s37, 22528
 s_add_u32 s38, s53, 131072
 buffer_load_dwordx4 v20, s[16:19], s38 offen lds
 s_add_u32 m0, s37, 23552
 s_add_u32 s38, s53, 196608
 buffer_load_dwordx4 v27, s[16:19], s38 offen lds
 ds_read_b64_tr_b16 v[112:113], v48 offset:24576
 ds_read_b64_tr_b16 v[114:115], v49 offset:0
 ds_read_b64_tr_b16 v[116:117], v50 offset:8192
 ds_read_b64_tr_b16 v[118:119], v51 offset:0
 ds_read_b64_tr_b16 v[120:121], v52 offset:24576
 ds_read_b64_tr_b16 v[122:123], v53 offset:0
 ds_read_b64_tr_b16 v[124:125], v54 offset:8192
 ds_read_b64_tr_b16 v[126:127], v55 offset:0
 s_waitcnt lgkmcnt(0)
 s_waitcnt vmcnt(13)
 s_barrier
 s_add_u32 s53, s35, 524288
 s_add_u32 m0, s37, 24576
 s_add_u32 s38, s53, 0
 buffer_load_dwordx4 v20, s[20:23], s38 offen lds
 s_add_u32 m0, s37, 25600
 s_add_u32 s38, s53, 65536
 buffer_load_dwordx4 v27, s[20:23], s38 offen lds
 s_add_u32 m0, s37, 26624
 s_add_u32 s38, s53, 131072
 buffer_load_dwordx4 v20, s[20:23], s38 offen lds
 s_add_u32 m0, s37, 27648
 s_add_u32 s38, s53, 196608
 buffer_load_dwordx4 v27, s[20:23], s38 offen lds
 ds_read_b64_tr_b16 v[96:97], v48 offset:28672
 ds_read_b64_tr_b16 v[98:99], v49 offset:20480
 ds_read_b64_tr_b16 v[100:101], v50 offset:4096
 ds_read_b64_tr_b16 v[102:103], v51 offset:4096
 ds_read_b64_tr_b16 v[104:105], v52 offset:28672
 ds_read_b64_tr_b16 v[106:107], v53 offset:20480
 ds_read_b64_tr_b16 v[108:109], v54 offset:4096
 ds_read_b64_tr_b16 v[110:111], v55 offset:4096
 s_waitcnt lgkmcnt(0)
 s_waitcnt vmcnt(13)
 s_barrier
 s_add_u32 s53, s35, 2621440
 s_add_u32 m0, s37, 28672
 s_add_u32 s38, s53, 0
 buffer_load_dwordx4 v20, s[24:27], s38 offen lds
 s_add_u32 m0, s37, 29696
 s_add_u32 s38, s53, 65536
 buffer_load_dwordx4 v27, s[24:27], s38 offen lds
 s_add_u32 m0, s37, 30720
 s_add_u32 s38, s53, 131072
 buffer_load_dwordx4 v20, s[24:27], s38 offen lds
 s_add_u32 m0, s37, 31744
 s_add_u32 s38, s53, 196608
 buffer_load_dwordx4 v27, s[24:27], s38 offen lds
 ds_read_b64_tr_b16 a[16:17], v48 offset:32768
 ds_read_b64_tr_b16 a[18:19], v49 offset:24576
 ds_read_b64_tr_b16 a[20:21], v50 offset:20480
 ds_read_b64_tr_b16 a[22:23], v51 offset:20480
 ds_read_b64_tr_b16 a[24:25], v52 offset:32768
 ds_read_b64_tr_b16 a[26:27], v53 offset:24576
 ds_read_b64_tr_b16 a[28:29], v54 offset:20480
 ds_read_b64_tr_b16 a[30:31], v55 offset:20480
 s_waitcnt lgkmcnt(0)
 s_waitcnt vmcnt(13)
 s_barrier
 s_add_u32 s53, s35, 4194304
 s_add_u32 m0, s37, 32768
 s_add_u32 s38, s53, 0
 buffer_load_dwordx4 v20, s[20:23], s38 offen lds
 s_add_u32 m0, s37, 33792
 s_add_u32 s38, s53, 65536
 buffer_load_dwordx4 v27, s[20:23], s38 offen lds
 s_add_u32 m0, s37, 34816
 s_add_u32 s38, s53, 131072
 buffer_load_dwordx4 v20, s[20:23], s38 offen lds
 s_add_u32 m0, s37, 35840
 s_add_u32 s38, s53, 196608
 buffer_load_dwordx4 v27, s[20:23], s38 offen lds
 ds_read_b64_tr_b16 v[32:33], v60 offset:0
 ds_read_b64_tr_b16 v[34:35], v49 offset:28672
 ds_read_b64_tr_b16 v[36:37], v50 offset:24576
 ds_read_b64_tr_b16 v[38:39], v51 offset:24576
 ds_read_b64_tr_b16 v[40:41], v61 offset:0
 ds_read_b64_tr_b16 v[42:43], v53 offset:28672
 ds_read_b64_tr_b16 v[44:45], v54 offset:24576
 ds_read_b64_tr_b16 v[46:47], v55 offset:24576
 s_waitcnt lgkmcnt(0)
 s_waitcnt vmcnt(12)
 s_barrier
 ds_write_b128 v1, v[32:35] offset:12288
 ds_write_b128 v1, v[36:39] offset:13312
 ds_write_b128 v1, v[40:43] offset:14336
 ds_write_b128 v1, v[44:47] offset:15360
 s_add_u32 s53, s35, 0
 s_mov_b32 m0, 0
 s_add_u32 s38, s53, 0
 buffer_load_dwordx4 v20, s[16:19], s38 offen lds
 s_mov_b32 m0, 1024
 s_add_u32 s38, s53, 65536
 buffer_load_dwordx4 v27, s[16:19], s38 offen lds
 s_mov_b32 m0, 2048
 s_add_u32 s38, s53, 131072
 buffer_load_dwordx4 v20, s[16:19], s38 offen lds
 s_mov_b32 m0, 3072
 s_add_u32 s38, s53, 196608
 buffer_load_dwordx4 v27, s[16:19], s38 offen lds
 ds_read_b64_tr_b16 a[80:81], v48 offset:20480
 ds_read_b64_tr_b16 a[82:83], v49 offset:32768
 ds_read_b64_tr_b16 a[84:85], v50 offset:28672
 ds_read_b64_tr_b16 a[86:87], v51 offset:28672
 ds_read_b64_tr_b16 a[88:89], v52 offset:20480
 ds_read_b64_tr_b16 a[90:91], v53 offset:32768
 ds_read_b64_tr_b16 a[92:93], v54 offset:28672
 ds_read_b64_tr_b16 a[94:95], v55 offset:28672
 s_waitcnt lgkmcnt(0)
 s_waitcnt vmcnt(12)
 s_barrier
 s_add_u32 s53, s36, 512
 s_add_u32 m0, s37, 20480
 s_add_u32 s38, s53, 0
 buffer_load_dwordx4 v21, s[28:31], s38 offen lds
 s_add_u32 m0, s37, 21504
 s_add_u32 s38, s53, 4608
 buffer_load_dwordx4 v21, s[28:31], s38 offen lds
 s_add_u32 m0, s37, 22528
 s_add_u32 s38, s53, 36864
 buffer_load_dwordx4 v21, s[28:31], s38 offen lds
 s_add_u32 m0, s37, 23552
 s_add_u32 s38, s53, 41472
 buffer_load_dwordx4 v21, s[28:31], s38 offen lds
 ds_read_b64_tr_b16 v[144:145], v48 offset:24576
 ds_read_b64_tr_b16 v[146:147], v60 offset:4096
 ds_read_b64_tr_b16 v[148:149], v50 offset:32768
 ds_read_b64_tr_b16 v[150:151], v51 offset:32768
 ds_read_b64_tr_b16 v[152:153], v52 offset:24576
 ds_read_b64_tr_b16 v[154:155], v61 offset:4096
 ds_read_b64_tr_b16 v[156:157], v54 offset:32768
 ds_read_b64_tr_b16 v[158:159], v55 offset:32768
 s_waitcnt lgkmcnt(0)
 s_waitcnt vmcnt(12)
 s_barrier
 s_add_u32 s53, s36, 74240
 s_add_u32 m0, s37, 24576
 s_add_u32 s38, s53, 0
 buffer_load_dwordx4 v21, s[28:31], s38 offen lds
 s_add_u32 m0, s37, 25600
 s_add_u32 s38, s53, 4608
 buffer_load_dwordx4 v21, s[28:31], s38 offen lds
 s_add_u32 m0, s37, 26624
 s_add_u32 s38, s53, 36864
 buffer_load_dwordx4 v21, s[28:31], s38 offen lds
 s_add_u32 m0, s37, 27648
 s_add_u32 s38, s53, 41472
 buffer_load_dwordx4 v21, s[28:31], s38 offen lds
 ds_read_b64_tr_b16 a[144:145], v48 offset:28672
 ds_read_b64_tr_b16 a[146:147], v49 offset:16384
 ds_read_b64_tr_b16 a[148:149], v60 offset:8192
 ds_read_b64_tr_b16 a[150:151], v60 offset:12288
 ds_read_b64_tr_b16 a[152:153], v52 offset:28672
 ds_read_b64_tr_b16 a[154:155], v53 offset:16384
 ds_read_b64_tr_b16 a[156:157], v61 offset:8192
 ds_read_b64_tr_b16 a[158:159], v61 offset:12288
 s_waitcnt lgkmcnt(0)
 s_waitcnt vmcnt(12)
 s_barrier
 v_readfirstlane_b32 s38, v71
 s_lshr_b32 s45, s38, 16
 s_and_b32 s38, s38, 0xffff
 s_cmp_ge_u32 s38, 32
 s_cselect_b32 s44, 1, 0
 buffer_load_dwordx4 v[8:11], v72, s[76:79], 0 offen offset:256
 buffer_load_dwordx4 v[12:15], v72, s[76:79], 0 offen offset:384
 s_add_u32 s53, s36, 768
 s_add_u32 m0, s37, 28672
 s_add_u32 s38, s53, 0
 buffer_load_dwordx4 v21, s[28:31], s38 offen lds
 s_add_u32 m0, s37, 29696
 s_add_u32 s38, s53, 4608
 buffer_load_dwordx4 v21, s[28:31], s38 offen lds
 s_add_u32 m0, s37, 30720
 s_add_u32 s38, s53, 36864
 buffer_load_dwordx4 v21, s[28:31], s38 offen lds
 s_add_u32 m0, s37, 31744
 s_add_u32 s38, s53, 41472
 buffer_load_dwordx4 v21, s[28:31], s38 offen lds
 ds_read_b64_tr_b16 a[224:225], v48 offset:32768
 ds_read_b64_tr_b16 a[226:227], v49 offset:0
 ds_read_b64_tr_b16 a[228:229], v50 offset:4096
 ds_read_b64_tr_b16 a[230:231], v51 offset:4096
 ds_read_b64_tr_b16 a[232:233], v52 offset:32768
 ds_read_b64_tr_b16 a[234:235], v53 offset:0
 ds_read_b64_tr_b16 a[236:237], v54 offset:4096
 ds_read_b64_tr_b16 a[238:239], v55 offset:4096
 s_waitcnt lgkmcnt(0)
 s_waitcnt vmcnt(14)
 s_barrier
 s_add_u32 s53, s36, 74496
 s_add_u32 m0, s37, 32768
 s_add_u32 s38, s53, 0
 buffer_load_dwordx4 v21, s[28:31], s38 offen lds
 s_add_u32 m0, s37, 33792
 s_add_u32 s38, s53, 4608
 buffer_load_dwordx4 v21, s[28:31], s38 offen lds
 s_add_u32 m0, s37, 34816
 s_add_u32 s38, s53, 36864
 buffer_load_dwordx4 v21, s[28:31], s38 offen lds
 s_add_u32 m0, s37, 35840
 s_add_u32 s38, s53, 41472
 buffer_load_dwordx4 v21, s[28:31], s38 offen lds
 ds_read_b64_tr_b16 v[80:81], v60 offset:0
 ds_read_b64_tr_b16 v[82:83], v49 offset:20480
 ds_read_b64_tr_b16 v[84:85], v50 offset:20480
 ds_read_b64_tr_b16 v[86:87], v51 offset:20480
 ds_read_b64_tr_b16 v[88:89], v61 offset:0
 ds_read_b64_tr_b16 v[90:91], v53 offset:20480
 ds_read_b64_tr_b16 v[92:93], v54 offset:20480
 ds_read_b64_tr_b16 v[94:95], v55 offset:20480
 s_waitcnt lgkmcnt(0)
 s_waitcnt vmcnt(14)
 s_barrier
 ds_read_b64_tr_b16 v[32:33], v56 offset:20480
 ds_read_b64_tr_b16 v[34:35], v57 offset:24576
 ds_read_b64_tr_b16 v[36:37], v58 offset:24576
 ds_read_b64_tr_b16 v[38:39], v59 offset:24576
 ds_read_b64_tr_b16 v[40:41], v56 offset:22528
 ds_read_b64_tr_b16 v[42:43], v57 offset:26624
 ds_read_b64_tr_b16 v[44:45], v58 offset:26624
 ds_read_b64_tr_b16 v[46:47], v59 offset:26624
 s_waitcnt lgkmcnt(0)
 s_waitcnt vmcnt(10)
 s_barrier
 ds_write_b128 v1, v[32:35] offset:20480
 ds_write_b128 v1, v[36:39] offset:21504
 ds_write_b128 v1, v[40:43] offset:22528
 ds_write_b128 v1, v[44:47] offset:23552
 ds_read_b64_tr_b16 v[32:33], v56 offset:24576
 ds_read_b64_tr_b16 v[34:35], v57 offset:28672
 ds_read_b64_tr_b16 v[36:37], v58 offset:28672
 ds_read_b64_tr_b16 v[38:39], v59 offset:28672
 ds_read_b64_tr_b16 v[40:41], v56 offset:26624
 ds_read_b64_tr_b16 v[42:43], v57 offset:30720
 ds_read_b64_tr_b16 v[44:45], v58 offset:30720
 ds_read_b64_tr_b16 v[46:47], v59 offset:30720
 s_waitcnt lgkmcnt(0)
 s_waitcnt vmcnt(4)
 s_barrier
 ds_write_b128 v1, v[32:35] offset:24576
 ds_write_b128 v1, v[36:39] offset:25600
 ds_write_b128 v1, v[40:43] offset:26624
 ds_write_b128 v1, v[44:47] offset:27648
 ds_read_b64_tr_b16 v[32:33], v56 offset:28672
 ds_read_b64_tr_b16 v[34:35], v57 offset:32768
 ds_read_b64_tr_b16 v[36:37], v58 offset:32768
 ds_read_b64_tr_b16 v[38:39], v59 offset:32768
 ds_read_b64_tr_b16 v[40:41], v56 offset:30720
 ds_read_b64_tr_b16 v[42:43], v57 offset:34816
 ds_read_b64_tr_b16 v[44:45], v58 offset:34816
 ds_read_b64_tr_b16 v[46:47], v59 offset:34816
 s_waitcnt lgkmcnt(0)
 s_waitcnt vmcnt(0)
 s_barrier
 ds_write_b128 v1, v[32:35] offset:28672
 ds_write_b128 v1, v[36:39] offset:29696
 ds_write_b128 v1, v[40:43] offset:30720
 ds_write_b128 v1, v[44:47] offset:31744
 ds_read_b64_tr_b16 v[32:33], v56 offset:32768
 ds_read_b64_tr_b16 v[34:35], v62 offset:4096
 ds_read_b64_tr_b16 v[36:37], v62 offset:8192
 ds_read_b64_tr_b16 v[38:39], v62 offset:12288
 ds_read_b64_tr_b16 v[40:41], v56 offset:34816
 ds_read_b64_tr_b16 v[42:43], v62 offset:6144
 ds_read_b64_tr_b16 v[44:45], v62 offset:10240
 ds_read_b64_tr_b16 v[46:47], v62 offset:14336
 s_waitcnt lgkmcnt(0)
 s_barrier
 ds_write_b128 v1, v[32:35] offset:32768
 ds_write_b128 v1, v[36:39] offset:33792
 ds_write_b128 v1, v[40:43] offset:34816
 ds_write_b128 v1, v[44:47] offset:35840
 ds_write_b128 v0, v[8:11] offset:2048
 ds_write_b128 v0, v[12:15] offset:3072
 s_waitcnt lgkmcnt(0)
 s_cmp_eq_u32 s44, 1
 s_cbranch_scc1 L_eok76
 v_mov_b32 v76, 32
poll78:
 buffer_load_dword v77, v74, s[8:11], 0 offen offset:64 sc1
 s_waitcnt vmcnt(0)
 v_and_b32 v78, 0xffff, v77
 v_cmp_le_u32 vcc, v76, v78
 s_cmp_eq_u64 vcc, exec
 s_cbranch_scc1 polld79
 s_cmp_eq_u32 s15, 0
 s_cbranch_scc1 polld79
 s_sub_u32 s15, s15, 1
 s_sleep 6
 s_branch poll78
polld79:
 v_readfirstlane_b32 s45, v77
 s_lshr_b32 s45, s45, 16
 s_branch L_edn77
L_eok76:
L_edn77:
 s_mov_b32 s32, s45
 s_branch L_wl70
L_wl72:
 s_add_u32 s53, s36, 0
 s_add_u32 m0, s37, 12288
 s_add_u32 s38, s53, 0
 buffer_load_dwordx4 v21, s[28:31], s38 offen lds
 s_add_u32 m0, s37, 13312
 s_add_u32 s38, s53, 4608
 buffer_load_dwordx4 v21, s[28:31], s38 offen lds
 s_add_u32 m0, s37, 14336
 s_add_u32 s38, s53, 36864
 buffer_load_dwordx4 v21, s[28:31], s38 offen lds
 s_add_u32 m0, s37, 15360
 s_add_u32 s38, s53, 41472
 buffer_load_dwordx4 v21, s[28:31], s38 offen lds
 s_add_u32 s53, s36, 73728
 s_add_u32 m0, s37, 8192
 s_add_u32 s38, s53, 0
 buffer_load_dwordx4 v21, s[28:31], s38 offen lds
 s_add_u32 m0, s37, 9216
 s_add_u32 s38, s53, 4608
 buffer_load_dwordx4 v21, s[28:31], s38 offen lds
 s_add_u32 m0, s37, 10240
 s_add_u32 s38, s53, 36864
 buffer_load_dwordx4 v21, s[28:31], s38 offen lds
 s_add_u32 m0, s37, 11264
 s_add_u32 s38, s53, 41472
 buffer_load_dwordx4 v21, s[28:31], s38 offen lds
 s_add_u32 s53, s36, 256
 s_add_u32 m0, s37, 4096
 s_add_u32 s38, s53, 0
 buffer_load_dwordx4 v21, s[28:31], s38 offen lds
 s_add_u32 m0, s37, 5120
 s_add_u32 s38, s53, 4608
 buffer_load_dwordx4 v21, s[28:31], s38 offen lds
 s_add_u32 m0, s37, 6144
 s_add_u32 s38, s53, 36864
 buffer_load_dwordx4 v21, s[28:31], s38 offen lds
 s_add_u32 m0, s37, 7168
 s_add_u32 s38, s53, 41472
 buffer_load_dwordx4 v21, s[28:31], s38 offen lds
 s_add_u32 s53, s36, 73984
 s_add_u32 m0, s37, 16384
 s_add_u32 s38, s53, 0
 buffer_load_dwordx4 v21, s[28:31], s38 offen lds
 s_add_u32 m0, s37, 17408
 s_add_u32 s38, s53, 4608
 buffer_load_dwordx4 v21, s[28:31], s38 offen lds
 s_add_u32 m0, s37, 18432
 s_add_u32 s38, s53, 36864
 buffer_load_dwordx4 v21, s[28:31], s38 offen lds
 s_add_u32 m0, s37, 19456
 s_add_u32 s38, s53, 41472
 buffer_load_dwordx4 v21, s[28:31], s38 offen lds
 s_mov_b32 s53, s36
 s_add_u32 m0, s37, 0
 s_add_u32 s38, s53, 0
 buffer_load_dwordx4 v22, s[28:31], s38 offen lds
 s_add_u32 m0, s37, 1024
 s_add_u32 s38, s53, 4608
 buffer_load_dwordx4 v22, s[28:31], s38 offen lds
 s_add_u32 m0, s37, 2048
 s_add_u32 s38, s53, 9216
 buffer_load_dwordx4 v22, s[28:31], s38 offen lds
 s_add_u32 m0, s37, 3072
 s_add_u32 s38, s53, 13824
 buffer_load_dwordx4 v22, s[28:31], s38 offen lds
 s_add_u32 s53, s35, 524288
 s_add_u32 m0, s37, 20480
 s_add_u32 s38, s53, 0
 buffer_load_dwordx4 v20, s[16:19], s38 offen lds
 s_add_u32 m0, s37, 21504
 s_add_u32 s38, s53, 65536
 buffer_load_dwordx4 v27, s[16:19], s38 offen lds
 s_add_u32 m0, s37, 22528
 s_add_u32 s38, s53, 131072
 buffer_load_dwordx4 v20, s[16:19], s38 offen lds
 s_add_u32 m0, s37, 23552
 s_add_u32 s38, s53, 196608
 buffer_load_dwordx4 v27, s[16:19], s38 offen lds
 s_add_u32 s53, s35, 524288
 s_add_u32 m0, s37, 24576
 s_add_u32 s38, s53, 0
 buffer_load_dwordx4 v20, s[24:27], s38 offen lds
 s_add_u32 m0, s37, 25600
 s_add_u32 s38, s53, 65536
 buffer_load_dwordx4 v27, s[24:27], s38 offen lds
 s_add_u32 m0, s37, 26624
 s_add_u32 s38, s53, 131072
 buffer_load_dwordx4 v20, s[24:27], s38 offen lds
 s_add_u32 m0, s37, 27648
 s_add_u32 s38, s53, 196608
 buffer_load_dwordx4 v27, s[24:27], s38 offen lds
 s_add_u32 s53, s35, 1572864
 s_add_u32 m0, s37, 28672
 s_add_u32 s38, s53, 0
 buffer_load_dwordx4 v20, s[16:19], s38 offen lds
 s_add_u32 m0, s37, 29696
 s_add_u32 s38, s53, 65536
 buffer_load_dwordx4 v27, s[16:19], s38 offen lds
 s_add_u32 m0, s37, 30720
 s_add_u32 s38, s53, 131072
 buffer_load_dwordx4 v20, s[16:19], s38 offen lds
 s_add_u32 m0, s37, 31744
 s_add_u32 s38, s53, 196608
 buffer_load_dwordx4 v27, s[16:19], s38 offen lds
 s_add_u32 s53, s35, 1572864
 s_add_u32 m0, s37, 32768
 s_add_u32 s38, s53, 0
 buffer_load_dwordx4 v20, s[20:23], s38 offen lds
 s_add_u32 m0, s37, 33792
 s_add_u32 s38, s53, 65536
 buffer_load_dwordx4 v27, s[20:23], s38 offen lds
 s_add_u32 m0, s37, 34816
 s_add_u32 s38, s53, 131072
 buffer_load_dwordx4 v20, s[20:23], s38 offen lds
 s_add_u32 m0, s37, 35840
 s_add_u32 s38, s53, 196608
 buffer_load_dwordx4 v27, s[20:23], s38 offen lds
 s_add_u32 s53, s35, 1572864
 s_mov_b32 m0, 4096
 s_add_u32 s38, s53, 0
 buffer_load_dwordx4 v20, s[24:27], s38 offen lds
 s_mov_b32 m0, 5120
 s_add_u32 s38, s53, 65536
 buffer_load_dwordx4 v27, s[24:27], s38 offen lds
 s_mov_b32 m0, 6144
 s_add_u32 s38, s53, 131072
 buffer_load_dwordx4 v20, s[24:27], s38 offen lds
 s_mov_b32 m0, 7168
 s_add_u32 s38, s53, 196608
 buffer_load_dwordx4 v27, s[24:27], s38 offen lds
 s_cmp_eq_u32 s52, 0
 s_cbranch_scc1 L_np80
 v_mov_b32 v8, -1
 v_mov_b32 v9, -1
 v_mov_b32 v10, -1
 v_mov_b32 v11, -1
 s_add_u32 s33, s49, 0
 buffer_store_dwordx4 v[8:11], v0, s[4:7], s33 offen offset:0 sc1
 buffer_store_dwordx4 v[8:11], v0, s[4:7], s33 offen offset:1024 sc1
 buffer_store_dwordx4 v[8:11], v0, s[4:7], s33 offen offset:2048 sc1
 buffer_store_dwordx4 v[8:11], v0, s[4:7], s33 offen offset:3072 sc1
 s_add_u32 s33, s49, 294912
 buffer_store_dwordx4 v[8:11], v0, s[4:7], s33 offen offset:0 sc1
 buffer_store_dwordx4 v[8:11], v0, s[4:7], s33 offen offset:1024 sc1
 buffer_store_dwordx4 v[8:11], v0, s[4:7], s33 offen offset:2048 sc1
 buffer_store_dwordx4 v[8:11], v0, s[4:7], s33 offen offset:3072 sc1
 s_add_u32 s33, s46, 9216
 buffer_store_dword v8, v4, s[4:7], s33 offen sc1
 s_add_u32 s33, s46, 18432
 buffer_store_dword v8, v4, s[4:7], s33 offen sc1
L_np80:
 s_waitcnt vmcnt(36)
 s_barrier
 ds_read_b64_tr_b16 v[176:177], v56 offset:0
 ds_read_b64_tr_b16 v[178:179], v57 offset:12288
 ds_read_b64_tr_b16 v[180:181], v58 offset:12288
 ds_read_b64_tr_b16 v[182:183], v59 offset:16384
 ds_read_b64_tr_b16 v[184:185], v56 offset:2048
 ds_read_b64_tr_b16 v[186:187], v57 offset:14336
 ds_read_b64_tr_b16 v[188:189], v58 offset:14336
 ds_read_b64_tr_b16 v[190:191], v59 offset:18432
 s_waitcnt lgkmcnt(0)
 s_waitcnt vmcnt(32)
 s_barrier
 s_add_u32 s53, s35, 2097152
 s_add_u32 m0, s37, 12288
 s_add_u32 s38, s53, 0
 buffer_load_dwordx4 v20, s[24:27], s38 offen lds
 s_add_u32 m0, s37, 13312
 s_add_u32 s38, s53, 65536
 buffer_load_dwordx4 v27, s[24:27], s38 offen lds
 s_add_u32 m0, s37, 14336
 s_add_u32 s38, s53, 131072
 buffer_load_dwordx4 v20, s[24:27], s38 offen lds
 s_add_u32 m0, s37, 15360
 s_add_u32 s38, s53, 196608
 buffer_load_dwordx4 v27, s[24:27], s38 offen lds
 ds_read_b64_tr_b16 v[192:193], v56 offset:8192
 ds_read_b64_tr_b16 v[194:195], v57 offset:8192
 ds_read_b64_tr_b16 v[196:197], v58 offset:0
 ds_read_b64_tr_b16 v[198:199], v59 offset:12288
 ds_read_b64_tr_b16 v[200:201], v56 offset:10240
 ds_read_b64_tr_b16 v[202:203], v57 offset:10240
 ds_read_b64_tr_b16 v[204:205], v58 offset:2048
 ds_read_b64_tr_b16 v[206:207], v59 offset:14336
 s_waitcnt lgkmcnt(0)
 s_waitcnt vmcnt(32)
 s_barrier
 s_add_u32 s53, s35, 2621440
 s_add_u32 m0, s37, 8192
 s_add_u32 s38, s53, 0
 buffer_load_dwordx4 v20, s[16:19], s38 offen lds
 s_add_u32 m0, s37, 9216
 s_add_u32 s38, s53, 65536
 buffer_load_dwordx4 v27, s[16:19], s38 offen lds
 s_add_u32 m0, s37, 10240
 s_add_u32 s38, s53, 131072
 buffer_load_dwordx4 v20, s[16:19], s38 offen lds
 s_add_u32 m0, s37, 11264
 s_add_u32 s38, s53, 196608
 buffer_load_dwordx4 v27, s[16:19], s38 offen lds
 ds_read_b64_tr_b16 v[208:209], v56 offset:16384
 ds_read_b64_tr_b16 v[210:211], v57 offset:4096
 ds_read_b64_tr_b16 v[212:213], v58 offset:16384
 ds_read_b64_tr_b16 v[214:215], v59 offset:8192
 ds_read_b64_tr_b16 v[216:217], v56 offset:18432
 ds_read_b64_tr_b16 v[218:219], v57 offset:6144
 ds_read_b64_tr_b16 v[220:221], v58 offset:18432
 ds_read_b64_tr_b16 v[222:223], v59 offset:10240
 s_waitcnt lgkmcnt(0)
 s_waitcnt vmcnt(32)
 s_barrier
 s_add_u32 s53, s35, 3145728
 s_add_u32 m0, s37, 4096
 s_add_u32 s38, s53, 0
 buffer_load_dwordx4 v20, s[24:27], s38 offen lds
 s_add_u32 m0, s37, 5120
 s_add_u32 s38, s53, 65536
 buffer_load_dwordx4 v27, s[24:27], s38 offen lds
 s_add_u32 m0, s37, 6144
 s_add_u32 s38, s53, 131072
 buffer_load_dwordx4 v20, s[24:27], s38 offen lds
 s_add_u32 m0, s37, 7168
 s_add_u32 s38, s53, 196608
 buffer_load_dwordx4 v27, s[24:27], s38 offen lds
 ds_read_b64_tr_b16 v[224:225], v56 offset:4096
 ds_read_b64_tr_b16 v[226:227], v57 offset:16384
 ds_read_b64_tr_b16 v[228:229], v58 offset:8192
 ds_read_b64_tr_b16 v[230:231], v59 offset:0
 ds_read_b64_tr_b16 v[232:233], v56 offset:6144
 ds_read_b64_tr_b16 v[234:235], v57 offset:18432
 ds_read_b64_tr_b16 v[236:237], v58 offset:10240
 ds_read_b64_tr_b16 v[238:239], v59 offset:2048
 s_waitcnt lgkmcnt(0)
 s_waitcnt vmcnt(32)
 s_barrier
 s_add_u32 s53, s35, 3670016
 s_add_u32 m0, s37, 16384
 s_add_u32 s38, s53, 0
 buffer_load_dwordx4 v20, s[16:19], s38 offen lds
 s_add_u32 m0, s37, 17408
 s_add_u32 s38, s53, 65536
 buffer_load_dwordx4 v27, s[16:19], s38 offen lds
 s_add_u32 m0, s37, 18432
 s_add_u32 s38, s53, 131072
 buffer_load_dwordx4 v20, s[16:19], s38 offen lds
 s_add_u32 m0, s37, 19456
 s_add_u32 s38, s53, 196608
 buffer_load_dwordx4 v27, s[16:19], s38 offen lds
 ds_read_b64_tr_b16 v[240:241], v23 offset:0
 ds_read_b64_tr_b16 v[242:243], v23 offset:512
 ds_read_b64_tr_b16 v[244:245], v23 offset:2048
 ds_read_b64_tr_b16 v[246:247], v23 offset:2560
 ds_read_b64_tr_b16 v[248:249], v24 offset:0
 ds_read_b64_tr_b16 v[250:251], v24 offset:512
 ds_read_b64_tr_b16 v[252:253], v24 offset:2048
 ds_read_b64_tr_b16 v[254:255], v24 offset:2560
 s_waitcnt lgkmcnt(0)
 s_waitcnt vmcnt(32)
 s_barrier
 s_add_u32 s53, s35, 4194304
 s_add_u32 m0, s37, 0
 s_add_u32 s38, s53, 0
 buffer_load_dwordx4 v20, s[16:19], s38 offen lds
 s_add_u32 m0, s37, 1024
 s_add_u32 s38, s53, 65536
 buffer_load_dwordx4 v27, s[16:19], s38 offen lds
 s_add_u32 m0, s37, 2048
 s_add_u32 s38, s53, 131072
 buffer_load_dwordx4 v20, s[16:19], s38 offen lds
 s_add_u32 m0, s37, 3072
 s_add_u32 s38, s53, 196608
 buffer_load_dwordx4 v27, s[16:19], s38 offen lds
 ds_read_b64_tr_b16 a[32:33], v48 offset:20480
 ds_read_b64_tr_b16 a[34:35], v49 offset:20480
 ds_read_b64_tr_b16 a[36:37], v50 offset:20480
 ds_read_b64_tr_b16 a[38:39], v51 offset:20480
 ds_read_b64_tr_b16 a[40:41], v52 offset:20480
 ds_read_b64_tr_b16 a[42:43], v53 offset:20480
 ds_read_b64_tr_b16 a[44:45], v54 offset:20480
 ds_read_b64_tr_b16 a[46:47], v55 offset:20480
 s_waitcnt lgkmcnt(0)
 s_waitcnt vmcnt(32)
 s_barrier
 s_add_u32 s53, s35, 4194304
 s_add_u32 m0, s37, 20480
 s_add_u32 s38, s53, 0
 buffer_load_dwordx4 v20, s[24:27], s38 offen lds
 s_add_u32 m0, s37, 21504
 s_add_u32 s38, s53, 65536
 buffer_load_dwordx4 v27, s[24:27], s38 offen lds
 s_add_u32 m0, s37, 22528
 s_add_u32 s38, s53, 131072
 buffer_load_dwordx4 v20, s[24:27], s38 offen lds
 s_add_u32 m0, s37, 23552
 s_add_u32 s38, s53, 196608
 buffer_load_dwordx4 v27, s[24:27], s38 offen lds
 ds_read_b64_tr_b16 a[64:65], v48 offset:24576
 ds_read_b64_tr_b16 a[66:67], v49 offset:24576
 ds_read_b64_tr_b16 a[68:69], v50 offset:24576
 ds_read_b64_tr_b16 a[70:71], v51 offset:24576
 ds_read_b64_tr_b16 a[72:73], v52 offset:24576
 ds_read_b64_tr_b16 a[74:75], v53 offset:24576
 ds_read_b64_tr_b16 a[76:77], v54 offset:24576
 ds_read_b64_tr_b16 a[78:79], v55 offset:24576
 s_waitcnt lgkmcnt(0)
 s_waitcnt vmcnt(32)
 s_barrier
 s_add_u32 s53, s35, 1048576
 s_add_u32 m0, s37, 24576
 s_add_u32 s38, s53, 0
 buffer_load_dwordx4 v20, s[16:19], s38 offen lds
 s_add_u32 m0, s37, 25600
 s_add_u32 s38, s53, 65536
 buffer_load_dwordx4 v27, s[16:19], s38 offen lds
 s_add_u32 m0, s37, 26624
 s_add_u32 s38, s53, 131072
 buffer_load_dwordx4 v20, s[16:19], s38 offen lds
 s_add_u32 m0, s37, 27648
 s_add_u32 s38, s53, 196608
 buffer_load_dwordx4 v27, s[16:19], s38 offen lds
 ds_read_b64_tr_b16 a[112:113], v48 offset:28672
 ds_read_b64_tr_b16 a[114:115], v49 offset:28672
 ds_read_b64_tr_b16 a[116:117], v50 offset:28672
 ds_read_b64_tr_b16 a[118:119], v51 offset:28672
 ds_read_b64_tr_b16 a[120:121], v52 offset:28672
 ds_read_b64_tr_b16 a[122:123], v53 offset:28672
 ds_read_b64_tr_b16 a[124:125], v54 offset:28672
 ds_read_b64_tr_b16 a[126:127], v55 offset:28672
 s_waitcnt lgkmcnt(0)
 s_waitcnt vmcnt(32)
 s_barrier
 s_add_u32 s53, s35, 2621440
 s_add_u32 m0, s37, 28672
 s_add_u32 s38, s53, 0
 buffer_load_dwordx4 v20, s[20:23], s38 offen lds
 s_add_u32 m0, s37, 29696
 s_add_u32 s38, s53, 65536
 buffer_load_dwordx4 v27, s[20:23], s38 offen lds
 s_add_u32 m0, s37, 30720
 s_add_u32 s38, s53, 131072
 buffer_load_dwordx4 v20, s[20:23], s38 offen lds
 s_add_u32 m0, s37, 31744
 s_add_u32 s38, s53, 196608
 buffer_load_dwordx4 v27, s[20:23], s38 offen lds
 ds_read_b64_tr_b16 a[128:129], v48 offset:32768
 ds_read_b64_tr_b16 a[130:131], v49 offset:32768
 ds_read_b64_tr_b16 a[132:133], v50 offset:32768
 ds_read_b64_tr_b16 a[134:135], v51 offset:32768
 ds_read_b64_tr_b16 a[136:137], v52 offset:32768
 ds_read_b64_tr_b16 a[138:139], v53 offset:32768
 ds_read_b64_tr_b16 a[140:141], v54 offset:32768
 ds_read_b64_tr_b16 a[142:143], v55 offset:32768
 s_waitcnt lgkmcnt(0)
 s_waitcnt vmcnt(32)
 s_barrier
 s_add_u32 s53, s35, 3145728
 s_add_u32 m0, s37, 32768
 s_add_u32 s38, s53, 0
 buffer_load_dwordx4 v20, s[20:23], s38 offen lds
 s_add_u32 m0, s37, 33792
 s_add_u32 s38, s53, 65536
 buffer_load_dwordx4 v27, s[20:23], s38 offen lds
 s_add_u32 m0, s37, 34816
 s_add_u32 s38, s53, 131072
 buffer_load_dwordx4 v20, s[20:23], s38 offen lds
 s_add_u32 m0, s37, 35840
 s_add_u32 s38, s53, 196608
 buffer_load_dwordx4 v27, s[20:23], s38 offen lds
 ds_read_b64_tr_b16 a[144:145], v60 offset:0
 ds_read_b64_tr_b16 a[146:147], v60 offset:4096
 ds_read_b64_tr_b16 a[148:149], v60 offset:8192
 ds_read_b64_tr_b16 a[150:151], v60 offset:12288
 ds_read_b64_tr_b16 a[152:153], v61 offset:0
 ds_read_b64_tr_b16 a[154:155], v61 offset:4096
 ds_read_b64_tr_b16 a[156:157], v61 offset:8192
 ds_read_b64_tr_b16 a[158:159], v61 offset:12288
 s_waitcnt lgkmcnt(0)
 s_waitcnt vmcnt(32)
 s_barrier
 s_add_u32 s53, s35, 3670016
 s_mov_b32 m0, 4096
 s_add_u32 s38, s53, 0
 buffer_load_dwordx4 v20, s[24:27], s38 offen lds
 s_mov_b32 m0, 5120
 s_add_u32 s38, s53, 65536
 buffer_load_dwordx4 v27, s[24:27], s38 offen lds
 s_mov_b32 m0, 6144
 s_add_u32 s38, s53, 131072
 buffer_load_dwordx4 v20, s[24:27], s38 offen lds
 s_mov_b32 m0, 7168
 s_add_u32 s38, s53, 196608
 buffer_load_dwordx4 v27, s[24:27], s38 offen lds
 ds_read_b64_tr_b16 a[176:177], v48 offset:0
 ds_read_b64_tr_b16 a[178:179], v49 offset:12288
 ds_read_b64_tr_b16 a[180:181], v50 offset:12288
 ds_read_b64_tr_b16 a[182:183], v51 offset:16384
 ds_read_b64_tr_b16 a[184:185], v52 offset:0
 ds_read_b64_tr_b16 a[186:187], v53 offset:12288
 ds_read_b64_tr_b16 a[188:189], v54 offset:12288
 ds_read_b64_tr_b16 a[190:191], v55 offset:16384
 s_waitcnt lgkmcnt(0)
 s_waitcnt vmcnt(32)
 s_barrier
 ds_read_b64_tr_b16 a[192:193], v48 offset:8192
 ds_read_b64_tr_b16 a[194:195], v49 offset:8192
 ds_read_b64_tr_b16 a[196:197], v50 offset:0
 ds_read_b64_tr_b16 a[198:199], v51 offset:12288
 ds_read_b64_tr_b16 a[200:201], v52 offset:8192
 ds_read_b64_tr_b16 a[202:203], v53 offset:8192
 ds_read_b64_tr_b16 a[204:205], v54 offset:0
 ds_read_b64_tr_b16 a[206:207], v55 offset:12288
 s_waitcnt lgkmcnt(0)
 s_waitcnt vmcnt(28)
 s_barrier
 s_add_u32 s53, s35, 2097152
 s_add_u32 m0, s37, 8192
 s_add_u32 s38, s53, 0
 buffer_load_dwordx4 v20, s[20:23], s38 offen lds
 s_add_u32 m0, s37, 9216
 s_add_u32 s38, s53, 65536
 buffer_load_dwordx4 v27, s[20:23], s38 offen lds
 s_add_u32 m0, s37, 10240
 s_add_u32 s38, s53, 131072
 buffer_load_dwordx4 v20, s[20:23], s38 offen lds
 s_add_u32 m0, s37, 11264
 s_add_u32 s38, s53, 196608
 buffer_load_dwordx4 v27, s[20:23], s38 offen lds
 ds_read_b64_tr_b16 a[240:241], v48 offset:16384
 ds_read_b64_tr_b16 a[242:243], v49 offset:4096
 ds_read_b64_tr_b16 a[244:245], v50 offset:16384
 ds_read_b64_tr_b16 a[246:247], v51 offset:8192
 ds_read_b64_tr_b16 a[248:249], v52 offset:16384
 ds_read_b64_tr_b16 a[250:251], v53 offset:4096
 ds_read_b64_tr_b16 a[252:253], v54 offset:16384
 ds_read_b64_tr_b16 a[254:255], v55 offset:8192
 s_waitcnt lgkmcnt(0)
 s_waitcnt vmcnt(28)
 s_barrier
 s_add_u32 s53, s35, 1048576
 s_add_u32 m0, s37, 4096
 s_add_u32 s38, s53, 0
 buffer_load_dwordx4 v20, s[20:23], s38 offen lds
 s_add_u32 m0, s37, 5120
 s_add_u32 s38, s53, 65536
 buffer_load_dwordx4 v27, s[20:23], s38 offen lds
 s_add_u32 m0, s37, 6144
 s_add_u32 s38, s53, 131072
 buffer_load_dwordx4 v20, s[20:23], s38 offen lds
 s_add_u32 m0, s37, 7168
 s_add_u32 s38, s53, 196608
 buffer_load_dwordx4 v27, s[20:23], s38 offen lds
 ds_read_b64_tr_b16 v[80:81], v48 offset:4096
 ds_read_b64_tr_b16 v[82:83], v49 offset:16384
 ds_read_b64_tr_b16 v[84:85], v50 offset:8192
 ds_read_b64_tr_b16 v[86:87], v51 offset:0
 ds_read_b64_tr_b16 v[88:89], v52 offset:4096
 ds_read_b64_tr_b16 v[90:91], v53 offset:16384
 ds_read_b64_tr_b16 v[92:93], v54 offset:8192
 ds_read_b64_tr_b16 v[94:95], v55 offset:0
 s_waitcnt lgkmcnt(0)
 s_waitcnt vmcnt(28)
 s_barrier
 s_add_u32 s53, s35, 3145728
 s_add_u32 m0, s37, 16384
 s_add_u32 s38, s53, 0
 buffer_load_dwordx4 v20, s[16:19], s38 offen lds
 s_add_u32 m0, s37, 17408
 s_add_u32 s38, s53, 65536
 buffer_load_dwordx4 v27, s[16:19], s38 offen lds
 s_add_u32 m0, s37, 18432
 s_add_u32 s38, s53, 131072
 buffer_load_dwordx4 v20, s[16:19], s38 offen lds
 s_add_u32 m0, s37, 19456
 s_add_u32 s38, s53, 196608
 buffer_load_dwordx4 v27, s[16:19], s38 offen lds
 ds_read_b64_tr_b16 v[128:129], v48 offset:12288
 ds_read_b64_tr_b16 v[130:131], v49 offset:0
 ds_read_b64_tr_b16 v[132:133], v50 offset:4096
 ds_read_b64_tr_b16 v[134:135], v51 offset:4096
 ds_read_b64_tr_b16 v[136:137], v52 offset:12288
 ds_read_b64_tr_b16 v[138:139], v53 offset:0
 ds_read_b64_tr_b16 v[140:141], v54 offset:4096
 ds_read_b64_tr_b16 v[142:143], v55 offset:4096
 s_waitcnt lgkmcnt(0)
 s_waitcnt vmcnt(28)
 s_barrier
 s_add_u32 s53, s35, 0
 s_add_u32 m0, s37, 0
 s_add_u32 s38, s53, 0
 buffer_load_dwordx4 v20, s[24:27], s38 offen lds
 s_add_u32 m0, s37, 1024
 s_add_u32 s38, s53, 65536
 buffer_load_dwordx4 v27, s[24:27], s38 offen lds
 s_add_u32 m0, s37, 2048
 s_add_u32 s38, s53, 131072
 buffer_load_dwordx4 v20, s[24:27], s38 offen lds
 s_add_u32 m0, s37, 3072
 s_add_u32 s38, s53, 196608
 buffer_load_dwordx4 v27, s[24:27], s38 offen lds
 ds_read_b64_tr_b16 v[160:161], v48 offset:20480
 ds_read_b64_tr_b16 v[162:163], v49 offset:20480
 ds_read_b64_tr_b16 v[164:165], v50 offset:20480
 ds_read_b64_tr_b16 v[166:167], v51 offset:20480
 ds_read_b64_tr_b16 v[168:169], v52 offset:20480
 ds_read_b64_tr_b16 v[170:171], v53 offset:20480
 ds_read_b64_tr_b16 v[172:173], v54 offset:20480
 ds_read_b64_tr_b16 v[174:175], v55 offset:20480
 s_waitcnt lgkmcnt(0)
 s_waitcnt vmcnt(28)
 s_barrier
 s_add_u32 s53, s35, 0
 s_add_u32 m0, s37, 20480
 s_add_u32 s38, s53, 0
 buffer_load_dwordx4 v20, s[20:23], s38 offen lds
 s_add_u32 m0, s37, 21504
 s_add_u32 s38, s53, 65536
 buffer_load_dwordx4 v27, s[20:23], s38 offen lds
 s_add_u32 m0, s37, 22528
 s_add_u32 s38, s53, 131072
 buffer_load_dwordx4 v20, s[20:23], s38 offen lds
 s_add_u32 m0, s37, 23552
 s_add_u32 s38, s53, 196608
 buffer_load_dwordx4 v27, s[20:23], s38 offen lds
 ds_read_b64_tr_b16 a[80:81], v48 offset:24576
 ds_read_b64_tr_b16 a[82:83], v49 offset:24576
 ds_read_b64_tr_b16 a[84:85], v50 offset:24576
 ds_read_b64_tr_b16 a[86:87], v51 offset:24576
 ds_read_b64_tr_b16 a[88:89], v52 offset:24576
 ds_read_b64_tr_b16 a[90:91], v53 offset:24576
 ds_read_b64_tr_b16 a[92:93], v54 offset:24576
 ds_read_b64_tr_b16 a[94:95], v55 offset:24576
 s_waitcnt lgkmcnt(0)
 s_waitcnt vmcnt(28)
 s_barrier
 s_add_u32 s53, s35, 1048576
 s_add_u32 m0, s37, 24576
 s_add_u32 s38, s53, 0
 buffer_load_dwordx4 v20, s[24:27], s38 offen lds
 s_add_u32 m0, s37, 25600
 s_add_u32 s38, s53, 65536
 buffer_load_dwordx4 v27, s[24:27], s38 offen lds
 s_add_u32 m0, s37, 26624
 s_add_u32 s38, s53, 131072
 buffer_load_dwordx4 v20, s[24:27], s38 offen lds
 s_add_u32 m0, s37, 27648
 s_add_u32 s38, s53, 196608
 buffer_load_dwordx4 v27, s[24:27], s38 offen lds
 ds_read_b64_tr_b16 v[32:33], v48 offset:28672
 ds_read_b64_tr_b16 v[34:35], v49 offset:28672
 ds_read_b64_tr_b16 v[36:37], v50 offset:28672
 ds_read_b64_tr_b16 v[38:39], v51 offset:28672
 ds_read_b64_tr_b16 v[40:41], v52 offset:28672
 ds_read_b64_tr_b16 v[42:43], v53 offset:28672
 ds_read_b64_tr_b16 v[44:45], v54 offset:28672
 ds_read_b64_tr_b16 v[46:47], v55 offset:28672
 s_waitcnt lgkmcnt(0)
 s_waitcnt vmcnt(28)
 s_barrier
 ds_write_b128 v1, v[32:35] offset:12288
 ds_write_b128 v1, v[36:39] offset:13312
 ds_write_b128 v1, v[40:43] offset:14336
 ds_write_b128 v1, v[44:47] offset:15360
 s_add_u32 s53, s35, 3670016
 s_add_u32 m0, s37, 28672
 s_add_u32 s38, s53, 0
 buffer_load_dwordx4 v20, s[20:23], s38 offen lds
 s_add_u32 m0, s37, 29696
 s_add_u32 s38, s53, 65536
 buffer_load_dwordx4 v27, s[20:23], s38 offen lds
 s_add_u32 m0, s37, 30720
 s_add_u32 s38, s53, 131072
 buffer_load_dwordx4 v20, s[20:23], s38 offen lds
 s_add_u32 m0, s37, 31744
 s_add_u32 s38, s53, 196608
 buffer_load_dwordx4 v27, s[20:23], s38 offen lds
 ds_read_b64_tr_b16 a[224:225], v48 offset:32768
 ds_read_b64_tr_b16 a[226:227], v49 offset:32768
 ds_read_b64_tr_b16 a[228:229], v50 offset:32768
 ds_read_b64_tr_b16 a[230:231], v51 offset:32768
 ds_read_b64_tr_b16 a[232:233], v52 offset:32768
 ds_read_b64_tr_b16 a[234:235], v53 offset:32768
 ds_read_b64_tr_b16 a[236:237], v54 offset:32768
 ds_read_b64_tr_b16 a[238:239], v55 offset:32768
 s_waitcnt lgkmcnt(0)
 s_waitcnt vmcnt(28)
 s_barrier
 s_add_u32 s53, s35, 2097152
 s_add_u32 m0, s37, 32768
 s_add_u32 s38, s53, 0
 buffer_load_dwordx4 v20, s[16:19], s38 offen lds
 s_add_u32 m0, s37, 33792
 s_add_u32 s38, s53, 65536
 buffer_load_dwordx4 v27, s[16:19], s38 offen lds
 s_add_u32 m0, s37, 34816
 s_add_u32 s38, s53, 131072
 buffer_load_dwordx4 v20, s[16:19], s38 offen lds
 s_add_u32 m0, s37, 35840
 s_add_u32 s38, s53, 196608
 buffer_load_dwordx4 v27, s[16:19], s38 offen lds
 ds_read_b64_tr_b16 v[112:113], v60 offset:0
 ds_read_b64_tr_b16 v[114:115], v60 offset:4096
 ds_read_b64_tr_b16 v[116:117], v60 offset:8192
 ds_read_b64_tr_b16 v[118:119], v60 offset:12288
 ds_read_b64_tr_b16 v[120:121], v61 offset:0
 ds_read_b64_tr_b16 v[122:123], v61 offset:4096
 ds_read_b64_tr_b16 v[124:125], v61 offset:8192
 ds_read_b64_tr_b16 v[126:127], v61 offset:12288
 s_waitcnt lgkmcnt(0)
 s_waitcnt vmcnt(28)
 s_barrier
 s_add_u32 s53, s35, 524288
 s_mov_b32 m0, 4096
 s_add_u32 s38, s53, 0
 buffer_load_dwordx4 v20, s[20:23], s38 offen lds
 s_mov_b32 m0, 5120
 s_add_u32 s38, s53, 65536
 buffer_load_dwordx4 v27, s[20:23], s38 offen lds
 s_mov_b32 m0, 6144
 s_add_u32 s38, s53, 131072
 buffer_load_dwordx4 v20, s[20:23], s38 offen lds
 s_mov_b32 m0, 7168
 s_add_u32 s38, s53, 196608
 buffer_load_dwordx4 v27, s[20:23], s38 offen lds
 ds_read_b64_tr_b16 v[32:33], v48 offset:4096
 ds_read_b64_tr_b16 v[34:35], v49 offset:8192
 ds_read_b64_tr_b16 v[36:37], v50 offset:12288
 ds_read_b64_tr_b16 v[38:39], v51 offset:16384
 ds_read_b64_tr_b16 v[40:41], v52 offset:4096
 ds_read_b64_tr_b16 v[42:43], v53 offset:8192
 ds_read_b64_tr_b16 v[44:45], v54 offset:12288
 ds_read_b64_tr_b16 v[46:47], v55 offset:16384
 s_waitcnt lgkmcnt(0)
 s_waitcnt vmcnt(28)
 s_barrier
 buffer_load_dword v71, v74, s[8:11], 0 offen offset:64 sc1
 ds_write_b128 v1, v[32:35] offset:8192
 ds_write_b128 v1, v[36:39] offset:9216
 ds_write_b128 v1, v[40:43] offset:10240
 ds_write_b128 v1, v[44:47] offset:11264
 ds_read_b64_tr_b16 v[32:33], v48 offset:12288
 ds_read_b64_tr_b16 v[34:35], v49 offset:4096
 ds_read_b64_tr_b16 v[36:37], v50 offset:0
 ds_read_b64_tr_b16 v[38:39], v51 offset:12288
 ds_read_b64_tr_b16 v[40:41], v52 offset:12288
 ds_read_b64_tr_b16 v[42:43], v53 offset:4096
 ds_read_b64_tr_b16 v[44:45], v54 offset:0
 ds_read_b64_tr_b16 v[46:47], v55 offset:12288
 s_waitcnt lgkmcnt(0)
 s_waitcnt vmcnt(25)
 s_barrier
 ds_write_b128 v1, v[32:35] offset:4096
 ds_write_b128 v1, v[36:39] offset:5120
 ds_write_b128 v1, v[40:43] offset:6144
 ds_write_b128 v1, v[44:47] offset:7168
 ds_read_b64_tr_b16 a[208:209], v48 offset:20480
 ds_read_b64_tr_b16 a[210:211], v49 offset:16384
 ds_read_b64_tr_b16 a[212:213], v50 offset:16384
 ds_read_b64_tr_b16 a[214:215], v51 offset:8192
 ds_read_b64_tr_b16 a[216:217], v52 offset:20480
 ds_read_b64_tr_b16 a[218:219], v53 offset:16384
 ds_read_b64_tr_b16 a[220:221], v54 offset:16384
 ds_read_b64_tr_b16 a[222:223], v55 offset:8192
 s_waitcnt lgkmcnt(0)
 s_waitcnt vmcnt(21)
 s_barrier
 s_add_u32 s53, s35, 2621440
 s_add_u32 m0, s37, 16384
 s_add_u32 s38, s53, 0
 buffer_load_dwordx4 v20, s[24:27], s38 offen lds
 s_add_u32 m0, s37, 17408
 s_add_u32 s38, s53, 65536
 buffer_load_dwordx4 v27, s[24:27], s38 offen lds
 s_add_u32 m0, s37, 18432
 s_add_u32 s38, s53, 131072
 buffer_load_dwordx4 v20, s[24:27], s38 offen lds
 s_add_u32 m0, s37, 19456
 s_add_u32 s38, s53, 196608
 buffer_load_dwordx4 v27, s[24:27], s38 offen lds
 ds_read_b64_tr_b16 a[16:17], v48 offset:24576
 ds_read_b64_tr_b16 a[18:19], v49 offset:0
 ds_read_b64_tr_b16 a[20:21], v50 offset:8192
 ds_read_b64_tr_b16 a[22:23], v51 offset:0
 ds_read_b64_tr_b16 a[24:25], v52 offset:24576
 ds_read_b64_tr_b16 a[26:27], v53 offset:0
 ds_read_b64_tr_b16 a[28:29], v54 offset:8192
 ds_read_b64_tr_b16 a[30:31], v55 offset:0
 s_waitcnt lgkmcnt(0)
 s_waitcnt vmcnt(21)
 s_barrier
 s_add_u32 s53, s35, 4194304
 s_add_u32 m0, s37, 0
 s_add_u32 s38, s53, 0
 buffer_load_dwordx4 v20, s[20:23], s38 offen lds
 s_add_u32 m0, s37, 1024
 s_add_u32 s38, s53, 65536
 buffer_load_dwordx4 v27, s[20:23], s38 offen lds
 s_add_u32 m0, s37, 2048
 s_add_u32 s38, s53, 131072
 buffer_load_dwordx4 v20, s[20:23], s38 offen lds
 s_add_u32 m0, s37, 3072
 s_add_u32 s38, s53, 196608
 buffer_load_dwordx4 v27, s[20:23], s38 offen lds
 ds_read_b64_tr_b16 a[0:1], v48 offset:28672
 ds_read_b64_tr_b16 a[2:3], v49 offset:20480
 ds_read_b64_tr_b16 a[4:5], v50 offset:4096
 ds_read_b64_tr_b16 a[6:7], v51 offset:4096
 ds_read_b64_tr_b16 a[8:9], v52 offset:28672
 ds_read_b64_tr_b16 a[10:11], v53 offset:20480
 ds_read_b64_tr_b16 a[12:13], v54 offset:4096
 ds_read_b64_tr_b16 a[14:15], v55 offset:4096
 s_waitcnt lgkmcnt(0)
 s_waitcnt vmcnt(21)
 s_barrier
 s_add_u32 s53, s35, 0
 s_add_u32 m0, s37, 20480
 s_add_u32 s38, s53, 0
 buffer_load_dwordx4 v20, s[16:19], s38 offen lds
 s_add_u32 m0, s37, 21504
 s_add_u32 s38, s53, 65536
 buffer_load_dwordx4 v27, s[16:19], s38 offen lds
 s_add_u32 m0, s37, 22528
 s_add_u32 s38, s53, 131072
 buffer_load_dwordx4 v20, s[16:19], s38 offen lds
 s_add_u32 m0, s37, 23552
 s_add_u32 s38, s53, 196608
 buffer_load_dwordx4 v27, s[16:19], s38 offen lds
 ds_read_b64_tr_b16 a[96:97], v48 offset:32768
 ds_read_b64_tr_b16 a[98:99], v49 offset:24576
 ds_read_b64_tr_b16 a[100:101], v50 offset:20480
 ds_read_b64_tr_b16 a[102:103], v51 offset:20480
 ds_read_b64_tr_b16 a[104:105], v52 offset:32768
 ds_read_b64_tr_b16 a[106:107], v53 offset:24576
 ds_read_b64_tr_b16 a[108:109], v54 offset:20480
 ds_read_b64_tr_b16 a[110:111], v55 offset:20480
 s_waitcnt lgkmcnt(0)
 s_waitcnt vmcnt(21)
 s_barrier
 s_add_u32 s53, s36, 512
 s_add_u32 m0, s37, 24576
 s_add_u32 s38, s53, 0
 buffer_load_dwordx4 v21, s[28:31], s38 offen lds
 s_add_u32 m0, s37, 25600
 s_add_u32 s38, s53, 4608
 buffer_load_dwordx4 v21, s[28:31], s38 offen lds
 s_add_u32 m0, s37, 26624
 s_add_u32 s38, s53, 36864
 buffer_load_dwordx4 v21, s[28:31], s38 offen lds
 s_add_u32 m0, s37, 27648
 s_add_u32 s38, s53, 41472
 buffer_load_dwordx4 v21, s[28:31], s38 offen lds
 ds_read_b64_tr_b16 v[96:97], v60 offset:0
 ds_read_b64_tr_b16 v[98:99], v49 offset:28672
 ds_read_b64_tr_b16 v[100:101], v50 offset:24576
 ds_read_b64_tr_b16 v[102:103], v51 offset:24576
 ds_read_b64_tr_b16 v[104:105], v61 offset:0
 ds_read_b64_tr_b16 v[106:107], v53 offset:28672
 ds_read_b64_tr_b16 v[108:109], v54 offset:24576
 ds_read_b64_tr_b16 v[110:111], v55 offset:24576
 s_waitcnt lgkmcnt(0)
 s_waitcnt vmcnt(21)
 s_barrier
 s_add_u32 s53, s36, 74240
 s_add_u32 m0, s37, 28672
 s_add_u32 s38, s53, 0
 buffer_load_dwordx4 v21, s[28:31], s38 offen lds
 s_add_u32 m0, s37, 29696
 s_add_u32 s38, s53, 4608
 buffer_load_dwordx4 v21, s[28:31], s38 offen lds
 s_add_u32 m0, s37, 30720
 s_add_u32 s38, s53, 36864
 buffer_load_dwordx4 v21, s[28:31], s38 offen lds
 s_add_u32 m0, s37, 31744
 s_add_u32 s38, s53, 41472
 buffer_load_dwordx4 v21, s[28:31], s38 offen lds
 ds_read_b64_tr_b16 a[160:161], v48 offset:20480
 ds_read_b64_tr_b16 a[162:163], v49 offset:32768
 ds_read_b64_tr_b16 a[164:165], v50 offset:28672
 ds_read_b64_tr_b16 a[166:167], v51 offset:28672
 ds_read_b64_tr_b16 a[168:169], v52 offset:20480
 ds_read_b64_tr_b16 a[170:171], v53 offset:32768
 ds_read_b64_tr_b16 a[172:173], v54 offset:28672
 ds_read_b64_tr_b16 a[174:175], v55 offset:28672
 s_waitcnt lgkmcnt(0)
 s_waitcnt vmcnt(21)
 s_barrier
 s_add_u32 s53, s36, 768
 s_add_u32 m0, s37, 32768
 s_add_u32 s38, s53, 0
 buffer_load_dwordx4 v21, s[28:31], s38 offen lds
 s_add_u32 m0, s37, 33792
 s_add_u32 s38, s53, 4608
 buffer_load_dwordx4 v21, s[28:31], s38 offen lds
 s_add_u32 m0, s37, 34816
 s_add_u32 s38, s53, 36864
 buffer_load_dwordx4 v21, s[28:31], s38 offen lds
 s_add_u32 m0, s37, 35840
 s_add_u32 s38, s53, 41472
 buffer_load_dwordx4 v21, s[28:31], s38 offen lds
 ds_read_b64_tr_b16 a[48:49], v48 offset:24576
 ds_read_b64_tr_b16 a[50:51], v60 offset:4096
 ds_read_b64_tr_b16 a[52:53], v50 offset:32768
 ds_read_b64_tr_b16 a[54:55], v51 offset:32768
 ds_read_b64_tr_b16 a[56:57], v52 offset:24576
 ds_read_b64_tr_b16 a[58:59], v61 offset:4096
 ds_read_b64_tr_b16 a[60:61], v54 offset:32768
 ds_read_b64_tr_b16 a[62:63], v55 offset:32768
 s_waitcnt lgkmcnt(0)
 s_waitcnt vmcnt(20)
 s_barrier
 s_add_u32 s53, s36, 74496
 s_mov_b32 m0, 4096
 s_add_u32 s38, s53, 0
 buffer_load_dwordx4 v21, s[28:31], s38 offen lds
 s_mov_b32 m0, 5120
 s_add_u32 s38, s53, 4608
 buffer_load_dwordx4 v21, s[28:31], s38 offen lds
 s_mov_b32 m0, 6144
 s_add_u32 s38, s53, 36864
 buffer_load_dwordx4 v21, s[28:31], s38 offen lds
 s_mov_b32 m0, 7168
 s_add_u32 s38, s53, 41472
 buffer_load_dwordx4 v21, s[28:31], s38 offen lds
 ds_read_b64_tr_b16 v[32:33], v48 offset:28672
 ds_read_b64_tr_b16 v[34:35], v49 offset:16384
 ds_read_b64_tr_b16 v[36:37], v60 offset:8192
 ds_read_b64_tr_b16 v[38:39], v60 offset:12288
 ds_read_b64_tr_b16 v[40:41], v52 offset:28672
 ds_read_b64_tr_b16 v[42:43], v53 offset:16384
 ds_read_b64_tr_b16 v[44:45], v61 offset:8192
 ds_read_b64_tr_b16 v[46:47], v61 offset:12288
 s_waitcnt lgkmcnt(0)
 s_waitcnt vmcnt(20)
 s_barrier
 v_readfirstlane_b32 s38, v71
 s_lshr_b32 s45, s38, 16
 s_and_b32 s38, s38, 0xffff
 s_cmp_ge_u32 s38, 32
 s_cselect_b32 s44, 1, 0
 buffer_load_dwordx4 v[8:11], v72, s[76:79], 0 offen offset:0
 buffer_load_dwordx4 v[12:15], v72, s[76:79], 0 offen offset:128
 ds_write_b128 v1, v[32:35] offset:16384
 ds_write_b128 v1, v[36:39] offset:17408
 ds_write_b128 v1, v[40:43] offset:18432
 ds_write_b128 v1, v[44:47] offset:19456
 ds_read_b64_tr_b16 v[144:145], v48 offset:32768
 ds_read_b64_tr_b16 v[146:147], v49 offset:0
 ds_read_b64_tr_b16 v[148:149], v50 offset:4096
 ds_read_b64_tr_b16 v[150:151], v51 offset:4096
 ds_read_b64_tr_b16 v[152:153], v52 offset:32768
 ds_read_b64_tr_b16 v[154:155], v53 offset:0
 ds_read_b64_tr_b16 v[156:157], v54 offset:4096
 ds_read_b64_tr_b16 v[158:159], v55 offset:4096
 s_waitcnt lgkmcnt(0)
 s_waitcnt vmcnt(18)
 s_barrier
 ds_read_b64_tr_b16 v[32:33], v60 offset:0
 ds_read_b64_tr_b16 v[34:35], v49 offset:20480
 ds_read_b64_tr_b16 v[36:37], v50 offset:20480
 ds_read_b64_tr_b16 v[38:39], v51 offset:20480
 ds_read_b64_tr_b16 v[40:41], v61 offset:0
 ds_read_b64_tr_b16 v[42:43], v53 offset:20480
 ds_read_b64_tr_b16 v[44:45], v54 offset:20480
 ds_read_b64_tr_b16 v[46:47], v55 offset:20480
 s_waitcnt lgkmcnt(0)
 s_waitcnt vmcnt(14)
 s_barrier
 ds_write_b128 v1, v[32:35] offset:0
 ds_write_b128 v1, v[36:39] offset:1024
 ds_write_b128 v1, v[40:43] offset:2048
 ds_write_b128 v1, v[44:47] offset:3072
 ds_read_b64_tr_b16 v[32:33], v56 offset:20480
 ds_read_b64_tr_b16 v[34:35], v57 offset:24576
 ds_read_b64_tr_b16 v[36:37], v58 offset:24576
 ds_read_b64_tr_b16 v[38:39], v59 offset:24576
 ds_read_b64_tr_b16 v[40:41], v56 offset:22528
 ds_read_b64_tr_b16 v[42:43], v57 offset:26624
 ds_read_b64_tr_b16 v[44:45], v58 offset:26624
 ds_read_b64_tr_b16 v[46:47], v59 offset:26624
 s_waitcnt lgkmcnt(0)
 s_waitcnt vmcnt(10)
 s_barrier
 ds_write_b128 v1, v[32:35] offset:20480
 ds_write_b128 v1, v[36:39] offset:21504
 ds_write_b128 v1, v[40:43] offset:22528
 ds_write_b128 v1, v[44:47] offset:23552
 ds_read_b64_tr_b16 v[32:33], v56 offset:24576
 ds_read_b64_tr_b16 v[34:35], v57 offset:28672
 ds_read_b64_tr_b16 v[36:37], v58 offset:28672
 ds_read_b64_tr_b16 v[38:39], v59 offset:28672
 ds_read_b64_tr_b16 v[40:41], v56 offset:26624
 ds_read_b64_tr_b16 v[42:43], v57 offset:30720
 ds_read_b64_tr_b16 v[44:45], v58 offset:30720
 ds_read_b64_tr_b16 v[46:47], v59 offset:30720
 s_waitcnt lgkmcnt(0)
 s_waitcnt vmcnt(6)
 s_barrier
 ds_write_b128 v1, v[32:35] offset:24576
 ds_write_b128 v1, v[36:39] offset:25600
 ds_write_b128 v1, v[40:43] offset:26624
 ds_write_b128 v1, v[44:47] offset:27648
 ds_read_b64_tr_b16 v[32:33], v56 offset:28672
 ds_read_b64_tr_b16 v[34:35], v57 offset:32768
 ds_read_b64_tr_b16 v[36:37], v58 offset:32768
 ds_read_b64_tr_b16 v[38:39], v59 offset:32768
 ds_read_b64_tr_b16 v[40:41], v56 offset:30720
 ds_read_b64_tr_b16 v[42:43], v57 offset:34816
 ds_read_b64_tr_b16 v[44:45], v58 offset:34816
 ds_read_b64_tr_b16 v[46:47], v59 offset:34816
 s_waitcnt lgkmcnt(0)
 s_waitcnt vmcnt(2)
 s_barrier
 ds_write_b128 v1, v[32:35] offset:28672
 ds_write_b128 v1, v[36:39] offset:29696
 ds_write_b128 v1, v[40:43] offset:30720
 ds_write_b128 v1, v[44:47] offset:31744
 ds_read_b64_tr_b16 v[32:33], v56 offset:32768
 ds_read_b64_tr_b16 v[34:35], v62 offset:4096
 ds_read_b64_tr_b16 v[36:37], v62 offset:8192
 ds_read_b64_tr_b16 v[38:39], v62 offset:12288
 ds_read_b64_tr_b16 v[40:41], v56 offset:34816
 ds_read_b64_tr_b16 v[42:43], v62 offset:6144
 ds_read_b64_tr_b16 v[44:45], v62 offset:10240
 ds_read_b64_tr_b16 v[46:47], v62 offset:14336
 s_waitcnt lgkmcnt(0)
 s_barrier
 ds_write_b128 v1, v[32:35] offset:32768
 ds_write_b128 v1, v[36:39] offset:33792
 ds_write_b128 v1, v[40:43] offset:34816
 ds_write_b128 v1, v[44:47] offset:35840
 s_waitcnt vmcnt(1)
 ds_write_b128 v0, v[8:11] offset:0
 s_waitcnt vmcnt(0)
 ds_write_b128 v0, v[12:15] offset:1024
 s_waitcnt lgkmcnt(0)
 s_cmp_eq_u32 s44, 1
 s_cbranch_scc1 L_eok81
 v_mov_b32 v76, 32
poll83:
 buffer_load_dword v77, v74, s[8:11], 0 offen offset:64 sc1
 s_waitcnt vmcnt(0)
 v_and_b32 v78, 0xffff, v77
 v_cmp_le_u32 vcc, v76, v78
 s_cmp_eq_u64 vcc, exec
 s_cbranch_scc1 polld84
 s_cmp_eq_u32 s15, 0
 s_cbranch_scc1 polld84
 s_sub_u32 s15, s15, 1
 s_sleep 6
 s_branch poll83
polld84:
 v_readfirstlane_b32 s45, v77
 s_lshr_b32 s45, s45, 16
 s_branch L_edn82
L_eok81:
L_edn82:
 s_mov_b32 s32, s45
 s_branch L_wl70
L_wl73:
 s_add_u32 s53, s36, 0
 s_add_u32 m0, s37, 12288
 s_add_u32 s38, s53, 0
 buffer_load_dwordx4 v21, s[28:31], s38 offen lds
 s_add_u32 m0, s37, 13312
 s_add_u32 s38, s53, 4608
 buffer_load_dwordx4 v21, s[28:31], s38 offen lds
 s_add_u32 m0, s37, 14336
 s_add_u32 s38, s53, 36864
 buffer_load_dwordx4 v21, s[28:31], s38 offen lds
 s_add_u32 m0, s37, 15360
 s_add_u32 s38, s53, 41472
 buffer_load_dwordx4 v21, s[28:31], s38 offen lds
 s_add_u32 s53, s36, 73728
 s_add_u32 m0, s37, 0
 s_add_u32 s38, s53, 0
 buffer_load_dwordx4 v21, s[28:31], s38 offen lds
 s_add_u32 m0, s37, 1024
 s_add_u32 s38, s53, 4608
 buffer_load_dwordx4 v21, s[28:31], s38 offen lds
 s_add_u32 m0, s37, 2048
 s_add_u32 s38, s53, 36864
 buffer_load_dwordx4 v21, s[28:31], s38 offen lds
 s_add_u32 m0, s37, 3072
 s_add_u32 s38, s53, 41472
 buffer_load_dwordx4 v21, s[28:31], s38 offen lds
 s_add_u32 s53, s36, 256
 s_add_u32 m0, s37, 16384
 s_add_u32 s38, s53, 0
 buffer_load_dwordx4 v21, s[28:31], s38 offen lds
 s_add_u32 m0, s37, 17408
 s_add_u32 s38, s53, 4608
 buffer_load_dwordx4 v21, s[28:31], s38 offen lds
 s_add_u32 m0, s37, 18432
 s_add_u32 s38, s53, 36864
 buffer_load_dwordx4 v21, s[28:31], s38 offen lds
 s_add_u32 m0, s37, 19456
 s_add_u32 s38, s53, 41472
 buffer_load_dwordx4 v21, s[28:31], s38 offen lds
 s_add_u32 s53, s36, 73984
 s_add_u32 m0, s37, 8192
 s_add_u32 s38, s53, 0
 buffer_load_dwordx4 v21, s[28:31], s38 offen lds
 s_add_u32 m0, s37, 9216
 s_add_u32 s38, s53, 4608
 buffer_load_dwordx4 v21, s[28:31], s38 offen lds
 s_add_u32 m0, s37, 10240
 s_add_u32 s38, s53, 36864
 buffer_load_dwordx4 v21, s[28:31], s38 offen lds
 s_add_u32 m0, s37, 11264
 s_add_u32 s38, s53, 41472
 buffer_load_dwordx4 v21, s[28:31], s38 offen lds
 s_mov_b32 s53, s36
 s_add_u32 m0, s37, 4096
 s_add_u32 s38, s53, 0
 buffer_load_dwordx4 v22, s[28:31], s38 offen lds
 s_add_u32 m0, s37, 5120
 s_add_u32 s38, s53, 4608
 buffer_load_dwordx4 v22, s[28:31], s38 offen lds
 s_add_u32 m0, s37, 6144
 s_add_u32 s38, s53, 9216
 buffer_load_dwordx4 v22, s[28:31], s38 offen lds
 s_add_u32 m0, s37, 7168
 s_add_u32 s38, s53, 13824
 buffer_load_dwordx4 v22, s[28:31], s38 offen lds
 s_add_u32 s53, s35, 524288
 s_add_u32 m0, s37, 20480
 s_add_u32 s38, s53, 0
 buffer_load_dwordx4 v20, s[16:19], s38 offen lds
 s_add_u32 m0, s37, 21504
 s_add_u32 s38, s53, 65536
 buffer_load_dwordx4 v27, s[16:19], s38 offen lds
 s_add_u32 m0, s37, 22528
 s_add_u32 s38, s53, 131072
 buffer_load_dwordx4 v20, s[16:19], s38 offen lds
 s_add_u32 m0, s37, 23552
 s_add_u32 s38, s53, 196608
 buffer_load_dwordx4 v27, s[16:19], s38 offen lds
 s_add_u32 s53, s35, 524288
 s_add_u32 m0, s37, 24576
 s_add_u32 s38, s53, 0
 buffer_load_dwordx4 v20, s[24:27], s38 offen lds
 s_add_u32 m0, s37, 25600
 s_add_u32 s38, s53, 65536
 buffer_load_dwordx4 v27, s[24:27], s38 offen lds
 s_add_u32 m0, s37, 26624
 s_add_u32 s38, s53, 131072
 buffer_load_dwordx4 v20, s[24:27], s38 offen lds
 s_add_u32 m0, s37, 27648
 s_add_u32 s38, s53, 196608
 buffer_load_dwordx4 v27, s[24:27], s38 offen lds
 s_add_u32 s53, s35, 1572864
 s_add_u32 m0, s37, 28672
 s_add_u32 s38, s53, 0
 buffer_load_dwordx4 v20, s[16:19], s38 offen lds
 s_add_u32 m0, s37, 29696
 s_add_u32 s38, s53, 65536
 buffer_load_dwordx4 v27, s[16:19], s38 offen lds
 s_add_u32 m0, s37, 30720
 s_add_u32 s38, s53, 131072
 buffer_load_dwordx4 v20, s[16:19], s38 offen lds
 s_add_u32 m0, s37, 31744
 s_add_u32 s38, s53, 196608
 buffer_load_dwordx4 v27, s[16:19], s38 offen lds
 s_add_u32 s53, s35, 1572864
 s_add_u32 m0, s37, 32768
 s_add_u32 s38, s53, 0
 buffer_load_dwordx4 v20, s[20:23], s38 offen lds
 s_add_u32 m0, s37, 33792
 s_add_u32 s38, s53, 65536
 buffer_load_dwordx4 v27, s[20:23], s38 offen lds
 s_add_u32 m0, s37, 34816
 s_add_u32 s38, s53, 131072
 buffer_load_dwordx4 v20, s[20:23], s38 offen lds
 s_add_u32 m0, s37, 35840
 s_add_u32 s38, s53, 196608
 buffer_load_dwordx4 v27, s[20:23], s38 offen lds
 s_add_u32 s53, s35, 1572864
 s_mov_b32 m0, 8192
 s_add_u32 s38, s53, 0
 buffer_load_dwordx4 v20, s[24:27], s38 offen lds
 s_mov_b32 m0, 9216
 s_add_u32 s38, s53, 65536
 buffer_load_dwordx4 v27, s[24:27], s38 offen lds
 s_mov_b32 m0, 10240
 s_add_u32 s38, s53, 131072
 buffer_load_dwordx4 v20, s[24:27], s38 offen lds
 s_mov_b32 m0, 11264
 s_add_u32 s38, s53, 196608
 buffer_load_dwordx4 v27, s[24:27], s38 offen lds
 s_cmp_eq_u32 s52, 0
 s_cbranch_scc1 L_np85
 v_mov_b32 v8, -1
 v_mov_b32 v9, -1
 v_mov_b32 v10, -1
 v_mov_b32 v11, -1
 s_add_u32 s33, s49, 0
 buffer_store_dwordx4 v[8:11], v0, s[4:7], s33 offen offset:0 sc1
 buffer_store_dwordx4 v[8:11], v0, s[4:7], s33 offen offset:1024 sc1
 buffer_store_dwordx4 v[8:11], v0, s[4:7], s33 offen offset:2048 sc1
 buffer_store_dwordx4 v[8:11], v0, s[4:7], s33 offen offset:3072 sc1
 s_add_u32 s33, s49, 294912
 buffer_store_dwordx4 v[8:11], v0, s[4:7], s33 offen offset:0 sc1
 buffer_store_dwordx4 v[8:11], v0, s[4:7], s33 offen offset:1024 sc1
 buffer_store_dwordx4 v[8:11], v0, s[4:7], s33 offen offset:2048 sc1
 buffer_store_dwordx4 v[8:11], v0, s[4:7], s33 offen offset:3072 sc1
 s_add_u32 s33, s46, 9216
 buffer_store_dword v8, v4, s[4:7], s33 offen sc1
 s_add_u32 s33, s46, 18432
 buffer_store_dword v8, v4, s[4:7], s33 offen sc1
L_np85:
 s_waitcnt vmcnt(36)
 s_barrier
 ds_read_b64_tr_b16 v[176:177], v56 offset:0
 ds_read_b64_tr_b16 v[178:179], v57 offset:12288
 ds_read_b64_tr_b16 v[180:181], v58 offset:12288
 ds_read_b64_tr_b16 v[182:183], v59 offset:16384
 ds_read_b64_tr_b16 v[184:185], v56 offset:2048
 ds_read_b64_tr_b16 v[186:187], v57 offset:14336
 ds_read_b64_tr_b16 v[188:189], v58 offset:14336
 ds_read_b64_tr_b16 v[190:191], v59 offset:18432
 s_waitcnt lgkmcnt(0)
 s_waitcnt vmcnt(32)
 s_barrier
 s_add_u32 s53, s35, 2097152
 s_add_u32 m0, s37, 12288
 s_add_u32 s38, s53, 0
 buffer_load_dwordx4 v20, s[24:27], s38 offen lds
 s_add_u32 m0, s37, 13312
 s_add_u32 s38, s53, 65536
 buffer_load_dwordx4 v27, s[24:27], s38 offen lds
 s_add_u32 m0, s37, 14336
 s_add_u32 s38, s53, 131072
 buffer_load_dwordx4 v20, s[24:27], s38 offen lds
 s_add_u32 m0, s37, 15360
 s_add_u32 s38, s53, 196608
 buffer_load_dwordx4 v27, s[24:27], s38 offen lds
 ds_read_b64_tr_b16 v[192:193], v56 offset:8192
 ds_read_b64_tr_b16 v[194:195], v57 offset:8192
 ds_read_b64_tr_b16 v[196:197], v58 offset:0
 ds_read_b64_tr_b16 v[198:199], v59 offset:12288
 ds_read_b64_tr_b16 v[200:201], v56 offset:10240
 ds_read_b64_tr_b16 v[202:203], v57 offset:10240
 ds_read_b64_tr_b16 v[204:205], v58 offset:2048
 ds_read_b64_tr_b16 v[206:207], v59 offset:14336
 s_waitcnt lgkmcnt(0)
 s_waitcnt vmcnt(32)
 s_barrier
 s_add_u32 s53, s35, 2621440
 s_add_u32 m0, s37, 0
 s_add_u32 s38, s53, 0
 buffer_load_dwordx4 v20, s[16:19], s38 offen lds
 s_add_u32 m0, s37, 1024
 s_add_u32 s38, s53, 65536
 buffer_load_dwordx4 v27, s[16:19], s38 offen lds
 s_add_u32 m0, s37, 2048
 s_add_u32 s38, s53, 131072
 buffer_load_dwordx4 v20, s[16:19], s38 offen lds
 s_add_u32 m0, s37, 3072
 s_add_u32 s38, s53, 196608
 buffer_load_dwordx4 v27, s[16:19], s38 offen lds
 ds_read_b64_tr_b16 v[208:209], v56 offset:16384
 ds_read_b64_tr_b16 v[210:211], v57 offset:4096
 ds_read_b64_tr_b16 v[212:213], v58 offset:16384
 ds_read_b64_tr_b16 v[214:215], v59 offset:8192
 ds_read_b64_tr_b16 v[216:217], v56 offset:18432
 ds_read_b64_tr_b16 v[218:219], v57 offset:6144
 ds_read_b64_tr_b16 v[220:221], v58 offset:18432
 ds_read_b64_tr_b16 v[222:223], v59 offset:10240
 s_waitcnt lgkmcnt(0)
 s_waitcnt vmcnt(32)
 s_barrier
 s_add_u32 s53, s35, 3145728
 s_add_u32 m0, s37, 16384
 s_add_u32 s38, s53, 0
 buffer_load_dwordx4 v20, s[24:27], s38 offen lds
 s_add_u32 m0, s37, 17408
 s_add_u32 s38, s53, 65536
 buffer_load_dwordx4 v27, s[24:27], s38 offen lds
 s_add_u32 m0, s37, 18432
 s_add_u32 s38, s53, 131072
 buffer_load_dwordx4 v20, s[24:27], s38 offen lds
 s_add_u32 m0, s37, 19456
 s_add_u32 s38, s53, 196608
 buffer_load_dwordx4 v27, s[24:27], s38 offen lds
 ds_read_b64_tr_b16 v[224:225], v56 offset:4096
 ds_read_b64_tr_b16 v[226:227], v57 offset:16384
 ds_read_b64_tr_b16 v[228:229], v58 offset:8192
 ds_read_b64_tr_b16 v[230:231], v59 offset:0
 ds_read_b64_tr_b16 v[232:233], v56 offset:6144
 ds_read_b64_tr_b16 v[234:235], v57 offset:18432
 ds_read_b64_tr_b16 v[236:237], v58 offset:10240
 ds_read_b64_tr_b16 v[238:239], v59 offset:2048
 s_waitcnt lgkmcnt(0)
 s_waitcnt vmcnt(32)
 s_barrier
 s_add_u32 s53, s35, 3670016
 s_add_u32 m0, s37, 8192
 s_add_u32 s38, s53, 0
 buffer_load_dwordx4 v20, s[16:19], s38 offen lds
 s_add_u32 m0, s37, 9216
 s_add_u32 s38, s53, 65536
 buffer_load_dwordx4 v27, s[16:19], s38 offen lds
 s_add_u32 m0, s37, 10240
 s_add_u32 s38, s53, 131072
 buffer_load_dwordx4 v20, s[16:19], s38 offen lds
 s_add_u32 m0, s37, 11264
 s_add_u32 s38, s53, 196608
 buffer_load_dwordx4 v27, s[16:19], s38 offen lds
 ds_read_b64_tr_b16 v[240:241], v23 offset:4096
 ds_read_b64_tr_b16 v[242:243], v23 offset:4608
 ds_read_b64_tr_b16 v[244:245], v23 offset:6144
 ds_read_b64_tr_b16 v[246:247], v23 offset:6656
 ds_read_b64_tr_b16 v[248:249], v24 offset:4096
 ds_read_b64_tr_b16 v[250:251], v24 offset:4608
 ds_read_b64_tr_b16 v[252:253], v24 offset:6144
 ds_read_b64_tr_b16 v[254:255], v24 offset:6656
 s_waitcnt lgkmcnt(0)
 s_waitcnt vmcnt(32)
 s_barrier
 s_add_u32 s53, s35, 4194304
 s_add_u32 m0, s37, 4096
 s_add_u32 s38, s53, 0
 buffer_load_dwordx4 v20, s[16:19], s38 offen lds
 s_add_u32 m0, s37, 5120
 s_add_u32 s38, s53, 65536
 buffer_load_dwordx4 v27, s[16:19], s38 offen lds
 s_add_u32 m0, s37, 6144
 s_add_u32 s38, s53, 131072
 buffer_load_dwordx4 v20, s[16:19], s38 offen lds
 s_add_u32 m0, s37, 7168
 s_add_u32 s38, s53, 196608
 buffer_load_dwordx4 v27, s[16:19], s38 offen lds
 ds_read_b64_tr_b16 a[160:161], v48 offset:20480
 ds_read_b64_tr_b16 a[162:163], v49 offset:20480
 ds_read_b64_tr_b16 a[164:165], v50 offset:20480
 ds_read_b64_tr_b16 a[166:167], v51 offset:20480
 ds_read_b64_tr_b16 a[168:169], v52 offset:20480
 ds_read_b64_tr_b16 a[170:171], v53 offset:20480
 ds_read_b64_tr_b16 a[172:173], v54 offset:20480
 ds_read_b64_tr_b16 a[174:175], v55 offset:20480
 s_waitcnt lgkmcnt(0)
 s_waitcnt vmcnt(32)
 s_barrier
 s_add_u32 s53, s35, 4194304
 s_add_u32 m0, s37, 20480
 s_add_u32 s38, s53, 0
 buffer_load_dwordx4 v20, s[24:27], s38 offen lds
 s_add_u32 m0, s37, 21504
 s_add_u32 s38, s53, 65536
 buffer_load_dwordx4 v27, s[24:27], s38 offen lds
 s_add_u32 m0, s37, 22528
 s_add_u32 s38, s53, 131072
 buffer_load_dwordx4 v20, s[24:27], s38 offen lds
 s_add_u32 m0, s37, 23552
 s_add_u32 s38, s53, 196608
 buffer_load_dwordx4 v27, s[24:27], s38 offen lds
 ds_read_b64_tr_b16 a[176:177], v48 offset:24576
 ds_read_b64_tr_b16 a[178:179], v49 offset:24576
 ds_read_b64_tr_b16 a[180:181], v50 offset:24576
 ds_read_b64_tr_b16 a[182:183], v51 offset:24576
 ds_read_b64_tr_b16 a[184:185], v52 offset:24576
 ds_read_b64_tr_b16 a[186:187], v53 offset:24576
 ds_read_b64_tr_b16 a[188:189], v54 offset:24576
 ds_read_b64_tr_b16 a[190:191], v55 offset:24576
 s_waitcnt lgkmcnt(0)
 s_waitcnt vmcnt(32)
 s_barrier
 s_add_u32 s53, s35, 1048576
 s_add_u32 m0, s37, 24576
 s_add_u32 s38, s53, 0
 buffer_load_dwordx4 v20, s[16:19], s38 offen lds
 s_add_u32 m0, s37, 25600
 s_add_u32 s38, s53, 65536
 buffer_load_dwordx4 v27, s[16:19], s38 offen lds
 s_add_u32 m0, s37, 26624
 s_add_u32 s38, s53, 131072
 buffer_load_dwordx4 v20, s[16:19], s38 offen lds
 s_add_u32 m0, s37, 27648
 s_add_u32 s38, s53, 196608
 buffer_load_dwordx4 v27, s[16:19], s38 offen lds
 ds_read_b64_tr_b16 a[208:209], v48 offset:28672
 ds_read_b64_tr_b16 a[210:211], v49 offset:28672
 ds_read_b64_tr_b16 a[212:213], v50 offset:28672
 ds_read_b64_tr_b16 a[214:215], v51 offset:28672
 ds_read_b64_tr_b16 a[216:217], v52 offset:28672
 ds_read_b64_tr_b16 a[218:219], v53 offset:28672
 ds_read_b64_tr_b16 a[220:221], v54 offset:28672
 ds_read_b64_tr_b16 a[222:223], v55 offset:28672
 s_waitcnt lgkmcnt(0)
 s_waitcnt vmcnt(32)
 s_barrier
 s_add_u32 s53, s35, 2621440
 s_add_u32 m0, s37, 28672
 s_add_u32 s38, s53, 0
 buffer_load_dwordx4 v20, s[20:23], s38 offen lds
 s_add_u32 m0, s37, 29696
 s_add_u32 s38, s53, 65536
 buffer_load_dwordx4 v27, s[20:23], s38 offen lds
 s_add_u32 m0, s37, 30720
 s_add_u32 s38, s53, 131072
 buffer_load_dwordx4 v20, s[20:23], s38 offen lds
 s_add_u32 m0, s37, 31744
 s_add_u32 s38, s53, 196608
 buffer_load_dwordx4 v27, s[20:23], s38 offen lds
 ds_read_b64_tr_b16 a[224:225], v48 offset:32768
 ds_read_b64_tr_b16 a[226:227], v49 offset:32768
 ds_read_b64_tr_b16 a[228:229], v50 offset:32768
 ds_read_b64_tr_b16 a[230:231], v51 offset:32768
 ds_read_b64_tr_b16 a[232:233], v52 offset:32768
 ds_read_b64_tr_b16 a[234:235], v53 offset:32768
 ds_read_b64_tr_b16 a[236:237], v54 offset:32768
 ds_read_b64_tr_b16 a[238:239], v55 offset:32768
 s_waitcnt lgkmcnt(0)
 s_waitcnt vmcnt(32)
 s_barrier
 s_add_u32 s53, s35, 3145728
 s_add_u32 m0, s37, 32768
 s_add_u32 s38, s53, 0
 buffer_load_dwordx4 v20, s[20:23], s38 offen lds
 s_add_u32 m0, s37, 33792
 s_add_u32 s38, s53, 65536
 buffer_load_dwordx4 v27, s[20:23], s38 offen lds
 s_add_u32 m0, s37, 34816
 s_add_u32 s38, s53, 131072
 buffer_load_dwordx4 v20, s[20:23], s38 offen lds
 s_add_u32 m0, s37, 35840
 s_add_u32 s38, s53, 196608
 buffer_load_dwordx4 v27, s[20:23], s38 offen lds
 ds_read_b64_tr_b16 a[240:241], v60 offset:0
 ds_read_b64_tr_b16 a[242:243], v60 offset:4096
 ds_read_b64_tr_b16 a[244:245], v60 offset:8192
 ds_read_b64_tr_b16 a[246:247], v60 offset:12288
 ds_read_b64_tr_b16 a[248:249], v61 offset:0
 ds_read_b64_tr_b16 a[250:251], v61 offset:4096
 ds_read_b64_tr_b16 a[252:253], v61 offset:8192
 ds_read_b64_tr_b16 a[254:255], v61 offset:12288
 s_waitcnt lgkmcnt(0)
 s_waitcnt vmcnt(32)
 s_barrier
 s_add_u32 s53, s35, 3670016
 s_mov_b32 m0, 8192
 s_add_u32 s38, s53, 0
 buffer_load_dwordx4 v20, s[24:27], s38 offen lds
 s_mov_b32 m0, 9216
 s_add_u32 s38, s53, 65536
 buffer_load_dwordx4 v27, s[24:27], s38 offen lds
 s_mov_b32 m0, 10240
 s_add_u32 s38, s53, 131072
 buffer_load_dwordx4 v20, s[24:27], s38 offen lds
 s_mov_b32 m0, 11264
 s_add_u32 s38, s53, 196608
 buffer_load_dwordx4 v27, s[24:27], s38 offen lds
 ds_read_b64_tr_b16 v[112:113], v48 offset:0
 ds_read_b64_tr_b16 v[114:115], v49 offset:12288
 ds_read_b64_tr_b16 v[116:117], v50 offset:12288
 ds_read_b64_tr_b16 v[118:119], v51 offset:16384
 ds_read_b64_tr_b16 v[120:121], v52 offset:0
 ds_read_b64_tr_b16 v[122:123], v53 offset:12288
 ds_read_b64_tr_b16 v[124:125], v54 offset:12288
 ds_read_b64_tr_b16 v[126:127], v55 offset:16384
 s_waitcnt lgkmcnt(0)
 s_waitcnt vmcnt(32)
 s_barrier
 s_add_u32 s53, s35, 2097152
 s_add_u32 m0, s37, 12288
 s_add_u32 s38, s53, 0
 buffer_load_dwordx4 v20, s[20:23], s38 offen lds
 s_add_u32 m0, s37, 13312
 s_add_u32 s38, s53, 65536
 buffer_load_dwordx4 v27, s[20:23], s38 offen lds
 s_add_u32 m0, s37, 14336
 s_add_u32 s38, s53, 131072
 buffer_load_dwordx4 v20, s[20:23], s38 offen lds
 s_add_u32 m0, s37, 15360
 s_add_u32 s38, s53, 196608
 buffer_load_dwordx4 v27, s[20:23], s38 offen lds
 ds_read_b64_tr_b16 v[128:129], v48 offset:8192
 ds_read_b64_tr_b16 v[130:131], v49 offset:8192
 ds_read_b64_tr_b16 v[132:133], v50 offset:0
 ds_read_b64_tr_b16 v[134:135], v51 offset:12288
 ds_read_b64_tr_b16 v[136:137], v52 offset:8192
 ds_read_b64_tr_b16 v[138:139], v53 offset:8192
 ds_read_b64_tr_b16 v[140:141], v54 offset:0
 ds_read_b64_tr_b16 v[142:143], v55 offset:12288
 s_waitcnt lgkmcnt(0)
 s_waitcnt vmcnt(32)
 s_barrier
 s_add_u32 s53, s35, 1048576
 s_add_u32 m0, s37, 0
 s_add_u32 s38, s53, 0
 buffer_load_dwordx4 v20, s[20:23], s38 offen lds
 s_add_u32 m0, s37, 1024
 s_add_u32 s38, s53, 65536
 buffer_load_dwordx4 v27, s[20:23], s38 offen lds
 s_add_u32 m0, s37, 2048
 s_add_u32 s38, s53, 131072
 buffer_load_dwordx4 v20, s[20:23], s38 offen lds
 s_add_u32 m0, s37, 3072
 s_add_u32 s38, s53, 196608
 buffer_load_dwordx4 v27, s[20:23], s38 offen lds
 ds_read_b64_tr_b16 a[16:17], v48 offset:16384
 ds_read_b64_tr_b16 a[18:19], v49 offset:4096
 ds_read_b64_tr_b16 a[20:21], v50 offset:16384
 ds_read_b64_tr_b16 a[22:23], v51 offset:8192
 ds_read_b64_tr_b16 a[24:25], v52 offset:16384
 ds_read_b64_tr_b16 a[26:27], v53 offset:4096
 ds_read_b64_tr_b16 a[28:29], v54 offset:16384
 ds_read_b64_tr_b16 a[30:31], v55 offset:8192
 s_waitcnt lgkmcnt(0)
 s_waitcnt vmcnt(32)
 s_barrier
 s_add_u32 s53, s35, 3145728
 s_add_u32 m0, s37, 16384
 s_add_u32 s38, s53, 0
 buffer_load_dwordx4 v20, s[16:19], s38 offen lds
 s_add_u32 m0, s37, 17408
 s_add_u32 s38, s53, 65536
 buffer_load_dwordx4 v27, s[16:19], s38 offen lds
 s_add_u32 m0, s37, 18432
 s_add_u32 s38, s53, 131072
 buffer_load_dwordx4 v20, s[16:19], s38 offen lds
 s_add_u32 m0, s37, 19456
 s_add_u32 s38, s53, 196608
 buffer_load_dwordx4 v27, s[16:19], s38 offen lds
 ds_read_b64_tr_b16 a[32:33], v48 offset:4096
 ds_read_b64_tr_b16 a[34:35], v49 offset:16384
 ds_read_b64_tr_b16 a[36:37], v50 offset:8192
 ds_read_b64_tr_b16 a[38:39], v51 offset:0
 ds_read_b64_tr_b16 a[40:41], v52 offset:4096
 ds_read_b64_tr_b16 a[42:43], v53 offset:16384
 ds_read_b64_tr_b16 a[44:45], v54 offset:8192
 ds_read_b64_tr_b16 a[46:47], v55 offset:0
 s_waitcnt lgkmcnt(0)
 s_waitcnt vmcnt(32)
 s_barrier
 s_add_u32 s53, s35, 0
 s_add_u32 m0, s37, 8192
 s_add_u32 s38, s53, 0
 buffer_load_dwordx4 v20, s[24:27], s38 offen lds
 s_add_u32 m0, s37, 9216
 s_add_u32 s38, s53, 65536
 buffer_load_dwordx4 v27, s[24:27], s38 offen lds
 s_add_u32 m0, s37, 10240
 s_add_u32 s38, s53, 131072
 buffer_load_dwordx4 v20, s[24:27], s38 offen lds
 s_add_u32 m0, s37, 11264
 s_add_u32 s38, s53, 196608
 buffer_load_dwordx4 v27, s[24:27], s38 offen lds
 ds_read_b64_tr_b16 a[80:81], v48 offset:12288
 ds_read_b64_tr_b16 a[82:83], v49 offset:0
 ds_read_b64_tr_b16 a[84:85], v50 offset:4096
 ds_read_b64_tr_b16 a[86:87], v51 offset:4096
 ds_read_b64_tr_b16 a[88:89], v52 offset:12288
 ds_read_b64_tr_b16 a[90:91], v53 offset:0
 ds_read_b64_tr_b16 a[92:93], v54 offset:4096
 ds_read_b64_tr_b16 a[94:95], v55 offset:4096
 s_waitcnt lgkmcnt(0)
 s_waitcnt vmcnt(32)
 s_barrier
 s_add_u32 s53, s35, 0
 s_add_u32 m0, s37, 4096
 s_add_u32 s38, s53, 0
 buffer_load_dwordx4 v20, s[20:23], s38 offen lds
 s_add_u32 m0, s37, 5120
 s_add_u32 s38, s53, 65536
 buffer_load_dwordx4 v27, s[20:23], s38 offen lds
 s_add_u32 m0, s37, 6144
 s_add_u32 s38, s53, 131072
 buffer_load_dwordx4 v20, s[20:23], s38 offen lds
 s_add_u32 m0, s37, 7168
 s_add_u32 s38, s53, 196608
 buffer_load_dwordx4 v27, s[20:23], s38 offen lds
 ds_read_b64_tr_b16 a[96:97], v48 offset:20480
 ds_read_b64_tr_b16 a[98:99], v49 offset:20480
 ds_read_b64_tr_b16 a[100:101], v50 offset:20480
 ds_read_b64_tr_b16 a[102:103], v51 offset:20480
 ds_read_b64_tr_b16 a[104:105], v52 offset:20480
 ds_read_b64_tr_b16 a[106:107], v53 offset:20480
 ds_read_b64_tr_b16 a[108:109], v54 offset:20480
 ds_read_b64_tr_b16 a[110:111], v55 offset:20480
 s_waitcnt lgkmcnt(0)
 s_waitcnt vmcnt(32)
 s_barrier
 s_add_u32 s53, s35, 1048576
 s_add_u32 m0, s37, 20480
 s_add_u32 s38, s53, 0
 buffer_load_dwordx4 v20, s[24:27], s38 offen lds
 s_add_u32 m0, s37, 21504
 s_add_u32 s38, s53, 65536
 buffer_load_dwordx4 v27, s[24:27], s38 offen lds
 s_add_u32 m0, s37, 22528
 s_add_u32 s38, s53, 131072
 buffer_load_dwordx4 v20, s[24:27], s38 offen lds
 s_add_u32 m0, s37, 23552
 s_add_u32 s38, s53, 196608
 buffer_load_dwordx4 v27, s[24:27], s38 offen lds
 ds_read_b64_tr_b16 a[192:193], v48 offset:24576
 ds_read_b64_tr_b16 a[194:195], v49 offset:24576
 ds_read_b64_tr_b16 a[196:197], v50 offset:24576
 ds_read_b64_tr_b16 a[198:199], v51 offset:24576
 ds_read_b64_tr_b16 a[200:201], v52 offset:24576
 ds_read_b64_tr_b16 a[202:203], v53 offset:24576
 ds_read_b64_tr_b16 a[204:205], v54 offset:24576
 ds_read_b64_tr_b16 a[206:207], v55 offset:24576
 s_waitcnt lgkmcnt(0)
 s_waitcnt vmcnt(32)
 s_barrier
 s_add_u32 s53, s35, 3670016
 s_add_u32 m0, s37, 24576
 s_add_u32 s38, s53, 0
 buffer_load_dwordx4 v20, s[20:23], s38 offen lds
 s_add_u32 m0, s37, 25600
 s_add_u32 s38, s53, 65536
 buffer_load_dwordx4 v27, s[20:23], s38 offen lds
 s_add_u32 m0, s37, 26624
 s_add_u32 s38, s53, 131072
 buffer_load_dwordx4 v20, s[20:23], s38 offen lds
 s_add_u32 m0, s37, 27648
 s_add_u32 s38, s53, 196608
 buffer_load_dwordx4 v27, s[20:23], s38 offen lds
 ds_read_b64_tr_b16 v[144:145], v48 offset:28672
 ds_read_b64_tr_b16 v[146:147], v49 offset:28672
 ds_read_b64_tr_b16 v[148:149], v50 offset:28672
 ds_read_b64_tr_b16 v[150:151], v51 offset:28672
 ds_read_b64_tr_b16 v[152:153], v52 offset:28672
 ds_read_b64_tr_b16 v[154:155], v53 offset:28672
 ds_read_b64_tr_b16 v[156:157], v54 offset:28672
 ds_read_b64_tr_b16 v[158:159], v55 offset:28672
 s_waitcnt lgkmcnt(0)
 s_waitcnt vmcnt(32)
 s_barrier
 s_add_u32 s53, s35, 2097152
 s_add_u32 m0, s37, 28672
 s_add_u32 s38, s53, 0
 buffer_load_dwordx4 v20, s[16:19], s38 offen lds
 s_add_u32 m0, s37, 29696
 s_add_u32 s38, s53, 65536
 buffer_load_dwordx4 v27, s[16:19], s38 offen lds
 s_add_u32 m0, s37, 30720
 s_add_u32 s38, s53, 131072
 buffer_load_dwordx4 v20, s[16:19], s38 offen lds
 s_add_u32 m0, s37, 31744
 s_add_u32 s38, s53, 196608
 buffer_load_dwordx4 v27, s[16:19], s38 offen lds
 ds_read_b64_tr_b16 a[0:1], v48 offset:32768
 ds_read_b64_tr_b16 a[2:3], v49 offset:32768
 ds_read_b64_tr_b16 a[4:5], v50 offset:32768
 ds_read_b64_tr_b16 a[6:7], v51 offset:32768
 ds_read_b64_tr_b16 a[8:9], v52 offset:32768
 ds_read_b64_tr_b16 a[10:11], v53 offset:32768
 ds_read_b64_tr_b16 a[12:13], v54 offset:32768
 ds_read_b64_tr_b16 a[14:15], v55 offset:32768
 s_waitcnt lgkmcnt(0)
 s_waitcnt vmcnt(32)
 s_barrier
 s_add_u32 s53, s35, 524288
 s_add_u32 m0, s37, 32768
 s_add_u32 s38, s53, 0
 buffer_load_dwordx4 v20, s[20:23], s38 offen lds
 s_add_u32 m0, s37, 33792
 s_add_u32 s38, s53, 65536
 buffer_load_dwordx4 v27, s[20:23], s38 offen lds
 s_add_u32 m0, s37, 34816
 s_add_u32 s38, s53, 131072
 buffer_load_dwordx4 v20, s[20:23], s38 offen lds
 s_add_u32 m0, s37, 35840
 s_add_u32 s38, s53, 196608
 buffer_load_dwordx4 v27, s[20:23], s38 offen lds
 ds_read_b64_tr_b16 a[64:65], v60 offset:0
 ds_read_b64_tr_b16 a[66:67], v60 offset:4096
 ds_read_b64_tr_b16 a[68:69], v60 offset:8192
 ds_read_b64_tr_b16 a[70:71], v60 offset:12288
 ds_read_b64_tr_b16 a[72:73], v61 offset:0
 ds_read_b64_tr_b16 a[74:75], v61 offset:4096
 ds_read_b64_tr_b16 a[76:77], v61 offset:8192
 ds_read_b64_tr_b16 a[78:79], v61 offset:12288
 s_waitcnt lgkmcnt(0)
 s_waitcnt vmcnt(32)
 s_barrier
 s_add_u32 s53, s35, 2621440
 s_mov_b32 m0, 8192
 s_add_u32 s38, s53, 0
 buffer_load_dwordx4 v20, s[24:27], s38 offen lds
 s_mov_b32 m0, 9216
 s_add_u32 s38, s53, 65536
 buffer_load_dwordx4 v27, s[24:27], s38 offen lds
 s_mov_b32 m0, 10240
 s_add_u32 s38, s53, 131072
 buffer_load_dwordx4 v20, s[24:27], s38 offen lds
 s_mov_b32 m0, 11264
 s_add_u32 s38, s53, 196608
 buffer_load_dwordx4 v27, s[24:27], s38 offen lds
 ds_read_b64_tr_b16 v[96:97], v48 offset:4096
 ds_read_b64_tr_b16 v[98:99], v49 offset:8192
 ds_read_b64_tr_b16 v[100:101], v50 offset:12288
 ds_read_b64_tr_b16 v[102:103], v51 offset:16384
 ds_read_b64_tr_b16 v[104:105], v52 offset:4096
 ds_read_b64_tr_b16 v[106:107], v53 offset:8192
 ds_read_b64_tr_b16 v[108:109], v54 offset:12288
 ds_read_b64_tr_b16 v[110:111], v55 offset:16384
 s_waitcnt lgkmcnt(0)
 s_waitcnt vmcnt(32)
 s_barrier
 buffer_load_dword v71, v74, s[8:11], 0 offen offset:64 sc1
 ds_read_b64_tr_b16 v[32:33], v48 offset:12288
 ds_read_b64_tr_b16 v[34:35], v49 offset:4096
 ds_read_b64_tr_b16 v[36:37], v50 offset:0
 ds_read_b64_tr_b16 v[38:39], v51 offset:12288
 ds_read_b64_tr_b16 v[40:41], v52 offset:12288
 ds_read_b64_tr_b16 v[42:43], v53 offset:4096
 ds_read_b64_tr_b16 v[44:45], v54 offset:0
 ds_read_b64_tr_b16 v[46:47], v55 offset:12288
 s_waitcnt lgkmcnt(0)
 s_waitcnt vmcnt(29)
 s_barrier
 ds_write_b128 v1, v[32:35] offset:12288
 ds_write_b128 v1, v[36:39] offset:13312
 ds_write_b128 v1, v[40:43] offset:14336
 ds_write_b128 v1, v[44:47] offset:15360
 ds_read_b64_tr_b16 v[32:33], v48 offset:20480
 ds_read_b64_tr_b16 v[34:35], v49 offset:16384
 ds_read_b64_tr_b16 v[36:37], v50 offset:16384
 ds_read_b64_tr_b16 v[38:39], v51 offset:8192
 ds_read_b64_tr_b16 v[40:41], v52 offset:20480
 ds_read_b64_tr_b16 v[42:43], v53 offset:16384
 ds_read_b64_tr_b16 v[44:45], v54 offset:16384
 ds_read_b64_tr_b16 v[46:47], v55 offset:8192
 s_waitcnt lgkmcnt(0)
 s_waitcnt vmcnt(25)
 s_barrier
 ds_write_b128 v1, v[32:35] offset:0
 ds_write_b128 v1, v[36:39] offset:1024
 ds_write_b128 v1, v[40:43] offset:2048
 ds_write_b128 v1, v[44:47] offset:3072
 ds_read_b64_tr_b16 a[144:145], v48 offset:24576
 ds_read_b64_tr_b16 a[146:147], v49 offset:0
 ds_read_b64_tr_b16 a[148:149], v50 offset:8192
 ds_read_b64_tr_b16 a[150:151], v51 offset:0
 ds_read_b64_tr_b16 a[152:153], v52 offset:24576
 ds_read_b64_tr_b16 a[154:155], v53 offset:0
 ds_read_b64_tr_b16 a[156:157], v54 offset:8192
 ds_read_b64_tr_b16 a[158:159], v55 offset:0
 s_waitcnt lgkmcnt(0)
 s_waitcnt vmcnt(21)
 s_barrier
 ds_read_b64_tr_b16 a[128:129], v48 offset:28672
 ds_read_b64_tr_b16 a[130:131], v49 offset:20480
 ds_read_b64_tr_b16 a[132:133], v50 offset:4096
 ds_read_b64_tr_b16 a[134:135], v51 offset:4096
 ds_read_b64_tr_b16 a[136:137], v52 offset:28672
 ds_read_b64_tr_b16 a[138:139], v53 offset:20480
 ds_read_b64_tr_b16 a[140:141], v54 offset:4096
 ds_read_b64_tr_b16 a[142:143], v55 offset:4096
 s_waitcnt lgkmcnt(0)
 s_waitcnt vmcnt(17)
 s_barrier
 s_add_u32 s53, s35, 4194304
 s_add_u32 m0, s37, 4096
 s_add_u32 s38, s53, 0
 buffer_load_dwordx4 v20, s[20:23], s38 offen lds
 s_add_u32 m0, s37, 5120
 s_add_u32 s38, s53, 65536
 buffer_load_dwordx4 v27, s[20:23], s38 offen lds
 s_add_u32 m0, s37, 6144
 s_add_u32 s38, s53, 131072
 buffer_load_dwordx4 v20, s[20:23], s38 offen lds
 s_add_u32 m0, s37, 7168
 s_add_u32 s38, s53, 196608
 buffer_load_dwordx4 v27, s[20:23], s38 offen lds
 ds_read_b64_tr_b16 v[32:33], v48 offset:32768
 ds_read_b64_tr_b16 v[34:35], v49 offset:24576
 ds_read_b64_tr_b16 v[36:37], v50 offset:20480
 ds_read_b64_tr_b16 v[38:39], v51 offset:20480
 ds_read_b64_tr_b16 v[40:41], v52 offset:32768
 ds_read_b64_tr_b16 v[42:43], v53 offset:24576
 ds_read_b64_tr_b16 v[44:45], v54 offset:20480
 ds_read_b64_tr_b16 v[46:47], v55 offset:20480
 s_waitcnt lgkmcnt(0)
 s_waitcnt vmcnt(17)
 s_barrier
 ds_write_b128 v1, v[32:35] offset:16384
 ds_write_b128 v1, v[36:39] offset:17408
 ds_write_b128 v1, v[40:43] offset:18432
 ds_write_b128 v1, v[44:47] offset:19456
 s_add_u32 s53, s35, 0
 s_add_u32 m0, s37, 20480
 s_add_u32 s38, s53, 0
 buffer_load_dwordx4 v20, s[16:19], s38 offen lds
 s_add_u32 m0, s37, 21504
 s_add_u32 s38, s53, 65536
 buffer_load_dwordx4 v27, s[16:19], s38 offen lds
 s_add_u32 m0, s37, 22528
 s_add_u32 s38, s53, 131072
 buffer_load_dwordx4 v20, s[16:19], s38 offen lds
 s_add_u32 m0, s37, 23552
 s_add_u32 s38, s53, 196608
 buffer_load_dwordx4 v27, s[16:19], s38 offen lds
 ds_read_b64_tr_b16 a[48:49], v60 offset:0
 ds_read_b64_tr_b16 a[50:51], v49 offset:28672
 ds_read_b64_tr_b16 a[52:53], v50 offset:24576
 ds_read_b64_tr_b16 a[54:55], v51 offset:24576
 ds_read_b64_tr_b16 a[56:57], v61 offset:0
 ds_read_b64_tr_b16 a[58:59], v53 offset:28672
 ds_read_b64_tr_b16 a[60:61], v54 offset:24576
 ds_read_b64_tr_b16 a[62:63], v55 offset:24576
 s_waitcnt lgkmcnt(0)
 s_waitcnt vmcnt(17)
 s_barrier
 s_add_u32 s53, s36, 512
 s_add_u32 m0, s37, 24576
 s_add_u32 s38, s53, 0
 buffer_load_dwordx4 v21, s[28:31], s38 offen lds
 s_add_u32 m0, s37, 25600
 s_add_u32 s38, s53, 4608
 buffer_load_dwordx4 v21, s[28:31], s38 offen lds
 s_add_u32 m0, s37, 26624
 s_add_u32 s38, s53, 36864
 buffer_load_dwordx4 v21, s[28:31], s38 offen lds
 s_add_u32 m0, s37, 27648
 s_add_u32 s38, s53, 41472
 buffer_load_dwordx4 v21, s[28:31], s38 offen lds
 ds_read_b64_tr_b16 v[80:81], v48 offset:20480
 ds_read_b64_tr_b16 v[82:83], v49 offset:32768
 ds_read_b64_tr_b16 v[84:85], v50 offset:28672
 ds_read_b64_tr_b16 v[86:87], v51 offset:28672
 ds_read_b64_tr_b16 v[88:89], v52 offset:20480
 ds_read_b64_tr_b16 v[90:91], v53 offset:32768
 ds_read_b64_tr_b16 v[92:93], v54 offset:28672
 ds_read_b64_tr_b16 v[94:95], v55 offset:28672
 s_waitcnt lgkmcnt(0)
 s_waitcnt vmcnt(17)
 s_barrier
 s_add_u32 s53, s36, 74240
 s_add_u32 m0, s37, 28672
 s_add_u32 s38, s53, 0
 buffer_load_dwordx4 v21, s[28:31], s38 offen lds
 s_add_u32 m0, s37, 29696
 s_add_u32 s38, s53, 4608
 buffer_load_dwordx4 v21, s[28:31], s38 offen lds
 s_add_u32 m0, s37, 30720
 s_add_u32 s38, s53, 36864
 buffer_load_dwordx4 v21, s[28:31], s38 offen lds
 s_add_u32 m0, s37, 31744
 s_add_u32 s38, s53, 41472
 buffer_load_dwordx4 v21, s[28:31], s38 offen lds
 ds_read_b64_tr_b16 v[32:33], v48 offset:24576
 ds_read_b64_tr_b16 v[34:35], v60 offset:4096
 ds_read_b64_tr_b16 v[36:37], v50 offset:32768
 ds_read_b64_tr_b16 v[38:39], v51 offset:32768
 ds_read_b64_tr_b16 v[40:41], v52 offset:24576
 ds_read_b64_tr_b16 v[42:43], v61 offset:4096
 ds_read_b64_tr_b16 v[44:45], v54 offset:32768
 ds_read_b64_tr_b16 v[46:47], v55 offset:32768
 s_waitcnt lgkmcnt(0)
 s_waitcnt vmcnt(17)
 s_barrier
 ds_write_b128 v1, v[32:35] offset:8192
 ds_write_b128 v1, v[36:39] offset:9216
 ds_write_b128 v1, v[40:43] offset:10240
 ds_write_b128 v1, v[44:47] offset:11264
 s_add_u32 s53, s36, 768
 s_add_u32 m0, s37, 32768
 s_add_u32 s38, s53, 0
 buffer_load_dwordx4 v21, s[28:31], s38 offen lds
 s_add_u32 m0, s37, 33792
 s_add_u32 s38, s53, 4608
 buffer_load_dwordx4 v21, s[28:31], s38 offen lds
 s_add_u32 m0, s37, 34816
 s_add_u32 s38, s53, 36864
 buffer_load_dwordx4 v21, s[28:31], s38 offen lds
 s_add_u32 m0, s37, 35840
 s_add_u32 s38, s53, 41472
 buffer_load_dwordx4 v21, s[28:31], s38 offen lds
 ds_read_b64_tr_b16 v[160:161], v48 offset:28672
 ds_read_b64_tr_b16 v[162:163], v49 offset:16384
 ds_read_b64_tr_b16 v[164:165], v60 offset:8192
 ds_read_b64_tr_b16 v[166:167], v60 offset:12288
 ds_read_b64_tr_b16 v[168:169], v52 offset:28672
 ds_read_b64_tr_b16 v[170:171], v53 offset:16384
 ds_read_b64_tr_b16 v[172:173], v61 offset:8192
 ds_read_b64_tr_b16 v[174:175], v61 offset:12288
 s_waitcnt lgkmcnt(0)
 s_waitcnt vmcnt(16)
 s_barrier
 v_readfirstlane_b32 s38, v71
 s_lshr_b32 s45, s38, 16
 s_and_b32 s38, s38, 0xffff
 s_cmp_ge_u32 s38, 32
 s_cselect_b32 s44, 1, 0
 buffer_load_dwordx4 v[8:11], v72, s[76:79], 0 offen offset:768
 buffer_load_dwordx4 v[12:15], v72, s[76:79], 0 offen offset:896
 s_add_u32 s53, s36, 74496
 s_mov_b32 m0, 8192
 s_add_u32 s38, s53, 0
 buffer_load_dwordx4 v21, s[28:31], s38 offen lds
 s_mov_b32 m0, 9216
 s_add_u32 s38, s53, 4608
 buffer_load_dwordx4 v21, s[28:31], s38 offen lds
 s_mov_b32 m0, 10240
 s_add_u32 s38, s53, 36864
 buffer_load_dwordx4 v21, s[28:31], s38 offen lds
 s_mov_b32 m0, 11264
 s_add_u32 s38, s53, 41472
 buffer_load_dwordx4 v21, s[28:31], s38 offen lds
 ds_read_b64_tr_b16 v[32:33], v48 offset:32768
 ds_read_b64_tr_b16 v[34:35], v49 offset:0
 ds_read_b64_tr_b16 v[36:37], v50 offset:4096
 ds_read_b64_tr_b16 v[38:39], v51 offset:4096
 ds_read_b64_tr_b16 v[40:41], v52 offset:32768
 ds_read_b64_tr_b16 v[42:43], v53 offset:0
 ds_read_b64_tr_b16 v[44:45], v54 offset:4096
 ds_read_b64_tr_b16 v[46:47], v55 offset:4096
 s_waitcnt lgkmcnt(0)
 s_waitcnt vmcnt(18)
 s_barrier
 ds_write_b128 v1, v[32:35] offset:4096
 ds_write_b128 v1, v[36:39] offset:5120
 ds_write_b128 v1, v[40:43] offset:6144
 ds_write_b128 v1, v[44:47] offset:7168
 ds_read_b64_tr_b16 a[112:113], v60 offset:0
 ds_read_b64_tr_b16 a[114:115], v49 offset:20480
 ds_read_b64_tr_b16 a[116:117], v50 offset:20480
 ds_read_b64_tr_b16 a[118:119], v51 offset:20480
 ds_read_b64_tr_b16 a[120:121], v61 offset:0
 ds_read_b64_tr_b16 a[122:123], v53 offset:20480
 ds_read_b64_tr_b16 a[124:125], v54 offset:20480
 ds_read_b64_tr_b16 a[126:127], v55 offset:20480
 s_waitcnt lgkmcnt(0)
 s_waitcnt vmcnt(14)
 s_barrier
 ds_read_b64_tr_b16 v[32:33], v56 offset:20480
 ds_read_b64_tr_b16 v[34:35], v57 offset:24576
 ds_read_b64_tr_b16 v[36:37], v58 offset:24576
 ds_read_b64_tr_b16 v[38:39], v59 offset:24576
 ds_read_b64_tr_b16 v[40:41], v56 offset:22528
 ds_read_b64_tr_b16 v[42:43], v57 offset:26624
 ds_read_b64_tr_b16 v[44:45], v58 offset:26624
 ds_read_b64_tr_b16 v[46:47], v59 offset:26624
 s_waitcnt lgkmcnt(0)
 s_waitcnt vmcnt(10)
 s_barrier
 ds_write_b128 v1, v[32:35] offset:20480
 ds_write_b128 v1, v[36:39] offset:21504
 ds_write_b128 v1, v[40:43] offset:22528
 ds_write_b128 v1, v[44:47] offset:23552
 ds_read_b64_tr_b16 v[32:33], v56 offset:24576
 ds_read_b64_tr_b16 v[34:35], v57 offset:28672
 ds_read_b64_tr_b16 v[36:37], v58 offset:28672
 ds_read_b64_tr_b16 v[38:39], v59 offset:28672
 ds_read_b64_tr_b16 v[40:41], v56 offset:26624
 ds_read_b64_tr_b16 v[42:43], v57 offset:30720
 ds_read_b64_tr_b16 v[44:45], v58 offset:30720
 ds_read_b64_tr_b16 v[46:47], v59 offset:30720
 s_waitcnt lgkmcnt(0)
 s_waitcnt vmcnt(6)
 s_barrier
 ds_write_b128 v1, v[32:35] offset:24576
 ds_write_b128 v1, v[36:39] offset:25600
 ds_write_b128 v1, v[40:43] offset:26624
 ds_write_b128 v1, v[44:47] offset:27648
 ds_read_b64_tr_b16 v[32:33], v56 offset:28672
 ds_read_b64_tr_b16 v[34:35], v57 offset:32768
 ds_read_b64_tr_b16 v[36:37], v58 offset:32768
 ds_read_b64_tr_b16 v[38:39], v59 offset:32768
 ds_read_b64_tr_b16 v[40:41], v56 offset:30720
 ds_read_b64_tr_b16 v[42:43], v57 offset:34816
 ds_read_b64_tr_b16 v[44:45], v58 offset:34816
 ds_read_b64_tr_b16 v[46:47], v59 offset:34816
 s_waitcnt lgkmcnt(0)
 s_waitcnt vmcnt(0)
 s_barrier
 ds_write_b128 v1, v[32:35] offset:28672
 ds_write_b128 v1, v[36:39] offset:29696
 ds_write_b128 v1, v[40:43] offset:30720
 ds_write_b128 v1, v[44:47] offset:31744
 ds_read_b64_tr_b16 v[32:33], v56 offset:32768
 ds_read_b64_tr_b16 v[34:35], v62 offset:4096
 ds_read_b64_tr_b16 v[36:37], v62 offset:8192
 ds_read_b64_tr_b16 v[38:39], v62 offset:12288
 ds_read_b64_tr_b16 v[40:41], v56 offset:34816
 ds_read_b64_tr_b16 v[42:43], v62 offset:6144
 ds_read_b64_tr_b16 v[44:45], v62 offset:10240
 ds_read_b64_tr_b16 v[46:47], v62 offset:14336
 s_waitcnt lgkmcnt(0)
 s_barrier
 ds_write_b128 v1, v[32:35] offset:32768
 ds_write_b128 v1, v[36:39] offset:33792
 ds_write_b128 v1, v[40:43] offset:34816
 ds_write_b128 v1, v[44:47] offset:35840
 ds_write_b128 v0, v[8:11] offset:6144
 ds_write_b128 v0, v[12:15] offset:7168
 s_waitcnt lgkmcnt(0)
 s_cmp_eq_u32 s44, 1
 s_cbranch_scc1 L_eok86
 v_mov_b32 v76, 32
poll88:
 buffer_load_dword v77, v74, s[8:11], 0 offen offset:64 sc1
 s_waitcnt vmcnt(0)
 v_and_b32 v78, 0xffff, v77
 v_cmp_le_u32 vcc, v76, v78
 s_cmp_eq_u64 vcc, exec
 s_cbranch_scc1 polld89
 s_cmp_eq_u32 s15, 0
 s_cbranch_scc1 polld89
 s_sub_u32 s15, s15, 1
 s_sleep 6
 s_branch poll88
polld89:
 v_readfirstlane_b32 s45, v77
 s_lshr_b32 s45, s45, 16
 s_branch L_edn87
L_eok86:
L_edn87:
 s_mov_b32 s32, s45
 s_branch L_wl70
L_wl74:
 s_add_u32 s53, s36, 0
 s_add_u32 m0, s37, 16384
 s_add_u32 s38, s53, 0
 buffer_load_dwordx4 v21, s[28:31], s38 offen lds
 s_add_u32 m0, s37, 17408
 s_add_u32 s38, s53, 4608
 buffer_load_dwordx4 v21, s[28:31], s38 offen lds
 s_add_u32 m0, s37, 18432
 s_add_u32 s38, s53, 36864
 buffer_load_dwordx4 v21, s[28:31], s38 offen lds
 s_add_u32 m0, s37, 19456
 s_add_u32 s38, s53, 41472
 buffer_load_dwordx4 v21, s[28:31], s38 offen lds
 s_add_u32 s53, s36, 73728
 s_add_u32 m0, s37, 12288
 s_add_u32 s38, s53, 0
 buffer_load_dwordx4 v21, s[28:31], s38 offen lds
 s_add_u32 m0, s37, 13312
 s_add_u32 s38, s53, 4608
 buffer_load_dwordx4 v21, s[28:31], s38 offen lds
 s_add_u32 m0, s37, 14336
 s_add_u32 s38, s53, 36864
 buffer_load_dwordx4 v21, s[28:31], s38 offen lds
 s_add_u32 m0, s37, 15360
 s_add_u32 s38, s53, 41472
 buffer_load_dwordx4 v21, s[28:31], s38 offen lds
 s_add_u32 s53, s36, 256
 s_add_u32 m0, s37, 8192
 s_add_u32 s38, s53, 0
 buffer_load_dwordx4 v21, s[28:31], s38 offen lds
 s_add_u32 m0, s37, 9216
 s_add_u32 s38, s53, 4608
 buffer_load_dwordx4 v21, s[28:31], s38 offen lds
 s_add_u32 m0, s37, 10240
 s_add_u32 s38, s53, 36864
 buffer_load_dwordx4 v21, s[28:31], s38 offen lds
 s_add_u32 m0, s37, 11264
 s_add_u32 s38, s53, 41472
 buffer_load_dwordx4 v21, s[28:31], s38 offen lds
 s_add_u32 s53, s36, 73984
 s_add_u32 m0, s37, 0
 s_add_u32 s38, s53, 0
 buffer_load_dwordx4 v21, s[28:31], s38 offen lds
 s_add_u32 m0, s37, 1024
 s_add_u32 s38, s53, 4608
 buffer_load_dwordx4 v21, s[28:31], s38 offen lds
 s_add_u32 m0, s37, 2048
 s_add_u32 s38, s53, 36864
 buffer_load_dwordx4 v21, s[28:31], s38 offen lds
 s_add_u32 m0, s37, 3072
 s_add_u32 s38, s53, 41472
 buffer_load_dwordx4 v21, s[28:31], s38 offen lds
 s_mov_b32 s53, s36
 s_add_u32 m0, s37, 4096
 s_add_u32 s38, s53, 0
 buffer_load_dwordx4 v22, s[28:31], s38 offen lds
 s_add_u32 m0, s37, 5120
 s_add_u32 s38, s53, 4608
 buffer_load_dwordx4 v22, s[28:31], s38 offen lds
 s_add_u32 m0, s37, 6144
 s_add_u32 s38, s53, 9216
 buffer_load_dwordx4 v22, s[28:31], s38 offen lds
 s_add_u32 m0, s37, 7168
 s_add_u32 s38, s53, 13824
 buffer_load_dwordx4 v22, s[28:31], s38 offen lds
 s_add_u32 s53, s35, 524288
 s_add_u32 m0, s37, 20480
 s_add_u32 s38, s53, 0
 buffer_load_dwordx4 v20, s[16:19], s38 offen lds
 s_add_u32 m0, s37, 21504
 s_add_u32 s38, s53, 65536
 buffer_load_dwordx4 v27, s[16:19], s38 offen lds
 s_add_u32 m0, s37, 22528
 s_add_u32 s38, s53, 131072
 buffer_load_dwordx4 v20, s[16:19], s38 offen lds
 s_add_u32 m0, s37, 23552
 s_add_u32 s38, s53, 196608
 buffer_load_dwordx4 v27, s[16:19], s38 offen lds
 s_add_u32 s53, s35, 524288
 s_add_u32 m0, s37, 24576
 s_add_u32 s38, s53, 0
 buffer_load_dwordx4 v20, s[24:27], s38 offen lds
 s_add_u32 m0, s37, 25600
 s_add_u32 s38, s53, 65536
 buffer_load_dwordx4 v27, s[24:27], s38 offen lds
 s_add_u32 m0, s37, 26624
 s_add_u32 s38, s53, 131072
 buffer_load_dwordx4 v20, s[24:27], s38 offen lds
 s_add_u32 m0, s37, 27648
 s_add_u32 s38, s53, 196608
 buffer_load_dwordx4 v27, s[24:27], s38 offen lds
 s_add_u32 s53, s35, 1572864
 s_add_u32 m0, s37, 28672
 s_add_u32 s38, s53, 0
 buffer_load_dwordx4 v20, s[16:19], s38 offen lds
 s_add_u32 m0, s37, 29696
 s_add_u32 s38, s53, 65536
 buffer_load_dwordx4 v27, s[16:19], s38 offen lds
 s_add_u32 m0, s37, 30720
 s_add_u32 s38, s53, 131072
 buffer_load_dwordx4 v20, s[16:19], s38 offen lds
 s_add_u32 m0, s37, 31744
 s_add_u32 s38, s53, 196608
 buffer_load_dwordx4 v27, s[16:19], s38 offen lds
 s_add_u32 s53, s35, 1572864
 s_add_u32 m0, s37, 32768
 s_add_u32 s38, s53, 0
 buffer_load_dwordx4 v20, s[20:23], s38 offen lds
 s_add_u32 m0, s37, 33792
 s_add_u32 s38, s53, 65536
 buffer_load_dwordx4 v27, s[20:23], s38 offen lds
 s_add_u32 m0, s37, 34816
 s_add_u32 s38, s53, 131072
 buffer_load_dwordx4 v20, s[20:23], s38 offen lds
 s_add_u32 m0, s37, 35840
 s_add_u32 s38, s53, 196608
 buffer_load_dwordx4 v27, s[20:23], s38 offen lds
 s_add_u32 s53, s35, 1572864
 s_mov_b32 m0, 12288
 s_add_u32 s38, s53, 0
 buffer_load_dwordx4 v20, s[24:27], s38 offen lds
 s_mov_b32 m0, 13312
 s_add_u32 s38, s53, 65536
 buffer_load_dwordx4 v27, s[24:27], s38 offen lds
 s_mov_b32 m0, 14336
 s_add_u32 s38, s53, 131072
 buffer_load_dwordx4 v20, s[24:27], s38 offen lds
 s_mov_b32 m0, 15360
 s_add_u32 s38, s53, 196608
 buffer_load_dwordx4 v27, s[24:27], s38 offen lds
 s_cmp_eq_u32 s52, 0
 s_cbranch_scc1 L_np90
 v_mov_b32 v8, -1
 v_mov_b32 v9, -1
 v_mov_b32 v10, -1
 v_mov_b32 v11, -1
 s_add_u32 s33, s49, 0
 buffer_store_dwordx4 v[8:11], v0, s[4:7], s33 offen offset:0 sc1
 buffer_store_dwordx4 v[8:11], v0, s[4:7], s33 offen offset:1024 sc1
 buffer_store_dwordx4 v[8:11], v0, s[4:7], s33 offen offset:2048 sc1
 buffer_store_dwordx4 v[8:11], v0, s[4:7], s33 offen offset:3072 sc1
 s_add_u32 s33, s49, 294912
 buffer_store_dwordx4 v[8:11], v0, s[4:7], s33 offen offset:0 sc1
 buffer_store_dwordx4 v[8:11], v0, s[4:7], s33 offen offset:1024 sc1
 buffer_store_dwordx4 v[8:11], v0, s[4:7], s33 offen offset:2048 sc1
 buffer_store_dwordx4 v[8:11], v0, s[4:7], s33 offen offset:3072 sc1
 s_add_u32 s33, s46, 9216
 buffer_store_dword v8, v4, s[4:7], s33 offen sc1
 s_add_u32 s33, s46, 18432
 buffer_store_dword v8, v4, s[4:7], s33 offen sc1
L_np90:
 s_waitcnt vmcnt(36)
 s_barrier
 ds_read_b64_tr_b16 v[176:177], v56 offset:0
 ds_read_b64_tr_b16 v[178:179], v57 offset:12288
 ds_read_b64_tr_b16 v[180:181], v58 offset:12288
 ds_read_b64_tr_b16 v[182:183], v59 offset:16384
 ds_read_b64_tr_b16 v[184:185], v56 offset:2048
 ds_read_b64_tr_b16 v[186:187], v57 offset:14336
 ds_read_b64_tr_b16 v[188:189], v58 offset:14336
 ds_read_b64_tr_b16 v[190:191], v59 offset:18432
 s_waitcnt lgkmcnt(0)
 s_waitcnt vmcnt(32)
 s_barrier
 s_add_u32 s53, s35, 2097152
 s_add_u32 m0, s37, 16384
 s_add_u32 s38, s53, 0
 buffer_load_dwordx4 v20, s[24:27], s38 offen lds
 s_add_u32 m0, s37, 17408
 s_add_u32 s38, s53, 65536
 buffer_load_dwordx4 v27, s[24:27], s38 offen lds
 s_add_u32 m0, s37, 18432
 s_add_u32 s38, s53, 131072
 buffer_load_dwordx4 v20, s[24:27], s38 offen lds
 s_add_u32 m0, s37, 19456
 s_add_u32 s38, s53, 196608
 buffer_load_dwordx4 v27, s[24:27], s38 offen lds
 ds_read_b64_tr_b16 v[192:193], v56 offset:8192
 ds_read_b64_tr_b16 v[194:195], v57 offset:8192
 ds_read_b64_tr_b16 v[196:197], v58 offset:0
 ds_read_b64_tr_b16 v[198:199], v59 offset:12288
 ds_read_b64_tr_b16 v[200:201], v56 offset:10240
 ds_read_b64_tr_b16 v[202:203], v57 offset:10240
 ds_read_b64_tr_b16 v[204:205], v58 offset:2048
 ds_read_b64_tr_b16 v[206:207], v59 offset:14336
 s_waitcnt lgkmcnt(0)
 s_waitcnt vmcnt(32)
 s_barrier
 s_add_u32 s53, s35, 2621440
 s_add_u32 m0, s37, 12288
 s_add_u32 s38, s53, 0
 buffer_load_dwordx4 v20, s[16:19], s38 offen lds
 s_add_u32 m0, s37, 13312
 s_add_u32 s38, s53, 65536
 buffer_load_dwordx4 v27, s[16:19], s38 offen lds
 s_add_u32 m0, s37, 14336
 s_add_u32 s38, s53, 131072
 buffer_load_dwordx4 v20, s[16:19], s38 offen lds
 s_add_u32 m0, s37, 15360
 s_add_u32 s38, s53, 196608
 buffer_load_dwordx4 v27, s[16:19], s38 offen lds
 ds_read_b64_tr_b16 v[208:209], v56 offset:16384
 ds_read_b64_tr_b16 v[210:211], v57 offset:4096
 ds_read_b64_tr_b16 v[212:213], v58 offset:16384
 ds_read_b64_tr_b16 v[214:215], v59 offset:8192
 ds_read_b64_tr_b16 v[216:217], v56 offset:18432
 ds_read_b64_tr_b16 v[218:219], v57 offset:6144
 ds_read_b64_tr_b16 v[220:221], v58 offset:18432
 ds_read_b64_tr_b16 v[222:223], v59 offset:10240
 s_waitcnt lgkmcnt(0)
 s_waitcnt vmcnt(32)
 s_barrier
 s_add_u32 s53, s35, 3145728
 s_add_u32 m0, s37, 8192
 s_add_u32 s38, s53, 0
 buffer_load_dwordx4 v20, s[24:27], s38 offen lds
 s_add_u32 m0, s37, 9216
 s_add_u32 s38, s53, 65536
 buffer_load_dwordx4 v27, s[24:27], s38 offen lds
 s_add_u32 m0, s37, 10240
 s_add_u32 s38, s53, 131072
 buffer_load_dwordx4 v20, s[24:27], s38 offen lds
 s_add_u32 m0, s37, 11264
 s_add_u32 s38, s53, 196608
 buffer_load_dwordx4 v27, s[24:27], s38 offen lds
 ds_read_b64_tr_b16 v[224:225], v56 offset:4096
 ds_read_b64_tr_b16 v[226:227], v57 offset:16384
 ds_read_b64_tr_b16 v[228:229], v58 offset:8192
 ds_read_b64_tr_b16 v[230:231], v59 offset:0
 ds_read_b64_tr_b16 v[232:233], v56 offset:6144
 ds_read_b64_tr_b16 v[234:235], v57 offset:18432
 ds_read_b64_tr_b16 v[236:237], v58 offset:10240
 ds_read_b64_tr_b16 v[238:239], v59 offset:2048
 s_waitcnt lgkmcnt(0)
 s_waitcnt vmcnt(32)
 s_barrier
 s_add_u32 s53, s35, 3670016
 s_add_u32 m0, s37, 0
 s_add_u32 s38, s53, 0
 buffer_load_dwordx4 v20, s[16:19], s38 offen lds
 s_add_u32 m0, s37, 1024
 s_add_u32 s38, s53, 65536
 buffer_load_dwordx4 v27, s[16:19], s38 offen lds
 s_add_u32 m0, s37, 2048
 s_add_u32 s38, s53, 131072
 buffer_load_dwordx4 v20, s[16:19], s38 offen lds
 s_add_u32 m0, s37, 3072
 s_add_u32 s38, s53, 196608
 buffer_load_dwordx4 v27, s[16:19], s38 offen lds
 ds_read_b64_tr_b16 v[240:241], v23 offset:4096
 ds_read_b64_tr_b16 v[242:243], v23 offset:4608
 ds_read_b64_tr_b16 v[244:245], v23 offset:6144
 ds_read_b64_tr_b16 v[246:247], v23 offset:6656
 ds_read_b64_tr_b16 v[248:249], v24 offset:4096
 ds_read_b64_tr_b16 v[250:251], v24 offset:4608
 ds_read_b64_tr_b16 v[252:253], v24 offset:6144
 ds_read_b64_tr_b16 v[254:255], v24 offset:6656
 s_waitcnt lgkmcnt(0)
 s_waitcnt vmcnt(32)
 s_barrier
 s_add_u32 s53, s35, 4194304
 s_add_u32 m0, s37, 4096
 s_add_u32 s38, s53, 0
 buffer_load_dwordx4 v20, s[16:19], s38 offen lds
 s_add_u32 m0, s37, 5120
 s_add_u32 s38, s53, 65536
 buffer_load_dwordx4 v27, s[16:19], s38 offen lds
 s_add_u32 m0, s37, 6144
 s_add_u32 s38, s53, 131072
 buffer_load_dwordx4 v20, s[16:19], s38 offen lds
 s_add_u32 m0, s37, 7168
 s_add_u32 s38, s53, 196608
 buffer_load_dwordx4 v27, s[16:19], s38 offen lds
 ds_read_b64_tr_b16 a[208:209], v48 offset:20480
 ds_read_b64_tr_b16 a[210:211], v49 offset:20480
 ds_read_b64_tr_b16 a[212:213], v50 offset:20480
 ds_read_b64_tr_b16 a[214:215], v51 offset:20480
 ds_read_b64_tr_b16 a[216:217], v52 offset:20480
 ds_read_b64_tr_b16 a[218:219], v53 offset:20480
 ds_read_b64_tr_b16 a[220:221], v54 offset:20480
 ds_read_b64_tr_b16 a[222:223], v55 offset:20480
 s_waitcnt lgkmcnt(0)
 s_waitcnt vmcnt(32)
 s_barrier
 s_add_u32 s53, s35, 4194304
 s_add_u32 m0, s37, 20480
 s_add_u32 s38, s53, 0
 buffer_load_dwordx4 v20, s[24:27], s38 offen lds
 s_add_u32 m0, s37, 21504
 s_add_u32 s38, s53, 65536
 buffer_load_dwordx4 v27, s[24:27], s38 offen lds
 s_add_u32 m0, s37, 22528
 s_add_u32 s38, s53, 131072
 buffer_load_dwordx4 v20, s[24:27], s38 offen lds
 s_add_u32 m0, s37, 23552
 s_add_u32 s38, s53, 196608
 buffer_load_dwordx4 v27, s[24:27], s38 offen lds
 ds_read_b64_tr_b16 a[240:241], v48 offset:24576
 ds_read_b64_tr_b16 a[242:243], v49 offset:24576
 ds_read_b64_tr_b16 a[244:245], v50 offset:24576
 ds_read_b64_tr_b16 a[246:247], v51 offset:24576
 ds_read_b64_tr_b16 a[248:249], v52 offset:24576
 ds_read_b64_tr_b16 a[250:251], v53 offset:24576
 ds_read_b64_tr_b16 a[252:253], v54 offset:24576
 ds_read_b64_tr_b16 a[254:255], v55 offset:24576
 s_waitcnt lgkmcnt(0)
 s_waitcnt vmcnt(32)
 s_barrier
 s_add_u32 s53, s35, 1048576
 s_add_u32 m0, s37, 24576
 s_add_u32 s38, s53, 0
 buffer_load_dwordx4 v20, s[16:19], s38 offen lds
 s_add_u32 m0, s37, 25600
 s_add_u32 s38, s53, 65536
 buffer_load_dwordx4 v27, s[16:19], s38 offen lds
 s_add_u32 m0, s37, 26624
 s_add_u32 s38, s53, 131072
 buffer_load_dwordx4 v20, s[16:19], s38 offen lds
 s_add_u32 m0, s37, 27648
 s_add_u32 s38, s53, 196608
 buffer_load_dwordx4 v27, s[16:19], s38 offen lds
 ds_read_b64_tr_b16 v[128:129], v48 offset:28672
 ds_read_b64_tr_b16 v[130:131], v49 offset:28672
 ds_read_b64_tr_b16 v[132:133], v50 offset:28672
 ds_read_b64_tr_b16 v[134:135], v51 offset:28672
 ds_read_b64_tr_b16 v[136:137], v52 offset:28672
 ds_read_b64_tr_b16 v[138:139], v53 offset:28672
 ds_read_b64_tr_b16 v[140:141], v54 offset:28672
 ds_read_b64_tr_b16 v[142:143], v55 offset:28672
 s_waitcnt lgkmcnt(0)
 s_waitcnt vmcnt(32)
 s_barrier
 s_add_u32 s53, s35, 2621440
 s_add_u32 m0, s37, 28672
 s_add_u32 s38, s53, 0
 buffer_load_dwordx4 v20, s[20:23], s38 offen lds
 s_add_u32 m0, s37, 29696
 s_add_u32 s38, s53, 65536
 buffer_load_dwordx4 v27, s[20:23], s38 offen lds
 s_add_u32 m0, s37, 30720
 s_add_u32 s38, s53, 131072
 buffer_load_dwordx4 v20, s[20:23], s38 offen lds
 s_add_u32 m0, s37, 31744
 s_add_u32 s38, s53, 196608
 buffer_load_dwordx4 v27, s[20:23], s38 offen lds
 ds_read_b64_tr_b16 v[144:145], v48 offset:32768
 ds_read_b64_tr_b16 v[146:147], v49 offset:32768
 ds_read_b64_tr_b16 v[148:149], v50 offset:32768
 ds_read_b64_tr_b16 v[150:151], v51 offset:32768
 ds_read_b64_tr_b16 v[152:153], v52 offset:32768
 ds_read_b64_tr_b16 v[154:155], v53 offset:32768
 ds_read_b64_tr_b16 v[156:157], v54 offset:32768
 ds_read_b64_tr_b16 v[158:159], v55 offset:32768
 s_waitcnt lgkmcnt(0)
 s_waitcnt vmcnt(32)
 s_barrier
 s_add_u32 s53, s35, 3145728
 s_add_u32 m0, s37, 32768
 s_add_u32 s38, s53, 0
 buffer_load_dwordx4 v20, s[20:23], s38 offen lds
 s_add_u32 m0, s37, 33792
 s_add_u32 s38, s53, 65536
 buffer_load_dwordx4 v27, s[20:23], s38 offen lds
 s_add_u32 m0, s37, 34816
 s_add_u32 s38, s53, 131072
 buffer_load_dwordx4 v20, s[20:23], s38 offen lds
 s_add_u32 m0, s37, 35840
 s_add_u32 s38, s53, 196608
 buffer_load_dwordx4 v27, s[20:23], s38 offen lds
 ds_read_b64_tr_b16 v[160:161], v60 offset:0
 ds_read_b64_tr_b16 v[162:163], v60 offset:4096
 ds_read_b64_tr_b16 v[164:165], v60 offset:8192
 ds_read_b64_tr_b16 v[166:167], v60 offset:12288
 ds_read_b64_tr_b16 v[168:169], v61 offset:0
 ds_read_b64_tr_b16 v[170:171], v61 offset:4096
 ds_read_b64_tr_b16 v[172:173], v61 offset:8192
 ds_read_b64_tr_b16 v[174:175], v61 offset:12288
 s_waitcnt lgkmcnt(0)
 s_waitcnt vmcnt(32)
 s_barrier
 s_add_u32 s53, s35, 3670016
 s_mov_b32 m0, 12288
 s_add_u32 s38, s53, 0
 buffer_load_dwordx4 v20, s[24:27], s38 offen lds
 s_mov_b32 m0, 13312
 s_add_u32 s38, s53, 65536
 buffer_load_dwordx4 v27, s[24:27], s38 offen lds
 s_mov_b32 m0, 14336
 s_add_u32 s38, s53, 131072
 buffer_load_dwordx4 v20, s[24:27], s38 offen lds
 s_mov_b32 m0, 15360
 s_add_u32 s38, s53, 196608
 buffer_load_dwordx4 v27, s[24:27], s38 offen lds
 ds_read_b64_tr_b16 a[16:17], v48 offset:0
 ds_read_b64_tr_b16 a[18:19], v49 offset:12288
 ds_read_b64_tr_b16 a[20:21], v50 offset:12288
 ds_read_b64_tr_b16 a[22:23], v51 offset:16384
 ds_read_b64_tr_b16 a[24:25], v52 offset:0
 ds_read_b64_tr_b16 a[26:27], v53 offset:12288
 ds_read_b64_tr_b16 a[28:29], v54 offset:12288
 ds_read_b64_tr_b16 a[30:31], v55 offset:16384
 s_waitcnt lgkmcnt(0)
 s_waitcnt vmcnt(32)
 s_barrier
 s_add_u32 s53, s35, 2097152
 s_add_u32 m0, s37, 16384
 s_add_u32 s38, s53, 0
 buffer_load_dwordx4 v20, s[20:23], s38 offen lds
 s_add_u32 m0, s37, 17408
 s_add_u32 s38, s53, 65536
 buffer_load_dwordx4 v27, s[20:23], s38 offen lds
 s_add_u32 m0, s37, 18432
 s_add_u32 s38, s53, 131072
 buffer_load_dwordx4 v20, s[20:23], s38 offen lds
 s_add_u32 m0, s37, 19456
 s_add_u32 s38, s53, 196608
 buffer_load_dwordx4 v27, s[20:23], s38 offen lds
 ds_read_b64_tr_b16 a[32:33], v48 offset:8192
 ds_read_b64_tr_b16 a[34:35], v49 offset:8192
 ds_read_b64_tr_b16 a[36:37], v50 offset:0
 ds_read_b64_tr_b16 a[38:39], v51 offset:12288
 ds_read_b64_tr_b16 a[40:41], v52 offset:8192
 ds_read_b64_tr_b16 a[42:43], v53 offset:8192
 ds_read_b64_tr_b16 a[44:45], v54 offset:0
 ds_read_b64_tr_b16 a[46:47], v55 offset:12288
 s_waitcnt lgkmcnt(0)
 s_waitcnt vmcnt(32)
 s_barrier
 s_add_u32 s53, s35, 1048576
 s_add_u32 m0, s37, 12288
 s_add_u32 s38, s53, 0
 buffer_load_dwordx4 v20, s[20:23], s38 offen lds
 s_add_u32 m0, s37, 13312
 s_add_u32 s38, s53, 65536
 buffer_load_dwordx4 v27, s[20:23], s38 offen lds
 s_add_u32 m0, s37, 14336
 s_add_u32 s38, s53, 131072
 buffer_load_dwordx4 v20, s[20:23], s38 offen lds
 s_add_u32 m0, s37, 15360
 s_add_u32 s38, s53, 196608
 buffer_load_dwordx4 v27, s[20:23], s38 offen lds
 ds_read_b64_tr_b16 a[144:145], v48 offset:16384
 ds_read_b64_tr_b16 a[146:147], v49 offset:4096
 ds_read_b64_tr_b16 a[148:149], v50 offset:16384
 ds_read_b64_tr_b16 a[150:151], v51 offset:8192
 ds_read_b64_tr_b16 a[152:153], v52 offset:16384
 ds_read_b64_tr_b16 a[154:155], v53 offset:4096
 ds_read_b64_tr_b16 a[156:157], v54 offset:16384
 ds_read_b64_tr_b16 a[158:159], v55 offset:8192
 s_waitcnt lgkmcnt(0)
 s_waitcnt vmcnt(32)
 s_barrier
 s_add_u32 s53, s35, 3145728
 s_add_u32 m0, s37, 8192
 s_add_u32 s38, s53, 0
 buffer_load_dwordx4 v20, s[16:19], s38 offen lds
 s_add_u32 m0, s37, 9216
 s_add_u32 s38, s53, 65536
 buffer_load_dwordx4 v27, s[16:19], s38 offen lds
 s_add_u32 m0, s37, 10240
 s_add_u32 s38, s53, 131072
 buffer_load_dwordx4 v20, s[16:19], s38 offen lds
 s_add_u32 m0, s37, 11264
 s_add_u32 s38, s53, 196608
 buffer_load_dwordx4 v27, s[16:19], s38 offen lds
 ds_read_b64_tr_b16 a[160:161], v48 offset:4096
 ds_read_b64_tr_b16 a[162:163], v49 offset:16384
 ds_read_b64_tr_b16 a[164:165], v50 offset:8192
 ds_read_b64_tr_b16 a[166:167], v51 offset:0
 ds_read_b64_tr_b16 a[168:169], v52 offset:4096
 ds_read_b64_tr_b16 a[170:171], v53 offset:16384
 ds_read_b64_tr_b16 a[172:173], v54 offset:8192
 ds_read_b64_tr_b16 a[174:175], v55 offset:0
 s_waitcnt lgkmcnt(0)
 s_waitcnt vmcnt(32)
 s_barrier
 s_add_u32 s53, s35, 0
 s_add_u32 m0, s37, 0
 s_add_u32 s38, s53, 0
 buffer_load_dwordx4 v20, s[24:27], s38 offen lds
 s_add_u32 m0, s37, 1024
 s_add_u32 s38, s53, 65536
 buffer_load_dwordx4 v27, s[24:27], s38 offen lds
 s_add_u32 m0, s37, 2048
 s_add_u32 s38, s53, 131072
 buffer_load_dwordx4 v20, s[24:27], s38 offen lds
 s_add_u32 m0, s37, 3072
 s_add_u32 s38, s53, 196608
 buffer_load_dwordx4 v27, s[24:27], s38 offen lds
 ds_read_b64_tr_b16 a[80:81], v48 offset:12288
 ds_read_b64_tr_b16 a[82:83], v49 offset:0
 ds_read_b64_tr_b16 a[84:85], v50 offset:4096
 ds_read_b64_tr_b16 a[86:87], v51 offset:4096
 ds_read_b64_tr_b16 a[88:89], v52 offset:12288
 ds_read_b64_tr_b16 a[90:91], v53 offset:0
 ds_read_b64_tr_b16 a[92:93], v54 offset:4096
 ds_read_b64_tr_b16 a[94:95], v55 offset:4096
 s_waitcnt lgkmcnt(0)
 s_waitcnt vmcnt(32)
 s_barrier
 s_add_u32 s53, s35, 0
 s_add_u32 m0, s37, 4096
 s_add_u32 s38, s53, 0
 buffer_load_dwordx4 v20, s[20:23], s38 offen lds
 s_add_u32 m0, s37, 5120
 s_add_u32 s38, s53, 65536
 buffer_load_dwordx4 v27, s[20:23], s38 offen lds
 s_add_u32 m0, s37, 6144
 s_add_u32 s38, s53, 131072
 buffer_load_dwordx4 v20, s[20:23], s38 offen lds
 s_add_u32 m0, s37, 7168
 s_add_u32 s38, s53, 196608
 buffer_load_dwordx4 v27, s[20:23], s38 offen lds
 ds_read_b64_tr_b16 a[96:97], v48 offset:20480
 ds_read_b64_tr_b16 a[98:99], v49 offset:20480
 ds_read_b64_tr_b16 a[100:101], v50 offset:20480
 ds_read_b64_tr_b16 a[102:103], v51 offset:20480
 ds_read_b64_tr_b16 a[104:105], v52 offset:20480
 ds_read_b64_tr_b16 a[106:107], v53 offset:20480
 ds_read_b64_tr_b16 a[108:109], v54 offset:20480
 ds_read_b64_tr_b16 a[110:111], v55 offset:20480
 s_waitcnt lgkmcnt(0)
 s_waitcnt vmcnt(32)
 s_barrier
 s_add_u32 s53, s35, 1048576
 s_add_u32 m0, s37, 20480
 s_add_u32 s38, s53, 0
 buffer_load_dwordx4 v20, s[24:27], s38 offen lds
 s_add_u32 m0, s37, 21504
 s_add_u32 s38, s53, 65536
 buffer_load_dwordx4 v27, s[24:27], s38 offen lds
 s_add_u32 m0, s37, 22528
 s_add_u32 s38, s53, 131072
 buffer_load_dwordx4 v20, s[24:27], s38 offen lds
 s_add_u32 m0, s37, 23552
 s_add_u32 s38, s53, 196608
 buffer_load_dwordx4 v27, s[24:27], s38 offen lds
 ds_read_b64_tr_b16 v[80:81], v48 offset:24576
 ds_read_b64_tr_b16 v[82:83], v49 offset:24576
 ds_read_b64_tr_b16 v[84:85], v50 offset:24576
 ds_read_b64_tr_b16 v[86:87], v51 offset:24576
 ds_read_b64_tr_b16 v[88:89], v52 offset:24576
 ds_read_b64_tr_b16 v[90:91], v53 offset:24576
 ds_read_b64_tr_b16 v[92:93], v54 offset:24576
 ds_read_b64_tr_b16 v[94:95], v55 offset:24576
 s_waitcnt lgkmcnt(0)
 s_waitcnt vmcnt(32)
 s_barrier
 s_add_u32 s53, s35, 3670016
 s_add_u32 m0, s37, 24576
 s_add_u32 s38, s53, 0
 buffer_load_dwordx4 v20, s[20:23], s38 offen lds
 s_add_u32 m0, s37, 25600
 s_add_u32 s38, s53, 65536
 buffer_load_dwordx4 v27, s[20:23], s38 offen lds
 s_add_u32 m0, s37, 26624
 s_add_u32 s38, s53, 131072
 buffer_load_dwordx4 v20, s[20:23], s38 offen lds
 s_add_u32 m0, s37, 27648
 s_add_u32 s38, s53, 196608
 buffer_load_dwordx4 v27, s[20:23], s38 offen lds
 ds_read_b64_tr_b16 a[48:49], v48 offset:28672
 ds_read_b64_tr_b16 a[50:51], v49 offset:28672
 ds_read_b64_tr_b16 a[52:53], v50 offset:28672
 ds_read_b64_tr_b16 a[54:55], v51 offset:28672
 ds_read_b64_tr_b16 a[56:57], v52 offset:28672
 ds_read_b64_tr_b16 a[58:59], v53 offset:28672
 ds_read_b64_tr_b16 a[60:61], v54 offset:28672
 ds_read_b64_tr_b16 a[62:63], v55 offset:28672
 s_waitcnt lgkmcnt(0)
 s_waitcnt vmcnt(32)
 s_barrier
 s_add_u32 s53, s35, 2097152
 s_add_u32 m0, s37, 28672
 s_add_u32 s38, s53, 0
 buffer_load_dwordx4 v20, s[16:19], s38 offen lds
 s_add_u32 m0, s37, 29696
 s_add_u32 s38, s53, 65536
 buffer_load_dwordx4 v27, s[16:19], s38 offen lds
 s_add_u32 m0, s37, 30720
 s_add_u32 s38, s53, 131072
 buffer_load_dwordx4 v20, s[16:19], s38 offen lds
 s_add_u32 m0, s37, 31744
 s_add_u32 s38, s53, 196608
 buffer_load_dwordx4 v27, s[16:19], s38 offen lds
 ds_read_b64_tr_b16 a[128:129], v48 offset:32768
 ds_read_b64_tr_b16 a[130:131], v49 offset:32768
 ds_read_b64_tr_b16 a[132:133], v50 offset:32768
 ds_read_b64_tr_b16 a[134:135], v51 offset:32768
 ds_read_b64_tr_b16 a[136:137], v52 offset:32768
 ds_read_b64_tr_b16 a[138:139], v53 offset:32768
 ds_read_b64_tr_b16 a[140:141], v54 offset:32768
 ds_read_b64_tr_b16 a[142:143], v55 offset:32768
 s_waitcnt lgkmcnt(0)
 s_waitcnt vmcnt(32)
 s_barrier
 s_add_u32 s53, s35, 524288
 s_add_u32 m0, s37, 32768
 s_add_u32 s38, s53, 0
 buffer_load_dwordx4 v20, s[20:23], s38 offen lds
 s_add_u32 m0, s37, 33792
 s_add_u32 s38, s53, 65536
 buffer_load_dwordx4 v27, s[20:23], s38 offen lds
 s_add_u32 m0, s37, 34816
 s_add_u32 s38, s53, 131072
 buffer_load_dwordx4 v20, s[20:23], s38 offen lds
 s_add_u32 m0, s37, 35840
 s_add_u32 s38, s53, 196608
 buffer_load_dwordx4 v27, s[20:23], s38 offen lds
 ds_read_b64_tr_b16 a[176:177], v60 offset:0
 ds_read_b64_tr_b16 a[178:179], v60 offset:4096
 ds_read_b64_tr_b16 a[180:181], v60 offset:8192
 ds_read_b64_tr_b16 a[182:183], v60 offset:12288
 ds_read_b64_tr_b16 a[184:185], v61 offset:0
 ds_read_b64_tr_b16 a[186:187], v61 offset:4096
 ds_read_b64_tr_b16 a[188:189], v61 offset:8192
 ds_read_b64_tr_b16 a[190:191], v61 offset:12288
 s_waitcnt lgkmcnt(0)
 s_waitcnt vmcnt(32)
 s_barrier
 s_add_u32 s53, s35, 2621440
 s_mov_b32 m0, 12288
 s_add_u32 s38, s53, 0
 buffer_load_dwordx4 v20, s[24:27], s38 offen lds
 s_mov_b32 m0, 13312
 s_add_u32 s38, s53, 65536
 buffer_load_dwordx4 v27, s[24:27], s38 offen lds
 s_mov_b32 m0, 14336
 s_add_u32 s38, s53, 131072
 buffer_load_dwordx4 v20, s[24:27], s38 offen lds
 s_mov_b32 m0, 15360
 s_add_u32 s38, s53, 196608
 buffer_load_dwordx4 v27, s[24:27], s38 offen lds
 ds_read_b64_tr_b16 a[0:1], v48 offset:4096
 ds_read_b64_tr_b16 a[2:3], v49 offset:8192
 ds_read_b64_tr_b16 a[4:5], v50 offset:12288
 ds_read_b64_tr_b16 a[6:7], v51 offset:16384
 ds_read_b64_tr_b16 a[8:9], v52 offset:4096
 ds_read_b64_tr_b16 a[10:11], v53 offset:8192
 ds_read_b64_tr_b16 a[12:13], v54 offset:12288
 ds_read_b64_tr_b16 a[14:15], v55 offset:16384
 s_waitcnt lgkmcnt(0)
 s_waitcnt vmcnt(32)
 s_barrier
 buffer_load_dword v71, v74, s[8:11], 0 offen offset:64 sc1
 ds_read_b64_tr_b16 v[96:97], v48 offset:12288
 ds_read_b64_tr_b16 v[98:99], v49 offset:4096
 ds_read_b64_tr_b16 v[100:101], v50 offset:0
 ds_read_b64_tr_b16 v[102:103], v51 offset:12288
 ds_read_b64_tr_b16 v[104:105], v52 offset:12288
 ds_read_b64_tr_b16 v[106:107], v53 offset:4096
 ds_read_b64_tr_b16 v[108:109], v54 offset:0
 ds_read_b64_tr_b16 v[110:111], v55 offset:12288
 s_waitcnt lgkmcnt(0)
 s_waitcnt vmcnt(29)
 s_barrier
 ds_read_b64_tr_b16 a[112:113], v48 offset:20480
 ds_read_b64_tr_b16 a[114:115], v49 offset:16384
 ds_read_b64_tr_b16 a[116:117], v50 offset:16384
 ds_read_b64_tr_b16 a[118:119], v51 offset:8192
 ds_read_b64_tr_b16 a[120:121], v52 offset:20480
 ds_read_b64_tr_b16 a[122:123], v53 offset:16384
 ds_read_b64_tr_b16 a[124:125], v54 offset:16384
 ds_read_b64_tr_b16 a[126:127], v55 offset:8192
 s_waitcnt lgkmcnt(0)
 s_waitcnt vmcnt(25)
 s_barrier
 ds_read_b64_tr_b16 v[32:33], v48 offset:24576
 ds_read_b64_tr_b16 v[34:35], v49 offset:0
 ds_read_b64_tr_b16 v[36:37], v50 offset:8192
 ds_read_b64_tr_b16 v[38:39], v51 offset:0
 ds_read_b64_tr_b16 v[40:41], v52 offset:24576
 ds_read_b64_tr_b16 v[42:43], v53 offset:0
 ds_read_b64_tr_b16 v[44:45], v54 offset:8192
 ds_read_b64_tr_b16 v[46:47], v55 offset:0
 s_waitcnt lgkmcnt(0)
 s_waitcnt vmcnt(21)
 s_barrier
 ds_write_b128 v1, v[32:35] offset:16384
 ds_write_b128 v1, v[36:39] offset:17408
 ds_write_b128 v1, v[40:43] offset:18432
 ds_write_b128 v1, v[44:47] offset:19456
 ds_read_b64_tr_b16 v[32:33], v48 offset:28672
 ds_read_b64_tr_b16 v[34:35], v49 offset:20480
 ds_read_b64_tr_b16 v[36:37], v50 offset:4096
 ds_read_b64_tr_b16 v[38:39], v51 offset:4096
 ds_read_b64_tr_b16 v[40:41], v52 offset:28672
 ds_read_b64_tr_b16 v[42:43], v53 offset:20480
 ds_read_b64_tr_b16 v[44:45], v54 offset:4096
 ds_read_b64_tr_b16 v[46:47], v55 offset:4096
 s_waitcnt lgkmcnt(0)
 s_waitcnt vmcnt(17)
 s_barrier
 ds_write_b128 v1, v[32:35] offset:12288
 ds_write_b128 v1, v[36:39] offset:13312
 ds_write_b128 v1, v[40:43] offset:14336
 ds_write_b128 v1, v[44:47] offset:15360
 s_add_u32 s53, s35, 4194304
 s_add_u32 m0, s37, 4096
 s_add_u32 s38, s53, 0
 buffer_load_dwordx4 v20, s[20:23], s38 offen lds
 s_add_u32 m0, s37, 5120
 s_add_u32 s38, s53, 65536
 buffer_load_dwordx4 v27, s[20:23], s38 offen lds
 s_add_u32 m0, s37, 6144
 s_add_u32 s38, s53, 131072
 buffer_load_dwordx4 v20, s[20:23], s38 offen lds
 s_add_u32 m0, s37, 7168
 s_add_u32 s38, s53, 196608
 buffer_load_dwordx4 v27, s[20:23], s38 offen lds
 ds_read_b64_tr_b16 v[112:113], v48 offset:32768
 ds_read_b64_tr_b16 v[114:115], v49 offset:24576
 ds_read_b64_tr_b16 v[116:117], v50 offset:20480
 ds_read_b64_tr_b16 v[118:119], v51 offset:20480
 ds_read_b64_tr_b16 v[120:121], v52 offset:32768
 ds_read_b64_tr_b16 v[122:123], v53 offset:24576
 ds_read_b64_tr_b16 v[124:125], v54 offset:20480
 ds_read_b64_tr_b16 v[126:127], v55 offset:20480
 s_waitcnt lgkmcnt(0)
 s_waitcnt vmcnt(17)
 s_barrier
 s_add_u32 s53, s35, 0
 s_add_u32 m0, s37, 20480
 s_add_u32 s38, s53, 0
 buffer_load_dwordx4 v20, s[16:19], s38 offen lds
 s_add_u32 m0, s37, 21504
 s_add_u32 s38, s53, 65536
 buffer_load_dwordx4 v27, s[16:19], s38 offen lds
 s_add_u32 m0, s37, 22528
 s_add_u32 s38, s53, 131072
 buffer_load_dwordx4 v20, s[16:19], s38 offen lds
 s_add_u32 m0, s37, 23552
 s_add_u32 s38, s53, 196608
 buffer_load_dwordx4 v27, s[16:19], s38 offen lds
 ds_read_b64_tr_b16 v[32:33], v60 offset:0
 ds_read_b64_tr_b16 v[34:35], v49 offset:28672
 ds_read_b64_tr_b16 v[36:37], v50 offset:24576
 ds_read_b64_tr_b16 v[38:39], v51 offset:24576
 ds_read_b64_tr_b16 v[40:41], v61 offset:0
 ds_read_b64_tr_b16 v[42:43], v53 offset:28672
 ds_read_b64_tr_b16 v[44:45], v54 offset:24576
 ds_read_b64_tr_b16 v[46:47], v55 offset:24576
 s_waitcnt lgkmcnt(0)
 s_waitcnt vmcnt(17)
 s_barrier
 ds_write_b128 v1, v[32:35] offset:8192
 ds_write_b128 v1, v[36:39] offset:9216
 ds_write_b128 v1, v[40:43] offset:10240
 ds_write_b128 v1, v[44:47] offset:11264
 s_add_u32 s53, s36, 512
 s_add_u32 m0, s37, 24576
 s_add_u32 s38, s53, 0
 buffer_load_dwordx4 v21, s[28:31], s38 offen lds
 s_add_u32 m0, s37, 25600
 s_add_u32 s38, s53, 4608
 buffer_load_dwordx4 v21, s[28:31], s38 offen lds
 s_add_u32 m0, s37, 26624
 s_add_u32 s38, s53, 36864
 buffer_load_dwordx4 v21, s[28:31], s38 offen lds
 s_add_u32 m0, s37, 27648
 s_add_u32 s38, s53, 41472
 buffer_load_dwordx4 v21, s[28:31], s38 offen lds
 ds_read_b64_tr_b16 v[32:33], v48 offset:20480
 ds_read_b64_tr_b16 v[34:35], v49 offset:32768
 ds_read_b64_tr_b16 v[36:37], v50 offset:28672
 ds_read_b64_tr_b16 v[38:39], v51 offset:28672
 ds_read_b64_tr_b16 v[40:41], v52 offset:20480
 ds_read_b64_tr_b16 v[42:43], v53 offset:32768
 ds_read_b64_tr_b16 v[44:45], v54 offset:28672
 ds_read_b64_tr_b16 v[46:47], v55 offset:28672
 s_waitcnt lgkmcnt(0)
 s_waitcnt vmcnt(17)
 s_barrier
 ds_write_b128 v1, v[32:35] offset:0
 ds_write_b128 v1, v[36:39] offset:1024
 ds_write_b128 v1, v[40:43] offset:2048
 ds_write_b128 v1, v[44:47] offset:3072
 s_add_u32 s53, s36, 74240
 s_add_u32 m0, s37, 28672
 s_add_u32 s38, s53, 0
 buffer_load_dwordx4 v21, s[28:31], s38 offen lds
 s_add_u32 m0, s37, 29696
 s_add_u32 s38, s53, 4608
 buffer_load_dwordx4 v21, s[28:31], s38 offen lds
 s_add_u32 m0, s37, 30720
 s_add_u32 s38, s53, 36864
 buffer_load_dwordx4 v21, s[28:31], s38 offen lds
 s_add_u32 m0, s37, 31744
 s_add_u32 s38, s53, 41472
 buffer_load_dwordx4 v21, s[28:31], s38 offen lds
 ds_read_b64_tr_b16 a[224:225], v48 offset:24576
 ds_read_b64_tr_b16 a[226:227], v60 offset:4096
 ds_read_b64_tr_b16 a[228:229], v50 offset:32768
 ds_read_b64_tr_b16 a[230:231], v51 offset:32768
 ds_read_b64_tr_b16 a[232:233], v52 offset:24576
 ds_read_b64_tr_b16 a[234:235], v61 offset:4096
 ds_read_b64_tr_b16 a[236:237], v54 offset:32768
 ds_read_b64_tr_b16 a[238:239], v55 offset:32768
 s_waitcnt lgkmcnt(0)
 s_waitcnt vmcnt(17)
 s_barrier
 s_add_u32 s53, s36, 768
 s_add_u32 m0, s37, 32768
 s_add_u32 s38, s53, 0
 buffer_load_dwordx4 v21, s[28:31], s38 offen lds
 s_add_u32 m0, s37, 33792
 s_add_u32 s38, s53, 4608
 buffer_load_dwordx4 v21, s[28:31], s38 offen lds
 s_add_u32 m0, s37, 34816
 s_add_u32 s38, s53, 36864
 buffer_load_dwordx4 v21, s[28:31], s38 offen lds
 s_add_u32 m0, s37, 35840
 s_add_u32 s38, s53, 41472
 buffer_load_dwordx4 v21, s[28:31], s38 offen lds
 ds_read_b64_tr_b16 a[64:65], v48 offset:28672
 ds_read_b64_tr_b16 a[66:67], v49 offset:16384
 ds_read_b64_tr_b16 a[68:69], v60 offset:8192
 ds_read_b64_tr_b16 a[70:71], v60 offset:12288
 ds_read_b64_tr_b16 a[72:73], v52 offset:28672
 ds_read_b64_tr_b16 a[74:75], v53 offset:16384
 ds_read_b64_tr_b16 a[76:77], v61 offset:8192
 ds_read_b64_tr_b16 a[78:79], v61 offset:12288
 s_waitcnt lgkmcnt(0)
 s_waitcnt vmcnt(16)
 s_barrier
 v_readfirstlane_b32 s38, v71
 s_lshr_b32 s45, s38, 16
 s_and_b32 s38, s38, 0xffff
 s_cmp_ge_u32 s38, 32
 s_cselect_b32 s44, 1, 0
 s_cbranch_scc0 L_kv091
 s_lshl_b32 s38, s40, 2
 s_add_u32 s38, s38, 0
 s_mov_b64 exec, 3
 buffer_load_dword v73, v75, s[4:7], s38 offen sc1
 s_mov_b64 exec, -1
L_kv091:
 buffer_load_dwordx4 v[8:11], v72, s[76:79], 0 offen offset:512
 buffer_load_dwordx4 v[12:15], v72, s[76:79], 0 offen offset:640
 buffer_load_dwordx4 v[16:19], v72, s[76:79], 0 offen offset:1024
 s_add_u32 s53, s36, 74496
 s_mov_b32 m0, 12288
 s_add_u32 s38, s53, 0
 buffer_load_dwordx4 v21, s[28:31], s38 offen lds
 s_mov_b32 m0, 13312
 s_add_u32 s38, s53, 4608
 buffer_load_dwordx4 v21, s[28:31], s38 offen lds
 s_mov_b32 m0, 14336
 s_add_u32 s38, s53, 36864
 buffer_load_dwordx4 v21, s[28:31], s38 offen lds
 s_mov_b32 m0, 15360
 s_add_u32 s38, s53, 41472
 buffer_load_dwordx4 v21, s[28:31], s38 offen lds
 ds_read_b64_tr_b16 v[32:33], v48 offset:32768
 ds_read_b64_tr_b16 v[34:35], v49 offset:0
 ds_read_b64_tr_b16 v[36:37], v50 offset:4096
 ds_read_b64_tr_b16 v[38:39], v51 offset:4096
 ds_read_b64_tr_b16 v[40:41], v52 offset:32768
 ds_read_b64_tr_b16 v[42:43], v53 offset:0
 ds_read_b64_tr_b16 v[44:45], v54 offset:4096
 ds_read_b64_tr_b16 v[46:47], v55 offset:4096
 s_waitcnt lgkmcnt(0)
 s_waitcnt vmcnt(19)
 s_barrier
 ds_write_b128 v1, v[32:35] offset:4096
 ds_write_b128 v1, v[36:39] offset:5120
 ds_write_b128 v1, v[40:43] offset:6144
 ds_write_b128 v1, v[44:47] offset:7168
 ds_read_b64_tr_b16 a[192:193], v60 offset:0
 ds_read_b64_tr_b16 a[194:195], v49 offset:20480
 ds_read_b64_tr_b16 a[196:197], v50 offset:20480
 ds_read_b64_tr_b16 a[198:199], v51 offset:20480
 ds_read_b64_tr_b16 a[200:201], v61 offset:0
 ds_read_b64_tr_b16 a[202:203], v53 offset:20480
 ds_read_b64_tr_b16 a[204:205], v54 offset:20480
 ds_read_b64_tr_b16 a[206:207], v55 offset:20480
 s_waitcnt lgkmcnt(0)
 s_waitcnt vmcnt(15)
 s_barrier
 ds_read_b64_tr_b16 v[32:33], v56 offset:20480
 ds_read_b64_tr_b16 v[34:35], v57 offset:24576
 ds_read_b64_tr_b16 v[36:37], v58 offset:24576
 ds_read_b64_tr_b16 v[38:39], v59 offset:24576
 ds_read_b64_tr_b16 v[40:41], v56 offset:22528
 ds_read_b64_tr_b16 v[42:43], v57 offset:26624
 ds_read_b64_tr_b16 v[44:45], v58 offset:26624
 ds_read_b64_tr_b16 v[46:47], v59 offset:26624
 s_waitcnt lgkmcnt(0)
 s_waitcnt vmcnt(11)
 s_barrier
 ds_write_b128 v1, v[32:35] offset:20480
 ds_write_b128 v1, v[36:39] offset:21504
 ds_write_b128 v1, v[40:43] offset:22528
 ds_write_b128 v1, v[44:47] offset:23552
 ds_read_b64_tr_b16 v[32:33], v56 offset:24576
 ds_read_b64_tr_b16 v[34:35], v57 offset:28672
 ds_read_b64_tr_b16 v[36:37], v58 offset:28672
 ds_read_b64_tr_b16 v[38:39], v59 offset:28672
 ds_read_b64_tr_b16 v[40:41], v56 offset:26624
 ds_read_b64_tr_b16 v[42:43], v57 offset:30720
 ds_read_b64_tr_b16 v[44:45], v58 offset:30720
 ds_read_b64_tr_b16 v[46:47], v59 offset:30720
 s_waitcnt lgkmcnt(0)
 s_waitcnt vmcnt(7)
 s_barrier
 ds_write_b128 v1, v[32:35] offset:24576
 ds_write_b128 v1, v[36:39] offset:25600
 ds_write_b128 v1, v[40:43] offset:26624
 ds_write_b128 v1, v[44:47] offset:27648
 ds_read_b64_tr_b16 v[32:33], v56 offset:28672
 ds_read_b64_tr_b16 v[34:35], v57 offset:32768
 ds_read_b64_tr_b16 v[36:37], v58 offset:32768
 ds_read_b64_tr_b16 v[38:39], v59 offset:32768
 ds_read_b64_tr_b16 v[40:41], v56 offset:30720
 ds_read_b64_tr_b16 v[42:43], v57 offset:34816
 ds_read_b64_tr_b16 v[44:45], v58 offset:34816
 ds_read_b64_tr_b16 v[46:47], v59 offset:34816
 s_waitcnt lgkmcnt(0)
 s_waitcnt vmcnt(0)
 s_barrier
 ds_write_b128 v1, v[32:35] offset:28672
 ds_write_b128 v1, v[36:39] offset:29696
 ds_write_b128 v1, v[40:43] offset:30720
 ds_write_b128 v1, v[44:47] offset:31744
 ds_read_b64_tr_b16 v[32:33], v56 offset:32768
 ds_read_b64_tr_b16 v[34:35], v62 offset:4096
 ds_read_b64_tr_b16 v[36:37], v62 offset:8192
 ds_read_b64_tr_b16 v[38:39], v62 offset:12288
 ds_read_b64_tr_b16 v[40:41], v56 offset:34816
 ds_read_b64_tr_b16 v[42:43], v62 offset:6144
 ds_read_b64_tr_b16 v[44:45], v62 offset:10240
 ds_read_b64_tr_b16 v[46:47], v62 offset:14336
 s_waitcnt lgkmcnt(0)
 s_barrier
 ds_write_b128 v1, v[32:35] offset:32768
 ds_write_b128 v1, v[36:39] offset:33792
 ds_write_b128 v1, v[40:43] offset:34816
 ds_write_b128 v1, v[44:47] offset:35840
 ds_write_b128 v0, v[8:11] offset:4096
 ds_write_b128 v0, v[12:15] offset:5120
 ds_write_b128 v0, v[16:19] offset:8192
 s_waitcnt lgkmcnt(0)
 s_cmp_eq_u32 s44, 1
 s_cbranch_scc1 L_eok92
 v_mov_b32 v76, 32
poll94:
 buffer_load_dword v77, v74, s[8:11], 0 offen offset:64 sc1
 s_waitcnt vmcnt(0)
 v_and_b32 v78, 0xffff, v77
 v_cmp_le_u32 vcc, v76, v78
 s_cmp_eq_u64 vcc, exec
 s_cbranch_scc1 polld95
 s_cmp_eq_u32 s15, 0
 s_cbranch_scc1 polld95
 s_sub_u32 s15, s15, 1
 s_sleep 6
 s_branch poll94
polld95:
 v_readfirstlane_b32 s45, v77
 s_lshr_b32 s45, s45, 16
 s_branch L_edn93
L_eok92:
 v_readlane_b32 s50, v73, 0
 v_readlane_b32 s51, v73, 1
L_edn93:
 s_mov_b32 s32, s45
L_wl70:
 s_mov_b32 s41, 0
 s_mov_b32 s42, 0
 s_mov_b32 s43, 9216
 s_mov_b32 s44, 18432
 s_mov_b32 s47, 0
 s_cmp_lg_u32 s32, 0
 s_cbranch_scc1 L_cdf
L_cdl:
 s_cmp_eq_u32 s14, 3
 s_cbranch_scc1 L_celio
 s_cmp_eq_u32 s14, 1
 s_cbranch_scc1 L_celr1
 s_cmp_eq_u32 s14, 0
 s_cbranch_scc1 L_celr0
 s_cmp_lt_u32 s40, 8
 s_cbranch_scc1 L_celr2
 s_branch L_celn2
L_celr0:
 v_mov_b64 v[40:41], 0
 v_mov_b64 v[42:43], 0
 v_mov_b64 v[44:45], 0
 v_mov_b64 v[46:47], 0
 v_mov_b64 v[48:49], 0
 v_mov_b64 v[50:51], 0
 v_mov_b64 v[52:53], 0
 v_mov_b64 v[54:55], 0
 v_mov_b64 v[56:57], 0
 v_mov_b64 v[58:59], 0
 v_mov_b64 v[60:61], 0
 v_mov_b64 v[62:63], 0
 ds_read_b128 v[24:27], v1 offset:0
 ds_read_b128 v[28:31], v1 offset:1024
 ds_read_b128 v[32:35], v1 offset:2048
 ds_read_b128 v[36:39], v1 offset:3072
 s_barrier
 s_add_u32 s34, s58, 4194304
 s_add_u32 s35, s58, 20971520
 buffer_load_dwordx4 v[64:67], v0, s[4:7], s34 offen offset:0
 buffer_load_dwordx4 v[68:71], v0, s[4:7], s34 offen offset:1024
 buffer_load_dwordx4 v[72:75], v0, s[4:7], s35 offen offset:0
 buffer_load_dwordx4 v[76:79], v0, s[4:7], s35 offen offset:1024
 s_add_u32 s37, s49, 294912
 s_branch L_b1lr0
L_cslr0:
 s_xor_b32 s37, s47, 294912
 s_add_u32 s37, s37, s49
 buffer_load_dwordx4 v[8:11], v0, s[4:7], s37 offen offset:0 sc1
 buffer_load_dwordx4 v[12:15], v0, s[4:7], s37 offen offset:1024 sc1
 buffer_load_dwordx4 v[16:19], v0, s[4:7], s37 offen offset:2048 sc1
 buffer_load_dwordx4 v[20:23], v0, s[4:7], s37 offen offset:3072 sc1
 s_add_u32 s34, s46, s42
 v_and_b32 v54, 64, v0
 v_lshrrev_b32 v54, 2, v54
 v_mov_b32 v55, 0x3f80
 v_lshlrev_b32 v54, v54, v55
 v_cndmask_b32 v56, 0, v54, s[62:63]
 v_cndmask_b32 v57, 0, v54, s[64:65]
 v_cndmask_b32 v58, 0, v54, s[66:67]
 v_cndmask_b32 v59, 0, v54, s[68:69]
 v_mov_b64 v[40:41], 0
 v_mov_b64 v[42:43], 0
 v_mov_b64 v[44:45], 0
 v_mov_b64 v[46:47], 0
 v_mov_b64 v[48:49], 0
 v_mov_b64 v[50:51], 0
 v_mov_b64 v[52:53], 0
 s_add_u32 s35, s58, 4194304
 s_add_u32 s36, s58, 20971520
 buffer_load_dwordx4 v[64:67], v0, s[4:7], s35 offen offset:0
 buffer_load_dwordx4 v[68:71], v0, s[4:7], s35 offen offset:1024
 buffer_load_dwordx4 v[72:75], v0, s[4:7], s36 offen offset:0
 buffer_load_dwordx4 v[76:79], v0, s[4:7], s36 offen offset:1024
 s_waitcnt vmcnt(7)
 v_mfma_f32_16x16x32_bf16 v[60:63], v[56:59], v[8:11], 0
 v_bitop3_b32 v54, v8, v10, s45 bitop3:0x7e
 s_waitcnt vmcnt(6)
 v_mfma_f32_16x16x32_bf16 v[60:63], v[56:59], v[12:15], v[60:63]
 v_bitop3_b32 v55, v12, v14, s45 bitop3:0x7e
 s_waitcnt vmcnt(5)
 v_mfma_f32_16x16x32_bf16 v[60:63], v[56:59], v[16:19], v[60:63]
 v_or_b32 v54, v54, v55
 v_bitop3_b32 v55, v16, v18, s45 bitop3:0x7e
 s_waitcnt vmcnt(4)
 v_mfma_f32_16x16x32_bf16 v[60:63], v[56:59], v[20:23], v[60:63]
 v_or_b32 v54, v54, v55
 v_bitop3_b32 v55, v20, v22, s45 bitop3:0x7e
 v_bitop3_b32 v54, v54, v55, 1 bitop3:0xa8
 v_cmp_ne_u32 vcc, 0, v54
 s_cmp_eq_u64 vcc, 0
 s_cbranch_scc1 L_rpdlr0
L_rplr0:
 s_cmp_eq_u32 s15, 0
 s_cbranch_scc1 L_rpdlr0
 s_sub_u32 s15, s15, 1
 buffer_load_dwordx4 v[8:11], v0, s[4:7], s37 offen offset:0 sc1
 buffer_load_dwordx4 v[12:15], v0, s[4:7], s37 offen offset:1024 sc1
 buffer_load_dwordx4 v[16:19], v0, s[4:7], s37 offen offset:2048 sc1
 buffer_load_dwordx4 v[20:23], v0, s[4:7], s37 offen offset:3072 sc1
 s_waitcnt vmcnt(3)
 v_mfma_f32_16x16x32_bf16 v[60:63], v[56:59], v[8:11], 0
 v_bitop3_b32 v54, v8, v10, s45 bitop3:0x7e
 s_waitcnt vmcnt(2)
 v_mfma_f32_16x16x32_bf16 v[60:63], v[56:59], v[12:15], v[60:63]
 v_bitop3_b32 v55, v12, v14, s45 bitop3:0x7e
 s_waitcnt vmcnt(1)
 v_mfma_f32_16x16x32_bf16 v[60:63], v[56:59], v[16:19], v[60:63]
 v_or_b32 v54, v54, v55
 v_bitop3_b32 v55, v16, v18, s45 bitop3:0x7e
 s_waitcnt vmcnt(0)
 v_mfma_f32_16x16x32_bf16 v[60:63], v[56:59], v[20:23], v[60:63]
 v_or_b32 v54, v54, v55
 v_bitop3_b32 v55, v20, v22, s45 bitop3:0x7e
 v_bitop3_b32 v54, v54, v55, 1 bitop3:0xa8
 v_cmp_ne_u32 vcc, 0, v54
 s_cmp_eq_u64 vcc, 0
 s_cbranch_scc0 L_rplr0
L_rpdlr0:
 s_nop 1
 v_add_f32_dpp v60, v60, v60 row_ror:8 row_mask:0xf bank_mask:0xf
 v_add_f32_dpp v61, v61, v61 row_ror:8 row_mask:0xf bank_mask:0xf
 v_cvt_pk_bf16_f32 v60, v60, v61
 buffer_store_dword v60, v4, s[4:7], s34 offen
 s_barrier
 s_add_u32 s33, s42, 159385600
 v_mov_b64 v[54:55], 0
 v_mov_b64 v[56:57], 0
 v_mov_b64 v[58:59], 0
 v_mov_b64 v[60:61], 0
 v_mov_b64 v[62:63], 0
 ds_read_b128 v[24:27], v1 offset:0
 ds_read_b128 v[28:31], v1 offset:1024
 ds_read_b128 v[32:35], v1 offset:2048
 ds_read_b128 v[36:39], v1 offset:3072
 buffer_load_dwordx4 v[8:11], v0, s[4:7], s33 offen offset:0 sc1
 buffer_load_dwordx4 v[12:15], v0, s[4:7], s33 offen offset:1024 sc1
L_pmlr0:
 s_waitcnt vmcnt(1)
 ds_write_b128 v0, v[8:11] offset:2048
 v_max3_u32 v16, v8, v9, v10
 s_waitcnt vmcnt(0)
 ds_write_b128 v0, v[12:15] offset:3072
 v_max3_u32 v16, v16, v11, v12
 v_max3_u32 v17, v13, v14, v15
 v_max_u32 v16, v16, v17
 v_cmp_eq_u32 vcc, -1, v16
 s_cmp_eq_u64 vcc, 0
 s_cbranch_scc1 L_b1lr0
 s_cmp_eq_u32 s15, 0
 s_cbranch_scc1 L_b1lr0
 s_sub_u32 s15, s15, 1
 buffer_load_dwordx4 v[8:11], v0, s[4:7], s33 offen offset:0 sc1
 buffer_load_dwordx4 v[12:15], v0, s[4:7], s33 offen offset:1024 sc1
 s_branch L_pmlr0
L_b1lr0:
 s_waitcnt lgkmcnt(2)
 v_smfmac_f32_16x16x64_bf16 v[40:43], v[8:11], v[24:31], v5
 ds_read_b128 v[24:27], v1 offset:4096
 s_waitcnt lgkmcnt(1)
 v_smfmac_f32_16x16x64_bf16 v[44:47], v[8:11], v[32:39], v5
 ds_read_b128 v[28:31], v1 offset:5120
 v_smfmac_f32_16x16x64_bf16 v[40:43], v[12:15], a[32:39], v5
 ds_read_b128 v[32:35], v1 offset:6144
 v_smfmac_f32_16x16x64_bf16 v[44:47], v[12:15], a[40:47], v5
 ds_read_b128 v[36:39], v1 offset:7168
 s_waitcnt lgkmcnt(4)
 s_barrier
 ds_read_b128 v[16:19], v0 offset:4096
 ds_read_b128 v[20:23], v0 offset:5120
 v_smfmac_f32_16x16x64_bf16 v[48:51], v[8:11], a[0:7], v5
 v_smfmac_f32_16x16x64_bf16 v[52:55], v[8:11], a[8:15], v5
 ds_read_b128 v[8:11], v0 offset:6144
 v_smfmac_f32_16x16x64_bf16 v[48:51], v[12:15], a[48:55], v5
 v_smfmac_f32_16x16x64_bf16 v[52:55], v[12:15], a[56:63], v5
 ds_read_b128 v[12:15], v0 offset:7168
 s_waitcnt lgkmcnt(3)
 v_smfmac_f32_16x16x64_bf16 v[40:43], v[16:19], a[80:87], v5
 v_smfmac_f32_16x16x64_bf16 v[44:47], v[16:19], a[88:95], v5
 v_smfmac_f32_16x16x64_bf16 v[48:51], v[16:19], v[24:31], v5
 ds_read_b128 v[24:27], v1 offset:12288
 v_smfmac_f32_16x16x64_bf16 v[52:55], v[16:19], v[32:39], v5
 ds_read_b128 v[16:19], v0 offset:8192
 s_waitcnt lgkmcnt(4)
 v_smfmac_f32_16x16x64_bf16 v[40:43], v[20:23], a[112:119], v5
 ds_read_b128 v[28:31], v1 offset:13312
 v_smfmac_f32_16x16x64_bf16 v[44:47], v[20:23], a[120:127], v5
 ds_read_b128 v[20:23], v0 offset:0
 s_waitcnt lgkmcnt(5)
 v_smfmac_f32_16x16x64_bf16 v[40:43], v[8:11], a[160:167], v5
 ds_read_b128 v[32:35], v1 offset:14336
 v_smfmac_f32_16x16x64_bf16 v[44:47], v[8:11], a[168:175], v5
 ds_read_b128 v[8:11], v0 offset:1024
 s_waitcnt lgkmcnt(6)
 v_smfmac_f32_16x16x64_bf16 v[40:43], v[12:15], a[192:199], v5
 ds_read_b128 v[36:39], v1 offset:15360
 v_smfmac_f32_16x16x64_bf16 v[44:47], v[12:15], a[200:207], v5
 s_waitcnt lgkmcnt(5)
 v_smfmac_f32_16x16x64_bf16 v[40:43], v[16:19], a[208:215], v5
 v_smfmac_f32_16x16x64_bf16 v[44:47], v[16:19], a[216:223], v5
 s_waitcnt lgkmcnt(3)
 v_smfmac_f32_16x16x64_bf16 v[40:43], v[20:23], v[80:87], v5
 s_waitcnt lgkmcnt(1)
 v_smfmac_f32_16x16x64_bf16 v[40:43], v[8:11], v[128:135], v5
 v_smfmac_f32_16x16x64_bf16 v[44:47], v[20:23], v[88:95], v5
 s_waitcnt lgkmcnt(0)
 v_smfmac_f32_16x16x64_bf16 v[44:47], v[8:11], v[136:143], v5
 v_pk_mul_f32 v[40:41], v[40:41], s[54:55]
 v_smfmac_f32_16x16x64_bf16 v[48:51], v[12:15], v[24:31], v5
 ds_read_b128 v[24:27], v1 offset:8192
 v_pk_mul_f32 v[42:43], v[42:43], s[54:55]
 v_smfmac_f32_16x16x64_bf16 v[52:55], v[12:15], v[32:39], v5
 ds_read_b128 v[12:15], v0 offset:5120
 v_cvt_pk_bf16_f32 v40, v40, v41
 v_smfmac_f32_16x16x64_bf16 v[48:51], v[16:19], a[224:231], v5
 ds_read_b128 v[28:31], v1 offset:9216
 v_cvt_pk_bf16_f32 v41, v42, v43
 v_smfmac_f32_16x16x64_bf16 v[52:55], v[16:19], a[232:239], v5
 ds_read_b128 v[16:19], v0 offset:6144
 v_pk_mul_f32 v[44:45], v[44:45], s[54:55]
 v_mfma_f32_16x16x16_bf16 v[40:43], v[40:41], v[6:7], 0
 ds_read_b128 v[32:35], v1 offset:10240
 v_pk_mul_f32 v[46:47], v[46:47], s[54:55]
 v_smfmac_f32_16x16x64_bf16 v[48:51], v[20:23], v[96:103], v5
 ds_read_b128 v[36:39], v1 offset:11264
 v_cvt_pk_bf16_f32 v44, v44, v45
 v_smfmac_f32_16x16x64_bf16 v[48:51], v[8:11], v[144:151], v5
 s_waitcnt lgkmcnt(4)
 v_cvt_pk_bf16_f32 v45, v46, v47
 v_smfmac_f32_16x16x64_bf16 v[48:51], v[12:15], a[128:135], v5
 v_cvt_pk_bf16_f32 v40, v40, v41
 v_mfma_f32_16x16x16_bf16 v[44:47], v[44:45], v[6:7], 0
 v_cvt_pk_bf16_f32 v41, v42, v43
 v_smfmac_f32_16x16x64_bf16 v[52:55], v[20:23], v[104:111], v5
 s_waitcnt lgkmcnt(2)
 v_smfmac_f32_16x16x64_bf16 v[48:51], v[16:19], v[24:31], v5
 ds_read_b128 v[24:27], v1 offset:16384
 v_cvt_pk_bf16_f32 v42, v44, v45
 v_smfmac_f32_16x16x64_bf16 v[52:55], v[8:11], v[152:159], v5
 ds_read_b128 v[28:31], v1 offset:17408
 v_cvt_pk_bf16_f32 v43, v46, v47
 v_smfmac_f32_16x16x64_bf16 v[52:55], v[12:15], a[136:143], v5
 s_waitcnt lgkmcnt(2)
 v_cvt_pk_bf16_f32 v48, v48, v49
 v_smfmac_f32_16x16x64_bf16 v[52:55], v[16:19], v[32:39], v5
 ds_read_b128 v[32:35], v1 offset:18432
 s_waitcnt vmcnt(2)
 v_cvt_pk_bf16_f32 v49, v50, v51
 ds_read_b128 v[36:39], v1 offset:19456
 s_add_u32 s33, s58, 37748736
 v_mfma_f32_16x16x16_bf16 v[48:51], v[48:49], v[6:7], 0
 v_mfma_f32_16x16x32_bf16 v[64:67], v[64:67], v[40:43], 0
 v_cvt_pk_bf16_f32 v52, v52, v53
 v_cvt_pk_bf16_f32 v53, v54, v55
 v_mfma_f32_16x16x32_bf16 v[68:71], v[68:71], v[40:43], 0
 v_mfma_f32_16x16x16_bf16 v[52:55], v[52:53], v[6:7], 0
 v_cvt_pk_bf16_f32 v48, v48, v49
 v_cvt_pk_bf16_f32 v49, v50, v51
 v_smfmac_f32_16x16x64_bf16 v[56:59], v[20:23], v[112:119], v5
 v_mov_b32_dpp v64, v68 quad_perm:[0,1,2,3] row_mask:0xf bank_mask:0xc
 v_mov_b32_dpp v65, v69 quad_perm:[0,1,2,3] row_mask:0xf bank_mask:0xc
 v_smfmac_f32_16x16x64_bf16 v[60:63], v[20:23], v[120:127], v5
 ds_read_b128 v[20:23], v0 offset:2048
 v_cvt_pk_bf16_f32 v50, v52, v53
 v_cvt_pk_bf16_f32 v51, v54, v55
 v_mov_b32_dpp v66, v70 quad_perm:[0,1,2,3] row_mask:0xf bank_mask:0xc
 v_mov_b32_dpp v67, v71 quad_perm:[0,1,2,3] row_mask:0xf bank_mask:0xc
 v_mfma_f32_16x16x32_bf16 v[44:47], v[48:51], v[40:43], 0
 ds_write_b128 v0, v[64:67] offset:9216
 v_smfmac_f32_16x16x64_bf16 v[56:59], v[8:11], v[160:167], v5
 buffer_store_dwordx4 v[48:51], v0, s[4:7], s33 offen sc1
 v_smfmac_f32_16x16x64_bf16 v[60:63], v[8:11], v[168:175], v5
 ds_read_b128 v[8:11], v0 offset:3072
 v_cndmask_b32 v52, v45, v44, s[56:57]
 v_cndmask_b32 v53, v47, v46, s[56:57]
 v_cndmask_b32 v52, v52, v53, s[60:61]
 ds_write_b32 v0, v52 offset:13312
 v_smfmac_f32_16x16x64_bf16 v[56:59], v[12:15], a[144:151], v5
 v_smfmac_f32_16x16x64_bf16 v[60:63], v[12:15], a[152:159], v5
 ds_read_b128 v[12:15], v0 offset:4096
 v_smfmac_f32_16x16x64_bf16 v[56:59], v[16:19], a[176:183], v5
 v_smfmac_f32_16x16x64_bf16 v[60:63], v[16:19], a[184:191], v5
 ds_read_b128 v[16:19], v0 offset:7168
 s_waitcnt lgkmcnt(2)
 s_barrier
 ds_read_b128 v[64:67], v0 offset:13312
 ds_read_b128 v[40:43], v0 offset:9216
 ds_read_b128 v[44:47], v0 offset:10240
 ds_read_b128 v[48:51], v0 offset:11264
 ds_read_b128 v[52:55], v0 offset:12288
 v_smfmac_f32_16x16x64_bf16 v[56:59], v[20:23], a[16:23], v5
 v_smfmac_f32_16x16x64_bf16 v[60:63], v[20:23], a[24:31], v5
 ds_read_b128 v[20:23], v0 offset:8192
 v_smfmac_f32_16x16x64_bf16 v[56:59], v[8:11], a[64:71], v5
 v_smfmac_f32_16x16x64_bf16 v[60:63], v[8:11], a[72:79], v5
 s_waitcnt lgkmcnt(7)
 s_waitcnt lgkmcnt(5)
 v_smfmac_f32_16x16x64_bf16 v[56:59], v[12:15], a[96:103], v5
 v_add_f32 v64, v64, v65
 v_smfmac_f32_16x16x64_bf16 v[60:63], v[12:15], a[104:111], v5
 s_waitcnt lgkmcnt(3)
 v_add_f32 v66, v66, v67
 v_smfmac_f32_16x16x64_bf16 v[56:59], v[16:19], v[24:31], v5
 v_pk_add_f32 v[40:41], v[40:41], v[44:45]
 v_smfmac_f32_16x16x64_bf16 v[60:63], v[16:19], v[32:39], v5
 s_waitcnt lgkmcnt(2)
 v_pk_add_f32 v[42:43], v[42:43], v[46:47]
 v_pk_add_f32 v[40:41], v[40:41], v[48:49]
 v_pk_add_f32 v[42:43], v[42:43], v[50:51]
 v_add_f32 v64, v64, v66
 s_waitcnt lgkmcnt(1)
 v_pk_add_f32 v[44:45], v[40:41], v[52:53]
 v_pk_add_f32 v[46:47], v[42:43], v[54:55]
 s_waitcnt lgkmcnt(0)
 v_smfmac_f32_16x16x64_bf16 v[56:59], v[20:23], a[240:247], v5
 v_max3_f32 v68, v44, v45, v46
 v_mov_b64 v[48:49], s[70:71]
 v_smfmac_f32_16x16x64_bf16 v[60:63], v[20:23], a[248:255], v5
 ds_read_b128 v[24:27], v1 offset:24576
 v_max3_f32 v68, v68, v47, v64
 v_mov_b64 v[50:51], s[72:73]
 ds_read_b128 v[28:31], v1 offset:25600
 v_max_f32_dpp v69, v68, v68 row_ror:8 row_mask:0xf bank_mask:0xf
 v_max_f32_dpp v68, v68, v68 row_ror:8 row_mask:0xf bank_mask:0xf
 ds_read_b128 v[32:35], v1 offset:26624
 ds_read_b128 v[36:39], v1 offset:27648
 v_permlane32_swap_b32 v68, v69
 v_max_f32 v70, v68, v69
 v_max_f32 v71, v68, v69
 ds_read_b128 v[8:11], v1 offset:20480
 ds_read_b128 v[12:15], v1 offset:21504
 v_permlane16_swap_b32 v70, v71
 ds_read_b128 v[16:19], v1 offset:22528
 v_max_f32 v68, v70, v71
 v_sub_f32 v64, v64, v68
 v_pk_add_f32 v[44:45], v[44:45], v[68:69] op_sel_hi:[1,0] neg_lo:[0,1] neg_hi:[0,1]
 v_pk_add_f32 v[46:47], v[46:47], v[68:69] op_sel_hi:[1,0] neg_lo:[0,1] neg_hi:[0,1]
 v_exp_f32 v64, v64
 ds_read_b128 v[20:23], v1 offset:23552
 v_exp_f32 v44, v44
 v_mov_b32_dpp v65, v64 row_ror:8 row_mask:0xf bank_mask:0xf
 v_exp_f32 v45, v45
 v_cvt_pk_bf16_f32 v56, v56, v57
 v_exp_f32 v46, v46
 v_cvt_pk_bf16_f32 v40, v64, v65
 v_cvt_pk_bf16_f32 v41, v64, v65
 v_exp_f32 v47, v47
 v_cvt_pk_bf16_f32 v57, v58, v59
 v_cvt_pk_bf16_f32 v42, v44, v45
 v_permlane32_swap_b32 v40, v41
 v_cvt_pk_bf16_f32 v58, v60, v61
 v_cvt_pk_bf16_f32 v43, v46, v47
 v_cvt_pk_bf16_f32 v59, v62, v63
 s_add_u32 s33, s58, 37748736
 v_mov_b32_dpp v44, v42 row_ror:8 row_mask:0xf bank_mask:0xf
 s_cmp_eq_u32 s41, 63
 v_mov_b32_dpp v45, v43 row_ror:8 row_mask:0xf bank_mask:0xf
 s_cbranch_scc1 L_lastlr0
 v_mfma_f32_16x16x32_bf16 v[52:55], v[48:51], v[40:43], 0
 v_lshrrev_b32 v46, 1, v0
 v_and_b32 v47, 0x70, v0
 v_mfma_f32_16x16x16_bf16 v[64:67], v[56:57], v[40:41], 0
 v_and_b32 v46, 0x180, v46
 v_mov_b64 v[60:61], 0
 v_mfma_f32_16x16x16_bf16 v[68:71], v[58:59], v[40:41], 0
 v_or_b32 v46, v46, v47
 v_mov_b64 v[62:63], 0
 buffer_store_dwordx4 v[56:59], v0, s[4:7], s33 offen offset:1024 sc1
 s_waitcnt vmcnt(3)
 v_mfma_f32_16x16x32_bf16 v[64:67], v[72:75], v[42:45], v[64:67]
 v_add_f32_dpp v52, v52, v52 row_ror:8 row_mask:0xf bank_mask:0xf
 v_bfe_u32 v47, v0, 7, 1
 s_waitcnt vmcnt(2)
 v_mfma_f32_16x16x32_bf16 v[68:71], v[76:79], v[42:45], v[68:71]
 v_rcp_f32 v52, v52
 v_lshl_add_u32 v47, v47, 9, v46
 v_mov_b64 v[48:49], 0
 v_mov_b64 v[50:51], 0
 v_mov_b64 v[56:57], 0
 v_mov_b64 v[58:59], 0
 v_pk_mul_f32 v[64:65], v[64:65], v[52:53] op_sel_hi:[1,0]
 v_pk_mul_f32 v[66:67], v[66:67], v[52:53] op_sel_hi:[1,0]
 v_pk_mul_f32 v[68:69], v[68:69], v[52:53] op_sel_hi:[1,0]
 v_pk_mul_f32 v[70:71], v[70:71], v[52:53] op_sel_hi:[1,0]
 v_cvt_pk_bf16_f32 v64, v64, v65
 v_cvt_pk_bf16_f32 v65, v66, v67
 v_cvt_pk_bf16_f32 v66, v68, v69
 v_cvt_pk_bf16_f32 v67, v70, v71
 s_mov_b64 exec, s[56:57]
 ds_write_b128 v46, v[64:67] offset:14336
 s_mov_b64 exec, -1
 v_mov_b32_dpp v64, v64 row_ror:8 row_mask:0xf bank_mask:0xc
 v_mov_b32_dpp v65, v65 row_ror:8 row_mask:0xf bank_mask:0xc
 v_mov_b32_dpp v66, v66 row_ror:8 row_mask:0xf bank_mask:0xc
 v_mov_b32_dpp v67, v67 row_ror:8 row_mask:0xf bank_mask:0xc
 s_bfe_u32 s52, s41, 0x10001
 s_sub_u32 s45, 0, s52
 s_waitcnt lgkmcnt(3)
 v_smfmac_f32_16x16x64_bf16 v[48:51], v[64:67], v[8:15], v5
 ds_read_b128 v[8:11], v1 offset:28672
 ds_read_b128 v[12:15], v1 offset:29696
 v_mov_b64 v[52:53], 0
 v_smfmac_f32_16x16x64_bf16 v[56:59], v[64:67], v[176:183], v5
 s_add_u32 s34, s46, s44
 v_mov_b32 v44, -1
 v_smfmac_f32_16x16x64_bf16 v[60:63], v[64:67], v[208:215], v5
 buffer_store_dword v44, v4, s[4:7], s34 offen
 v_mov_b64 v[54:55], 0
 s_add_u32 s33, s48, s47
 s_add_u32 s34, s59, s47
 s_waitcnt lgkmcnt(2)
 s_barrier
 ds_read_b128 v[68:71], v46 offset:14848
 ds_read_b128 v[72:75], v46 offset:15360
 ds_read_b128 v[76:79], v46 offset:15872
 ds_read_b128 v[40:43], v47 offset:14336
 ds_read_b128 v[44:47], v47 offset:15360
 s_waitcnt lgkmcnt(4)
 v_smfmac_f32_16x16x64_bf16 v[48:51], v[68:71], v[16:23], v5
 ds_read_b128 v[16:19], v1 offset:30720
 s_waitcnt lgkmcnt(4)
 v_smfmac_f32_16x16x64_bf16 v[48:51], v[72:75], v[24:31], v5
 ds_read_b128 v[20:23], v1 offset:31744
 s_waitcnt lgkmcnt(4)
 v_smfmac_f32_16x16x64_bf16 v[48:51], v[76:79], v[32:39], v5
 ds_read_b128 v[24:27], v1 offset:32768
 s_waitcnt lgkmcnt(4)
 v_smfmac_f32_16x16x64_bf16 v[52:55], v[40:43], v[240:247], v5
 ds_read_b128 v[28:31], v1 offset:33792
 s_waitcnt lgkmcnt(4)
 v_smfmac_f32_16x16x64_bf16 v[52:55], v[44:47], v[248:255], v5
 ds_read_b128 v[32:35], v1 offset:34816
 v_cvt_pk_bf16_f32 v48, v48, v49
 v_smfmac_f32_16x16x64_bf16 v[56:59], v[68:71], v[184:191], v5
 ds_read_b128 v[36:39], v1 offset:35840
 s_add_u32 s35, s33, 131072
 v_cvt_pk_bf16_f32 v49, v50, v51
 v_smfmac_f32_16x16x64_bf16 v[56:59], v[72:75], v[192:199], v5
 v_and_or_b32 v48, v48, -2, s52
 v_permlane32_swap_b32 v52, v54
 v_smfmac_f32_16x16x64_bf16 v[56:59], v[76:79], v[200:207], v5
 buffer_store_dwordx2 v[48:49], v3, s[4:7], s35 offen
 v_permlane32_swap_b32 v53, v55
 v_smfmac_f32_16x16x64_bf16 v[60:63], v[68:71], v[216:223], v5
 v_mov_b64 v[40:41], 0
 v_add_f32 v52, v52, v54
 v_smfmac_f32_16x16x64_bf16 v[60:63], v[72:75], v[224:231], v5
 v_mov_b64 v[42:43], 0
 v_add_f32 v53, v53, v55
 v_smfmac_f32_16x16x64_bf16 v[60:63], v[76:79], v[232:239], v5
 s_add_u32 s35, s33, 0
 v_cvt_pk_bf16_f32 v56, v56, v57
 v_cvt_pk_bf16_f32 v52, v52, v53
 v_smfmac_f32_16x16x64_bf16 v[40:43], v[64:67], v[8:15], v5
 v_cvt_pk_bf16_f32 v57, v58, v59
 v_and_or_b32 v52, v52, -2, s52
 s_waitcnt lgkmcnt(4)
 v_smfmac_f32_16x16x64_bf16 v[40:43], v[68:71], v[16:23], v5
 buffer_store_dword v52, v2, s[4:7], s34 offen
 v_and_or_b32 v56, v56, -2, s52
 v_cvt_pk_bf16_f32 v60, v60, v61
 s_waitcnt lgkmcnt(2)
 v_smfmac_f32_16x16x64_bf16 v[40:43], v[72:75], v[24:31], v5
 buffer_store_dwordx2 v[56:57], v3, s[4:7], s35 offen
 s_add_u32 s35, s33, 65536
 v_cvt_pk_bf16_f32 v61, v62, v63
 s_waitcnt lgkmcnt(0)
 v_smfmac_f32_16x16x64_bf16 v[40:43], v[76:79], v[32:39], v5
 v_and_or_b32 v60, v60, -2, s52
 buffer_store_dwordx2 v[60:61], v3, s[4:7], s35 offen
 s_add_u32 s35, s33, 196608
 s_mov_b32 s36, s42
 s_mov_b32 s42, s43
 s_mov_b32 s43, s44
 s_mov_b32 s44, s36
 s_xor_b32 s47, s47, 294912
 s_add_u32 s41, s41, 1
 s_add_u32 s58, s58, 262144
 v_cvt_pk_bf16_f32 v40, v40, v41
 v_cvt_pk_bf16_f32 v41, v42, v43
 v_and_or_b32 v40, v40, -2, s52
 buffer_store_dwordx2 v[40:41], v3, s[4:7], s35 offen
 s_branch L_cslr0
L_lastlr0:
 buffer_store_dwordx4 v[56:59], v0, s[4:7], s33 offen offset:1024 sc1
 s_branch L_chx
L_celr1:
 v_mov_b64 v[40:41], 0
 v_mov_b64 v[42:43], 0
 v_mov_b64 v[44:45], 0
 v_mov_b64 v[46:47], 0
 v_mov_b64 v[48:49], 0
 v_mov_b64 v[50:51], 0
 v_mov_b64 v[52:53], 0
 v_mov_b64 v[54:55], 0
 v_mov_b64 v[56:57], 0
 v_mov_b64 v[58:59], 0
 v_mov_b64 v[60:61], 0
 v_mov_b64 v[62:63], 0
 ds_read_b128 v[24:27], v1 offset:0
 ds_read_b128 v[28:31], v1 offset:1024
 ds_read_b128 v[32:35], v1 offset:2048
 ds_read_b128 v[36:39], v1 offset:3072
 s_barrier
 s_add_u32 s34, s58, 4194304
 s_add_u32 s35, s58, 20971520
 buffer_load_dwordx4 v[64:67], v0, s[4:7], s34 offen offset:0
 buffer_load_dwordx4 v[68:71], v0, s[4:7], s34 offen offset:1024
 buffer_load_dwordx4 v[72:75], v0, s[4:7], s35 offen offset:0
 buffer_load_dwordx4 v[76:79], v0, s[4:7], s35 offen offset:1024
 s_add_u32 s37, s49, 294912
 s_branch L_b1lr1
L_cslr1:
 s_xor_b32 s37, s47, 294912
 s_add_u32 s37, s37, s49
 s_add_u32 s34, s46, s42
 v_and_b32 v54, 64, v0
 v_lshrrev_b32 v54, 2, v54
 v_mov_b32 v55, 0x3f80
 v_lshlrev_b32 v54, v54, v55
 v_cndmask_b32 v56, 0, v54, s[62:63]
 v_cndmask_b32 v57, 0, v54, s[64:65]
 v_cndmask_b32 v58, 0, v54, s[66:67]
 v_cndmask_b32 v59, 0, v54, s[68:69]
 v_mov_b64 v[40:41], 0
 v_mov_b64 v[42:43], 0
 v_mov_b64 v[44:45], 0
 v_mov_b64 v[46:47], 0
 v_mov_b64 v[48:49], 0
 v_mov_b64 v[50:51], 0
 v_mov_b64 v[52:53], 0
 buffer_load_dwordx4 v[8:11], v0, s[4:7], s37 offen offset:0 sc1
 buffer_load_dwordx4 v[12:15], v0, s[4:7], s37 offen offset:1024 sc1
 buffer_load_dwordx4 v[16:19], v0, s[4:7], s37 offen offset:2048 sc1
 buffer_load_dwordx4 v[20:23], v0, s[4:7], s37 offen offset:3072 sc1
 s_add_u32 s35, s58, 4194304
 s_add_u32 s36, s58, 20971520
 buffer_load_dwordx4 v[64:67], v0, s[4:7], s35 offen offset:0
 buffer_load_dwordx4 v[68:71], v0, s[4:7], s35 offen offset:1024
 buffer_load_dwordx4 v[72:75], v0, s[4:7], s36 offen offset:0
 buffer_load_dwordx4 v[76:79], v0, s[4:7], s36 offen offset:1024
 s_waitcnt vmcnt(7)
 v_mfma_f32_16x16x32_bf16 v[60:63], v[56:59], v[8:11], 0
 v_bitop3_b32 v54, v8, v10, s45 bitop3:0x7e
 s_waitcnt vmcnt(6)
 v_mfma_f32_16x16x32_bf16 v[60:63], v[56:59], v[12:15], v[60:63]
 v_bitop3_b32 v55, v12, v14, s45 bitop3:0x7e
 s_waitcnt vmcnt(5)
 v_mfma_f32_16x16x32_bf16 v[60:63], v[56:59], v[16:19], v[60:63]
 v_or_b32 v54, v54, v55
 v_bitop3_b32 v55, v16, v18, s45 bitop3:0x7e
 s_waitcnt vmcnt(4)
 v_mfma_f32_16x16x32_bf16 v[60:63], v[56:59], v[20:23], v[60:63]
 v_or_b32 v54, v54, v55
 v_bitop3_b32 v55, v20, v22, s45 bitop3:0x7e
 v_bitop3_b32 v54, v54, v55, 1 bitop3:0xa8
 v_cmp_ne_u32 vcc, 0, v54
 s_cmp_eq_u64 vcc, 0
 s_cbranch_scc1 L_rpdlr1
L_rplr1:
 s_cmp_eq_u32 s15, 0
 s_cbranch_scc1 L_rpdlr1
 s_sub_u32 s15, s15, 1
 buffer_load_dwordx4 v[8:11], v0, s[4:7], s37 offen offset:0 sc1
 buffer_load_dwordx4 v[12:15], v0, s[4:7], s37 offen offset:1024 sc1
 buffer_load_dwordx4 v[16:19], v0, s[4:7], s37 offen offset:2048 sc1
 buffer_load_dwordx4 v[20:23], v0, s[4:7], s37 offen offset:3072 sc1
 s_waitcnt vmcnt(3)
 v_mfma_f32_16x16x32_bf16 v[60:63], v[56:59], v[8:11], 0
 v_bitop3_b32 v54, v8, v10, s45 bitop3:0x7e
 s_waitcnt vmcnt(2)
 v_mfma_f32_16x16x32_bf16 v[60:63], v[56:59], v[12:15], v[60:63]
 v_bitop3_b32 v55, v12, v14, s45 bitop3:0x7e
 s_waitcnt vmcnt(1)
 v_mfma_f32_16x16x32_bf16 v[60:63], v[56:59], v[16:19], v[60:63]
 v_or_b32 v54, v54, v55
 v_bitop3_b32 v55, v16, v18, s45 bitop3:0x7e
 s_waitcnt vmcnt(0)
 v_mfma_f32_16x16x32_bf16 v[60:63], v[56:59], v[20:23], v[60:63]
 v_or_b32 v54, v54, v55
 v_bitop3_b32 v55, v20, v22, s45 bitop3:0x7e
 v_bitop3_b32 v54, v54, v55, 1 bitop3:0xa8
 v_cmp_ne_u32 vcc, 0, v54
 s_cmp_eq_u64 vcc, 0
 s_cbranch_scc0 L_rplr1
L_rpdlr1:
 s_nop 1
 v_add_f32_dpp v60, v60, v60 row_ror:8 row_mask:0xf bank_mask:0xf
 v_add_f32_dpp v61, v61, v61 row_ror:8 row_mask:0xf bank_mask:0xf
 v_cvt_pk_bf16_f32 v60, v60, v61
 buffer_store_dword v60, v4, s[4:7], s34 offen
 s_barrier
 s_add_u32 s33, s42, 159383552
 v_mov_b64 v[54:55], 0
 v_mov_b64 v[56:57], 0
 v_mov_b64 v[58:59], 0
 v_mov_b64 v[60:61], 0
 v_mov_b64 v[62:63], 0
 ds_read_b128 v[24:27], v1 offset:0
 ds_read_b128 v[28:31], v1 offset:1024
 ds_read_b128 v[32:35], v1 offset:2048
 ds_read_b128 v[36:39], v1 offset:3072
 buffer_load_dwordx4 v[8:11], v0, s[4:7], s33 offen offset:0 sc1
 buffer_load_dwordx4 v[12:15], v0, s[4:7], s33 offen offset:1024 sc1
L_pmlr1:
 s_waitcnt vmcnt(1)
 ds_write_b128 v0, v[8:11] offset:0
 v_max3_u32 v16, v8, v9, v10
 s_waitcnt vmcnt(0)
 ds_write_b128 v0, v[12:15] offset:1024
 v_max3_u32 v16, v16, v11, v12
 v_max3_u32 v17, v13, v14, v15
 v_max_u32 v16, v16, v17
 v_cmp_eq_u32 vcc, -1, v16
 s_cmp_eq_u64 vcc, 0
 s_cbranch_scc1 L_b1lr1
 s_cmp_eq_u32 s15, 0
 s_cbranch_scc1 L_b1lr1
 s_sub_u32 s15, s15, 1
 buffer_load_dwordx4 v[8:11], v0, s[4:7], s33 offen offset:0 sc1
 buffer_load_dwordx4 v[12:15], v0, s[4:7], s33 offen offset:1024 sc1
 s_branch L_pmlr1
L_b1lr1:
 s_waitcnt lgkmcnt(2)
 v_smfmac_f32_16x16x64_bf16 v[40:43], v[8:11], v[24:31], v5
 ds_read_b128 v[24:27], v1 offset:4096
 s_waitcnt lgkmcnt(1)
 v_smfmac_f32_16x16x64_bf16 v[44:47], v[8:11], v[32:39], v5
 ds_read_b128 v[28:31], v1 offset:5120
 v_smfmac_f32_16x16x64_bf16 v[40:43], v[12:15], a[32:39], v5
 ds_read_b128 v[32:35], v1 offset:6144
 v_smfmac_f32_16x16x64_bf16 v[44:47], v[12:15], a[40:47], v5
 ds_read_b128 v[36:39], v1 offset:7168
 s_waitcnt lgkmcnt(4)
 s_barrier
 ds_read_b128 v[16:19], v0 offset:2048
 ds_read_b128 v[20:23], v0 offset:3072
 v_smfmac_f32_16x16x64_bf16 v[48:51], v[8:11], a[0:7], v5
 v_smfmac_f32_16x16x64_bf16 v[52:55], v[8:11], a[8:15], v5
 ds_read_b128 v[8:11], v0 offset:4096
 v_smfmac_f32_16x16x64_bf16 v[48:51], v[12:15], a[48:55], v5
 v_smfmac_f32_16x16x64_bf16 v[52:55], v[12:15], a[56:63], v5
 ds_read_b128 v[12:15], v0 offset:5120
 s_waitcnt lgkmcnt(3)
 v_smfmac_f32_16x16x64_bf16 v[40:43], v[16:19], a[80:87], v5
 v_smfmac_f32_16x16x64_bf16 v[44:47], v[16:19], a[88:95], v5
 v_smfmac_f32_16x16x64_bf16 v[48:51], v[16:19], v[24:31], v5
 ds_read_b128 v[24:27], v1 offset:12288
 v_smfmac_f32_16x16x64_bf16 v[52:55], v[16:19], v[32:39], v5
 ds_read_b128 v[16:19], v0 offset:6144
 s_waitcnt lgkmcnt(4)
 v_smfmac_f32_16x16x64_bf16 v[40:43], v[20:23], a[112:119], v5
 ds_read_b128 v[28:31], v1 offset:13312
 v_smfmac_f32_16x16x64_bf16 v[44:47], v[20:23], a[120:127], v5
 ds_read_b128 v[20:23], v0 offset:7168
 s_waitcnt lgkmcnt(5)
 v_smfmac_f32_16x16x64_bf16 v[40:43], v[8:11], a[160:167], v5
 ds_read_b128 v[32:35], v1 offset:14336
 v_smfmac_f32_16x16x64_bf16 v[44:47], v[8:11], a[168:175], v5
 ds_read_b128 v[8:11], v0 offset:8192
 s_waitcnt lgkmcnt(6)
 v_smfmac_f32_16x16x64_bf16 v[40:43], v[12:15], a[192:199], v5
 ds_read_b128 v[36:39], v1 offset:15360
 v_smfmac_f32_16x16x64_bf16 v[44:47], v[12:15], a[200:207], v5
 s_waitcnt lgkmcnt(5)
 v_smfmac_f32_16x16x64_bf16 v[40:43], v[16:19], a[208:215], v5
 v_smfmac_f32_16x16x64_bf16 v[44:47], v[16:19], a[216:223], v5
 s_waitcnt lgkmcnt(3)
 v_smfmac_f32_16x16x64_bf16 v[40:43], v[20:23], v[80:87], v5
 s_waitcnt lgkmcnt(1)
 v_smfmac_f32_16x16x64_bf16 v[40:43], v[8:11], v[128:135], v5
 v_smfmac_f32_16x16x64_bf16 v[44:47], v[20:23], v[88:95], v5
 s_waitcnt lgkmcnt(0)
 v_smfmac_f32_16x16x64_bf16 v[44:47], v[8:11], v[136:143], v5
 v_pk_mul_f32 v[40:41], v[40:41], s[54:55]
 v_smfmac_f32_16x16x64_bf16 v[48:51], v[12:15], v[24:31], v5
 ds_read_b128 v[24:27], v1 offset:8192
 v_pk_mul_f32 v[42:43], v[42:43], s[54:55]
 v_smfmac_f32_16x16x64_bf16 v[52:55], v[12:15], v[32:39], v5
 ds_read_b128 v[12:15], v0 offset:3072
 v_cvt_pk_bf16_f32 v40, v40, v41
 v_smfmac_f32_16x16x64_bf16 v[48:51], v[16:19], a[224:231], v5
 ds_read_b128 v[28:31], v1 offset:9216
 v_cvt_pk_bf16_f32 v41, v42, v43
 v_smfmac_f32_16x16x64_bf16 v[52:55], v[16:19], a[232:239], v5
 ds_read_b128 v[16:19], v0 offset:4096
 v_pk_mul_f32 v[44:45], v[44:45], s[54:55]
 v_mfma_f32_16x16x16_bf16 v[40:43], v[40:41], v[6:7], 0
 ds_read_b128 v[32:35], v1 offset:10240
 v_pk_mul_f32 v[46:47], v[46:47], s[54:55]
 v_smfmac_f32_16x16x64_bf16 v[48:51], v[20:23], v[96:103], v5
 ds_read_b128 v[36:39], v1 offset:11264
 v_cvt_pk_bf16_f32 v44, v44, v45
 v_smfmac_f32_16x16x64_bf16 v[48:51], v[8:11], v[144:151], v5
 s_waitcnt lgkmcnt(4)
 v_cvt_pk_bf16_f32 v45, v46, v47
 v_smfmac_f32_16x16x64_bf16 v[48:51], v[12:15], a[128:135], v5
 v_cvt_pk_bf16_f32 v40, v40, v41
 v_mfma_f32_16x16x16_bf16 v[44:47], v[44:45], v[6:7], 0
 v_cvt_pk_bf16_f32 v41, v42, v43
 v_smfmac_f32_16x16x64_bf16 v[52:55], v[20:23], v[104:111], v5
 s_waitcnt lgkmcnt(2)
 v_smfmac_f32_16x16x64_bf16 v[48:51], v[16:19], v[24:31], v5
 ds_read_b128 v[24:27], v1 offset:16384
 v_cvt_pk_bf16_f32 v42, v44, v45
 v_smfmac_f32_16x16x64_bf16 v[52:55], v[8:11], v[152:159], v5
 ds_read_b128 v[28:31], v1 offset:17408
 v_cvt_pk_bf16_f32 v43, v46, v47
 v_smfmac_f32_16x16x64_bf16 v[52:55], v[12:15], a[136:143], v5
 s_waitcnt lgkmcnt(2)
 v_cvt_pk_bf16_f32 v48, v48, v49
 v_smfmac_f32_16x16x64_bf16 v[52:55], v[16:19], v[32:39], v5
 ds_read_b128 v[32:35], v1 offset:18432
 s_waitcnt vmcnt(2)
 v_cvt_pk_bf16_f32 v49, v50, v51
 ds_read_b128 v[36:39], v1 offset:19456
 s_add_u32 s33, s58, 37748736
 v_mfma_f32_16x16x16_bf16 v[48:51], v[48:49], v[6:7], 0
 v_mfma_f32_16x16x32_bf16 v[64:67], v[64:67], v[40:43], 0
 v_cvt_pk_bf16_f32 v52, v52, v53
 v_cvt_pk_bf16_f32 v53, v54, v55
 v_mfma_f32_16x16x32_bf16 v[68:71], v[68:71], v[40:43], 0
 v_mfma_f32_16x16x16_bf16 v[52:55], v[52:53], v[6:7], 0
 v_cvt_pk_bf16_f32 v48, v48, v49
 v_cvt_pk_bf16_f32 v49, v50, v51
 v_smfmac_f32_16x16x64_bf16 v[56:59], v[20:23], v[112:119], v5
 v_mov_b32_dpp v64, v68 quad_perm:[0,1,2,3] row_mask:0xf bank_mask:0xc
 v_mov_b32_dpp v65, v69 quad_perm:[0,1,2,3] row_mask:0xf bank_mask:0xc
 v_smfmac_f32_16x16x64_bf16 v[60:63], v[20:23], v[120:127], v5
 ds_read_b128 v[20:23], v0 offset:0
 v_cvt_pk_bf16_f32 v50, v52, v53
 v_cvt_pk_bf16_f32 v51, v54, v55
 v_mov_b32_dpp v66, v70 quad_perm:[0,1,2,3] row_mask:0xf bank_mask:0xc
 v_mov_b32_dpp v67, v71 quad_perm:[0,1,2,3] row_mask:0xf bank_mask:0xc
 v_mfma_f32_16x16x32_bf16 v[44:47], v[48:51], v[40:43], 0
 ds_write_b128 v0, v[64:67] offset:10240
 v_smfmac_f32_16x16x64_bf16 v[56:59], v[8:11], v[160:167], v5
 buffer_store_dwordx4 v[48:51], v0, s[4:7], s33 offen sc1
 v_smfmac_f32_16x16x64_bf16 v[60:63], v[8:11], v[168:175], v5
 ds_read_b128 v[8:11], v0 offset:1024
 v_cndmask_b32 v52, v45, v44, s[56:57]
 v_cndmask_b32 v53, v47, v46, s[56:57]
 v_cndmask_b32 v52, v52, v53, s[60:61]
 ds_write_b32 v0, v52 offset:13316
 v_smfmac_f32_16x16x64_bf16 v[56:59], v[12:15], a[144:151], v5
 v_smfmac_f32_16x16x64_bf16 v[60:63], v[12:15], a[152:159], v5
 ds_read_b128 v[12:15], v0 offset:2048
 v_smfmac_f32_16x16x64_bf16 v[56:59], v[16:19], a[176:183], v5
 v_smfmac_f32_16x16x64_bf16 v[60:63], v[16:19], a[184:191], v5
 ds_read_b128 v[16:19], v0 offset:5120
 s_waitcnt lgkmcnt(2)
 s_barrier
 ds_read_b128 v[64:67], v0 offset:13312
 ds_read_b128 v[40:43], v0 offset:9216
 ds_read_b128 v[44:47], v0 offset:10240
 ds_read_b128 v[48:51], v0 offset:11264
 ds_read_b128 v[52:55], v0 offset:12288
 v_smfmac_f32_16x16x64_bf16 v[56:59], v[20:23], a[16:23], v5
 v_smfmac_f32_16x16x64_bf16 v[60:63], v[20:23], a[24:31], v5
 ds_read_b128 v[20:23], v0 offset:6144
 v_smfmac_f32_16x16x64_bf16 v[56:59], v[8:11], a[64:71], v5
 v_smfmac_f32_16x16x64_bf16 v[60:63], v[8:11], a[72:79], v5
 s_waitcnt lgkmcnt(7)
 s_waitcnt lgkmcnt(5)
 v_smfmac_f32_16x16x64_bf16 v[56:59], v[12:15], a[96:103], v5
 v_add_f32 v64, v64, v65
 v_smfmac_f32_16x16x64_bf16 v[60:63], v[12:15], a[104:111], v5
 s_waitcnt lgkmcnt(3)
 v_add_f32 v66, v66, v67
 v_smfmac_f32_16x16x64_bf16 v[56:59], v[16:19], v[24:31], v5
 v_pk_add_f32 v[40:41], v[40:41], v[44:45]
 v_smfmac_f32_16x16x64_bf16 v[60:63], v[16:19], v[32:39], v5
 s_waitcnt lgkmcnt(2)
 v_pk_add_f32 v[42:43], v[42:43], v[46:47]
 v_pk_add_f32 v[40:41], v[40:41], v[48:49]
 v_pk_add_f32 v[42:43], v[42:43], v[50:51]
 v_add_f32 v64, v64, v66
 s_waitcnt lgkmcnt(1)
 v_pk_add_f32 v[44:45], v[40:41], v[52:53]
 v_pk_add_f32 v[46:47], v[42:43], v[54:55]
 s_waitcnt lgkmcnt(0)
 v_smfmac_f32_16x16x64_bf16 v[56:59], v[20:23], a[240:247], v5
 v_max3_f32 v68, v44, v45, v46
 v_mov_b64 v[48:49], s[70:71]
 v_smfmac_f32_16x16x64_bf16 v[60:63], v[20:23], a[248:255], v5
 ds_read_b128 v[24:27], v1 offset:24576
 v_max3_f32 v68, v68, v47, v64
 v_mov_b64 v[50:51], s[72:73]
 ds_read_b128 v[28:31], v1 offset:25600
 v_max_f32_dpp v69, v68, v68 row_ror:8 row_mask:0xf bank_mask:0xf
 v_max_f32_dpp v68, v68, v68 row_ror:8 row_mask:0xf bank_mask:0xf
 ds_read_b128 v[32:35], v1 offset:26624
 ds_read_b128 v[36:39], v1 offset:27648
 v_permlane32_swap_b32 v68, v69
 v_max_f32 v70, v68, v69
 v_max_f32 v71, v68, v69
 ds_read_b128 v[8:11], v1 offset:20480
 ds_read_b128 v[12:15], v1 offset:21504
 v_permlane16_swap_b32 v70, v71
 ds_read_b128 v[16:19], v1 offset:22528
 v_max_f32 v68, v70, v71
 v_sub_f32 v64, v64, v68
 v_pk_add_f32 v[44:45], v[44:45], v[68:69] op_sel_hi:[1,0] neg_lo:[0,1] neg_hi:[0,1]
 v_pk_add_f32 v[46:47], v[46:47], v[68:69] op_sel_hi:[1,0] neg_lo:[0,1] neg_hi:[0,1]
 v_exp_f32 v64, v64
 ds_read_b128 v[20:23], v1 offset:23552
 v_exp_f32 v44, v44
 v_mov_b32_dpp v65, v64 row_ror:8 row_mask:0xf bank_mask:0xf
 v_exp_f32 v45, v45
 v_cvt_pk_bf16_f32 v56, v56, v57
 v_exp_f32 v46, v46
 v_cvt_pk_bf16_f32 v40, v64, v65
 v_cvt_pk_bf16_f32 v41, v64, v65
 v_exp_f32 v47, v47
 v_cvt_pk_bf16_f32 v57, v58, v59
 v_cvt_pk_bf16_f32 v42, v44, v45
 v_permlane32_swap_b32 v40, v41
 v_cvt_pk_bf16_f32 v58, v60, v61
 v_cvt_pk_bf16_f32 v43, v46, v47
 v_cvt_pk_bf16_f32 v59, v62, v63
 s_add_u32 s33, s58, 37748736
 v_mov_b32_dpp v44, v42 row_ror:8 row_mask:0xf bank_mask:0xf
 s_cmp_eq_u32 s41, 63
 v_mov_b32_dpp v45, v43 row_ror:8 row_mask:0xf bank_mask:0xf
 s_cbranch_scc1 L_lastlr1
 v_mfma_f32_16x16x32_bf16 v[52:55], v[48:51], v[40:43], 0
 v_lshrrev_b32 v46, 1, v0
 v_and_b32 v47, 0x70, v0
 v_mfma_f32_16x16x16_bf16 v[64:67], v[56:57], v[40:41], 0
 v_and_b32 v46, 0x180, v46
 v_mov_b64 v[60:61], 0
 v_mfma_f32_16x16x16_bf16 v[68:71], v[58:59], v[40:41], 0
 v_or_b32 v46, v46, v47
 v_mov_b64 v[62:63], 0
 buffer_store_dwordx4 v[56:59], v0, s[4:7], s33 offen offset:1024 sc1
 s_waitcnt vmcnt(3)
 v_mfma_f32_16x16x32_bf16 v[64:67], v[72:75], v[42:45], v[64:67]
 v_add_f32_dpp v52, v52, v52 row_ror:8 row_mask:0xf bank_mask:0xf
 v_bfe_u32 v47, v0, 7, 1
 s_waitcnt vmcnt(2)
 v_mfma_f32_16x16x32_bf16 v[68:71], v[76:79], v[42:45], v[68:71]
 v_rcp_f32 v52, v52
 v_lshl_add_u32 v47, v47, 9, v46
 v_mov_b64 v[48:49], 0
 v_mov_b64 v[50:51], 0
 v_mov_b64 v[56:57], 0
 v_mov_b64 v[58:59], 0
 v_pk_mul_f32 v[64:65], v[64:65], v[52:53] op_sel_hi:[1,0]
 v_pk_mul_f32 v[66:67], v[66:67], v[52:53] op_sel_hi:[1,0]
 v_pk_mul_f32 v[68:69], v[68:69], v[52:53] op_sel_hi:[1,0]
 v_pk_mul_f32 v[70:71], v[70:71], v[52:53] op_sel_hi:[1,0]
 v_cvt_pk_bf16_f32 v64, v64, v65
 v_cvt_pk_bf16_f32 v65, v66, v67
 v_cvt_pk_bf16_f32 v66, v68, v69
 v_cvt_pk_bf16_f32 v67, v70, v71
 s_mov_b64 exec, s[56:57]
 ds_write_b128 v46, v[64:67] offset:14848
 s_mov_b64 exec, -1
 v_mov_b32_dpp v64, v64 row_ror:8 row_mask:0xf bank_mask:0xc
 v_mov_b32_dpp v65, v65 row_ror:8 row_mask:0xf bank_mask:0xc
 v_mov_b32_dpp v66, v66 row_ror:8 row_mask:0xf bank_mask:0xc
 v_mov_b32_dpp v67, v67 row_ror:8 row_mask:0xf bank_mask:0xc
 s_bfe_u32 s52, s41, 0x10001
 s_sub_u32 s45, 0, s52
 s_waitcnt lgkmcnt(1)
 v_smfmac_f32_16x16x64_bf16 v[48:51], v[64:67], v[16:23], v5
 ds_read_b128 v[16:19], v1 offset:30720
 ds_read_b128 v[20:23], v1 offset:31744
 v_mov_b64 v[52:53], 0
 v_smfmac_f32_16x16x64_bf16 v[56:59], v[64:67], v[184:191], v5
 s_add_u32 s34, s46, s44
 v_mov_b32 v44, -1
 v_smfmac_f32_16x16x64_bf16 v[60:63], v[64:67], v[216:223], v5
 buffer_store_dword v44, v4, s[4:7], s34 offen
 v_mov_b64 v[54:55], 0
 s_add_u32 s33, s48, s47
 s_add_u32 s34, s59, s47
 s_waitcnt lgkmcnt(2)
 s_barrier
 ds_read_b128 v[68:71], v46 offset:14336
 ds_read_b128 v[72:75], v46 offset:15360
 ds_read_b128 v[76:79], v46 offset:15872
 ds_read_b128 v[40:43], v47 offset:14336
 ds_read_b128 v[44:47], v47 offset:15360
 s_waitcnt lgkmcnt(4)
 v_smfmac_f32_16x16x64_bf16 v[48:51], v[68:71], v[8:15], v5
 ds_read_b128 v[8:11], v1 offset:28672
 s_waitcnt lgkmcnt(4)
 v_smfmac_f32_16x16x64_bf16 v[48:51], v[72:75], v[24:31], v5
 ds_read_b128 v[12:15], v1 offset:29696
 s_waitcnt lgkmcnt(4)
 v_smfmac_f32_16x16x64_bf16 v[48:51], v[76:79], v[32:39], v5
 ds_read_b128 v[24:27], v1 offset:32768
 s_waitcnt lgkmcnt(4)
 v_smfmac_f32_16x16x64_bf16 v[52:55], v[40:43], v[240:247], v5
 ds_read_b128 v[28:31], v1 offset:33792
 s_waitcnt lgkmcnt(4)
 v_smfmac_f32_16x16x64_bf16 v[52:55], v[44:47], v[248:255], v5
 ds_read_b128 v[32:35], v1 offset:34816
 v_cvt_pk_bf16_f32 v48, v48, v49
 v_smfmac_f32_16x16x64_bf16 v[56:59], v[68:71], v[176:183], v5
 ds_read_b128 v[36:39], v1 offset:35840
 s_add_u32 s35, s33, 131072
 v_cvt_pk_bf16_f32 v49, v50, v51
 v_smfmac_f32_16x16x64_bf16 v[56:59], v[72:75], v[192:199], v5
 v_and_or_b32 v48, v48, -2, s52
 v_permlane32_swap_b32 v52, v54
 v_smfmac_f32_16x16x64_bf16 v[56:59], v[76:79], v[200:207], v5
 buffer_store_dwordx2 v[48:49], v3, s[4:7], s35 offen
 v_permlane32_swap_b32 v53, v55
 v_smfmac_f32_16x16x64_bf16 v[60:63], v[68:71], v[208:215], v5
 v_mov_b64 v[40:41], 0
 v_add_f32 v52, v52, v54
 v_smfmac_f32_16x16x64_bf16 v[60:63], v[72:75], v[224:231], v5
 v_mov_b64 v[42:43], 0
 v_add_f32 v53, v53, v55
 v_smfmac_f32_16x16x64_bf16 v[60:63], v[76:79], v[232:239], v5
 s_add_u32 s35, s33, 0
 v_cvt_pk_bf16_f32 v56, v56, v57
 v_cvt_pk_bf16_f32 v52, v52, v53
 v_smfmac_f32_16x16x64_bf16 v[40:43], v[64:67], v[16:23], v5
 v_cvt_pk_bf16_f32 v57, v58, v59
 v_and_or_b32 v52, v52, -2, s52
 s_waitcnt lgkmcnt(4)
 v_smfmac_f32_16x16x64_bf16 v[40:43], v[68:71], v[8:15], v5
 buffer_store_dword v52, v2, s[4:7], s34 offen
 v_and_or_b32 v56, v56, -2, s52
 v_cvt_pk_bf16_f32 v60, v60, v61
 s_waitcnt lgkmcnt(2)
 v_smfmac_f32_16x16x64_bf16 v[40:43], v[72:75], v[24:31], v5
 buffer_store_dwordx2 v[56:57], v3, s[4:7], s35 offen
 s_add_u32 s35, s33, 65536
 v_cvt_pk_bf16_f32 v61, v62, v63
 s_waitcnt lgkmcnt(0)
 v_smfmac_f32_16x16x64_bf16 v[40:43], v[76:79], v[32:39], v5
 v_and_or_b32 v60, v60, -2, s52
 buffer_store_dwordx2 v[60:61], v3, s[4:7], s35 offen
 s_add_u32 s35, s33, 196608
 s_mov_b32 s36, s42
 s_mov_b32 s42, s43
 s_mov_b32 s43, s44
 s_mov_b32 s44, s36
 s_xor_b32 s47, s47, 294912
 s_add_u32 s41, s41, 1
 s_add_u32 s58, s58, 262144
 v_cvt_pk_bf16_f32 v40, v40, v41
 v_cvt_pk_bf16_f32 v41, v42, v43
 v_and_or_b32 v40, v40, -2, s52
 buffer_store_dwordx2 v[40:41], v3, s[4:7], s35 offen
 s_branch L_cslr1
L_lastlr1:
 buffer_store_dwordx4 v[56:59], v0, s[4:7], s33 offen offset:1024 sc1
 s_branch L_chx
L_celr2:
 v_mov_b64 v[40:41], 0
 v_mov_b64 v[42:43], 0
 v_mov_b64 v[44:45], 0
 v_mov_b64 v[46:47], 0
 v_mov_b64 v[48:49], 0
 v_mov_b64 v[50:51], 0
 v_mov_b64 v[52:53], 0
 v_mov_b64 v[54:55], 0
 v_mov_b64 v[56:57], 0
 v_mov_b64 v[58:59], 0
 v_mov_b64 v[60:61], 0
 v_mov_b64 v[62:63], 0
 ds_read_b128 v[24:27], v1 offset:0
 ds_read_b128 v[28:31], v1 offset:1024
 ds_read_b128 v[32:35], v1 offset:2048
 ds_read_b128 v[36:39], v1 offset:3072
 s_barrier
 s_add_u32 s34, s58, 4194304
 s_add_u32 s35, s58, 20971520
 buffer_load_dwordx4 v[64:67], v0, s[4:7], s34 offen offset:0
 buffer_load_dwordx4 v[68:71], v0, s[4:7], s34 offen offset:1024
 buffer_load_dwordx4 v[72:75], v0, s[4:7], s35 offen offset:0
 buffer_load_dwordx4 v[76:79], v0, s[4:7], s35 offen offset:1024
 s_add_u32 s37, s49, 294912
 s_branch L_b1lr2
L_cslr2:
 s_xor_b32 s37, s47, 294912
 s_add_u32 s37, s37, s49
 buffer_load_dwordx4 v[8:11], v0, s[4:7], s37 offen offset:0 sc1
 buffer_load_dwordx4 v[12:15], v0, s[4:7], s37 offen offset:1024 sc1
 buffer_load_dwordx4 v[16:19], v0, s[4:7], s37 offen offset:2048 sc1
 buffer_load_dwordx4 v[20:23], v0, s[4:7], s37 offen offset:3072 sc1
 s_add_u32 s34, s46, s42
 v_and_b32 v54, 64, v0
 v_lshrrev_b32 v54, 2, v54
 v_mov_b32 v55, 0x3f80
 v_lshlrev_b32 v54, v54, v55
 v_cndmask_b32 v56, 0, v54, s[62:63]
 v_cndmask_b32 v57, 0, v54, s[64:65]
 v_cndmask_b32 v58, 0, v54, s[66:67]
 v_cndmask_b32 v59, 0, v54, s[68:69]
 v_mov_b64 v[40:41], 0
 v_mov_b64 v[42:43], 0
 v_mov_b64 v[44:45], 0
 v_mov_b64 v[46:47], 0
 v_mov_b64 v[48:49], 0
 v_mov_b64 v[50:51], 0
 v_mov_b64 v[52:53], 0
 s_add_u32 s35, s58, 4194304
 s_add_u32 s36, s58, 20971520
 buffer_load_dwordx4 v[64:67], v0, s[4:7], s35 offen offset:0
 buffer_load_dwordx4 v[68:71], v0, s[4:7], s35 offen offset:1024
 buffer_load_dwordx4 v[72:75], v0, s[4:7], s36 offen offset:0
 buffer_load_dwordx4 v[76:79], v0, s[4:7], s36 offen offset:1024
 s_waitcnt vmcnt(7)
 v_mfma_f32_16x16x32_bf16 v[60:63], v[56:59], v[8:11], 0
 v_bitop3_b32 v54, v8, v9, s45 bitop3:0x7e
 v_bitop3_b32 v55, v10, v11, s45 bitop3:0x7e
 s_waitcnt vmcnt(6)
 v_mfma_f32_16x16x32_bf16 v[60:63], v[56:59], v[12:15], v[60:63]
 v_or_b32 v54, v54, v55
 v_bitop3_b32 v55, v12, v13, s45 bitop3:0x7e
 v_or_b32 v54, v54, v55
 v_bitop3_b32 v55, v14, v15, s45 bitop3:0x7e
 s_waitcnt vmcnt(5)
 v_mfma_f32_16x16x32_bf16 v[60:63], v[56:59], v[16:19], v[60:63]
 v_or_b32 v54, v54, v55
 v_bitop3_b32 v55, v16, v17, s45 bitop3:0x7e
 v_or_b32 v54, v54, v55
 v_bitop3_b32 v55, v18, v19, s45 bitop3:0x7e
 s_waitcnt vmcnt(4)
 v_mfma_f32_16x16x32_bf16 v[60:63], v[56:59], v[20:23], v[60:63]
 v_or_b32 v54, v54, v55
 v_bitop3_b32 v55, v20, v21, s45 bitop3:0x7e
 v_or_b32 v54, v54, v55
 v_bitop3_b32 v55, v22, v23, s45 bitop3:0x7e
 v_bitop3_b32 v54, v54, v55, 1 bitop3:0xa8
 v_cmp_ne_u32 vcc, 0, v54
 s_cmp_eq_u64 vcc, 0
 s_cbranch_scc1 L_rpdlr2
L_rplr2:
 s_cmp_eq_u32 s15, 0
 s_cbranch_scc1 L_rpdlr2
 s_sub_u32 s15, s15, 1
 buffer_load_dwordx4 v[8:11], v0, s[4:7], s37 offen offset:0 sc1
 buffer_load_dwordx4 v[12:15], v0, s[4:7], s37 offen offset:1024 sc1
 buffer_load_dwordx4 v[16:19], v0, s[4:7], s37 offen offset:2048 sc1
 buffer_load_dwordx4 v[20:23], v0, s[4:7], s37 offen offset:3072 sc1
 s_waitcnt vmcnt(3)
 v_mfma_f32_16x16x32_bf16 v[60:63], v[56:59], v[8:11], 0
 v_bitop3_b32 v54, v8, v9, s45 bitop3:0x7e
 v_bitop3_b32 v55, v10, v11, s45 bitop3:0x7e
 s_waitcnt vmcnt(2)
 v_mfma_f32_16x16x32_bf16 v[60:63], v[56:59], v[12:15], v[60:63]
 v_or_b32 v54, v54, v55
 v_bitop3_b32 v55, v12, v13, s45 bitop3:0x7e
 v_or_b32 v54, v54, v55
 v_bitop3_b32 v55, v14, v15, s45 bitop3:0x7e
 s_waitcnt vmcnt(1)
 v_mfma_f32_16x16x32_bf16 v[60:63], v[56:59], v[16:19], v[60:63]
 v_or_b32 v54, v54, v55
 v_bitop3_b32 v55, v16, v17, s45 bitop3:0x7e
 v_or_b32 v54, v54, v55
 v_bitop3_b32 v55, v18, v19, s45 bitop3:0x7e
 s_waitcnt vmcnt(0)
 v_mfma_f32_16x16x32_bf16 v[60:63], v[56:59], v[20:23], v[60:63]
 v_or_b32 v54, v54, v55
 v_bitop3_b32 v55, v20, v21, s45 bitop3:0x7e
 v_or_b32 v54, v54, v55
 v_bitop3_b32 v55, v22, v23, s45 bitop3:0x7e
 v_bitop3_b32 v54, v54, v55, 1 bitop3:0xa8
 v_cmp_ne_u32 vcc, 0, v54
 s_cmp_eq_u64 vcc, 0
 s_cbranch_scc0 L_rplr2
L_rpdlr2:
 v_add_f32_dpp v60, v60, v60 row_ror:8 row_mask:0xf bank_mask:0xf
 v_add_f32_dpp v61, v61, v61 row_ror:8 row_mask:0xf bank_mask:0xf
 v_cvt_pk_bf16_f32 v60, v60, v61
 buffer_store_dword v60, v4, s[4:7], s34 offen
 s_barrier
 s_add_u32 s33, s42, 159389696
 v_mov_b64 v[54:55], 0
 v_mov_b64 v[56:57], 0
 v_mov_b64 v[58:59], 0
 v_mov_b64 v[60:61], 0
 v_mov_b64 v[62:63], 0
 ds_read_b128 v[24:27], v1 offset:0
 ds_read_b128 v[28:31], v1 offset:1024
 ds_read_b128 v[32:35], v1 offset:2048
 ds_read_b128 v[36:39], v1 offset:3072
 buffer_load_dwordx4 v[8:11], v0, s[4:7], s33 offen offset:0 sc1
 buffer_load_dwordx4 v[12:15], v0, s[4:7], s33 offen offset:1024 sc1
L_pmlr2:
 s_waitcnt vmcnt(1)
 ds_write_b128 v0, v[8:11] offset:6144
 v_max3_u32 v16, v8, v9, v10
 s_waitcnt vmcnt(0)
 ds_write_b128 v0, v[12:15] offset:7168
 v_max3_u32 v16, v16, v11, v12
 v_max3_u32 v17, v13, v14, v15
 v_max_u32 v16, v16, v17
 v_cmp_eq_u32 vcc, -1, v16
 s_cmp_eq_u64 vcc, 0
 s_cbranch_scc1 L_b1lr2
 s_cmp_eq_u32 s15, 0
 s_cbranch_scc1 L_b1lr2
 s_sub_u32 s15, s15, 1
 buffer_load_dwordx4 v[8:11], v0, s[4:7], s33 offen offset:0 sc1
 buffer_load_dwordx4 v[12:15], v0, s[4:7], s33 offen offset:1024 sc1
 s_branch L_pmlr2
L_b1lr2:
 s_waitcnt lgkmcnt(2)
 v_smfmac_f32_16x16x64_bf16 v[40:43], v[8:11], v[24:31], v5
 ds_read_b128 v[24:27], v1 offset:4096
 s_waitcnt lgkmcnt(1)
 v_smfmac_f32_16x16x64_bf16 v[44:47], v[8:11], v[32:39], v5
 ds_read_b128 v[28:31], v1 offset:5120
 v_smfmac_f32_16x16x64_bf16 v[40:43], v[12:15], a[32:39], v5
 ds_read_b128 v[32:35], v1 offset:6144
 v_smfmac_f32_16x16x64_bf16 v[44:47], v[12:15], a[40:47], v5
 ds_read_b128 v[36:39], v1 offset:7168
 s_waitcnt lgkmcnt(4)
 s_barrier
 ds_read_b128 v[16:19], v0 offset:8192
 ds_read_b128 v[20:23], v0 offset:0
 v_smfmac_f32_16x16x64_bf16 v[48:51], v[8:11], a[0:7], v5
 v_smfmac_f32_16x16x64_bf16 v[52:55], v[8:11], a[8:15], v5
 ds_read_b128 v[8:11], v0 offset:1024
 v_smfmac_f32_16x16x64_bf16 v[48:51], v[12:15], a[48:55], v5
 v_smfmac_f32_16x16x64_bf16 v[52:55], v[12:15], a[56:63], v5
 ds_read_b128 v[12:15], v0 offset:2048
 s_waitcnt lgkmcnt(3)
 v_smfmac_f32_16x16x64_bf16 v[40:43], v[16:19], a[80:87], v5
 v_smfmac_f32_16x16x64_bf16 v[44:47], v[16:19], a[88:95], v5
 v_smfmac_f32_16x16x64_bf16 v[48:51], v[16:19], v[24:31], v5
 ds_read_b128 v[24:27], v1 offset:12288
 v_smfmac_f32_16x16x64_bf16 v[52:55], v[16:19], v[32:39], v5
 ds_read_b128 v[16:19], v0 offset:3072
 s_waitcnt lgkmcnt(4)
 v_smfmac_f32_16x16x64_bf16 v[40:43], v[20:23], a[112:119], v5
 ds_read_b128 v[28:31], v1 offset:13312
 v_smfmac_f32_16x16x64_bf16 v[44:47], v[20:23], a[120:127], v5
 ds_read_b128 v[20:23], v0 offset:4096
 s_waitcnt lgkmcnt(5)
 v_smfmac_f32_16x16x64_bf16 v[40:43], v[8:11], a[160:167], v5
 ds_read_b128 v[32:35], v1 offset:14336
 v_smfmac_f32_16x16x64_bf16 v[44:47], v[8:11], a[168:175], v5
 ds_read_b128 v[8:11], v0 offset:5120
 s_waitcnt lgkmcnt(6)
 v_smfmac_f32_16x16x64_bf16 v[40:43], v[12:15], a[192:199], v5
 ds_read_b128 v[36:39], v1 offset:15360
 v_smfmac_f32_16x16x64_bf16 v[44:47], v[12:15], a[200:207], v5
 s_waitcnt lgkmcnt(5)
 v_smfmac_f32_16x16x64_bf16 v[40:43], v[16:19], a[208:215], v5
 v_smfmac_f32_16x16x64_bf16 v[44:47], v[16:19], a[216:223], v5
 s_waitcnt lgkmcnt(3)
 v_smfmac_f32_16x16x64_bf16 v[40:43], v[20:23], v[80:87], v5
 s_waitcnt lgkmcnt(1)
 v_smfmac_f32_16x16x64_bf16 v[40:43], v[8:11], v[128:135], v5
 v_smfmac_f32_16x16x64_bf16 v[44:47], v[20:23], v[88:95], v5
 s_waitcnt lgkmcnt(0)
 v_smfmac_f32_16x16x64_bf16 v[44:47], v[8:11], v[136:143], v5
 v_pk_mul_f32 v[40:41], v[40:41], s[54:55]
 v_smfmac_f32_16x16x64_bf16 v[48:51], v[12:15], v[24:31], v5
 ds_read_b128 v[24:27], v1 offset:8192
 v_pk_mul_f32 v[42:43], v[42:43], s[54:55]
 v_smfmac_f32_16x16x64_bf16 v[52:55], v[12:15], v[32:39], v5
 ds_read_b128 v[12:15], v0 offset:0
 v_cvt_pk_bf16_f32 v40, v40, v41
 v_smfmac_f32_16x16x64_bf16 v[48:51], v[16:19], a[224:231], v5
 ds_read_b128 v[28:31], v1 offset:9216
 v_cvt_pk_bf16_f32 v41, v42, v43
 v_smfmac_f32_16x16x64_bf16 v[52:55], v[16:19], a[232:239], v5
 ds_read_b128 v[16:19], v0 offset:1024
 v_pk_mul_f32 v[44:45], v[44:45], s[54:55]
 v_mfma_f32_16x16x16_bf16 v[40:43], v[40:41], v[6:7], 0
 ds_read_b128 v[32:35], v1 offset:10240
 v_pk_mul_f32 v[46:47], v[46:47], s[54:55]
 v_smfmac_f32_16x16x64_bf16 v[48:51], v[20:23], v[96:103], v5
 ds_read_b128 v[36:39], v1 offset:11264
 v_cvt_pk_bf16_f32 v44, v44, v45
 v_smfmac_f32_16x16x64_bf16 v[48:51], v[8:11], v[144:151], v5
 s_waitcnt lgkmcnt(4)
 v_cvt_pk_bf16_f32 v45, v46, v47
 v_smfmac_f32_16x16x64_bf16 v[48:51], v[12:15], a[128:135], v5
 v_cvt_pk_bf16_f32 v40, v40, v41
 v_mfma_f32_16x16x16_bf16 v[44:47], v[44:45], v[6:7], 0
 v_cvt_pk_bf16_f32 v41, v42, v43
 v_smfmac_f32_16x16x64_bf16 v[52:55], v[20:23], v[104:111], v5
 s_waitcnt lgkmcnt(2)
 v_smfmac_f32_16x16x64_bf16 v[48:51], v[16:19], v[24:31], v5
 ds_read_b128 v[24:27], v1 offset:16384
 v_cvt_pk_bf16_f32 v42, v44, v45
 v_smfmac_f32_16x16x64_bf16 v[52:55], v[8:11], v[152:159], v5
 ds_read_b128 v[28:31], v1 offset:17408
 v_cvt_pk_bf16_f32 v43, v46, v47
 v_smfmac_f32_16x16x64_bf16 v[52:55], v[12:15], a[136:143], v5
 s_waitcnt lgkmcnt(2)
 v_cvt_pk_bf16_f32 v48, v48, v49
 v_smfmac_f32_16x16x64_bf16 v[52:55], v[16:19], v[32:39], v5
 ds_read_b128 v[32:35], v1 offset:18432
 s_waitcnt vmcnt(2)
 v_cvt_pk_bf16_f32 v49, v50, v51
 ds_read_b128 v[36:39], v1 offset:19456
 s_add_u32 s33, s58, 37748736
 v_mfma_f32_16x16x16_bf16 v[48:51], v[48:49], v[6:7], 0
 v_mfma_f32_16x16x32_bf16 v[64:67], v[64:67], v[40:43], 0
 v_cvt_pk_bf16_f32 v52, v52, v53
 v_cvt_pk_bf16_f32 v53, v54, v55
 v_mfma_f32_16x16x32_bf16 v[68:71], v[68:71], v[40:43], 0
 v_mfma_f32_16x16x16_bf16 v[52:55], v[52:53], v[6:7], 0
 v_cvt_pk_bf16_f32 v48, v48, v49
 v_cvt_pk_bf16_f32 v49, v50, v51
 v_smfmac_f32_16x16x64_bf16 v[56:59], v[20:23], v[112:119], v5
 v_mov_b32_dpp v64, v68 quad_perm:[0,1,2,3] row_mask:0xf bank_mask:0xc
 v_mov_b32_dpp v65, v69 quad_perm:[0,1,2,3] row_mask:0xf bank_mask:0xc
 v_smfmac_f32_16x16x64_bf16 v[60:63], v[20:23], v[120:127], v5
 ds_read_b128 v[20:23], v0 offset:6144
 v_cvt_pk_bf16_f32 v50, v52, v53
 v_cvt_pk_bf16_f32 v51, v54, v55
 v_mov_b32_dpp v66, v70 quad_perm:[0,1,2,3] row_mask:0xf bank_mask:0xc
 v_mov_b32_dpp v67, v71 quad_perm:[0,1,2,3] row_mask:0xf bank_mask:0xc
 v_mfma_f32_16x16x32_bf16 v[44:47], v[48:51], v[40:43], 0
 ds_write_b128 v0, v[64:67] offset:11264
 v_smfmac_f32_16x16x64_bf16 v[56:59], v[8:11], v[160:167], v5
 buffer_store_dwordx4 v[48:51], v0, s[4:7], s33 offen sc1
 v_smfmac_f32_16x16x64_bf16 v[60:63], v[8:11], v[168:175], v5
 ds_read_b128 v[8:11], v0 offset:7168
 v_cndmask_b32 v52, v45, v44, s[56:57]
 v_cndmask_b32 v53, v47, v46, s[56:57]
 v_cndmask_b32 v52, v52, v53, s[60:61]
 ds_write_b32 v0, v52 offset:13320
 v_smfmac_f32_16x16x64_bf16 v[56:59], v[12:15], a[144:151], v5
 v_smfmac_f32_16x16x64_bf16 v[60:63], v[12:15], a[152:159], v5
 ds_read_b128 v[12:15], v0 offset:8192
 v_smfmac_f32_16x16x64_bf16 v[56:59], v[16:19], a[176:183], v5
 v_smfmac_f32_16x16x64_bf16 v[60:63], v[16:19], a[184:191], v5
 ds_read_b128 v[16:19], v0 offset:2048
 s_waitcnt lgkmcnt(2)
 s_barrier
 ds_read_b128 v[64:67], v0 offset:13312
 ds_read_b128 v[40:43], v0 offset:9216
 ds_read_b128 v[44:47], v0 offset:10240
 ds_read_b128 v[48:51], v0 offset:11264
 ds_read_b128 v[52:55], v0 offset:12288
 v_smfmac_f32_16x16x64_bf16 v[56:59], v[20:23], a[16:23], v5
 v_smfmac_f32_16x16x64_bf16 v[60:63], v[20:23], a[24:31], v5
 ds_read_b128 v[20:23], v0 offset:3072
 v_smfmac_f32_16x16x64_bf16 v[56:59], v[8:11], a[64:71], v5
 v_smfmac_f32_16x16x64_bf16 v[60:63], v[8:11], a[72:79], v5
 s_waitcnt lgkmcnt(7)
 s_waitcnt lgkmcnt(5)
 v_smfmac_f32_16x16x64_bf16 v[56:59], v[12:15], a[96:103], v5
 v_add_f32 v64, v64, v65
 v_smfmac_f32_16x16x64_bf16 v[60:63], v[12:15], a[104:111], v5
 s_waitcnt lgkmcnt(3)
 v_add_f32 v66, v66, v67
 v_smfmac_f32_16x16x64_bf16 v[56:59], v[16:19], v[24:31], v5
 v_pk_add_f32 v[40:41], v[40:41], v[44:45]
 v_smfmac_f32_16x16x64_bf16 v[60:63], v[16:19], v[32:39], v5
 s_waitcnt lgkmcnt(2)
 v_pk_add_f32 v[42:43], v[42:43], v[46:47]
 v_pk_add_f32 v[40:41], v[40:41], v[48:49]
 v_pk_add_f32 v[42:43], v[42:43], v[50:51]
 v_add_f32 v64, v64, v66
 s_waitcnt lgkmcnt(1)
 v_pk_add_f32 v[44:45], v[40:41], v[52:53]
 v_pk_add_f32 v[46:47], v[42:43], v[54:55]
 s_waitcnt lgkmcnt(0)
 v_smfmac_f32_16x16x64_bf16 v[56:59], v[20:23], a[240:247], v5
 v_max3_f32 v68, v44, v45, v46
 v_mov_b64 v[48:49], s[70:71]
 v_smfmac_f32_16x16x64_bf16 v[60:63], v[20:23], a[248:255], v5
 ds_read_b128 v[24:27], v1 offset:24576
 v_max3_f32 v68, v68, v47, v64
 v_mov_b64 v[50:51], s[72:73]
 ds_read_b128 v[28:31], v1 offset:25600
 v_max_f32_dpp v69, v68, v68 row_ror:8 row_mask:0xf bank_mask:0xf
 v_max_f32_dpp v68, v68, v68 row_ror:8 row_mask:0xf bank_mask:0xf
 ds_read_b128 v[32:35], v1 offset:26624
 ds_read_b128 v[36:39], v1 offset:27648
 v_permlane32_swap_b32 v68, v69
 v_max_f32 v70, v68, v69
 v_max_f32 v71, v68, v69
 ds_read_b128 v[8:11], v1 offset:20480
 ds_read_b128 v[12:15], v1 offset:21504
 v_permlane16_swap_b32 v70, v71
 ds_read_b128 v[16:19], v1 offset:22528
 v_max_f32 v68, v70, v71
 v_sub_f32 v64, v64, v68
 v_pk_add_f32 v[44:45], v[44:45], v[68:69] op_sel_hi:[1,0] neg_lo:[0,1] neg_hi:[0,1]
 v_pk_add_f32 v[46:47], v[46:47], v[68:69] op_sel_hi:[1,0] neg_lo:[0,1] neg_hi:[0,1]
 v_exp_f32 v64, v64
 ds_read_b128 v[20:23], v1 offset:23552
 v_exp_f32 v44, v44
 v_mov_b32_dpp v65, v64 row_ror:8 row_mask:0xf bank_mask:0xf
 v_exp_f32 v45, v45
 v_cvt_pk_bf16_f32 v56, v56, v57
 v_exp_f32 v46, v46
 v_cvt_pk_bf16_f32 v40, v64, v65
 v_cvt_pk_bf16_f32 v41, v64, v65
 v_exp_f32 v47, v47
 v_cvt_pk_bf16_f32 v57, v58, v59
 v_cvt_pk_bf16_f32 v42, v44, v45
 v_permlane32_swap_b32 v40, v41
 v_cvt_pk_bf16_f32 v58, v60, v61
 v_cvt_pk_bf16_f32 v43, v46, v47
 v_cvt_pk_bf16_f32 v59, v62, v63
 s_add_u32 s33, s58, 37748736
 v_mov_b32_dpp v44, v42 row_ror:8 row_mask:0xf bank_mask:0xf
 s_cmp_eq_u32 s41, 63
 v_mov_b32_dpp v45, v43 row_ror:8 row_mask:0xf bank_mask:0xf
 s_cbranch_scc1 L_lastlr2
 v_mfma_f32_16x16x32_bf16 v[52:55], v[48:51], v[40:43], 0
 v_lshrrev_b32 v46, 1, v0
 v_and_b32 v47, 0x70, v0
 v_mfma_f32_16x16x16_bf16 v[64:67], v[56:57], v[40:41], 0
 v_and_b32 v46, 0x180, v46
 v_mov_b64 v[60:61], 0
 v_mfma_f32_16x16x16_bf16 v[68:71], v[58:59], v[40:41], 0
 v_or_b32 v46, v46, v47
 v_mov_b64 v[62:63], 0
 buffer_store_dwordx4 v[56:59], v0, s[4:7], s33 offen offset:1024 sc1
 s_waitcnt vmcnt(3)
 v_mfma_f32_16x16x32_bf16 v[64:67], v[72:75], v[42:45], v[64:67]
 v_add_f32_dpp v52, v52, v52 row_ror:8 row_mask:0xf bank_mask:0xf
 v_bfe_u32 v47, v0, 7, 1
 s_waitcnt vmcnt(2)
 v_mfma_f32_16x16x32_bf16 v[68:71], v[76:79], v[42:45], v[68:71]
 v_rcp_f32 v52, v52
 v_lshl_add_u32 v47, v47, 9, v46
 v_mov_b64 v[48:49], 0
 v_mov_b64 v[50:51], 0
 v_mov_b64 v[56:57], 0
 v_mov_b64 v[58:59], 0
 v_pk_mul_f32 v[64:65], v[64:65], v[52:53] op_sel_hi:[1,0]
 v_pk_mul_f32 v[66:67], v[66:67], v[52:53] op_sel_hi:[1,0]
 v_pk_mul_f32 v[68:69], v[68:69], v[52:53] op_sel_hi:[1,0]
 v_pk_mul_f32 v[70:71], v[70:71], v[52:53] op_sel_hi:[1,0]
 v_cvt_pk_bf16_f32 v64, v64, v65
 v_cvt_pk_bf16_f32 v65, v66, v67
 v_cvt_pk_bf16_f32 v66, v68, v69
 v_cvt_pk_bf16_f32 v67, v70, v71
 s_mov_b64 exec, s[56:57]
 ds_write_b128 v46, v[64:67] offset:15360
 s_mov_b64 exec, -1
 v_mov_b32_dpp v64, v64 row_ror:8 row_mask:0xf bank_mask:0xc
 v_mov_b32_dpp v65, v65 row_ror:8 row_mask:0xf bank_mask:0xc
 v_mov_b32_dpp v66, v66 row_ror:8 row_mask:0xf bank_mask:0xc
 v_mov_b32_dpp v67, v67 row_ror:8 row_mask:0xf bank_mask:0xc
 s_bfe_u32 s52, s41, 0x10001
 s_sub_u32 s45, 0, s52
 s_waitcnt lgkmcnt(7)
 v_smfmac_f32_16x16x64_bf16 v[48:51], v[64:67], v[24:31], v5
 ds_read_b128 v[24:27], v1 offset:32768
 ds_read_b128 v[28:31], v1 offset:33792
 v_mov_b64 v[52:53], 0
 v_smfmac_f32_16x16x64_bf16 v[56:59], v[64:67], v[192:199], v5
 s_add_u32 s34, s46, s44
 v_mov_b32 v44, -1
 v_smfmac_f32_16x16x64_bf16 v[60:63], v[64:67], v[224:231], v5
 buffer_store_dword v44, v4, s[4:7], s34 offen
 v_mov_b64 v[54:55], 0
 s_add_u32 s33, s48, s47
 s_add_u32 s34, s59, s47
 s_waitcnt lgkmcnt(2)
 s_barrier
 ds_read_b128 v[68:71], v46 offset:14336
 ds_read_b128 v[72:75], v46 offset:14848
 ds_read_b128 v[76:79], v46 offset:15872
 ds_read_b128 v[40:43], v47 offset:14336
 ds_read_b128 v[44:47], v47 offset:15360
 s_waitcnt lgkmcnt(4)
 v_smfmac_f32_16x16x64_bf16 v[48:51], v[68:71], v[8:15], v5
 ds_read_b128 v[8:11], v1 offset:28672
 s_waitcnt lgkmcnt(4)
 v_smfmac_f32_16x16x64_bf16 v[48:51], v[72:75], v[16:23], v5
 ds_read_b128 v[12:15], v1 offset:29696
 s_waitcnt lgkmcnt(4)
 v_smfmac_f32_16x16x64_bf16 v[48:51], v[76:79], v[32:39], v5
 ds_read_b128 v[16:19], v1 offset:30720
 s_waitcnt lgkmcnt(4)
 v_smfmac_f32_16x16x64_bf16 v[52:55], v[40:43], v[240:247], v5
 ds_read_b128 v[20:23], v1 offset:31744
 s_waitcnt lgkmcnt(4)
 v_smfmac_f32_16x16x64_bf16 v[52:55], v[44:47], v[248:255], v5
 ds_read_b128 v[32:35], v1 offset:34816
 v_cvt_pk_bf16_f32 v48, v48, v49
 v_smfmac_f32_16x16x64_bf16 v[56:59], v[68:71], v[176:183], v5
 ds_read_b128 v[36:39], v1 offset:35840
 s_add_u32 s35, s33, 131072
 v_cvt_pk_bf16_f32 v49, v50, v51
 v_smfmac_f32_16x16x64_bf16 v[56:59], v[72:75], v[184:191], v5
 v_and_or_b32 v48, v48, -2, s52
 v_permlane32_swap_b32 v52, v54
 v_smfmac_f32_16x16x64_bf16 v[56:59], v[76:79], v[200:207], v5
 buffer_store_dwordx2 v[48:49], v3, s[4:7], s35 offen
 v_permlane32_swap_b32 v53, v55
 v_smfmac_f32_16x16x64_bf16 v[60:63], v[68:71], v[208:215], v5
 v_mov_b64 v[40:41], 0
 v_add_f32 v52, v52, v54
 v_smfmac_f32_16x16x64_bf16 v[60:63], v[72:75], v[216:223], v5
 v_mov_b64 v[42:43], 0
 v_add_f32 v53, v53, v55
 v_smfmac_f32_16x16x64_bf16 v[60:63], v[76:79], v[232:239], v5
 s_add_u32 s35, s33, 0
 v_cvt_pk_bf16_f32 v56, v56, v57
 v_cvt_pk_bf16_f32 v52, v52, v53
 v_smfmac_f32_16x16x64_bf16 v[40:43], v[64:67], v[24:31], v5
 v_cvt_pk_bf16_f32 v57, v58, v59
 v_and_or_b32 v52, v52, -2, s52
 s_waitcnt lgkmcnt(4)
 v_smfmac_f32_16x16x64_bf16 v[40:43], v[68:71], v[8:15], v5
 buffer_store_dword v52, v2, s[4:7], s34 offen
 v_and_or_b32 v56, v56, -2, s52
 v_cvt_pk_bf16_f32 v60, v60, v61
 s_waitcnt lgkmcnt(2)
 v_smfmac_f32_16x16x64_bf16 v[40:43], v[72:75], v[16:23], v5
 buffer_store_dwordx2 v[56:57], v3, s[4:7], s35 offen
 s_add_u32 s35, s33, 65536
 v_cvt_pk_bf16_f32 v61, v62, v63
 s_waitcnt lgkmcnt(0)
 v_smfmac_f32_16x16x64_bf16 v[40:43], v[76:79], v[32:39], v5
 v_and_or_b32 v60, v60, -2, s52
 buffer_store_dwordx2 v[60:61], v3, s[4:7], s35 offen
 s_add_u32 s35, s33, 196608
 s_mov_b32 s36, s42
 s_mov_b32 s42, s43
 s_mov_b32 s43, s44
 s_mov_b32 s44, s36
 s_xor_b32 s47, s47, 294912
 s_add_u32 s41, s41, 1
 s_add_u32 s58, s58, 262144
 v_cvt_pk_bf16_f32 v40, v40, v41
 v_cvt_pk_bf16_f32 v41, v42, v43
 v_and_or_b32 v40, v40, -2, s52
 buffer_store_dwordx2 v[40:41], v3, s[4:7], s35 offen
 s_branch L_cslr2
L_lastlr2:
 buffer_store_dwordx4 v[56:59], v0, s[4:7], s33 offen offset:1024 sc1
 s_branch L_chx
L_celn2:
 v_mov_b64 v[40:41], 0
 v_mov_b64 v[42:43], 0
 v_mov_b64 v[44:45], 0
 v_mov_b64 v[46:47], 0
 v_mov_b64 v[48:49], 0
 v_mov_b64 v[50:51], 0
 v_mov_b64 v[52:53], 0
 v_mov_b64 v[54:55], 0
 v_mov_b64 v[56:57], 0
 v_mov_b64 v[58:59], 0
 v_mov_b64 v[60:61], 0
 v_mov_b64 v[62:63], 0
 ds_read_b128 v[24:27], v1 offset:0
 ds_read_b128 v[28:31], v1 offset:1024
 ds_read_b128 v[32:35], v1 offset:2048
 ds_read_b128 v[36:39], v1 offset:3072
 s_barrier
 s_add_u32 s34, s58, 4194304
 s_add_u32 s35, s58, 20971520
 buffer_load_dwordx4 v[64:67], v0, s[4:7], s34 offen offset:0
 buffer_load_dwordx4 v[68:71], v0, s[4:7], s34 offen offset:1024
 buffer_load_dwordx4 v[72:75], v0, s[4:7], s35 offen offset:0
 buffer_load_dwordx4 v[76:79], v0, s[4:7], s35 offen offset:1024
 s_branch L_b1ln2
L_csln2:
 s_add_u32 s34, s58, 4194304
 s_add_u32 s35, s58, 20971520
 buffer_load_dwordx4 v[64:67], v0, s[4:7], s34 offen offset:0
 buffer_load_dwordx4 v[68:71], v0, s[4:7], s34 offen offset:1024
 buffer_load_dwordx4 v[72:75], v0, s[4:7], s35 offen offset:0
 buffer_load_dwordx4 v[76:79], v0, s[4:7], s35 offen offset:1024
 s_barrier
 s_add_u32 s33, s42, 159389696
 v_mov_b64 v[40:41], 0
 v_mov_b64 v[42:43], 0
 v_mov_b64 v[44:45], 0
 v_mov_b64 v[46:47], 0
 v_mov_b64 v[48:49], 0
 v_mov_b64 v[50:51], 0
 v_mov_b64 v[52:53], 0
 v_mov_b64 v[54:55], 0
 v_mov_b64 v[56:57], 0
 v_mov_b64 v[58:59], 0
 v_mov_b64 v[60:61], 0
 v_mov_b64 v[62:63], 0
 ds_read_b128 v[24:27], v1 offset:0
 ds_read_b128 v[28:31], v1 offset:1024
 ds_read_b128 v[32:35], v1 offset:2048
 ds_read_b128 v[36:39], v1 offset:3072
 buffer_load_dwordx4 v[8:11], v0, s[4:7], s33 offen offset:0 sc1
 buffer_load_dwordx4 v[12:15], v0, s[4:7], s33 offen offset:1024 sc1
L_pmln2:
 s_waitcnt vmcnt(1)
 ds_write_b128 v0, v[8:11] offset:6144
 v_max3_u32 v16, v8, v9, v10
 s_waitcnt vmcnt(0)
 ds_write_b128 v0, v[12:15] offset:7168
 v_max3_u32 v16, v16, v11, v12
 v_max3_u32 v17, v13, v14, v15
 v_max_u32 v16, v16, v17
 v_cmp_eq_u32 vcc, -1, v16
 s_cmp_eq_u64 vcc, 0
 s_cbranch_scc1 L_b1ln2
 s_cmp_eq_u32 s15, 0
 s_cbranch_scc1 L_b1ln2
 s_sub_u32 s15, s15, 1
 buffer_load_dwordx4 v[8:11], v0, s[4:7], s33 offen offset:0 sc1
 buffer_load_dwordx4 v[12:15], v0, s[4:7], s33 offen offset:1024 sc1
 s_branch L_pmln2
L_b1ln2:
 s_waitcnt lgkmcnt(2)
 v_smfmac_f32_16x16x64_bf16 v[40:43], v[8:11], v[24:31], v5
 ds_read_b128 v[24:27], v1 offset:4096
 s_waitcnt lgkmcnt(1)
 v_smfmac_f32_16x16x64_bf16 v[44:47], v[8:11], v[32:39], v5
 ds_read_b128 v[28:31], v1 offset:5120
 v_smfmac_f32_16x16x64_bf16 v[40:43], v[12:15], a[32:39], v5
 ds_read_b128 v[32:35], v1 offset:6144
 v_smfmac_f32_16x16x64_bf16 v[44:47], v[12:15], a[40:47], v5
 ds_read_b128 v[36:39], v1 offset:7168
 s_waitcnt lgkmcnt(4)
 s_barrier
 ds_read_b128 v[16:19], v0 offset:8192
 ds_read_b128 v[20:23], v0 offset:0
 v_smfmac_f32_16x16x64_bf16 v[48:51], v[8:11], a[0:7], v5
 v_smfmac_f32_16x16x64_bf16 v[52:55], v[8:11], a[8:15], v5
 ds_read_b128 v[8:11], v0 offset:1024
 v_smfmac_f32_16x16x64_bf16 v[48:51], v[12:15], a[48:55], v5
 v_smfmac_f32_16x16x64_bf16 v[52:55], v[12:15], a[56:63], v5
 ds_read_b128 v[12:15], v0 offset:2048
 s_waitcnt lgkmcnt(3)
 v_smfmac_f32_16x16x64_bf16 v[40:43], v[16:19], a[80:87], v5
 v_smfmac_f32_16x16x64_bf16 v[44:47], v[16:19], a[88:95], v5
 v_smfmac_f32_16x16x64_bf16 v[48:51], v[16:19], v[24:31], v5
 ds_read_b128 v[24:27], v1 offset:12288
 v_smfmac_f32_16x16x64_bf16 v[52:55], v[16:19], v[32:39], v5
 ds_read_b128 v[16:19], v0 offset:3072
 s_waitcnt lgkmcnt(4)
 v_smfmac_f32_16x16x64_bf16 v[40:43], v[20:23], a[112:119], v5
 ds_read_b128 v[28:31], v1 offset:13312
 v_smfmac_f32_16x16x64_bf16 v[44:47], v[20:23], a[120:127], v5
 ds_read_b128 v[20:23], v0 offset:4096
 s_waitcnt lgkmcnt(5)
 v_smfmac_f32_16x16x64_bf16 v[40:43], v[8:11], a[160:167], v5
 ds_read_b128 v[32:35], v1 offset:14336
 v_smfmac_f32_16x16x64_bf16 v[44:47], v[8:11], a[168:175], v5
 ds_read_b128 v[8:11], v0 offset:5120
 s_waitcnt lgkmcnt(6)
 v_smfmac_f32_16x16x64_bf16 v[40:43], v[12:15], a[192:199], v5
 ds_read_b128 v[36:39], v1 offset:15360
 v_smfmac_f32_16x16x64_bf16 v[44:47], v[12:15], a[200:207], v5
 s_waitcnt lgkmcnt(5)
 v_smfmac_f32_16x16x64_bf16 v[40:43], v[16:19], a[208:215], v5
 v_smfmac_f32_16x16x64_bf16 v[44:47], v[16:19], a[216:223], v5
 s_waitcnt lgkmcnt(3)
 v_smfmac_f32_16x16x64_bf16 v[40:43], v[20:23], v[80:87], v5
 s_waitcnt lgkmcnt(1)
 v_smfmac_f32_16x16x64_bf16 v[40:43], v[8:11], v[128:135], v5
 v_smfmac_f32_16x16x64_bf16 v[44:47], v[20:23], v[88:95], v5
 s_waitcnt lgkmcnt(0)
 v_smfmac_f32_16x16x64_bf16 v[44:47], v[8:11], v[136:143], v5
 v_pk_mul_f32 v[40:41], v[40:41], s[54:55]
 v_smfmac_f32_16x16x64_bf16 v[48:51], v[12:15], v[24:31], v5
 ds_read_b128 v[24:27], v1 offset:8192
 v_pk_mul_f32 v[42:43], v[42:43], s[54:55]
 v_smfmac_f32_16x16x64_bf16 v[52:55], v[12:15], v[32:39], v5
 ds_read_b128 v[12:15], v0 offset:0
 v_cvt_pk_bf16_f32 v40, v40, v41
 v_smfmac_f32_16x16x64_bf16 v[48:51], v[16:19], a[224:231], v5
 ds_read_b128 v[28:31], v1 offset:9216
 v_cvt_pk_bf16_f32 v41, v42, v43
 v_smfmac_f32_16x16x64_bf16 v[52:55], v[16:19], a[232:239], v5
 ds_read_b128 v[16:19], v0 offset:1024
 v_pk_mul_f32 v[44:45], v[44:45], s[54:55]
 v_mfma_f32_16x16x16_bf16 v[40:43], v[40:41], v[6:7], 0
 ds_read_b128 v[32:35], v1 offset:10240
 v_pk_mul_f32 v[46:47], v[46:47], s[54:55]
 v_smfmac_f32_16x16x64_bf16 v[48:51], v[20:23], v[96:103], v5
 ds_read_b128 v[36:39], v1 offset:11264
 v_cvt_pk_bf16_f32 v44, v44, v45
 v_smfmac_f32_16x16x64_bf16 v[48:51], v[8:11], v[144:151], v5
 s_waitcnt lgkmcnt(4)
 v_cvt_pk_bf16_f32 v45, v46, v47
 v_smfmac_f32_16x16x64_bf16 v[48:51], v[12:15], a[128:135], v5
 v_cvt_pk_bf16_f32 v40, v40, v41
 v_mfma_f32_16x16x16_bf16 v[44:47], v[44:45], v[6:7], 0
 v_cvt_pk_bf16_f32 v41, v42, v43
 v_smfmac_f32_16x16x64_bf16 v[52:55], v[20:23], v[104:111], v5
 s_waitcnt lgkmcnt(2)
 v_smfmac_f32_16x16x64_bf16 v[48:51], v[16:19], v[24:31], v5
 ds_read_b128 v[24:27], v1 offset:16384
 v_cvt_pk_bf16_f32 v42, v44, v45
 v_smfmac_f32_16x16x64_bf16 v[52:55], v[8:11], v[152:159], v5
 ds_read_b128 v[28:31], v1 offset:17408
 v_cvt_pk_bf16_f32 v43, v46, v47
 v_smfmac_f32_16x16x64_bf16 v[52:55], v[12:15], a[136:143], v5
 s_waitcnt lgkmcnt(2)
 v_cvt_pk_bf16_f32 v48, v48, v49
 v_smfmac_f32_16x16x64_bf16 v[52:55], v[16:19], v[32:39], v5
 ds_read_b128 v[32:35], v1 offset:18432
 s_waitcnt vmcnt(2)
 v_cvt_pk_bf16_f32 v49, v50, v51
 ds_read_b128 v[36:39], v1 offset:19456
 s_add_u32 s33, s58, 37748736
 v_mfma_f32_16x16x16_bf16 v[48:51], v[48:49], v[6:7], 0
 v_mfma_f32_16x16x32_bf16 v[64:67], v[64:67], v[40:43], 0
 v_cvt_pk_bf16_f32 v52, v52, v53
 v_cvt_pk_bf16_f32 v53, v54, v55
 v_mfma_f32_16x16x32_bf16 v[68:71], v[68:71], v[40:43], 0
 v_mfma_f32_16x16x16_bf16 v[52:55], v[52:53], v[6:7], 0
 v_cvt_pk_bf16_f32 v48, v48, v49
 v_cvt_pk_bf16_f32 v49, v50, v51
 v_smfmac_f32_16x16x64_bf16 v[56:59], v[20:23], v[112:119], v5
 v_mov_b32_dpp v64, v68 quad_perm:[0,1,2,3] row_mask:0xf bank_mask:0xc
 v_mov_b32_dpp v65, v69 quad_perm:[0,1,2,3] row_mask:0xf bank_mask:0xc
 v_smfmac_f32_16x16x64_bf16 v[60:63], v[20:23], v[120:127], v5
 ds_read_b128 v[20:23], v0 offset:6144
 v_cvt_pk_bf16_f32 v50, v52, v53
 v_cvt_pk_bf16_f32 v51, v54, v55
 v_mov_b32_dpp v66, v70 quad_perm:[0,1,2,3] row_mask:0xf bank_mask:0xc
 v_mov_b32_dpp v67, v71 quad_perm:[0,1,2,3] row_mask:0xf bank_mask:0xc
 v_mfma_f32_16x16x32_bf16 v[44:47], v[48:51], v[40:43], 0
 ds_write_b128 v0, v[64:67] offset:11264
 v_smfmac_f32_16x16x64_bf16 v[56:59], v[8:11], v[160:167], v5
 buffer_store_dwordx4 v[48:51], v0, s[4:7], s33 offen sc1
 v_smfmac_f32_16x16x64_bf16 v[60:63], v[8:11], v[168:175], v5
 ds_read_b128 v[8:11], v0 offset:7168
 v_cndmask_b32 v52, v45, v44, s[56:57]
 v_cndmask_b32 v53, v47, v46, s[56:57]
 v_cndmask_b32 v52, v52, v53, s[60:61]
 ds_write_b32 v0, v52 offset:13320
 v_smfmac_f32_16x16x64_bf16 v[56:59], v[12:15], a[144:151], v5
 v_smfmac_f32_16x16x64_bf16 v[60:63], v[12:15], a[152:159], v5
 ds_read_b128 v[12:15], v0 offset:8192
 v_smfmac_f32_16x16x64_bf16 v[56:59], v[16:19], a[176:183], v5
 v_smfmac_f32_16x16x64_bf16 v[60:63], v[16:19], a[184:191], v5
 ds_read_b128 v[16:19], v0 offset:2048
 s_waitcnt lgkmcnt(2)
 s_barrier
 ds_read_b128 v[64:67], v0 offset:13312
 ds_read_b128 v[40:43], v0 offset:9216
 ds_read_b128 v[44:47], v0 offset:10240
 ds_read_b128 v[48:51], v0 offset:11264
 ds_read_b128 v[52:55], v0 offset:12288
 v_smfmac_f32_16x16x64_bf16 v[56:59], v[20:23], a[16:23], v5
 v_smfmac_f32_16x16x64_bf16 v[60:63], v[20:23], a[24:31], v5
 ds_read_b128 v[20:23], v0 offset:3072
 v_smfmac_f32_16x16x64_bf16 v[56:59], v[8:11], a[64:71], v5
 v_smfmac_f32_16x16x64_bf16 v[60:63], v[8:11], a[72:79], v5
 s_waitcnt lgkmcnt(7)
 s_waitcnt lgkmcnt(5)
 v_smfmac_f32_16x16x64_bf16 v[56:59], v[12:15], a[96:103], v5
 v_add_f32 v64, v64, v65
 v_smfmac_f32_16x16x64_bf16 v[60:63], v[12:15], a[104:111], v5
 s_waitcnt lgkmcnt(3)
 v_add_f32 v66, v66, v67
 v_smfmac_f32_16x16x64_bf16 v[56:59], v[16:19], v[24:31], v5
 v_pk_add_f32 v[40:41], v[40:41], v[44:45]
 v_smfmac_f32_16x16x64_bf16 v[60:63], v[16:19], v[32:39], v5
 s_waitcnt lgkmcnt(2)
 v_pk_add_f32 v[42:43], v[42:43], v[46:47]
 v_pk_add_f32 v[40:41], v[40:41], v[48:49]
 v_pk_add_f32 v[42:43], v[42:43], v[50:51]
 v_add_f32 v64, v64, v66
 s_waitcnt lgkmcnt(1)
 v_pk_add_f32 v[44:45], v[40:41], v[52:53]
 v_pk_add_f32 v[46:47], v[42:43], v[54:55]
 s_waitcnt lgkmcnt(0)
 v_smfmac_f32_16x16x64_bf16 v[56:59], v[20:23], a[240:247], v5
 v_max3_f32 v68, v44, v45, v46
 v_mov_b64 v[48:49], s[70:71]
 v_smfmac_f32_16x16x64_bf16 v[60:63], v[20:23], a[248:255], v5
 ds_read_b128 v[24:27], v1 offset:24576
 v_max3_f32 v68, v68, v47, v64
 v_mov_b64 v[50:51], s[72:73]
 ds_read_b128 v[28:31], v1 offset:25600
 v_max_f32_dpp v69, v68, v68 row_ror:8 row_mask:0xf bank_mask:0xf
 v_max_f32_dpp v68, v68, v68 row_ror:8 row_mask:0xf bank_mask:0xf
 ds_read_b128 v[32:35], v1 offset:26624
 ds_read_b128 v[36:39], v1 offset:27648
 v_permlane32_swap_b32 v68, v69
 v_max_f32 v70, v68, v69
 v_max_f32 v71, v68, v69
 ds_read_b128 v[8:11], v1 offset:20480
 ds_read_b128 v[12:15], v1 offset:21504
 v_permlane16_swap_b32 v70, v71
 ds_read_b128 v[16:19], v1 offset:22528
 v_max_f32 v68, v70, v71
 v_sub_f32 v64, v64, v68
 v_pk_add_f32 v[44:45], v[44:45], v[68:69] op_sel_hi:[1,0] neg_lo:[0,1] neg_hi:[0,1]
 v_pk_add_f32 v[46:47], v[46:47], v[68:69] op_sel_hi:[1,0] neg_lo:[0,1] neg_hi:[0,1]
 v_exp_f32 v64, v64
 ds_read_b128 v[20:23], v1 offset:23552
 v_exp_f32 v44, v44
 v_mov_b32_dpp v65, v64 row_ror:8 row_mask:0xf bank_mask:0xf
 v_exp_f32 v45, v45
 v_cvt_pk_bf16_f32 v56, v56, v57
 v_exp_f32 v46, v46
 v_cvt_pk_bf16_f32 v40, v64, v65
 v_cvt_pk_bf16_f32 v41, v64, v65
 v_exp_f32 v47, v47
 v_cvt_pk_bf16_f32 v57, v58, v59
 v_cvt_pk_bf16_f32 v42, v44, v45
 v_permlane32_swap_b32 v40, v41
 v_cvt_pk_bf16_f32 v58, v60, v61
 v_cvt_pk_bf16_f32 v43, v46, v47
 v_cvt_pk_bf16_f32 v59, v62, v63
 s_add_u32 s33, s58, 37748736
 v_mov_b32_dpp v44, v42 row_ror:8 row_mask:0xf bank_mask:0xf
 s_cmp_eq_u32 s41, 63
 v_mov_b32_dpp v45, v43 row_ror:8 row_mask:0xf bank_mask:0xf
 s_cbranch_scc1 L_lastln2
 v_mfma_f32_16x16x32_bf16 v[52:55], v[48:51], v[40:43], 0
 v_lshrrev_b32 v46, 1, v0
 v_and_b32 v47, 0x70, v0
 v_mfma_f32_16x16x16_bf16 v[64:67], v[56:57], v[40:41], 0
 v_and_b32 v46, 0x180, v46
 v_mov_b64 v[60:61], 0
 v_mfma_f32_16x16x16_bf16 v[68:71], v[58:59], v[40:41], 0
 v_or_b32 v46, v46, v47
 v_mov_b64 v[62:63], 0
 buffer_store_dwordx4 v[56:59], v0, s[4:7], s33 offen offset:1024 sc1
 s_waitcnt vmcnt(3)
 v_mfma_f32_16x16x32_bf16 v[64:67], v[72:75], v[42:45], v[64:67]
 v_add_f32_dpp v52, v52, v52 row_ror:8 row_mask:0xf bank_mask:0xf
 v_bfe_u32 v47, v0, 7, 1
 s_waitcnt vmcnt(2)
 v_mfma_f32_16x16x32_bf16 v[68:71], v[76:79], v[42:45], v[68:71]
 v_rcp_f32 v52, v52
 v_lshl_add_u32 v47, v47, 9, v46
 v_mov_b64 v[48:49], 0
 v_mov_b64 v[50:51], 0
 v_mov_b64 v[56:57], 0
 v_mov_b64 v[58:59], 0
 v_pk_mul_f32 v[64:65], v[64:65], v[52:53] op_sel_hi:[1,0]
 v_pk_mul_f32 v[66:67], v[66:67], v[52:53] op_sel_hi:[1,0]
 v_pk_mul_f32 v[68:69], v[68:69], v[52:53] op_sel_hi:[1,0]
 v_pk_mul_f32 v[70:71], v[70:71], v[52:53] op_sel_hi:[1,0]
 v_cvt_pk_bf16_f32 v64, v64, v65
 v_cvt_pk_bf16_f32 v65, v66, v67
 v_cvt_pk_bf16_f32 v66, v68, v69
 v_cvt_pk_bf16_f32 v67, v70, v71
 s_mov_b64 exec, s[56:57]
 ds_write_b128 v46, v[64:67] offset:15360
 s_mov_b64 exec, -1
 v_mov_b32_dpp v64, v64 row_ror:8 row_mask:0xf bank_mask:0xc
 v_mov_b32_dpp v65, v65 row_ror:8 row_mask:0xf bank_mask:0xc
 v_mov_b32_dpp v66, v66 row_ror:8 row_mask:0xf bank_mask:0xc
 v_mov_b32_dpp v67, v67 row_ror:8 row_mask:0xf bank_mask:0xc
 s_bfe_u32 s52, s41, 0x10001
 s_sub_u32 s45, 0, s52
 s_waitcnt lgkmcnt(7)
 v_smfmac_f32_16x16x64_bf16 v[48:51], v[64:67], v[24:31], v5
 ds_read_b128 v[24:27], v1 offset:32768
 ds_read_b128 v[28:31], v1 offset:33792
 v_mov_b64 v[52:53], 0
 v_smfmac_f32_16x16x64_bf16 v[56:59], v[64:67], v[192:199], v5
 v_mov_b64 v[54:55], 0
 v_smfmac_f32_16x16x64_bf16 v[60:63], v[64:67], v[224:231], v5
 s_add_u32 s33, s48, s47
 s_add_u32 s34, s59, s47
 s_waitcnt lgkmcnt(2)
 s_barrier
 ds_read_b128 v[68:71], v46 offset:14336
 ds_read_b128 v[72:75], v46 offset:14848
 ds_read_b128 v[76:79], v46 offset:15872
 ds_read_b128 v[40:43], v47 offset:14336
 ds_read_b128 v[44:47], v47 offset:15360
 s_waitcnt lgkmcnt(4)
 v_smfmac_f32_16x16x64_bf16 v[48:51], v[68:71], v[8:15], v5
 ds_read_b128 v[8:11], v1 offset:28672
 s_waitcnt lgkmcnt(4)
 v_smfmac_f32_16x16x64_bf16 v[48:51], v[72:75], v[16:23], v5
 ds_read_b128 v[12:15], v1 offset:29696
 s_waitcnt lgkmcnt(4)
 v_smfmac_f32_16x16x64_bf16 v[48:51], v[76:79], v[32:39], v5
 ds_read_b128 v[16:19], v1 offset:30720
 s_waitcnt lgkmcnt(4)
 v_smfmac_f32_16x16x64_bf16 v[52:55], v[40:43], v[240:247], v5
 ds_read_b128 v[20:23], v1 offset:31744
 s_waitcnt lgkmcnt(4)
 v_smfmac_f32_16x16x64_bf16 v[52:55], v[44:47], v[248:255], v5
 ds_read_b128 v[32:35], v1 offset:34816
 v_cvt_pk_bf16_f32 v48, v48, v49
 v_smfmac_f32_16x16x64_bf16 v[56:59], v[68:71], v[176:183], v5
 ds_read_b128 v[36:39], v1 offset:35840
 s_add_u32 s35, s33, 131072
 v_cvt_pk_bf16_f32 v49, v50, v51
 v_smfmac_f32_16x16x64_bf16 v[56:59], v[72:75], v[184:191], v5
 v_and_or_b32 v48, v48, -2, s52
 v_permlane32_swap_b32 v52, v54
 v_smfmac_f32_16x16x64_bf16 v[56:59], v[76:79], v[200:207], v5
 buffer_store_dwordx2 v[48:49], v3, s[4:7], s35 offen
 v_permlane32_swap_b32 v53, v55
 v_smfmac_f32_16x16x64_bf16 v[60:63], v[68:71], v[208:215], v5
 v_mov_b64 v[40:41], 0
 v_add_f32 v52, v52, v54
 v_smfmac_f32_16x16x64_bf16 v[60:63], v[72:75], v[216:223], v5
 v_mov_b64 v[42:43], 0
 v_add_f32 v53, v53, v55
 v_smfmac_f32_16x16x64_bf16 v[60:63], v[76:79], v[232:239], v5
 s_add_u32 s35, s33, 0
 v_cvt_pk_bf16_f32 v56, v56, v57
 v_cvt_pk_bf16_f32 v52, v52, v53
 v_smfmac_f32_16x16x64_bf16 v[40:43], v[64:67], v[24:31], v5
 v_cvt_pk_bf16_f32 v57, v58, v59
 v_and_or_b32 v52, v52, -2, s52
 s_waitcnt lgkmcnt(4)
 v_smfmac_f32_16x16x64_bf16 v[40:43], v[68:71], v[8:15], v5
 buffer_store_dword v52, v2, s[4:7], s34 offen
 v_and_or_b32 v56, v56, -2, s52
 v_cvt_pk_bf16_f32 v60, v60, v61
 s_waitcnt lgkmcnt(2)
 v_smfmac_f32_16x16x64_bf16 v[40:43], v[72:75], v[16:23], v5
 buffer_store_dwordx2 v[56:57], v3, s[4:7], s35 offen
 s_add_u32 s35, s33, 65536
 v_cvt_pk_bf16_f32 v61, v62, v63
 s_waitcnt lgkmcnt(0)
 v_smfmac_f32_16x16x64_bf16 v[40:43], v[76:79], v[32:39], v5
 v_and_or_b32 v60, v60, -2, s52
 buffer_store_dwordx2 v[60:61], v3, s[4:7], s35 offen
 s_add_u32 s35, s33, 196608
 s_mov_b32 s36, s42
 s_mov_b32 s42, s43
 s_mov_b32 s43, s44
 s_mov_b32 s44, s36
 s_xor_b32 s47, s47, 294912
 s_add_u32 s41, s41, 1
 s_add_u32 s58, s58, 262144
 v_cvt_pk_bf16_f32 v40, v40, v41
 v_cvt_pk_bf16_f32 v41, v42, v43
 v_and_or_b32 v40, v40, -2, s52
 buffer_store_dwordx2 v[40:41], v3, s[4:7], s35 offen
 s_branch L_csln2
L_lastln2:
 buffer_store_dwordx4 v[56:59], v0, s[4:7], s33 offen offset:1024 sc1
 s_branch L_chx
L_celio:
 v_mov_b64 v[40:41], 0
 v_mov_b64 v[42:43], 0
 v_mov_b64 v[44:45], 0
 v_mov_b64 v[46:47], 0
 v_mov_b64 v[48:49], 0
 v_mov_b64 v[50:51], 0
 v_mov_b64 v[52:53], 0
 v_mov_b64 v[54:55], 0
 v_mov_b64 v[56:57], 0
 v_mov_b64 v[58:59], 0
 v_mov_b64 v[60:61], 0
 v_mov_b64 v[62:63], 0
 ds_read_b128 v[24:27], v1 offset:0
 ds_read_b128 v[28:31], v1 offset:1024
 ds_read_b128 v[32:35], v1 offset:2048
 ds_read_b128 v[36:39], v1 offset:3072
 s_lshr_b32 s34, s41, 1
 s_add_u32 s34, s34, 1
 s_mov_b32 s35, s34
 s_bitcmp1_b32 s41, 0
 s_cselect_b32 s33, s51, s50
 s_cmp_ge_u32 s33, s35
 s_cbranch_scc1 L_oklio96
 v_lshlrev_b32 v21, 3, v0
 s_lshl_b32 s36, s40, 2
 s_add_u32 s36, s36, 0
L_fllio96:
 s_mov_b64 exec, 3
 buffer_load_dword v20, v21, s[4:7], s36 offen sc1
 s_mov_b64 exec, -1
 s_waitcnt vmcnt(0)
 v_readlane_b32 s50, v20, 0
 v_readlane_b32 s51, v20, 1
 s_bitcmp1_b32 s41, 0
 s_cselect_b32 s33, s51, s50
 s_cmp_ge_u32 s33, s34
 s_cbranch_scc1 L_oklio96
 s_cmp_eq_u32 s15, 0
 s_cbranch_scc1 L_oklio96
 s_sub_u32 s15, s15, 1
 s_branch L_fllio96
L_oklio96:
 s_add_u32 s34, s34, 1
 s_cmp_ge_u32 s33, s34
 s_cselect_b32 s33, 2, 0
 s_add_u32 s33, s33, s41
 s_min_u32 s33, s33, 63
 s_lshl_b32 s33, s33, 5
 s_add_u32 s33, s33, s40
 s_lshl_b32 s39, s33, 13
 s_barrier
 s_add_u32 s34, s58, 4194304
 s_add_u32 s35, s58, 20971520
 buffer_load_dwordx4 v[64:67], v0, s[4:7], s34 offen offset:0
 buffer_load_dwordx4 v[68:71], v0, s[4:7], s34 offen offset:1024
 buffer_load_dwordx4 v[72:75], v0, s[4:7], s35 offen offset:0
 buffer_load_dwordx4 v[76:79], v0, s[4:7], s35 offen offset:1024
 v_lshlrev_b32 v20, 3, v0
 s_add_u32 s34, s39, 4194304
 s_add_u32 s35, s39, 20971520
 buffer_load_dword v4, v20, s[4:7], s34 offen
 buffer_load_dword v4, v20, s[4:7], s35 offen
 s_add_u32 s34, s41, 1
 s_lshr_b32 s34, s34, 1
 s_add_u32 s34, s34, 1
 s_min_u32 s34, s34, 32
 s_mov_b32 s35, s34
 s_bitcmp1_b32 s41, 0
 s_cselect_b32 s33, s50, s51
 s_cmp_ge_u32 s33, s35
 s_cbranch_scc1 L_oklio97
 v_lshlrev_b32 v21, 3, v0
 s_lshl_b32 s36, s40, 2
 s_add_u32 s36, s36, 0
L_fllio97:
 s_mov_b64 exec, 3
 buffer_load_dword v20, v21, s[4:7], s36 offen sc1
 s_mov_b64 exec, -1
 s_waitcnt vmcnt(0)
 v_readlane_b32 s50, v20, 0
 v_readlane_b32 s51, v20, 1
 s_bitcmp1_b32 s41, 0
 s_cselect_b32 s33, s50, s51
 s_cmp_ge_u32 s33, s34
 s_cbranch_scc1 L_oklio97
 s_cmp_eq_u32 s15, 0
 s_cbranch_scc1 L_oklio97
 s_sub_u32 s15, s15, 1
 s_branch L_fllio97
L_oklio97:
 s_add_u32 s34, s34, 1
 s_cmp_ge_u32 s33, s34
 s_cselect_b32 s33, 3, 1
 s_add_u32 s33, s33, s41
 s_min_u32 s33, s33, 63
 s_lshl_b32 s33, s33, 5
 s_add_u32 s33, s33, s40
 s_lshl_b32 s39, s33, 13
 s_branch L_b1lio
L_cslio:
 v_mov_b64 v[40:41], 0
 v_mov_b64 v[42:43], 0
 v_mov_b64 v[44:45], 0
 v_mov_b64 v[46:47], 0
 v_mov_b64 v[48:49], 0
 v_mov_b64 v[50:51], 0
 v_mov_b64 v[52:53], 0
 v_mov_b64 v[54:55], 0
 v_mov_b64 v[56:57], 0
 v_mov_b64 v[58:59], 0
 v_mov_b64 v[60:61], 0
 v_mov_b64 v[62:63], 0
 ds_read_b128 v[24:27], v1 offset:0
 ds_read_b128 v[28:31], v1 offset:1024
 ds_read_b128 v[32:35], v1 offset:2048
 ds_read_b128 v[36:39], v1 offset:3072
 s_add_u32 s34, s58, 4194304
 s_add_u32 s35, s58, 20971520
 buffer_load_dwordx4 v[64:67], v0, s[4:7], s34 offen offset:0
 buffer_load_dwordx4 v[68:71], v0, s[4:7], s34 offen offset:1024
 buffer_load_dwordx4 v[72:75], v0, s[4:7], s35 offen offset:0
 buffer_load_dwordx4 v[76:79], v0, s[4:7], s35 offen offset:1024
 s_add_u32 s34, s41, 1
 s_lshr_b32 s34, s34, 1
 s_add_u32 s34, s34, 1
 s_min_u32 s34, s34, 32
 s_add_u32 s35, s34, 1
 s_min_u32 s35, s35, 32
 s_bitcmp1_b32 s41, 0
 s_cselect_b32 s33, s50, s51
 s_cmp_ge_u32 s33, s35
 s_cbranch_scc1 L_oklio98
 v_lshlrev_b32 v9, 3, v0
 s_lshl_b32 s36, s40, 2
 s_add_u32 s36, s36, 0
L_fllio98:
 s_mov_b64 exec, 3
 buffer_load_dword v8, v9, s[4:7], s36 offen sc1
 s_mov_b64 exec, -1
 s_waitcnt vmcnt(0)
 v_readlane_b32 s50, v8, 0
 v_readlane_b32 s51, v8, 1
 s_bitcmp1_b32 s41, 0
 s_cselect_b32 s33, s50, s51
 s_cmp_ge_u32 s33, s34
 s_cbranch_scc1 L_oklio98
 s_cmp_eq_u32 s15, 0
 s_cbranch_scc1 L_oklio98
 s_sub_u32 s15, s15, 1
 s_branch L_fllio98
L_oklio98:
 s_add_u32 s34, s34, 1
 s_cmp_ge_u32 s33, s34
 s_cselect_b32 s33, 3, 1
 s_add_u32 s33, s33, s41
 s_min_u32 s33, s33, 63
 s_lshl_b32 s33, s33, 5
 s_add_u32 s33, s33, s40
 s_lshl_b32 s39, s33, 13
 s_barrier
 s_add_u32 s33, s42, 159387648
 s_add_u32 s34, s42, 159391744
 buffer_load_dwordx4 v[8:11], v0, s[4:7], s33 offen offset:0 sc1
 buffer_load_dwordx4 v[12:15], v0, s[4:7], s33 offen offset:1024 sc1
 buffer_load_dwordx4 v[16:19], v0, s[4:7], s34 offen sc1
L_pmlio:
 s_waitcnt vmcnt(2)
 ds_write_b128 v0, v[8:11] offset:4096
 v_max3_u32 v20, v8, v9, v10
 s_waitcnt vmcnt(1)
 ds_write_b128 v0, v[12:15] offset:5120
 v_max3_u32 v20, v20, v11, v12
 v_max3_u32 v21, v13, v14, v15
 s_waitcnt vmcnt(0)
 ds_write_b128 v0, v[16:19] offset:8192
 v_max3_u32 v20, v20, v16, v17
 v_max3_u32 v21, v21, v18, v19
 v_max_u32 v20, v20, v21
 v_cmp_eq_u32 vcc, -1, v20
 s_cmp_eq_u64 vcc, 0
 s_cbranch_scc1 L_b1lio
 s_cmp_eq_u32 s15, 0
 s_cbranch_scc1 L_b1lio
 s_sub_u32 s15, s15, 1
 buffer_load_dwordx4 v[8:11], v0, s[4:7], s33 offen offset:0 sc1
 buffer_load_dwordx4 v[12:15], v0, s[4:7], s33 offen offset:1024 sc1
 buffer_load_dwordx4 v[16:19], v0, s[4:7], s34 offen sc1
 s_branch L_pmlio
L_b1lio:
 s_waitcnt lgkmcnt(2)
 v_smfmac_f32_16x16x64_bf16 v[40:43], v[8:11], v[24:31], v5
 ds_read_b128 v[24:27], v1 offset:4096
 s_waitcnt lgkmcnt(1)
 v_smfmac_f32_16x16x64_bf16 v[44:47], v[8:11], v[32:39], v5
 ds_read_b128 v[28:31], v1 offset:5120
 v_smfmac_f32_16x16x64_bf16 v[40:43], v[12:15], a[32:39], v5
 ds_read_b128 v[32:35], v1 offset:6144
 v_smfmac_f32_16x16x64_bf16 v[44:47], v[12:15], a[40:47], v5
 ds_read_b128 v[36:39], v1 offset:7168
 v_smfmac_f32_16x16x64_bf16 v[40:43], v[16:19], a[80:87], v5
 v_smfmac_f32_16x16x64_bf16 v[44:47], v[16:19], a[88:95], v5
 s_waitcnt lgkmcnt(4)
 s_barrier
 ds_read_b128 v[20:23], v0 offset:6144
 v_smfmac_f32_16x16x64_bf16 v[48:51], v[8:11], a[0:7], v5
 s_lshl_b32 s36, s40, 7
 s_add_u32 s36, s36, 4096
 v_mov_b32 v62, s41
 v_smfmac_f32_16x16x64_bf16 v[52:55], v[8:11], a[8:15], v5
 ds_read_b128 v[8:11], v0 offset:7168
 v_smfmac_f32_16x16x64_bf16 v[48:51], v[12:15], a[48:55], v5
 s_mov_b64 exec, 1
 buffer_store_dword v62, v0, s[4:7], s36 offen sc1
 s_mov_b64 exec, -1
 v_smfmac_f32_16x16x64_bf16 v[52:55], v[12:15], a[56:63], v5
 ds_read_b128 v[12:15], v0 offset:0
 s_add_u32 s34, s39, 4194304
 s_add_u32 s35, s39, 20971520
 v_lshlrev_b32 v63, 3, v0
 s_waitcnt lgkmcnt(5)
 v_smfmac_f32_16x16x64_bf16 v[48:51], v[16:19], v[24:31], v5
 ds_read_b128 v[24:27], v1 offset:12288
 buffer_load_dword v4, v63, s[4:7], s34 offen
 s_waitcnt lgkmcnt(4)
 v_smfmac_f32_16x16x64_bf16 v[52:55], v[16:19], v[32:39], v5
 ds_read_b128 v[16:19], v0 offset:1024
 s_waitcnt lgkmcnt(4)
 v_smfmac_f32_16x16x64_bf16 v[40:43], v[20:23], a[112:119], v5
 ds_read_b128 v[28:31], v1 offset:13312
 buffer_load_dword v4, v63, s[4:7], s35 offen
 v_smfmac_f32_16x16x64_bf16 v[44:47], v[20:23], a[120:127], v5
 ds_read_b128 v[20:23], v0 offset:2048
 s_waitcnt lgkmcnt(5)
 v_smfmac_f32_16x16x64_bf16 v[40:43], v[8:11], a[160:167], v5
 ds_read_b128 v[32:35], v1 offset:14336
 v_mov_b64 v[62:63], 0
 v_smfmac_f32_16x16x64_bf16 v[44:47], v[8:11], a[168:175], v5
 ds_read_b128 v[8:11], v0 offset:3072
 s_waitcnt lgkmcnt(6)
 v_smfmac_f32_16x16x64_bf16 v[40:43], v[12:15], a[192:199], v5
 ds_read_b128 v[36:39], v1 offset:15360
 v_smfmac_f32_16x16x64_bf16 v[44:47], v[12:15], a[200:207], v5
 s_waitcnt lgkmcnt(5)
 v_smfmac_f32_16x16x64_bf16 v[40:43], v[16:19], a[208:215], v5
 v_smfmac_f32_16x16x64_bf16 v[44:47], v[16:19], a[216:223], v5
 s_waitcnt lgkmcnt(3)
 v_smfmac_f32_16x16x64_bf16 v[40:43], v[20:23], v[80:87], v5
 s_waitcnt lgkmcnt(1)
 v_smfmac_f32_16x16x64_bf16 v[40:43], v[8:11], v[128:135], v5
 v_smfmac_f32_16x16x64_bf16 v[44:47], v[20:23], v[88:95], v5
 s_waitcnt lgkmcnt(0)
 v_smfmac_f32_16x16x64_bf16 v[44:47], v[8:11], v[136:143], v5
 v_pk_mul_f32 v[40:41], v[40:41], s[54:55]
 v_smfmac_f32_16x16x64_bf16 v[48:51], v[12:15], v[24:31], v5
 ds_read_b128 v[24:27], v1 offset:8192
 v_pk_mul_f32 v[42:43], v[42:43], s[54:55]
 v_smfmac_f32_16x16x64_bf16 v[52:55], v[12:15], v[32:39], v5
 ds_read_b128 v[12:15], v0 offset:6144
 v_cvt_pk_bf16_f32 v40, v40, v41
 v_smfmac_f32_16x16x64_bf16 v[48:51], v[16:19], a[224:231], v5
 ds_read_b128 v[28:31], v1 offset:9216
 v_cvt_pk_bf16_f32 v41, v42, v43
 v_smfmac_f32_16x16x64_bf16 v[52:55], v[16:19], a[232:239], v5
 ds_read_b128 v[16:19], v0 offset:7168
 v_pk_mul_f32 v[44:45], v[44:45], s[54:55]
 v_mfma_f32_16x16x16_bf16 v[40:43], v[40:41], v[6:7], 0
 ds_read_b128 v[32:35], v1 offset:10240
 v_pk_mul_f32 v[46:47], v[46:47], s[54:55]
 v_smfmac_f32_16x16x64_bf16 v[48:51], v[20:23], v[96:103], v5
 ds_read_b128 v[36:39], v1 offset:11264
 v_cvt_pk_bf16_f32 v44, v44, v45
 v_smfmac_f32_16x16x64_bf16 v[48:51], v[8:11], v[144:151], v5
 s_waitcnt lgkmcnt(4)
 v_cvt_pk_bf16_f32 v45, v46, v47
 v_smfmac_f32_16x16x64_bf16 v[48:51], v[12:15], a[128:135], v5
 v_cvt_pk_bf16_f32 v40, v40, v41
 v_mfma_f32_16x16x16_bf16 v[44:47], v[44:45], v[6:7], 0
 v_cvt_pk_bf16_f32 v41, v42, v43
 v_smfmac_f32_16x16x64_bf16 v[52:55], v[20:23], v[104:111], v5
 s_waitcnt lgkmcnt(2)
 v_smfmac_f32_16x16x64_bf16 v[48:51], v[16:19], v[24:31], v5
 ds_read_b128 v[24:27], v1 offset:16384
 v_cvt_pk_bf16_f32 v42, v44, v45
 v_smfmac_f32_16x16x64_bf16 v[52:55], v[8:11], v[152:159], v5
 ds_read_b128 v[28:31], v1 offset:17408
 v_cvt_pk_bf16_f32 v43, v46, v47
 v_smfmac_f32_16x16x64_bf16 v[52:55], v[12:15], a[136:143], v5
 s_waitcnt lgkmcnt(2)
 v_cvt_pk_bf16_f32 v48, v48, v49
 v_smfmac_f32_16x16x64_bf16 v[52:55], v[16:19], v[32:39], v5
 ds_read_b128 v[32:35], v1 offset:18432
 s_waitcnt vmcnt(7)
 v_cvt_pk_bf16_f32 v49, v50, v51
 ds_read_b128 v[36:39], v1 offset:19456
 s_add_u32 s33, s58, 37748736
 v_mfma_f32_16x16x16_bf16 v[48:51], v[48:49], v[6:7], 0
 v_mfma_f32_16x16x32_bf16 v[64:67], v[64:67], v[40:43], 0
 v_cvt_pk_bf16_f32 v52, v52, v53
 v_cvt_pk_bf16_f32 v53, v54, v55
 v_mfma_f32_16x16x32_bf16 v[68:71], v[68:71], v[40:43], 0
 v_mfma_f32_16x16x16_bf16 v[52:55], v[52:53], v[6:7], 0
 v_cvt_pk_bf16_f32 v48, v48, v49
 v_cvt_pk_bf16_f32 v49, v50, v51
 v_smfmac_f32_16x16x64_bf16 v[56:59], v[20:23], v[112:119], v5
 v_mov_b32_dpp v64, v68 quad_perm:[0,1,2,3] row_mask:0xf bank_mask:0xc
 v_mov_b32_dpp v65, v69 quad_perm:[0,1,2,3] row_mask:0xf bank_mask:0xc
 v_smfmac_f32_16x16x64_bf16 v[60:63], v[20:23], v[120:127], v5
 ds_read_b128 v[20:23], v0 offset:4096
 v_cvt_pk_bf16_f32 v50, v52, v53
 v_cvt_pk_bf16_f32 v51, v54, v55
 v_mov_b32_dpp v66, v70 quad_perm:[0,1,2,3] row_mask:0xf bank_mask:0xc
 v_mov_b32_dpp v67, v71 quad_perm:[0,1,2,3] row_mask:0xf bank_mask:0xc
 v_mfma_f32_16x16x32_bf16 v[44:47], v[48:51], v[40:43], 0
 ds_write_b128 v0, v[64:67] offset:12288
 v_smfmac_f32_16x16x64_bf16 v[56:59], v[8:11], v[160:167], v5
 buffer_store_dwordx4 v[48:51], v0, s[4:7], s33 offen sc1
 v_smfmac_f32_16x16x64_bf16 v[60:63], v[8:11], v[168:175], v5
 ds_read_b128 v[8:11], v0 offset:5120
 v_cndmask_b32 v52, v45, v44, s[56:57]
 v_cndmask_b32 v53, v47, v46, s[56:57]
 v_cndmask_b32 v52, v52, v53, s[60:61]
 ds_write_b32 v0, v52 offset:13324
 v_smfmac_f32_16x16x64_bf16 v[56:59], v[12:15], a[144:151], v5
 v_smfmac_f32_16x16x64_bf16 v[60:63], v[12:15], a[152:159], v5
 ds_read_b128 v[12:15], v0 offset:8192
 v_smfmac_f32_16x16x64_bf16 v[56:59], v[16:19], a[176:183], v5
 v_smfmac_f32_16x16x64_bf16 v[60:63], v[16:19], a[184:191], v5
 ds_read_b128 v[16:19], v0 offset:0
 s_waitcnt lgkmcnt(2)
 s_barrier
 ds_read_b128 v[64:67], v0 offset:13312
 ds_read_b128 v[40:43], v0 offset:9216
 ds_read_b128 v[44:47], v0 offset:10240
 ds_read_b128 v[48:51], v0 offset:11264
 ds_read_b128 v[52:55], v0 offset:12288
 v_smfmac_f32_16x16x64_bf16 v[56:59], v[20:23], a[16:23], v5
 v_smfmac_f32_16x16x64_bf16 v[60:63], v[20:23], a[24:31], v5
 ds_read_b128 v[20:23], v0 offset:1024
 v_smfmac_f32_16x16x64_bf16 v[56:59], v[8:11], a[64:71], v5
 v_smfmac_f32_16x16x64_bf16 v[60:63], v[8:11], a[72:79], v5
 s_waitcnt lgkmcnt(7)
 s_waitcnt lgkmcnt(5)
 v_smfmac_f32_16x16x64_bf16 v[56:59], v[12:15], a[96:103], v5
 v_add_f32 v64, v64, v65
 v_smfmac_f32_16x16x64_bf16 v[60:63], v[12:15], a[104:111], v5
 s_waitcnt lgkmcnt(3)
 v_add_f32 v66, v66, v67
 v_smfmac_f32_16x16x64_bf16 v[56:59], v[16:19], v[24:31], v5
 v_pk_add_f32 v[40:41], v[40:41], v[44:45]
 v_smfmac_f32_16x16x64_bf16 v[60:63], v[16:19], v[32:39], v5
 s_waitcnt lgkmcnt(2)
 v_pk_add_f32 v[42:43], v[42:43], v[46:47]
 v_pk_add_f32 v[40:41], v[40:41], v[48:49]
 v_pk_add_f32 v[42:43], v[42:43], v[50:51]
 v_add_f32 v64, v64, v66
 s_waitcnt lgkmcnt(1)
 v_pk_add_f32 v[44:45], v[40:41], v[52:53]
 v_pk_add_f32 v[46:47], v[42:43], v[54:55]
 s_waitcnt lgkmcnt(0)
 v_smfmac_f32_16x16x64_bf16 v[56:59], v[20:23], a[240:247], v5
 v_max3_f32 v68, v44, v45, v46
 v_mov_b64 v[48:49], s[70:71]
 v_smfmac_f32_16x16x64_bf16 v[60:63], v[20:23], a[248:255], v5
 ds_read_b128 v[24:27], v1 offset:24576
 v_max3_f32 v68, v68, v47, v64
 v_mov_b64 v[50:51], s[72:73]
 ds_read_b128 v[28:31], v1 offset:25600
 v_max_f32_dpp v69, v68, v68 row_ror:8 row_mask:0xf bank_mask:0xf
 v_max_f32_dpp v68, v68, v68 row_ror:8 row_mask:0xf bank_mask:0xf
 ds_read_b128 v[32:35], v1 offset:26624
 ds_read_b128 v[36:39], v1 offset:27648
 v_permlane32_swap_b32 v68, v69
 v_max_f32 v70, v68, v69
 v_max_f32 v71, v68, v69
 ds_read_b128 v[8:11], v1 offset:20480
 ds_read_b128 v[12:15], v1 offset:21504
 v_permlane16_swap_b32 v70, v71
 ds_read_b128 v[16:19], v1 offset:22528
 v_max_f32 v68, v70, v71
 v_sub_f32 v64, v64, v68
 v_pk_add_f32 v[44:45], v[44:45], v[68:69] op_sel_hi:[1,0] neg_lo:[0,1] neg_hi:[0,1]
 v_pk_add_f32 v[46:47], v[46:47], v[68:69] op_sel_hi:[1,0] neg_lo:[0,1] neg_hi:[0,1]
 v_exp_f32 v64, v64
 ds_read_b128 v[20:23], v1 offset:23552
 v_exp_f32 v44, v44
 v_mov_b32_dpp v65, v64 row_ror:8 row_mask:0xf bank_mask:0xf
 v_exp_f32 v45, v45
 v_cvt_pk_bf16_f32 v56, v56, v57
 v_exp_f32 v46, v46
 v_cvt_pk_bf16_f32 v40, v64, v65
 v_cvt_pk_bf16_f32 v41, v64, v65
 v_exp_f32 v47, v47
 v_cvt_pk_bf16_f32 v57, v58, v59
 v_cvt_pk_bf16_f32 v42, v44, v45
 v_permlane32_swap_b32 v40, v41
 v_cvt_pk_bf16_f32 v58, v60, v61
 v_cvt_pk_bf16_f32 v43, v46, v47
 v_cvt_pk_bf16_f32 v59, v62, v63
 s_add_u32 s33, s58, 37748736
 v_mov_b32_dpp v44, v42 row_ror:8 row_mask:0xf bank_mask:0xf
 s_cmp_eq_u32 s41, 63
 v_mov_b32_dpp v45, v43 row_ror:8 row_mask:0xf bank_mask:0xf
 s_cbranch_scc1 L_lastlio
 v_mfma_f32_16x16x32_bf16 v[52:55], v[48:51], v[40:43], 0
 v_lshrrev_b32 v46, 1, v0
 v_and_b32 v47, 0x70, v0
 v_mfma_f32_16x16x16_bf16 v[64:67], v[56:57], v[40:41], 0
 v_and_b32 v46, 0x180, v46
 v_mov_b64 v[60:61], 0
 v_mfma_f32_16x16x16_bf16 v[68:71], v[58:59], v[40:41], 0
 v_or_b32 v46, v46, v47
 v_mov_b64 v[62:63], 0
 buffer_store_dwordx4 v[56:59], v0, s[4:7], s33 offen offset:1024 sc1
 s_waitcnt vmcnt(8)
 v_mfma_f32_16x16x32_bf16 v[64:67], v[72:75], v[42:45], v[64:67]
 v_add_f32_dpp v52, v52, v52 row_ror:8 row_mask:0xf bank_mask:0xf
 v_bfe_u32 v47, v0, 7, 1
 s_waitcnt vmcnt(7)
 v_mfma_f32_16x16x32_bf16 v[68:71], v[76:79], v[42:45], v[68:71]
 v_rcp_f32 v52, v52
 v_lshl_add_u32 v47, v47, 9, v46
 v_mov_b64 v[48:49], 0
 v_mov_b64 v[50:51], 0
 v_mov_b64 v[56:57], 0
 v_mov_b64 v[58:59], 0
 v_pk_mul_f32 v[64:65], v[64:65], v[52:53] op_sel_hi:[1,0]
 v_pk_mul_f32 v[66:67], v[66:67], v[52:53] op_sel_hi:[1,0]
 v_pk_mul_f32 v[68:69], v[68:69], v[52:53] op_sel_hi:[1,0]
 v_pk_mul_f32 v[70:71], v[70:71], v[52:53] op_sel_hi:[1,0]
 v_cvt_pk_bf16_f32 v64, v64, v65
 v_cvt_pk_bf16_f32 v65, v66, v67
 v_cvt_pk_bf16_f32 v66, v68, v69
 v_cvt_pk_bf16_f32 v67, v70, v71
 s_mov_b64 exec, s[56:57]
 ds_write_b128 v46, v[64:67] offset:15872
 s_mov_b64 exec, -1
 v_mov_b32_dpp v64, v64 row_ror:8 row_mask:0xf bank_mask:0xc
 v_mov_b32_dpp v65, v65 row_ror:8 row_mask:0xf bank_mask:0xc
 v_mov_b32_dpp v66, v66 row_ror:8 row_mask:0xf bank_mask:0xc
 v_mov_b32_dpp v67, v67 row_ror:8 row_mask:0xf bank_mask:0xc
 s_bfe_u32 s52, s41, 0x10001
 s_sub_u32 s45, 0, s52
 s_waitcnt lgkmcnt(5)
 v_smfmac_f32_16x16x64_bf16 v[48:51], v[64:67], v[32:39], v5
 ds_read_b128 v[32:35], v1 offset:34816
 ds_read_b128 v[36:39], v1 offset:35840
 v_mov_b64 v[52:53], 0
 v_smfmac_f32_16x16x64_bf16 v[56:59], v[64:67], v[200:207], v5
 v_mov_b64 v[54:55], 0
 v_smfmac_f32_16x16x64_bf16 v[60:63], v[64:67], v[232:239], v5
 s_add_u32 s33, s48, s47
 s_add_u32 s34, s59, s47
 s_waitcnt lgkmcnt(2)
 s_barrier
 ds_read_b128 v[68:71], v46 offset:14336
 ds_read_b128 v[72:75], v46 offset:14848
 ds_read_b128 v[76:79], v46 offset:15360
 ds_read_b128 v[40:43], v47 offset:14336
 ds_read_b128 v[44:47], v47 offset:15360
 s_waitcnt lgkmcnt(4)
 v_smfmac_f32_16x16x64_bf16 v[48:51], v[68:71], v[8:15], v5
 ds_read_b128 v[8:11], v1 offset:28672
 s_waitcnt lgkmcnt(4)
 v_smfmac_f32_16x16x64_bf16 v[48:51], v[72:75], v[16:23], v5
 ds_read_b128 v[12:15], v1 offset:29696
 s_waitcnt lgkmcnt(4)
 v_smfmac_f32_16x16x64_bf16 v[48:51], v[76:79], v[24:31], v5
 ds_read_b128 v[16:19], v1 offset:30720
 s_waitcnt lgkmcnt(4)
 v_smfmac_f32_16x16x64_bf16 v[52:55], v[40:43], v[240:247], v5
 ds_read_b128 v[20:23], v1 offset:31744
 s_waitcnt lgkmcnt(4)
 v_smfmac_f32_16x16x64_bf16 v[52:55], v[44:47], v[248:255], v5
 ds_read_b128 v[24:27], v1 offset:32768
 v_cvt_pk_bf16_f32 v48, v48, v49
 v_smfmac_f32_16x16x64_bf16 v[56:59], v[68:71], v[176:183], v5
 ds_read_b128 v[28:31], v1 offset:33792
 s_add_u32 s35, s33, 131072
 v_cvt_pk_bf16_f32 v49, v50, v51
 v_smfmac_f32_16x16x64_bf16 v[56:59], v[72:75], v[184:191], v5
 v_and_or_b32 v48, v48, -2, s52
 v_permlane32_swap_b32 v52, v54
 v_smfmac_f32_16x16x64_bf16 v[56:59], v[76:79], v[192:199], v5
 buffer_store_dwordx2 v[48:49], v3, s[4:7], s35 offen
 v_permlane32_swap_b32 v53, v55
 v_smfmac_f32_16x16x64_bf16 v[60:63], v[68:71], v[208:215], v5
 v_mov_b64 v[40:41], 0
 v_add_f32 v52, v52, v54
 v_smfmac_f32_16x16x64_bf16 v[60:63], v[72:75], v[216:223], v5
 v_mov_b64 v[42:43], 0
 v_add_f32 v53, v53, v55
 v_smfmac_f32_16x16x64_bf16 v[60:63], v[76:79], v[224:231], v5
 s_add_u32 s35, s33, 0
 v_cvt_pk_bf16_f32 v56, v56, v57
 v_cvt_pk_bf16_f32 v52, v52, v53
 v_smfmac_f32_16x16x64_bf16 v[40:43], v[64:67], v[32:39], v5
 v_cvt_pk_bf16_f32 v57, v58, v59
 v_and_or_b32 v52, v52, -2, s52
 s_waitcnt lgkmcnt(4)
 v_smfmac_f32_16x16x64_bf16 v[40:43], v[68:71], v[8:15], v5
 buffer_store_dword v52, v2, s[4:7], s34 offen
 v_and_or_b32 v56, v56, -2, s52
 v_cvt_pk_bf16_f32 v60, v60, v61
 s_waitcnt lgkmcnt(2)
 v_smfmac_f32_16x16x64_bf16 v[40:43], v[72:75], v[16:23], v5
 buffer_store_dwordx2 v[56:57], v3, s[4:7], s35 offen
 s_add_u32 s35, s33, 65536
 v_cvt_pk_bf16_f32 v61, v62, v63
 s_waitcnt lgkmcnt(0)
 v_smfmac_f32_16x16x64_bf16 v[40:43], v[76:79], v[24:31], v5
 v_and_or_b32 v60, v60, -2, s52
 buffer_store_dwordx2 v[60:61], v3, s[4:7], s35 offen
 s_add_u32 s35, s33, 196608
 s_mov_b32 s36, s42
 s_mov_b32 s42, s43
 s_mov_b32 s43, s44
 s_mov_b32 s44, s36
 s_xor_b32 s47, s47, 294912
 s_add_u32 s41, s41, 1
 s_add_u32 s58, s58, 262144
 v_cvt_pk_bf16_f32 v40, v40, v41
 v_cvt_pk_bf16_f32 v41, v42, v43
 v_and_or_b32 v40, v40, -2, s52
 buffer_store_dwordx2 v[40:41], v3, s[4:7], s35 offen
 s_branch L_cslio
L_lastlio:
 buffer_store_dwordx4 v[56:59], v0, s[4:7], s33 offen offset:1024 sc1
 s_branch L_chx
L_cdf:
 s_cmp_eq_u32 s14, 3
 s_cbranch_scc1 L_cefio
 s_cmp_eq_u32 s14, 1
 s_cbranch_scc1 L_cefr1
 s_cmp_eq_u32 s14, 0
 s_cbranch_scc1 L_cefr0
 s_cmp_lt_u32 s40, 8
 s_cbranch_scc1 L_cefr2
 s_branch L_cefn2
L_cefr0:
 v_mov_b64 v[40:41], 0
 v_mov_b64 v[42:43], 0
 v_mov_b64 v[44:45], 0
 v_mov_b64 v[46:47], 0
 v_mov_b64 v[48:49], 0
 v_mov_b64 v[50:51], 0
 v_mov_b64 v[52:53], 0
 v_mov_b64 v[54:55], 0
 v_mov_b64 v[56:57], 0
 v_mov_b64 v[58:59], 0
 v_mov_b64 v[60:61], 0
 v_mov_b64 v[62:63], 0
 ds_read_b128 v[24:27], v1 offset:0
 ds_read_b128 v[28:31], v1 offset:1024
 ds_read_b128 v[32:35], v1 offset:2048
 ds_read_b128 v[36:39], v1 offset:3072
 s_barrier
 s_add_u32 s34, s58, 4194304
 s_add_u32 s35, s58, 20971520
 buffer_load_dwordx4 v[64:67], v0, s[4:7], s34 offen offset:0
 buffer_load_dwordx4 v[68:71], v0, s[4:7], s34 offen offset:1024
 buffer_load_dwordx4 v[72:75], v0, s[4:7], s35 offen offset:0
 buffer_load_dwordx4 v[76:79], v0, s[4:7], s35 offen offset:1024
 s_add_u32 s37, s49, 294912
 s_branch L_b1fr0
L_csfr0:
 s_xor_b32 s37, s47, 294912
 s_add_u32 s37, s37, s49
 buffer_load_dwordx4 v[8:11], v0, s[4:7], s37 offen offset:0 sc1
 buffer_load_dwordx4 v[12:15], v0, s[4:7], s37 offen offset:1024 sc1
 buffer_load_dwordx4 v[16:19], v0, s[4:7], s37 offen offset:2048 sc1
 buffer_load_dwordx4 v[20:23], v0, s[4:7], s37 offen offset:3072 sc1
 s_add_u32 s34, s46, s42
 v_and_b32 v54, 64, v0
 v_lshrrev_b32 v54, 2, v54
 v_mov_b32 v55, 0x3f80
 v_lshlrev_b32 v54, v54, v55
 v_cndmask_b32 v56, 0, v54, s[62:63]
 v_cndmask_b32 v57, 0, v54, s[64:65]
 v_cndmask_b32 v58, 0, v54, s[66:67]
 v_cndmask_b32 v59, 0, v54, s[68:69]
 v_mov_b64 v[40:41], 0
 v_mov_b64 v[42:43], 0
 v_mov_b64 v[44:45], 0
 v_mov_b64 v[46:47], 0
 v_mov_b64 v[48:49], 0
 v_mov_b64 v[50:51], 0
 v_mov_b64 v[52:53], 0
 s_add_u32 s35, s58, 4194304
 s_add_u32 s36, s58, 20971520
 buffer_load_dwordx4 v[64:67], v0, s[4:7], s35 offen offset:0
 buffer_load_dwordx4 v[68:71], v0, s[4:7], s35 offen offset:1024
 buffer_load_dwordx4 v[72:75], v0, s[4:7], s36 offen offset:0
 buffer_load_dwordx4 v[76:79], v0, s[4:7], s36 offen offset:1024
 s_waitcnt vmcnt(7)
 v_mfma_f32_16x16x32_bf16 v[60:63], v[56:59], v[8:11], 0
 v_bitop3_b32 v54, v8, v10, s45 bitop3:0x7e
 s_waitcnt vmcnt(6)
 v_mfma_f32_16x16x32_bf16 v[60:63], v[56:59], v[12:15], v[60:63]
 v_bitop3_b32 v55, v12, v14, s45 bitop3:0x7e
 s_waitcnt vmcnt(5)
 v_mfma_f32_16x16x32_bf16 v[60:63], v[56:59], v[16:19], v[60:63]
 v_or_b32 v54, v54, v55
 v_bitop3_b32 v55, v16, v18, s45 bitop3:0x7e
 s_waitcnt vmcnt(4)
 v_mfma_f32_16x16x32_bf16 v[60:63], v[56:59], v[20:23], v[60:63]
 v_or_b32 v54, v54, v55
 v_bitop3_b32 v55, v20, v22, s45 bitop3:0x7e
 v_bitop3_b32 v54, v54, v55, 1 bitop3:0xa8
 v_cmp_ne_u32 vcc, 0, v54
 s_cmp_eq_u64 vcc, 0
 s_cbranch_scc1 L_rpdfr0
L_rpfr0:
 s_cmp_eq_u32 s15, 0
 s_cbranch_scc1 L_rpdfr0
 s_sub_u32 s15, s15, 1
 buffer_load_dwordx4 v[8:11], v0, s[4:7], s37 offen offset:0 sc1
 buffer_load_dwordx4 v[12:15], v0, s[4:7], s37 offen offset:1024 sc1
 buffer_load_dwordx4 v[16:19], v0, s[4:7], s37 offen offset:2048 sc1
 buffer_load_dwordx4 v[20:23], v0, s[4:7], s37 offen offset:3072 sc1
 s_waitcnt vmcnt(3)
 v_mfma_f32_16x16x32_bf16 v[60:63], v[56:59], v[8:11], 0
 v_bitop3_b32 v54, v8, v10, s45 bitop3:0x7e
 s_waitcnt vmcnt(2)
 v_mfma_f32_16x16x32_bf16 v[60:63], v[56:59], v[12:15], v[60:63]
 v_bitop3_b32 v55, v12, v14, s45 bitop3:0x7e
 s_waitcnt vmcnt(1)
 v_mfma_f32_16x16x32_bf16 v[60:63], v[56:59], v[16:19], v[60:63]
 v_or_b32 v54, v54, v55
 v_bitop3_b32 v55, v16, v18, s45 bitop3:0x7e
 s_waitcnt vmcnt(0)
 v_mfma_f32_16x16x32_bf16 v[60:63], v[56:59], v[20:23], v[60:63]
 v_or_b32 v54, v54, v55
 v_bitop3_b32 v55, v20, v22, s45 bitop3:0x7e
 v_bitop3_b32 v54, v54, v55, 1 bitop3:0xa8
 v_cmp_ne_u32 vcc, 0, v54
 s_cmp_eq_u64 vcc, 0
 s_cbranch_scc0 L_rpfr0
L_rpdfr0:
 s_nop 1
 v_add_f32_dpp v60, v60, v60 row_ror:8 row_mask:0xf bank_mask:0xf
 v_add_f32_dpp v61, v61, v61 row_ror:8 row_mask:0xf bank_mask:0xf
 v_cvt_pk_bf16_f32 v60, v60, v61
 buffer_store_dword v60, v4, s[4:7], s34 offen sc1
 s_barrier
 s_add_u32 s33, s42, 159385600
 v_mov_b64 v[54:55], 0
 v_mov_b64 v[56:57], 0
 v_mov_b64 v[58:59], 0
 v_mov_b64 v[60:61], 0
 v_mov_b64 v[62:63], 0
 ds_read_b128 v[24:27], v1 offset:0
 ds_read_b128 v[28:31], v1 offset:1024
 ds_read_b128 v[32:35], v1 offset:2048
 ds_read_b128 v[36:39], v1 offset:3072
 buffer_load_dwordx4 v[8:11], v0, s[4:7], s33 offen offset:0 sc1
 buffer_load_dwordx4 v[12:15], v0, s[4:7], s33 offen offset:1024 sc1
L_pmfr0:
 s_waitcnt vmcnt(1)
 ds_write_b128 v0, v[8:11] offset:2048
 v_max3_u32 v16, v8, v9, v10
 s_waitcnt vmcnt(0)
 ds_write_b128 v0, v[12:15] offset:3072
 v_max3_u32 v16, v16, v11, v12
 v_max3_u32 v17, v13, v14, v15
 v_max_u32 v16, v16, v17
 v_cmp_eq_u32 vcc, -1, v16
 s_cmp_eq_u64 vcc, 0
 s_cbranch_scc1 L_b1fr0
 s_cmp_eq_u32 s15, 0
 s_cbranch_scc1 L_b1fr0
 s_sub_u32 s15, s15, 1
 buffer_load_dwordx4 v[8:11], v0, s[4:7], s33 offen offset:0 sc1
 buffer_load_dwordx4 v[12:15], v0, s[4:7], s33 offen offset:1024 sc1
 s_branch L_pmfr0
L_b1fr0:
 s_waitcnt lgkmcnt(2)
 v_smfmac_f32_16x16x64_bf16 v[40:43], v[8:11], v[24:31], v5
 ds_read_b128 v[24:27], v1 offset:4096
 s_waitcnt lgkmcnt(1)
 v_smfmac_f32_16x16x64_bf16 v[44:47], v[8:11], v[32:39], v5
 ds_read_b128 v[28:31], v1 offset:5120
 v_smfmac_f32_16x16x64_bf16 v[40:43], v[12:15], a[32:39], v5
 ds_read_b128 v[32:35], v1 offset:6144
 v_smfmac_f32_16x16x64_bf16 v[44:47], v[12:15], a[40:47], v5
 ds_read_b128 v[36:39], v1 offset:7168
 s_waitcnt lgkmcnt(4)
 s_barrier
 ds_read_b128 v[16:19], v0 offset:4096
 ds_read_b128 v[20:23], v0 offset:5120
 v_smfmac_f32_16x16x64_bf16 v[48:51], v[8:11], a[0:7], v5
 v_smfmac_f32_16x16x64_bf16 v[52:55], v[8:11], a[8:15], v5
 ds_read_b128 v[8:11], v0 offset:6144
 v_smfmac_f32_16x16x64_bf16 v[48:51], v[12:15], a[48:55], v5
 v_smfmac_f32_16x16x64_bf16 v[52:55], v[12:15], a[56:63], v5
 ds_read_b128 v[12:15], v0 offset:7168
 s_waitcnt lgkmcnt(3)
 v_smfmac_f32_16x16x64_bf16 v[40:43], v[16:19], a[80:87], v5
 v_smfmac_f32_16x16x64_bf16 v[44:47], v[16:19], a[88:95], v5
 v_smfmac_f32_16x16x64_bf16 v[48:51], v[16:19], v[24:31], v5
 ds_read_b128 v[24:27], v1 offset:12288
 v_smfmac_f32_16x16x64_bf16 v[52:55], v[16:19], v[32:39], v5
 ds_read_b128 v[16:19], v0 offset:8192
 s_waitcnt lgkmcnt(4)
 v_smfmac_f32_16x16x64_bf16 v[40:43], v[20:23], a[112:119], v5
 ds_read_b128 v[28:31], v1 offset:13312
 v_smfmac_f32_16x16x64_bf16 v[44:47], v[20:23], a[120:127], v5
 ds_read_b128 v[20:23], v0 offset:0
 s_waitcnt lgkmcnt(5)
 v_smfmac_f32_16x16x64_bf16 v[40:43], v[8:11], a[160:167], v5
 ds_read_b128 v[32:35], v1 offset:14336
 v_smfmac_f32_16x16x64_bf16 v[44:47], v[8:11], a[168:175], v5
 ds_read_b128 v[8:11], v0 offset:1024
 s_waitcnt lgkmcnt(6)
 v_smfmac_f32_16x16x64_bf16 v[40:43], v[12:15], a[192:199], v5
 ds_read_b128 v[36:39], v1 offset:15360
 v_smfmac_f32_16x16x64_bf16 v[44:47], v[12:15], a[200:207], v5
 s_waitcnt lgkmcnt(5)
 v_smfmac_f32_16x16x64_bf16 v[40:43], v[16:19], a[208:215], v5
 v_smfmac_f32_16x16x64_bf16 v[44:47], v[16:19], a[216:223], v5
 s_waitcnt lgkmcnt(3)
 v_smfmac_f32_16x16x64_bf16 v[40:43], v[20:23], v[80:87], v5
 s_waitcnt lgkmcnt(1)
 v_smfmac_f32_16x16x64_bf16 v[40:43], v[8:11], v[128:135], v5
 v_smfmac_f32_16x16x64_bf16 v[44:47], v[20:23], v[88:95], v5
 s_waitcnt lgkmcnt(0)
 v_smfmac_f32_16x16x64_bf16 v[44:47], v[8:11], v[136:143], v5
 v_pk_mul_f32 v[40:41], v[40:41], s[54:55]
 v_smfmac_f32_16x16x64_bf16 v[48:51], v[12:15], v[24:31], v5
 ds_read_b128 v[24:27], v1 offset:8192
 v_pk_mul_f32 v[42:43], v[42:43], s[54:55]
 v_smfmac_f32_16x16x64_bf16 v[52:55], v[12:15], v[32:39], v5
 ds_read_b128 v[12:15], v0 offset:5120
 v_cvt_pk_bf16_f32 v40, v40, v41
 v_smfmac_f32_16x16x64_bf16 v[48:51], v[16:19], a[224:231], v5
 ds_read_b128 v[28:31], v1 offset:9216
 v_cvt_pk_bf16_f32 v41, v42, v43
 v_smfmac_f32_16x16x64_bf16 v[52:55], v[16:19], a[232:239], v5
 ds_read_b128 v[16:19], v0 offset:6144
 v_pk_mul_f32 v[44:45], v[44:45], s[54:55]
 v_mfma_f32_16x16x16_bf16 v[40:43], v[40:41], v[6:7], 0
 ds_read_b128 v[32:35], v1 offset:10240
 v_pk_mul_f32 v[46:47], v[46:47], s[54:55]
 v_smfmac_f32_16x16x64_bf16 v[48:51], v[20:23], v[96:103], v5
 ds_read_b128 v[36:39], v1 offset:11264
 v_cvt_pk_bf16_f32 v44, v44, v45
 v_smfmac_f32_16x16x64_bf16 v[48:51], v[8:11], v[144:151], v5
 s_waitcnt lgkmcnt(4)
 v_cvt_pk_bf16_f32 v45, v46, v47
 v_smfmac_f32_16x16x64_bf16 v[48:51], v[12:15], a[128:135], v5
 v_cvt_pk_bf16_f32 v40, v40, v41
 v_mfma_f32_16x16x16_bf16 v[44:47], v[44:45], v[6:7], 0
 v_cvt_pk_bf16_f32 v41, v42, v43
 v_smfmac_f32_16x16x64_bf16 v[52:55], v[20:23], v[104:111], v5
 s_waitcnt lgkmcnt(2)
 v_smfmac_f32_16x16x64_bf16 v[48:51], v[16:19], v[24:31], v5
 ds_read_b128 v[24:27], v1 offset:16384
 v_cvt_pk_bf16_f32 v42, v44, v45
 v_smfmac_f32_16x16x64_bf16 v[52:55], v[8:11], v[152:159], v5
 ds_read_b128 v[28:31], v1 offset:17408
 v_cvt_pk_bf16_f32 v43, v46, v47
 v_smfmac_f32_16x16x64_bf16 v[52:55], v[12:15], a[136:143], v5
 s_waitcnt lgkmcnt(2)
 v_cvt_pk_bf16_f32 v48, v48, v49
 v_smfmac_f32_16x16x64_bf16 v[52:55], v[16:19], v[32:39], v5
 ds_read_b128 v[32:35], v1 offset:18432
 s_waitcnt vmcnt(2)
 v_cvt_pk_bf16_f32 v49, v50, v51
 ds_read_b128 v[36:39], v1 offset:19456
 s_add_u32 s33, s58, 37748736
 v_mfma_f32_16x16x16_bf16 v[48:51], v[48:49], v[6:7], 0
 v_mfma_f32_16x16x32_bf16 v[64:67], v[64:67], v[40:43], 0
 v_cvt_pk_bf16_f32 v52, v52, v53
 v_cvt_pk_bf16_f32 v53, v54, v55
 v_mfma_f32_16x16x32_bf16 v[68:71], v[68:71], v[40:43], 0
 v_mfma_f32_16x16x16_bf16 v[52:55], v[52:53], v[6:7], 0
 v_cvt_pk_bf16_f32 v48, v48, v49
 v_cvt_pk_bf16_f32 v49, v50, v51
 v_smfmac_f32_16x16x64_bf16 v[56:59], v[20:23], v[112:119], v5
 v_mov_b32_dpp v64, v68 quad_perm:[0,1,2,3] row_mask:0xf bank_mask:0xc
 v_mov_b32_dpp v65, v69 quad_perm:[0,1,2,3] row_mask:0xf bank_mask:0xc
 v_smfmac_f32_16x16x64_bf16 v[60:63], v[20:23], v[120:127], v5
 ds_read_b128 v[20:23], v0 offset:2048
 v_cvt_pk_bf16_f32 v50, v52, v53
 v_cvt_pk_bf16_f32 v51, v54, v55
 v_mov_b32_dpp v66, v70 quad_perm:[0,1,2,3] row_mask:0xf bank_mask:0xc
 v_mov_b32_dpp v67, v71 quad_perm:[0,1,2,3] row_mask:0xf bank_mask:0xc
 v_mfma_f32_16x16x32_bf16 v[44:47], v[48:51], v[40:43], 0
 ds_write_b128 v0, v[64:67] offset:9216
 v_smfmac_f32_16x16x64_bf16 v[56:59], v[8:11], v[160:167], v5
 buffer_store_dwordx4 v[48:51], v0, s[4:7], s33 offen sc1
 v_smfmac_f32_16x16x64_bf16 v[60:63], v[8:11], v[168:175], v5
 ds_read_b128 v[8:11], v0 offset:3072
 v_cndmask_b32 v52, v45, v44, s[56:57]
 v_cndmask_b32 v53, v47, v46, s[56:57]
 v_cndmask_b32 v52, v52, v53, s[60:61]
 ds_write_b32 v0, v52 offset:13312
 v_smfmac_f32_16x16x64_bf16 v[56:59], v[12:15], a[144:151], v5
 v_smfmac_f32_16x16x64_bf16 v[60:63], v[12:15], a[152:159], v5
 ds_read_b128 v[12:15], v0 offset:4096
 v_smfmac_f32_16x16x64_bf16 v[56:59], v[16:19], a[176:183], v5
 v_smfmac_f32_16x16x64_bf16 v[60:63], v[16:19], a[184:191], v5
 ds_read_b128 v[16:19], v0 offset:7168
 s_waitcnt lgkmcnt(2)
 s_barrier
 ds_read_b128 v[64:67], v0 offset:13312
 ds_read_b128 v[40:43], v0 offset:9216
 ds_read_b128 v[44:47], v0 offset:10240
 ds_read_b128 v[48:51], v0 offset:11264
 ds_read_b128 v[52:55], v0 offset:12288
 v_smfmac_f32_16x16x64_bf16 v[56:59], v[20:23], a[16:23], v5
 v_smfmac_f32_16x16x64_bf16 v[60:63], v[20:23], a[24:31], v5
 ds_read_b128 v[20:23], v0 offset:8192
 v_smfmac_f32_16x16x64_bf16 v[56:59], v[8:11], a[64:71], v5
 v_smfmac_f32_16x16x64_bf16 v[60:63], v[8:11], a[72:79], v5
 s_waitcnt lgkmcnt(7)
 s_waitcnt lgkmcnt(5)
 v_smfmac_f32_16x16x64_bf16 v[56:59], v[12:15], a[96:103], v5
 v_add_f32 v64, v64, v65
 v_smfmac_f32_16x16x64_bf16 v[60:63], v[12:15], a[104:111], v5
 s_waitcnt lgkmcnt(3)
 v_add_f32 v66, v66, v67
 v_smfmac_f32_16x16x64_bf16 v[56:59], v[16:19], v[24:31], v5
 v_pk_add_f32 v[40:41], v[40:41], v[44:45]
 v_smfmac_f32_16x16x64_bf16 v[60:63], v[16:19], v[32:39], v5
 s_waitcnt lgkmcnt(2)
 v_pk_add_f32 v[42:43], v[42:43], v[46:47]
 v_pk_add_f32 v[40:41], v[40:41], v[48:49]
 v_pk_add_f32 v[42:43], v[42:43], v[50:51]
 v_add_f32 v64, v64, v66
 s_waitcnt lgkmcnt(1)
 v_pk_add_f32 v[44:45], v[40:41], v[52:53]
 v_pk_add_f32 v[46:47], v[42:43], v[54:55]
 s_waitcnt lgkmcnt(0)
 v_smfmac_f32_16x16x64_bf16 v[56:59], v[20:23], a[240:247], v5
 v_max3_f32 v68, v44, v45, v46
 v_mov_b64 v[48:49], s[70:71]
 v_smfmac_f32_16x16x64_bf16 v[60:63], v[20:23], a[248:255], v5
 ds_read_b128 v[24:27], v1 offset:24576
 v_max3_f32 v68, v68, v47, v64
 v_mov_b64 v[50:51], s[72:73]
 ds_read_b128 v[28:31], v1 offset:25600
 v_max_f32_dpp v69, v68, v68 row_ror:8 row_mask:0xf bank_mask:0xf
 v_max_f32_dpp v68, v68, v68 row_ror:8 row_mask:0xf bank_mask:0xf
 ds_read_b128 v[32:35], v1 offset:26624
 ds_read_b128 v[36:39], v1 offset:27648
 v_permlane32_swap_b32 v68, v69
 v_max_f32 v70, v68, v69
 v_max_f32 v71, v68, v69
 ds_read_b128 v[8:11], v1 offset:20480
 ds_read_b128 v[12:15], v1 offset:21504
 v_permlane16_swap_b32 v70, v71
 ds_read_b128 v[16:19], v1 offset:22528
 v_max_f32 v68, v70, v71
 v_sub_f32 v64, v64, v68
 v_pk_add_f32 v[44:45], v[44:45], v[68:69] op_sel_hi:[1,0] neg_lo:[0,1] neg_hi:[0,1]
 v_pk_add_f32 v[46:47], v[46:47], v[68:69] op_sel_hi:[1,0] neg_lo:[0,1] neg_hi:[0,1]
 v_exp_f32 v64, v64
 ds_read_b128 v[20:23], v1 offset:23552
 v_exp_f32 v44, v44
 v_mov_b32_dpp v65, v64 row_ror:8 row_mask:0xf bank_mask:0xf
 v_exp_f32 v45, v45
 v_cvt_pk_bf16_f32 v56, v56, v57
 v_exp_f32 v46, v46
 v_cvt_pk_bf16_f32 v40, v64, v65
 v_cvt_pk_bf16_f32 v41, v64, v65
 v_exp_f32 v47, v47
 v_cvt_pk_bf16_f32 v57, v58, v59
 v_cvt_pk_bf16_f32 v42, v44, v45
 v_permlane32_swap_b32 v40, v41
 v_cvt_pk_bf16_f32 v58, v60, v61
 v_cvt_pk_bf16_f32 v43, v46, v47
 v_cvt_pk_bf16_f32 v59, v62, v63
 s_add_u32 s33, s58, 37748736
 v_mov_b32_dpp v44, v42 row_ror:8 row_mask:0xf bank_mask:0xf
 s_cmp_eq_u32 s41, 63
 v_mov_b32_dpp v45, v43 row_ror:8 row_mask:0xf bank_mask:0xf
 s_cbranch_scc1 L_lastfr0
 v_mfma_f32_16x16x32_bf16 v[52:55], v[48:51], v[40:43], 0
 v_lshrrev_b32 v46, 1, v0
 v_and_b32 v47, 0x70, v0
 v_mfma_f32_16x16x16_bf16 v[64:67], v[56:57], v[40:41], 0
 v_and_b32 v46, 0x180, v46
 v_mov_b64 v[60:61], 0
 v_mfma_f32_16x16x16_bf16 v[68:71], v[58:59], v[40:41], 0
 v_or_b32 v46, v46, v47
 v_mov_b64 v[62:63], 0
 buffer_store_dwordx4 v[56:59], v0, s[4:7], s33 offen offset:1024 sc1
 s_waitcnt vmcnt(3)
 v_mfma_f32_16x16x32_bf16 v[64:67], v[72:75], v[42:45], v[64:67]
 v_add_f32_dpp v52, v52, v52 row_ror:8 row_mask:0xf bank_mask:0xf
 v_bfe_u32 v47, v0, 7, 1
 s_waitcnt vmcnt(2)
 v_mfma_f32_16x16x32_bf16 v[68:71], v[76:79], v[42:45], v[68:71]
 v_rcp_f32 v52, v52
 v_lshl_add_u32 v47, v47, 9, v46
 v_mov_b64 v[48:49], 0
 v_mov_b64 v[50:51], 0
 v_mov_b64 v[56:57], 0
 v_mov_b64 v[58:59], 0
 v_pk_mul_f32 v[64:65], v[64:65], v[52:53] op_sel_hi:[1,0]
 v_pk_mul_f32 v[66:67], v[66:67], v[52:53] op_sel_hi:[1,0]
 v_pk_mul_f32 v[68:69], v[68:69], v[52:53] op_sel_hi:[1,0]
 v_pk_mul_f32 v[70:71], v[70:71], v[52:53] op_sel_hi:[1,0]
 v_cvt_pk_bf16_f32 v64, v64, v65
 v_cvt_pk_bf16_f32 v65, v66, v67
 v_cvt_pk_bf16_f32 v66, v68, v69
 v_cvt_pk_bf16_f32 v67, v70, v71
 s_mov_b64 exec, s[56:57]
 ds_write_b128 v46, v[64:67] offset:14336
 s_mov_b64 exec, -1
 v_mov_b32_dpp v64, v64 row_ror:8 row_mask:0xf bank_mask:0xc
 v_mov_b32_dpp v65, v65 row_ror:8 row_mask:0xf bank_mask:0xc
 v_mov_b32_dpp v66, v66 row_ror:8 row_mask:0xf bank_mask:0xc
 v_mov_b32_dpp v67, v67 row_ror:8 row_mask:0xf bank_mask:0xc
 s_bfe_u32 s52, s41, 0x10001
 s_sub_u32 s45, 0, s52
 s_waitcnt lgkmcnt(3)
 v_smfmac_f32_16x16x64_bf16 v[48:51], v[64:67], v[8:15], v5
 ds_read_b128 v[8:11], v1 offset:28672
 ds_read_b128 v[12:15], v1 offset:29696
 v_mov_b64 v[52:53], 0
 v_smfmac_f32_16x16x64_bf16 v[56:59], v[64:67], v[176:183], v5
 s_add_u32 s34, s46, s44
 v_mov_b32 v44, -1
 v_smfmac_f32_16x16x64_bf16 v[60:63], v[64:67], v[208:215], v5
 buffer_store_dword v44, v4, s[4:7], s34 offen sc1
 v_mov_b64 v[54:55], 0
 s_add_u32 s33, s48, s47
 s_add_u32 s34, s59, s47
 s_waitcnt lgkmcnt(2)
 s_barrier
 ds_read_b128 v[68:71], v46 offset:14848
 ds_read_b128 v[72:75], v46 offset:15360
 ds_read_b128 v[76:79], v46 offset:15872
 ds_read_b128 v[40:43], v47 offset:14336
 ds_read_b128 v[44:47], v47 offset:15360
 s_waitcnt lgkmcnt(4)
 v_smfmac_f32_16x16x64_bf16 v[48:51], v[68:71], v[16:23], v5
 ds_read_b128 v[16:19], v1 offset:30720
 s_waitcnt lgkmcnt(4)
 v_smfmac_f32_16x16x64_bf16 v[48:51], v[72:75], v[24:31], v5
 ds_read_b128 v[20:23], v1 offset:31744
 s_waitcnt lgkmcnt(4)
 v_smfmac_f32_16x16x64_bf16 v[48:51], v[76:79], v[32:39], v5
 ds_read_b128 v[24:27], v1 offset:32768
 s_waitcnt lgkmcnt(4)
 v_smfmac_f32_16x16x64_bf16 v[52:55], v[40:43], v[240:247], v5
 ds_read_b128 v[28:31], v1 offset:33792
 s_waitcnt lgkmcnt(4)
 v_smfmac_f32_16x16x64_bf16 v[52:55], v[44:47], v[248:255], v5
 ds_read_b128 v[32:35], v1 offset:34816
 v_cvt_pk_bf16_f32 v48, v48, v49
 v_smfmac_f32_16x16x64_bf16 v[56:59], v[68:71], v[184:191], v5
 ds_read_b128 v[36:39], v1 offset:35840
 s_add_u32 s35, s33, 131072
 v_cvt_pk_bf16_f32 v49, v50, v51
 v_smfmac_f32_16x16x64_bf16 v[56:59], v[72:75], v[192:199], v5
 v_and_or_b32 v48, v48, -2, s52
 v_permlane32_swap_b32 v52, v54
 v_smfmac_f32_16x16x64_bf16 v[56:59], v[76:79], v[200:207], v5
 buffer_store_dwordx2 v[48:49], v3, s[4:7], s35 offen sc1
 v_permlane32_swap_b32 v53, v55
 v_smfmac_f32_16x16x64_bf16 v[60:63], v[68:71], v[216:223], v5
 v_mov_b64 v[40:41], 0
 v_add_f32 v52, v52, v54
 v_smfmac_f32_16x16x64_bf16 v[60:63], v[72:75], v[224:231], v5
 v_mov_b64 v[42:43], 0
 v_add_f32 v53, v53, v55
 v_smfmac_f32_16x16x64_bf16 v[60:63], v[76:79], v[232:239], v5
 s_add_u32 s35, s33, 0
 v_cvt_pk_bf16_f32 v56, v56, v57
 v_cvt_pk_bf16_f32 v52, v52, v53
 v_smfmac_f32_16x16x64_bf16 v[40:43], v[64:67], v[8:15], v5
 v_cvt_pk_bf16_f32 v57, v58, v59
 v_and_or_b32 v52, v52, -2, s52
 s_waitcnt lgkmcnt(4)
 v_smfmac_f32_16x16x64_bf16 v[40:43], v[68:71], v[16:23], v5
 buffer_store_dword v52, v2, s[4:7], s34 offen sc1
 v_and_or_b32 v56, v56, -2, s52
 v_cvt_pk_bf16_f32 v60, v60, v61
 s_waitcnt lgkmcnt(2)
 v_smfmac_f32_16x16x64_bf16 v[40:43], v[72:75], v[24:31], v5
 buffer_store_dwordx2 v[56:57], v3, s[4:7], s35 offen sc1
 s_add_u32 s35, s33, 65536
 v_cvt_pk_bf16_f32 v61, v62, v63
 s_waitcnt lgkmcnt(0)
 v_smfmac_f32_16x16x64_bf16 v[40:43], v[76:79], v[32:39], v5
 v_and_or_b32 v60, v60, -2, s52
 buffer_store_dwordx2 v[60:61], v3, s[4:7], s35 offen sc1
 s_add_u32 s35, s33, 196608
 s_mov_b32 s36, s42
 s_mov_b32 s42, s43
 s_mov_b32 s43, s44
 s_mov_b32 s44, s36
 s_xor_b32 s47, s47, 294912
 s_add_u32 s41, s41, 1
 s_add_u32 s58, s58, 262144
 v_cvt_pk_bf16_f32 v40, v40, v41
 v_cvt_pk_bf16_f32 v41, v42, v43
 v_and_or_b32 v40, v40, -2, s52
 buffer_store_dwordx2 v[40:41], v3, s[4:7], s35 offen sc1
 s_branch L_csfr0
L_lastfr0:
 buffer_store_dwordx4 v[56:59], v0, s[4:7], s33 offen offset:1024 sc1
 s_branch L_chx
L_cefr1:
 v_mov_b64 v[40:41], 0
 v_mov_b64 v[42:43], 0
 v_mov_b64 v[44:45], 0
 v_mov_b64 v[46:47], 0
 v_mov_b64 v[48:49], 0
 v_mov_b64 v[50:51], 0
 v_mov_b64 v[52:53], 0
 v_mov_b64 v[54:55], 0
 v_mov_b64 v[56:57], 0
 v_mov_b64 v[58:59], 0
 v_mov_b64 v[60:61], 0
 v_mov_b64 v[62:63], 0
 ds_read_b128 v[24:27], v1 offset:0
 ds_read_b128 v[28:31], v1 offset:1024
 ds_read_b128 v[32:35], v1 offset:2048
 ds_read_b128 v[36:39], v1 offset:3072
 s_barrier
 s_add_u32 s34, s58, 4194304
 s_add_u32 s35, s58, 20971520
 buffer_load_dwordx4 v[64:67], v0, s[4:7], s34 offen offset:0
 buffer_load_dwordx4 v[68:71], v0, s[4:7], s34 offen offset:1024
 buffer_load_dwordx4 v[72:75], v0, s[4:7], s35 offen offset:0
 buffer_load_dwordx4 v[76:79], v0, s[4:7], s35 offen offset:1024
 s_add_u32 s37, s49, 294912
 s_branch L_b1fr1
L_csfr1:
 s_xor_b32 s37, s47, 294912
 s_add_u32 s37, s37, s49
 s_add_u32 s34, s46, s42
 v_and_b32 v54, 64, v0
 v_lshrrev_b32 v54, 2, v54
 v_mov_b32 v55, 0x3f80
 v_lshlrev_b32 v54, v54, v55
 v_cndmask_b32 v56, 0, v54, s[62:63]
 v_cndmask_b32 v57, 0, v54, s[64:65]
 v_cndmask_b32 v58, 0, v54, s[66:67]
 v_cndmask_b32 v59, 0, v54, s[68:69]
 v_mov_b64 v[40:41], 0
 v_mov_b64 v[42:43], 0
 v_mov_b64 v[44:45], 0
 v_mov_b64 v[46:47], 0
 v_mov_b64 v[48:49], 0
 v_mov_b64 v[50:51], 0
 v_mov_b64 v[52:53], 0
 buffer_load_dwordx4 v[8:11], v0, s[4:7], s37 offen offset:0 sc1
 buffer_load_dwordx4 v[12:15], v0, s[4:7], s37 offen offset:1024 sc1
 buffer_load_dwordx4 v[16:19], v0, s[4:7], s37 offen offset:2048 sc1
 buffer_load_dwordx4 v[20:23], v0, s[4:7], s37 offen offset:3072 sc1
 s_add_u32 s35, s58, 4194304
 s_add_u32 s36, s58, 20971520
 buffer_load_dwordx4 v[64:67], v0, s[4:7], s35 offen offset:0
 buffer_load_dwordx4 v[68:71], v0, s[4:7], s35 offen offset:1024
 buffer_load_dwordx4 v[72:75], v0, s[4:7], s36 offen offset:0
 buffer_load_dwordx4 v[76:79], v0, s[4:7], s36 offen offset:1024
 s_waitcnt vmcnt(7)
 v_mfma_f32_16x16x32_bf16 v[60:63], v[56:59], v[8:11], 0
 v_bitop3_b32 v54, v8, v10, s45 bitop3:0x7e
 s_waitcnt vmcnt(6)
 v_mfma_f32_16x16x32_bf16 v[60:63], v[56:59], v[12:15], v[60:63]
 v_bitop3_b32 v55, v12, v14, s45 bitop3:0x7e
 s_waitcnt vmcnt(5)
 v_mfma_f32_16x16x32_bf16 v[60:63], v[56:59], v[16:19], v[60:63]
 v_or_b32 v54, v54, v55
 v_bitop3_b32 v55, v16, v18, s45 bitop3:0x7e
 s_waitcnt vmcnt(4)
 v_mfma_f32_16x16x32_bf16 v[60:63], v[56:59], v[20:23], v[60:63]
 v_or_b32 v54, v54, v55
 v_bitop3_b32 v55, v20, v22, s45 bitop3:0x7e
 v_bitop3_b32 v54, v54, v55, 1 bitop3:0xa8
 v_cmp_ne_u32 vcc, 0, v54
 s_cmp_eq_u64 vcc, 0
 s_cbranch_scc1 L_rpdfr1
L_rpfr1:
 s_cmp_eq_u32 s15, 0
 s_cbranch_scc1 L_rpdfr1
 s_sub_u32 s15, s15, 1
 buffer_load_dwordx4 v[8:11], v0, s[4:7], s37 offen offset:0 sc1
 buffer_load_dwordx4 v[12:15], v0, s[4:7], s37 offen offset:1024 sc1
 buffer_load_dwordx4 v[16:19], v0, s[4:7], s37 offen offset:2048 sc1
 buffer_load_dwordx4 v[20:23], v0, s[4:7], s37 offen offset:3072 sc1
 s_waitcnt vmcnt(3)
 v_mfma_f32_16x16x32_bf16 v[60:63], v[56:59], v[8:11], 0
 v_bitop3_b32 v54, v8, v10, s45 bitop3:0x7e
 s_waitcnt vmcnt(2)
 v_mfma_f32_16x16x32_bf16 v[60:63], v[56:59], v[12:15], v[60:63]
 v_bitop3_b32 v55, v12, v14, s45 bitop3:0x7e
 s_waitcnt vmcnt(1)
 v_mfma_f32_16x16x32_bf16 v[60:63], v[56:59], v[16:19], v[60:63]
 v_or_b32 v54, v54, v55
 v_bitop3_b32 v55, v16, v18, s45 bitop3:0x7e
 s_waitcnt vmcnt(0)
 v_mfma_f32_16x16x32_bf16 v[60:63], v[56:59], v[20:23], v[60:63]
 v_or_b32 v54, v54, v55
 v_bitop3_b32 v55, v20, v22, s45 bitop3:0x7e
 v_bitop3_b32 v54, v54, v55, 1 bitop3:0xa8
 v_cmp_ne_u32 vcc, 0, v54
 s_cmp_eq_u64 vcc, 0
 s_cbranch_scc0 L_rpfr1
L_rpdfr1:
 s_nop 1
 v_add_f32_dpp v60, v60, v60 row_ror:8 row_mask:0xf bank_mask:0xf
 v_add_f32_dpp v61, v61, v61 row_ror:8 row_mask:0xf bank_mask:0xf
 v_cvt_pk_bf16_f32 v60, v60, v61
 buffer_store_dword v60, v4, s[4:7], s34 offen sc1
 s_barrier
 s_add_u32 s33, s42, 159383552
 v_mov_b64 v[54:55], 0
 v_mov_b64 v[56:57], 0
 v_mov_b64 v[58:59], 0
 v_mov_b64 v[60:61], 0
 v_mov_b64 v[62:63], 0
 ds_read_b128 v[24:27], v1 offset:0
 ds_read_b128 v[28:31], v1 offset:1024
 ds_read_b128 v[32:35], v1 offset:2048
 ds_read_b128 v[36:39], v1 offset:3072
 buffer_load_dwordx4 v[8:11], v0, s[4:7], s33 offen offset:0 sc1
 buffer_load_dwordx4 v[12:15], v0, s[4:7], s33 offen offset:1024 sc1
L_pmfr1:
 s_waitcnt vmcnt(1)
 ds_write_b128 v0, v[8:11] offset:0
 v_max3_u32 v16, v8, v9, v10
 s_waitcnt vmcnt(0)
 ds_write_b128 v0, v[12:15] offset:1024
 v_max3_u32 v16, v16, v11, v12
 v_max3_u32 v17, v13, v14, v15
 v_max_u32 v16, v16, v17
 v_cmp_eq_u32 vcc, -1, v16
 s_cmp_eq_u64 vcc, 0
 s_cbranch_scc1 L_b1fr1
 s_cmp_eq_u32 s15, 0
 s_cbranch_scc1 L_b1fr1
 s_sub_u32 s15, s15, 1
 buffer_load_dwordx4 v[8:11], v0, s[4:7], s33 offen offset:0 sc1
 buffer_load_dwordx4 v[12:15], v0, s[4:7], s33 offen offset:1024 sc1
 s_branch L_pmfr1
L_b1fr1:
 s_waitcnt lgkmcnt(2)
 v_smfmac_f32_16x16x64_bf16 v[40:43], v[8:11], v[24:31], v5
 ds_read_b128 v[24:27], v1 offset:4096
 s_waitcnt lgkmcnt(1)
 v_smfmac_f32_16x16x64_bf16 v[44:47], v[8:11], v[32:39], v5
 ds_read_b128 v[28:31], v1 offset:5120
 v_smfmac_f32_16x16x64_bf16 v[40:43], v[12:15], a[32:39], v5
 ds_read_b128 v[32:35], v1 offset:6144
 v_smfmac_f32_16x16x64_bf16 v[44:47], v[12:15], a[40:47], v5
 ds_read_b128 v[36:39], v1 offset:7168
 s_waitcnt lgkmcnt(4)
 s_barrier
 ds_read_b128 v[16:19], v0 offset:2048
 ds_read_b128 v[20:23], v0 offset:3072
 v_smfmac_f32_16x16x64_bf16 v[48:51], v[8:11], a[0:7], v5
 v_smfmac_f32_16x16x64_bf16 v[52:55], v[8:11], a[8:15], v5
 ds_read_b128 v[8:11], v0 offset:4096
 v_smfmac_f32_16x16x64_bf16 v[48:51], v[12:15], a[48:55], v5
 v_smfmac_f32_16x16x64_bf16 v[52:55], v[12:15], a[56:63], v5
 ds_read_b128 v[12:15], v0 offset:5120
 s_waitcnt lgkmcnt(3)
 v_smfmac_f32_16x16x64_bf16 v[40:43], v[16:19], a[80:87], v5
 v_smfmac_f32_16x16x64_bf16 v[44:47], v[16:19], a[88:95], v5
 v_smfmac_f32_16x16x64_bf16 v[48:51], v[16:19], v[24:31], v5
 ds_read_b128 v[24:27], v1 offset:12288
 v_smfmac_f32_16x16x64_bf16 v[52:55], v[16:19], v[32:39], v5
 ds_read_b128 v[16:19], v0 offset:6144
 s_waitcnt lgkmcnt(4)
 v_smfmac_f32_16x16x64_bf16 v[40:43], v[20:23], a[112:119], v5
 ds_read_b128 v[28:31], v1 offset:13312
 v_smfmac_f32_16x16x64_bf16 v[44:47], v[20:23], a[120:127], v5
 ds_read_b128 v[20:23], v0 offset:7168
 s_waitcnt lgkmcnt(5)
 v_smfmac_f32_16x16x64_bf16 v[40:43], v[8:11], a[160:167], v5
 ds_read_b128 v[32:35], v1 offset:14336
 v_smfmac_f32_16x16x64_bf16 v[44:47], v[8:11], a[168:175], v5
 ds_read_b128 v[8:11], v0 offset:8192
 s_waitcnt lgkmcnt(6)
 v_smfmac_f32_16x16x64_bf16 v[40:43], v[12:15], a[192:199], v5
 ds_read_b128 v[36:39], v1 offset:15360
 v_smfmac_f32_16x16x64_bf16 v[44:47], v[12:15], a[200:207], v5
 s_waitcnt lgkmcnt(5)
 v_smfmac_f32_16x16x64_bf16 v[40:43], v[16:19], a[208:215], v5
 v_smfmac_f32_16x16x64_bf16 v[44:47], v[16:19], a[216:223], v5
 s_waitcnt lgkmcnt(3)
 v_smfmac_f32_16x16x64_bf16 v[40:43], v[20:23], v[80:87], v5
 s_waitcnt lgkmcnt(1)
 v_smfmac_f32_16x16x64_bf16 v[40:43], v[8:11], v[128:135], v5
 v_smfmac_f32_16x16x64_bf16 v[44:47], v[20:23], v[88:95], v5
 s_waitcnt lgkmcnt(0)
 v_smfmac_f32_16x16x64_bf16 v[44:47], v[8:11], v[136:143], v5
 v_pk_mul_f32 v[40:41], v[40:41], s[54:55]
 v_smfmac_f32_16x16x64_bf16 v[48:51], v[12:15], v[24:31], v5
 ds_read_b128 v[24:27], v1 offset:8192
 v_pk_mul_f32 v[42:43], v[42:43], s[54:55]
 v_smfmac_f32_16x16x64_bf16 v[52:55], v[12:15], v[32:39], v5
 ds_read_b128 v[12:15], v0 offset:3072
 v_cvt_pk_bf16_f32 v40, v40, v41
 v_smfmac_f32_16x16x64_bf16 v[48:51], v[16:19], a[224:231], v5
 ds_read_b128 v[28:31], v1 offset:9216
 v_cvt_pk_bf16_f32 v41, v42, v43
 v_smfmac_f32_16x16x64_bf16 v[52:55], v[16:19], a[232:239], v5
 ds_read_b128 v[16:19], v0 offset:4096
 v_pk_mul_f32 v[44:45], v[44:45], s[54:55]
 v_mfma_f32_16x16x16_bf16 v[40:43], v[40:41], v[6:7], 0
 ds_read_b128 v[32:35], v1 offset:10240
 v_pk_mul_f32 v[46:47], v[46:47], s[54:55]
 v_smfmac_f32_16x16x64_bf16 v[48:51], v[20:23], v[96:103], v5
 ds_read_b128 v[36:39], v1 offset:11264
 v_cvt_pk_bf16_f32 v44, v44, v45
 v_smfmac_f32_16x16x64_bf16 v[48:51], v[8:11], v[144:151], v5
 s_waitcnt lgkmcnt(4)
 v_cvt_pk_bf16_f32 v45, v46, v47
 v_smfmac_f32_16x16x64_bf16 v[48:51], v[12:15], a[128:135], v5
 v_cvt_pk_bf16_f32 v40, v40, v41
 v_mfma_f32_16x16x16_bf16 v[44:47], v[44:45], v[6:7], 0
 v_cvt_pk_bf16_f32 v41, v42, v43
 v_smfmac_f32_16x16x64_bf16 v[52:55], v[20:23], v[104:111], v5
 s_waitcnt lgkmcnt(2)
 v_smfmac_f32_16x16x64_bf16 v[48:51], v[16:19], v[24:31], v5
 ds_read_b128 v[24:27], v1 offset:16384
 v_cvt_pk_bf16_f32 v42, v44, v45
 v_smfmac_f32_16x16x64_bf16 v[52:55], v[8:11], v[152:159], v5
 ds_read_b128 v[28:31], v1 offset:17408
 v_cvt_pk_bf16_f32 v43, v46, v47
 v_smfmac_f32_16x16x64_bf16 v[52:55], v[12:15], a[136:143], v5
 s_waitcnt lgkmcnt(2)
 v_cvt_pk_bf16_f32 v48, v48, v49
 v_smfmac_f32_16x16x64_bf16 v[52:55], v[16:19], v[32:39], v5
 ds_read_b128 v[32:35], v1 offset:18432
 s_waitcnt vmcnt(2)
 v_cvt_pk_bf16_f32 v49, v50, v51
 ds_read_b128 v[36:39], v1 offset:19456
 s_add_u32 s33, s58, 37748736
 v_mfma_f32_16x16x16_bf16 v[48:51], v[48:49], v[6:7], 0
 v_mfma_f32_16x16x32_bf16 v[64:67], v[64:67], v[40:43], 0
 v_cvt_pk_bf16_f32 v52, v52, v53
 v_cvt_pk_bf16_f32 v53, v54, v55
 v_mfma_f32_16x16x32_bf16 v[68:71], v[68:71], v[40:43], 0
 v_mfma_f32_16x16x16_bf16 v[52:55], v[52:53], v[6:7], 0
 v_cvt_pk_bf16_f32 v48, v48, v49
 v_cvt_pk_bf16_f32 v49, v50, v51
 v_smfmac_f32_16x16x64_bf16 v[56:59], v[20:23], v[112:119], v5
 v_mov_b32_dpp v64, v68 quad_perm:[0,1,2,3] row_mask:0xf bank_mask:0xc
 v_mov_b32_dpp v65, v69 quad_perm:[0,1,2,3] row_mask:0xf bank_mask:0xc
 v_smfmac_f32_16x16x64_bf16 v[60:63], v[20:23], v[120:127], v5
 ds_read_b128 v[20:23], v0 offset:0
 v_cvt_pk_bf16_f32 v50, v52, v53
 v_cvt_pk_bf16_f32 v51, v54, v55
 v_mov_b32_dpp v66, v70 quad_perm:[0,1,2,3] row_mask:0xf bank_mask:0xc
 v_mov_b32_dpp v67, v71 quad_perm:[0,1,2,3] row_mask:0xf bank_mask:0xc
 v_mfma_f32_16x16x32_bf16 v[44:47], v[48:51], v[40:43], 0
 ds_write_b128 v0, v[64:67] offset:10240
 v_smfmac_f32_16x16x64_bf16 v[56:59], v[8:11], v[160:167], v5
 buffer_store_dwordx4 v[48:51], v0, s[4:7], s33 offen sc1
 v_smfmac_f32_16x16x64_bf16 v[60:63], v[8:11], v[168:175], v5
 ds_read_b128 v[8:11], v0 offset:1024
 v_cndmask_b32 v52, v45, v44, s[56:57]
 v_cndmask_b32 v53, v47, v46, s[56:57]
 v_cndmask_b32 v52, v52, v53, s[60:61]
 ds_write_b32 v0, v52 offset:13316
 v_smfmac_f32_16x16x64_bf16 v[56:59], v[12:15], a[144:151], v5
 v_smfmac_f32_16x16x64_bf16 v[60:63], v[12:15], a[152:159], v5
 ds_read_b128 v[12:15], v0 offset:2048
 v_smfmac_f32_16x16x64_bf16 v[56:59], v[16:19], a[176:183], v5
 v_smfmac_f32_16x16x64_bf16 v[60:63], v[16:19], a[184:191], v5
 ds_read_b128 v[16:19], v0 offset:5120
 s_waitcnt lgkmcnt(2)
 s_barrier
 ds_read_b128 v[64:67], v0 offset:13312
 ds_read_b128 v[40:43], v0 offset:9216
 ds_read_b128 v[44:47], v0 offset:10240
 ds_read_b128 v[48:51], v0 offset:11264
 ds_read_b128 v[52:55], v0 offset:12288
 v_smfmac_f32_16x16x64_bf16 v[56:59], v[20:23], a[16:23], v5
 v_smfmac_f32_16x16x64_bf16 v[60:63], v[20:23], a[24:31], v5
 ds_read_b128 v[20:23], v0 offset:6144
 v_smfmac_f32_16x16x64_bf16 v[56:59], v[8:11], a[64:71], v5
 v_smfmac_f32_16x16x64_bf16 v[60:63], v[8:11], a[72:79], v5
 s_waitcnt lgkmcnt(7)
 s_waitcnt lgkmcnt(5)
 v_smfmac_f32_16x16x64_bf16 v[56:59], v[12:15], a[96:103], v5
 v_add_f32 v64, v64, v65
 v_smfmac_f32_16x16x64_bf16 v[60:63], v[12:15], a[104:111], v5
 s_waitcnt lgkmcnt(3)
 v_add_f32 v66, v66, v67
 v_smfmac_f32_16x16x64_bf16 v[56:59], v[16:19], v[24:31], v5
 v_pk_add_f32 v[40:41], v[40:41], v[44:45]
 v_smfmac_f32_16x16x64_bf16 v[60:63], v[16:19], v[32:39], v5
 s_waitcnt lgkmcnt(2)
 v_pk_add_f32 v[42:43], v[42:43], v[46:47]
 v_pk_add_f32 v[40:41], v[40:41], v[48:49]
 v_pk_add_f32 v[42:43], v[42:43], v[50:51]
 v_add_f32 v64, v64, v66
 s_waitcnt lgkmcnt(1)
 v_pk_add_f32 v[44:45], v[40:41], v[52:53]
 v_pk_add_f32 v[46:47], v[42:43], v[54:55]
 s_waitcnt lgkmcnt(0)
 v_smfmac_f32_16x16x64_bf16 v[56:59], v[20:23], a[240:247], v5
 v_max3_f32 v68, v44, v45, v46
 v_mov_b64 v[48:49], s[70:71]
 v_smfmac_f32_16x16x64_bf16 v[60:63], v[20:23], a[248:255], v5
 ds_read_b128 v[24:27], v1 offset:24576
 v_max3_f32 v68, v68, v47, v64
 v_mov_b64 v[50:51], s[72:73]
 ds_read_b128 v[28:31], v1 offset:25600
 v_max_f32_dpp v69, v68, v68 row_ror:8 row_mask:0xf bank_mask:0xf
 v_max_f32_dpp v68, v68, v68 row_ror:8 row_mask:0xf bank_mask:0xf
 ds_read_b128 v[32:35], v1 offset:26624
 ds_read_b128 v[36:39], v1 offset:27648
 v_permlane32_swap_b32 v68, v69
 v_max_f32 v70, v68, v69
 v_max_f32 v71, v68, v69
 ds_read_b128 v[8:11], v1 offset:20480
 ds_read_b128 v[12:15], v1 offset:21504
 v_permlane16_swap_b32 v70, v71
 ds_read_b128 v[16:19], v1 offset:22528
 v_max_f32 v68, v70, v71
 v_sub_f32 v64, v64, v68
 v_pk_add_f32 v[44:45], v[44:45], v[68:69] op_sel_hi:[1,0] neg_lo:[0,1] neg_hi:[0,1]
 v_pk_add_f32 v[46:47], v[46:47], v[68:69] op_sel_hi:[1,0] neg_lo:[0,1] neg_hi:[0,1]
 v_exp_f32 v64, v64
 ds_read_b128 v[20:23], v1 offset:23552
 v_exp_f32 v44, v44
 v_mov_b32_dpp v65, v64 row_ror:8 row_mask:0xf bank_mask:0xf
 v_exp_f32 v45, v45
 v_cvt_pk_bf16_f32 v56, v56, v57
 v_exp_f32 v46, v46
 v_cvt_pk_bf16_f32 v40, v64, v65
 v_cvt_pk_bf16_f32 v41, v64, v65
 v_exp_f32 v47, v47
 v_cvt_pk_bf16_f32 v57, v58, v59
 v_cvt_pk_bf16_f32 v42, v44, v45
 v_permlane32_swap_b32 v40, v41
 v_cvt_pk_bf16_f32 v58, v60, v61
 v_cvt_pk_bf16_f32 v43, v46, v47
 v_cvt_pk_bf16_f32 v59, v62, v63
 s_add_u32 s33, s58, 37748736
 v_mov_b32_dpp v44, v42 row_ror:8 row_mask:0xf bank_mask:0xf
 s_cmp_eq_u32 s41, 63
 v_mov_b32_dpp v45, v43 row_ror:8 row_mask:0xf bank_mask:0xf
 s_cbranch_scc1 L_lastfr1
 v_mfma_f32_16x16x32_bf16 v[52:55], v[48:51], v[40:43], 0
 v_lshrrev_b32 v46, 1, v0
 v_and_b32 v47, 0x70, v0
 v_mfma_f32_16x16x16_bf16 v[64:67], v[56:57], v[40:41], 0
 v_and_b32 v46, 0x180, v46
 v_mov_b64 v[60:61], 0
 v_mfma_f32_16x16x16_bf16 v[68:71], v[58:59], v[40:41], 0
 v_or_b32 v46, v46, v47
 v_mov_b64 v[62:63], 0
 buffer_store_dwordx4 v[56:59], v0, s[4:7], s33 offen offset:1024 sc1
 s_waitcnt vmcnt(3)
 v_mfma_f32_16x16x32_bf16 v[64:67], v[72:75], v[42:45], v[64:67]
 v_add_f32_dpp v52, v52, v52 row_ror:8 row_mask:0xf bank_mask:0xf
 v_bfe_u32 v47, v0, 7, 1
 s_waitcnt vmcnt(2)
 v_mfma_f32_16x16x32_bf16 v[68:71], v[76:79], v[42:45], v[68:71]
 v_rcp_f32 v52, v52
 v_lshl_add_u32 v47, v47, 9, v46
 v_mov_b64 v[48:49], 0
 v_mov_b64 v[50:51], 0
 v_mov_b64 v[56:57], 0
 v_mov_b64 v[58:59], 0
 v_pk_mul_f32 v[64:65], v[64:65], v[52:53] op_sel_hi:[1,0]
 v_pk_mul_f32 v[66:67], v[66:67], v[52:53] op_sel_hi:[1,0]
 v_pk_mul_f32 v[68:69], v[68:69], v[52:53] op_sel_hi:[1,0]
 v_pk_mul_f32 v[70:71], v[70:71], v[52:53] op_sel_hi:[1,0]
 v_cvt_pk_bf16_f32 v64, v64, v65
 v_cvt_pk_bf16_f32 v65, v66, v67
 v_cvt_pk_bf16_f32 v66, v68, v69
 v_cvt_pk_bf16_f32 v67, v70, v71
 s_mov_b64 exec, s[56:57]
 ds_write_b128 v46, v[64:67] offset:14848
 s_mov_b64 exec, -1
 v_mov_b32_dpp v64, v64 row_ror:8 row_mask:0xf bank_mask:0xc
 v_mov_b32_dpp v65, v65 row_ror:8 row_mask:0xf bank_mask:0xc
 v_mov_b32_dpp v66, v66 row_ror:8 row_mask:0xf bank_mask:0xc
 v_mov_b32_dpp v67, v67 row_ror:8 row_mask:0xf bank_mask:0xc
 s_bfe_u32 s52, s41, 0x10001
 s_sub_u32 s45, 0, s52
 s_waitcnt lgkmcnt(1)
 v_smfmac_f32_16x16x64_bf16 v[48:51], v[64:67], v[16:23], v5
 ds_read_b128 v[16:19], v1 offset:30720
 ds_read_b128 v[20:23], v1 offset:31744
 v_mov_b64 v[52:53], 0
 v_smfmac_f32_16x16x64_bf16 v[56:59], v[64:67], v[184:191], v5
 s_add_u32 s34, s46, s44
 v_mov_b32 v44, -1
 v_smfmac_f32_16x16x64_bf16 v[60:63], v[64:67], v[216:223], v5
 buffer_store_dword v44, v4, s[4:7], s34 offen sc1
 v_mov_b64 v[54:55], 0
 s_add_u32 s33, s48, s47
 s_add_u32 s34, s59, s47
 s_waitcnt lgkmcnt(2)
 s_barrier
 ds_read_b128 v[68:71], v46 offset:14336
 ds_read_b128 v[72:75], v46 offset:15360
 ds_read_b128 v[76:79], v46 offset:15872
 ds_read_b128 v[40:43], v47 offset:14336
 ds_read_b128 v[44:47], v47 offset:15360
 s_waitcnt lgkmcnt(4)
 v_smfmac_f32_16x16x64_bf16 v[48:51], v[68:71], v[8:15], v5
 ds_read_b128 v[8:11], v1 offset:28672
 s_waitcnt lgkmcnt(4)
 v_smfmac_f32_16x16x64_bf16 v[48:51], v[72:75], v[24:31], v5
 ds_read_b128 v[12:15], v1 offset:29696
 s_waitcnt lgkmcnt(4)
 v_smfmac_f32_16x16x64_bf16 v[48:51], v[76:79], v[32:39], v5
 ds_read_b128 v[24:27], v1 offset:32768
 s_waitcnt lgkmcnt(4)
 v_smfmac_f32_16x16x64_bf16 v[52:55], v[40:43], v[240:247], v5
 ds_read_b128 v[28:31], v1 offset:33792
 s_waitcnt lgkmcnt(4)
 v_smfmac_f32_16x16x64_bf16 v[52:55], v[44:47], v[248:255], v5
 ds_read_b128 v[32:35], v1 offset:34816
 v_cvt_pk_bf16_f32 v48, v48, v49
 v_smfmac_f32_16x16x64_bf16 v[56:59], v[68:71], v[176:183], v5
 ds_read_b128 v[36:39], v1 offset:35840
 s_add_u32 s35, s33, 131072
 v_cvt_pk_bf16_f32 v49, v50, v51
 v_smfmac_f32_16x16x64_bf16 v[56:59], v[72:75], v[192:199], v5
 v_and_or_b32 v48, v48, -2, s52
 v_permlane32_swap_b32 v52, v54
 v_smfmac_f32_16x16x64_bf16 v[56:59], v[76:79], v[200:207], v5
 buffer_store_dwordx2 v[48:49], v3, s[4:7], s35 offen sc1
 v_permlane32_swap_b32 v53, v55
 v_smfmac_f32_16x16x64_bf16 v[60:63], v[68:71], v[208:215], v5
 v_mov_b64 v[40:41], 0
 v_add_f32 v52, v52, v54
 v_smfmac_f32_16x16x64_bf16 v[60:63], v[72:75], v[224:231], v5
 v_mov_b64 v[42:43], 0
 v_add_f32 v53, v53, v55
 v_smfmac_f32_16x16x64_bf16 v[60:63], v[76:79], v[232:239], v5
 s_add_u32 s35, s33, 0
 v_cvt_pk_bf16_f32 v56, v56, v57
 v_cvt_pk_bf16_f32 v52, v52, v53
 v_smfmac_f32_16x16x64_bf16 v[40:43], v[64:67], v[16:23], v5
 v_cvt_pk_bf16_f32 v57, v58, v59
 v_and_or_b32 v52, v52, -2, s52
 s_waitcnt lgkmcnt(4)
 v_smfmac_f32_16x16x64_bf16 v[40:43], v[68:71], v[8:15], v5
 buffer_store_dword v52, v2, s[4:7], s34 offen sc1
 v_and_or_b32 v56, v56, -2, s52
 v_cvt_pk_bf16_f32 v60, v60, v61
 s_waitcnt lgkmcnt(2)
 v_smfmac_f32_16x16x64_bf16 v[40:43], v[72:75], v[24:31], v5
 buffer_store_dwordx2 v[56:57], v3, s[4:7], s35 offen sc1
 s_add_u32 s35, s33, 65536
 v_cvt_pk_bf16_f32 v61, v62, v63
 s_waitcnt lgkmcnt(0)
 v_smfmac_f32_16x16x64_bf16 v[40:43], v[76:79], v[32:39], v5
 v_and_or_b32 v60, v60, -2, s52
 buffer_store_dwordx2 v[60:61], v3, s[4:7], s35 offen sc1
 s_add_u32 s35, s33, 196608
 s_mov_b32 s36, s42
 s_mov_b32 s42, s43
 s_mov_b32 s43, s44
 s_mov_b32 s44, s36
 s_xor_b32 s47, s47, 294912
 s_add_u32 s41, s41, 1
 s_add_u32 s58, s58, 262144
 v_cvt_pk_bf16_f32 v40, v40, v41
 v_cvt_pk_bf16_f32 v41, v42, v43
 v_and_or_b32 v40, v40, -2, s52
 buffer_store_dwordx2 v[40:41], v3, s[4:7], s35 offen sc1
 s_branch L_csfr1
L_lastfr1:
 buffer_store_dwordx4 v[56:59], v0, s[4:7], s33 offen offset:1024 sc1
 s_branch L_chx
L_cefr2:
 v_mov_b64 v[40:41], 0
 v_mov_b64 v[42:43], 0
 v_mov_b64 v[44:45], 0
 v_mov_b64 v[46:47], 0
 v_mov_b64 v[48:49], 0
 v_mov_b64 v[50:51], 0
 v_mov_b64 v[52:53], 0
 v_mov_b64 v[54:55], 0
 v_mov_b64 v[56:57], 0
 v_mov_b64 v[58:59], 0
 v_mov_b64 v[60:61], 0
 v_mov_b64 v[62:63], 0
 ds_read_b128 v[24:27], v1 offset:0
 ds_read_b128 v[28:31], v1 offset:1024
 ds_read_b128 v[32:35], v1 offset:2048
 ds_read_b128 v[36:39], v1 offset:3072
 s_barrier
 s_add_u32 s34, s58, 4194304
 s_add_u32 s35, s58, 20971520
 buffer_load_dwordx4 v[64:67], v0, s[4:7], s34 offen offset:0
 buffer_load_dwordx4 v[68:71], v0, s[4:7], s34 offen offset:1024
 buffer_load_dwordx4 v[72:75], v0, s[4:7], s35 offen offset:0
 buffer_load_dwordx4 v[76:79], v0, s[4:7], s35 offen offset:1024
 s_add_u32 s37, s49, 294912
 s_branch L_b1fr2
L_csfr2:
 s_xor_b32 s37, s47, 294912
 s_add_u32 s37, s37, s49
 buffer_load_dwordx4 v[8:11], v0, s[4:7], s37 offen offset:0 sc1
 buffer_load_dwordx4 v[12:15], v0, s[4:7], s37 offen offset:1024 sc1
 buffer_load_dwordx4 v[16:19], v0, s[4:7], s37 offen offset:2048 sc1
 buffer_load_dwordx4 v[20:23], v0, s[4:7], s37 offen offset:3072 sc1
 s_add_u32 s34, s46, s42
 v_and_b32 v54, 64, v0
 v_lshrrev_b32 v54, 2, v54
 v_mov_b32 v55, 0x3f80
 v_lshlrev_b32 v54, v54, v55
 v_cndmask_b32 v56, 0, v54, s[62:63]
 v_cndmask_b32 v57, 0, v54, s[64:65]
 v_cndmask_b32 v58, 0, v54, s[66:67]
 v_cndmask_b32 v59, 0, v54, s[68:69]
 v_mov_b64 v[40:41], 0
 v_mov_b64 v[42:43], 0
 v_mov_b64 v[44:45], 0
 v_mov_b64 v[46:47], 0
 v_mov_b64 v[48:49], 0
 v_mov_b64 v[50:51], 0
 v_mov_b64 v[52:53], 0
 s_add_u32 s35, s58, 4194304
 s_add_u32 s36, s58, 20971520
 buffer_load_dwordx4 v[64:67], v0, s[4:7], s35 offen offset:0
 buffer_load_dwordx4 v[68:71], v0, s[4:7], s35 offen offset:1024
 buffer_load_dwordx4 v[72:75], v0, s[4:7], s36 offen offset:0
 buffer_load_dwordx4 v[76:79], v0, s[4:7], s36 offen offset:1024
 s_waitcnt vmcnt(7)
 v_mfma_f32_16x16x32_bf16 v[60:63], v[56:59], v[8:11], 0
 v_bitop3_b32 v54, v8, v9, s45 bitop3:0x7e
 v_bitop3_b32 v55, v10, v11, s45 bitop3:0x7e
 s_waitcnt vmcnt(6)
 v_mfma_f32_16x16x32_bf16 v[60:63], v[56:59], v[12:15], v[60:63]
 v_or_b32 v54, v54, v55
 v_bitop3_b32 v55, v12, v13, s45 bitop3:0x7e
 v_or_b32 v54, v54, v55
 v_bitop3_b32 v55, v14, v15, s45 bitop3:0x7e
 s_waitcnt vmcnt(5)
 v_mfma_f32_16x16x32_bf16 v[60:63], v[56:59], v[16:19], v[60:63]
 v_or_b32 v54, v54, v55
 v_bitop3_b32 v55, v16, v17, s45 bitop3:0x7e
 v_or_b32 v54, v54, v55
 v_bitop3_b32 v55, v18, v19, s45 bitop3:0x7e
 s_waitcnt vmcnt(4)
 v_mfma_f32_16x16x32_bf16 v[60:63], v[56:59], v[20:23], v[60:63]
 v_or_b32 v54, v54, v55
 v_bitop3_b32 v55, v20, v21, s45 bitop3:0x7e
 v_or_b32 v54, v54, v55
 v_bitop3_b32 v55, v22, v23, s45 bitop3:0x7e
 v_bitop3_b32 v54, v54, v55, 1 bitop3:0xa8
 v_cmp_ne_u32 vcc, 0, v54
 s_cmp_eq_u64 vcc, 0
 s_cbranch_scc1 L_rpdfr2
L_rpfr2:
 s_cmp_eq_u32 s15, 0
 s_cbranch_scc1 L_rpdfr2
 s_sub_u32 s15, s15, 1
 buffer_load_dwordx4 v[8:11], v0, s[4:7], s37 offen offset:0 sc1
 buffer_load_dwordx4 v[12:15], v0, s[4:7], s37 offen offset:1024 sc1
 buffer_load_dwordx4 v[16:19], v0, s[4:7], s37 offen offset:2048 sc1
 buffer_load_dwordx4 v[20:23], v0, s[4:7], s37 offen offset:3072 sc1
 s_waitcnt vmcnt(3)
 v_mfma_f32_16x16x32_bf16 v[60:63], v[56:59], v[8:11], 0
 v_bitop3_b32 v54, v8, v9, s45 bitop3:0x7e
 v_bitop3_b32 v55, v10, v11, s45 bitop3:0x7e
 s_waitcnt vmcnt(2)
 v_mfma_f32_16x16x32_bf16 v[60:63], v[56:59], v[12:15], v[60:63]
 v_or_b32 v54, v54, v55
 v_bitop3_b32 v55, v12, v13, s45 bitop3:0x7e
 v_or_b32 v54, v54, v55
 v_bitop3_b32 v55, v14, v15, s45 bitop3:0x7e
 s_waitcnt vmcnt(1)
 v_mfma_f32_16x16x32_bf16 v[60:63], v[56:59], v[16:19], v[60:63]
 v_or_b32 v54, v54, v55
 v_bitop3_b32 v55, v16, v17, s45 bitop3:0x7e
 v_or_b32 v54, v54, v55
 v_bitop3_b32 v55, v18, v19, s45 bitop3:0x7e
 s_waitcnt vmcnt(0)
 v_mfma_f32_16x16x32_bf16 v[60:63], v[56:59], v[20:23], v[60:63]
 v_or_b32 v54, v54, v55
 v_bitop3_b32 v55, v20, v21, s45 bitop3:0x7e
 v_or_b32 v54, v54, v55
 v_bitop3_b32 v55, v22, v23, s45 bitop3:0x7e
 v_bitop3_b32 v54, v54, v55, 1 bitop3:0xa8
 v_cmp_ne_u32 vcc, 0, v54
 s_cmp_eq_u64 vcc, 0
 s_cbranch_scc0 L_rpfr2
L_rpdfr2:
 v_add_f32_dpp v60, v60, v60 row_ror:8 row_mask:0xf bank_mask:0xf
 v_add_f32_dpp v61, v61, v61 row_ror:8 row_mask:0xf bank_mask:0xf
 v_cvt_pk_bf16_f32 v60, v60, v61
 buffer_store_dword v60, v4, s[4:7], s34 offen sc1
 s_barrier
 s_add_u32 s33, s42, 159389696
 v_mov_b64 v[54:55], 0
 v_mov_b64 v[56:57], 0
 v_mov_b64 v[58:59], 0
 v_mov_b64 v[60:61], 0
 v_mov_b64 v[62:63], 0
 ds_read_b128 v[24:27], v1 offset:0
 ds_read_b128 v[28:31], v1 offset:1024
 ds_read_b128 v[32:35], v1 offset:2048
 ds_read_b128 v[36:39], v1 offset:3072
 buffer_load_dwordx4 v[8:11], v0, s[4:7], s33 offen offset:0 sc1
 buffer_load_dwordx4 v[12:15], v0, s[4:7], s33 offen offset:1024 sc1
L_pmfr2:
 s_waitcnt vmcnt(1)
 ds_write_b128 v0, v[8:11] offset:6144
 v_max3_u32 v16, v8, v9, v10
 s_waitcnt vmcnt(0)
 ds_write_b128 v0, v[12:15] offset:7168
 v_max3_u32 v16, v16, v11, v12
 v_max3_u32 v17, v13, v14, v15
 v_max_u32 v16, v16, v17
 v_cmp_eq_u32 vcc, -1, v16
 s_cmp_eq_u64 vcc, 0
 s_cbranch_scc1 L_b1fr2
 s_cmp_eq_u32 s15, 0
 s_cbranch_scc1 L_b1fr2
 s_sub_u32 s15, s15, 1
 buffer_load_dwordx4 v[8:11], v0, s[4:7], s33 offen offset:0 sc1
 buffer_load_dwordx4 v[12:15], v0, s[4:7], s33 offen offset:1024 sc1
 s_branch L_pmfr2
L_b1fr2:
 s_waitcnt lgkmcnt(2)
 v_smfmac_f32_16x16x64_bf16 v[40:43], v[8:11], v[24:31], v5
 ds_read_b128 v[24:27], v1 offset:4096
 s_waitcnt lgkmcnt(1)
 v_smfmac_f32_16x16x64_bf16 v[44:47], v[8:11], v[32:39], v5
 ds_read_b128 v[28:31], v1 offset:5120
 v_smfmac_f32_16x16x64_bf16 v[40:43], v[12:15], a[32:39], v5
 ds_read_b128 v[32:35], v1 offset:6144
 v_smfmac_f32_16x16x64_bf16 v[44:47], v[12:15], a[40:47], v5
 ds_read_b128 v[36:39], v1 offset:7168
 s_waitcnt lgkmcnt(4)
 s_barrier
 ds_read_b128 v[16:19], v0 offset:8192
 ds_read_b128 v[20:23], v0 offset:0
 v_smfmac_f32_16x16x64_bf16 v[48:51], v[8:11], a[0:7], v5
 v_smfmac_f32_16x16x64_bf16 v[52:55], v[8:11], a[8:15], v5
 ds_read_b128 v[8:11], v0 offset:1024
 v_smfmac_f32_16x16x64_bf16 v[48:51], v[12:15], a[48:55], v5
 v_smfmac_f32_16x16x64_bf16 v[52:55], v[12:15], a[56:63], v5
 ds_read_b128 v[12:15], v0 offset:2048
 s_waitcnt lgkmcnt(3)
 v_smfmac_f32_16x16x64_bf16 v[40:43], v[16:19], a[80:87], v5
 v_smfmac_f32_16x16x64_bf16 v[44:47], v[16:19], a[88:95], v5
 v_smfmac_f32_16x16x64_bf16 v[48:51], v[16:19], v[24:31], v5
 ds_read_b128 v[24:27], v1 offset:12288
 v_smfmac_f32_16x16x64_bf16 v[52:55], v[16:19], v[32:39], v5
 ds_read_b128 v[16:19], v0 offset:3072
 s_waitcnt lgkmcnt(4)
 v_smfmac_f32_16x16x64_bf16 v[40:43], v[20:23], a[112:119], v5
 ds_read_b128 v[28:31], v1 offset:13312
 v_smfmac_f32_16x16x64_bf16 v[44:47], v[20:23], a[120:127], v5
 ds_read_b128 v[20:23], v0 offset:4096
 s_waitcnt lgkmcnt(5)
 v_smfmac_f32_16x16x64_bf16 v[40:43], v[8:11], a[160:167], v5
 ds_read_b128 v[32:35], v1 offset:14336
 v_smfmac_f32_16x16x64_bf16 v[44:47], v[8:11], a[168:175], v5
 ds_read_b128 v[8:11], v0 offset:5120
 s_waitcnt lgkmcnt(6)
 v_smfmac_f32_16x16x64_bf16 v[40:43], v[12:15], a[192:199], v5
 ds_read_b128 v[36:39], v1 offset:15360
 v_smfmac_f32_16x16x64_bf16 v[44:47], v[12:15], a[200:207], v5
 s_waitcnt lgkmcnt(5)
 v_smfmac_f32_16x16x64_bf16 v[40:43], v[16:19], a[208:215], v5
 v_smfmac_f32_16x16x64_bf16 v[44:47], v[16:19], a[216:223], v5
 s_waitcnt lgkmcnt(3)
 v_smfmac_f32_16x16x64_bf16 v[40:43], v[20:23], v[80:87], v5
 s_waitcnt lgkmcnt(1)
 v_smfmac_f32_16x16x64_bf16 v[40:43], v[8:11], v[128:135], v5
 v_smfmac_f32_16x16x64_bf16 v[44:47], v[20:23], v[88:95], v5
 s_waitcnt lgkmcnt(0)
 v_smfmac_f32_16x16x64_bf16 v[44:47], v[8:11], v[136:143], v5
 v_pk_mul_f32 v[40:41], v[40:41], s[54:55]
 v_smfmac_f32_16x16x64_bf16 v[48:51], v[12:15], v[24:31], v5
 ds_read_b128 v[24:27], v1 offset:8192
 v_pk_mul_f32 v[42:43], v[42:43], s[54:55]
 v_smfmac_f32_16x16x64_bf16 v[52:55], v[12:15], v[32:39], v5
 ds_read_b128 v[12:15], v0 offset:0
 v_cvt_pk_bf16_f32 v40, v40, v41
 v_smfmac_f32_16x16x64_bf16 v[48:51], v[16:19], a[224:231], v5
 ds_read_b128 v[28:31], v1 offset:9216
 v_cvt_pk_bf16_f32 v41, v42, v43
 v_smfmac_f32_16x16x64_bf16 v[52:55], v[16:19], a[232:239], v5
 ds_read_b128 v[16:19], v0 offset:1024
 v_pk_mul_f32 v[44:45], v[44:45], s[54:55]
 v_mfma_f32_16x16x16_bf16 v[40:43], v[40:41], v[6:7], 0
 ds_read_b128 v[32:35], v1 offset:10240
 v_pk_mul_f32 v[46:47], v[46:47], s[54:55]
 v_smfmac_f32_16x16x64_bf16 v[48:51], v[20:23], v[96:103], v5
 ds_read_b128 v[36:39], v1 offset:11264
 v_cvt_pk_bf16_f32 v44, v44, v45
 v_smfmac_f32_16x16x64_bf16 v[48:51], v[8:11], v[144:151], v5
 s_waitcnt lgkmcnt(4)
 v_cvt_pk_bf16_f32 v45, v46, v47
 v_smfmac_f32_16x16x64_bf16 v[48:51], v[12:15], a[128:135], v5
 v_cvt_pk_bf16_f32 v40, v40, v41
 v_mfma_f32_16x16x16_bf16 v[44:47], v[44:45], v[6:7], 0
 v_cvt_pk_bf16_f32 v41, v42, v43
 v_smfmac_f32_16x16x64_bf16 v[52:55], v[20:23], v[104:111], v5
 s_waitcnt lgkmcnt(2)
 v_smfmac_f32_16x16x64_bf16 v[48:51], v[16:19], v[24:31], v5
 ds_read_b128 v[24:27], v1 offset:16384
 v_cvt_pk_bf16_f32 v42, v44, v45
 v_smfmac_f32_16x16x64_bf16 v[52:55], v[8:11], v[152:159], v5
 ds_read_b128 v[28:31], v1 offset:17408
 v_cvt_pk_bf16_f32 v43, v46, v47
 v_smfmac_f32_16x16x64_bf16 v[52:55], v[12:15], a[136:143], v5
 s_waitcnt lgkmcnt(2)
 v_cvt_pk_bf16_f32 v48, v48, v49
 v_smfmac_f32_16x16x64_bf16 v[52:55], v[16:19], v[32:39], v5
 ds_read_b128 v[32:35], v1 offset:18432
 s_waitcnt vmcnt(2)
 v_cvt_pk_bf16_f32 v49, v50, v51
 ds_read_b128 v[36:39], v1 offset:19456
 s_add_u32 s33, s58, 37748736
 v_mfma_f32_16x16x16_bf16 v[48:51], v[48:49], v[6:7], 0
 v_mfma_f32_16x16x32_bf16 v[64:67], v[64:67], v[40:43], 0
 v_cvt_pk_bf16_f32 v52, v52, v53
 v_cvt_pk_bf16_f32 v53, v54, v55
 v_mfma_f32_16x16x32_bf16 v[68:71], v[68:71], v[40:43], 0
 v_mfma_f32_16x16x16_bf16 v[52:55], v[52:53], v[6:7], 0
 v_cvt_pk_bf16_f32 v48, v48, v49
 v_cvt_pk_bf16_f32 v49, v50, v51
 v_smfmac_f32_16x16x64_bf16 v[56:59], v[20:23], v[112:119], v5
 v_mov_b32_dpp v64, v68 quad_perm:[0,1,2,3] row_mask:0xf bank_mask:0xc
 v_mov_b32_dpp v65, v69 quad_perm:[0,1,2,3] row_mask:0xf bank_mask:0xc
 v_smfmac_f32_16x16x64_bf16 v[60:63], v[20:23], v[120:127], v5
 ds_read_b128 v[20:23], v0 offset:6144
 v_cvt_pk_bf16_f32 v50, v52, v53
 v_cvt_pk_bf16_f32 v51, v54, v55
 v_mov_b32_dpp v66, v70 quad_perm:[0,1,2,3] row_mask:0xf bank_mask:0xc
 v_mov_b32_dpp v67, v71 quad_perm:[0,1,2,3] row_mask:0xf bank_mask:0xc
 v_mfma_f32_16x16x32_bf16 v[44:47], v[48:51], v[40:43], 0
 ds_write_b128 v0, v[64:67] offset:11264
 v_smfmac_f32_16x16x64_bf16 v[56:59], v[8:11], v[160:167], v5
 buffer_store_dwordx4 v[48:51], v0, s[4:7], s33 offen sc1
 v_smfmac_f32_16x16x64_bf16 v[60:63], v[8:11], v[168:175], v5
 ds_read_b128 v[8:11], v0 offset:7168
 v_cndmask_b32 v52, v45, v44, s[56:57]
 v_cndmask_b32 v53, v47, v46, s[56:57]
 v_cndmask_b32 v52, v52, v53, s[60:61]
 ds_write_b32 v0, v52 offset:13320
 v_smfmac_f32_16x16x64_bf16 v[56:59], v[12:15], a[144:151], v5
 v_smfmac_f32_16x16x64_bf16 v[60:63], v[12:15], a[152:159], v5
 ds_read_b128 v[12:15], v0 offset:8192
 v_smfmac_f32_16x16x64_bf16 v[56:59], v[16:19], a[176:183], v5
 v_smfmac_f32_16x16x64_bf16 v[60:63], v[16:19], a[184:191], v5
 ds_read_b128 v[16:19], v0 offset:2048
 s_waitcnt lgkmcnt(2)
 s_barrier
 ds_read_b128 v[64:67], v0 offset:13312
 ds_read_b128 v[40:43], v0 offset:9216
 ds_read_b128 v[44:47], v0 offset:10240
 ds_read_b128 v[48:51], v0 offset:11264
 ds_read_b128 v[52:55], v0 offset:12288
 v_smfmac_f32_16x16x64_bf16 v[56:59], v[20:23], a[16:23], v5
 v_smfmac_f32_16x16x64_bf16 v[60:63], v[20:23], a[24:31], v5
 ds_read_b128 v[20:23], v0 offset:3072
 v_smfmac_f32_16x16x64_bf16 v[56:59], v[8:11], a[64:71], v5
 v_smfmac_f32_16x16x64_bf16 v[60:63], v[8:11], a[72:79], v5
 s_waitcnt lgkmcnt(7)
 s_waitcnt lgkmcnt(5)
 v_smfmac_f32_16x16x64_bf16 v[56:59], v[12:15], a[96:103], v5
 v_add_f32 v64, v64, v65
 v_smfmac_f32_16x16x64_bf16 v[60:63], v[12:15], a[104:111], v5
 s_waitcnt lgkmcnt(3)
 v_add_f32 v66, v66, v67
 v_smfmac_f32_16x16x64_bf16 v[56:59], v[16:19], v[24:31], v5
 v_pk_add_f32 v[40:41], v[40:41], v[44:45]
 v_smfmac_f32_16x16x64_bf16 v[60:63], v[16:19], v[32:39], v5
 s_waitcnt lgkmcnt(2)
 v_pk_add_f32 v[42:43], v[42:43], v[46:47]
 v_pk_add_f32 v[40:41], v[40:41], v[48:49]
 v_pk_add_f32 v[42:43], v[42:43], v[50:51]
 v_add_f32 v64, v64, v66
 s_waitcnt lgkmcnt(1)
 v_pk_add_f32 v[44:45], v[40:41], v[52:53]
 v_pk_add_f32 v[46:47], v[42:43], v[54:55]
 s_waitcnt lgkmcnt(0)
 v_smfmac_f32_16x16x64_bf16 v[56:59], v[20:23], a[240:247], v5
 v_max3_f32 v68, v44, v45, v46
 v_mov_b64 v[48:49], s[70:71]
 v_smfmac_f32_16x16x64_bf16 v[60:63], v[20:23], a[248:255], v5
 ds_read_b128 v[24:27], v1 offset:24576
 v_max3_f32 v68, v68, v47, v64
 v_mov_b64 v[50:51], s[72:73]
 ds_read_b128 v[28:31], v1 offset:25600
 v_max_f32_dpp v69, v68, v68 row_ror:8 row_mask:0xf bank_mask:0xf
 v_max_f32_dpp v68, v68, v68 row_ror:8 row_mask:0xf bank_mask:0xf
 ds_read_b128 v[32:35], v1 offset:26624
 ds_read_b128 v[36:39], v1 offset:27648
 v_permlane32_swap_b32 v68, v69
 v_max_f32 v70, v68, v69
 v_max_f32 v71, v68, v69
 ds_read_b128 v[8:11], v1 offset:20480
 ds_read_b128 v[12:15], v1 offset:21504
 v_permlane16_swap_b32 v70, v71
 ds_read_b128 v[16:19], v1 offset:22528
 v_max_f32 v68, v70, v71
 v_sub_f32 v64, v64, v68
 v_pk_add_f32 v[44:45], v[44:45], v[68:69] op_sel_hi:[1,0] neg_lo:[0,1] neg_hi:[0,1]
 v_pk_add_f32 v[46:47], v[46:47], v[68:69] op_sel_hi:[1,0] neg_lo:[0,1] neg_hi:[0,1]
 v_exp_f32 v64, v64
 ds_read_b128 v[20:23], v1 offset:23552
 v_exp_f32 v44, v44
 v_mov_b32_dpp v65, v64 row_ror:8 row_mask:0xf bank_mask:0xf
 v_exp_f32 v45, v45
 v_cvt_pk_bf16_f32 v56, v56, v57
 v_exp_f32 v46, v46
 v_cvt_pk_bf16_f32 v40, v64, v65
 v_cvt_pk_bf16_f32 v41, v64, v65
 v_exp_f32 v47, v47
 v_cvt_pk_bf16_f32 v57, v58, v59
 v_cvt_pk_bf16_f32 v42, v44, v45
 v_permlane32_swap_b32 v40, v41
 v_cvt_pk_bf16_f32 v58, v60, v61
 v_cvt_pk_bf16_f32 v43, v46, v47
 v_cvt_pk_bf16_f32 v59, v62, v63
 s_add_u32 s33, s58, 37748736
 v_mov_b32_dpp v44, v42 row_ror:8 row_mask:0xf bank_mask:0xf
 s_cmp_eq_u32 s41, 63
 v_mov_b32_dpp v45, v43 row_ror:8 row_mask:0xf bank_mask:0xf
 s_cbranch_scc1 L_lastfr2
 v_mfma_f32_16x16x32_bf16 v[52:55], v[48:51], v[40:43], 0
 v_lshrrev_b32 v46, 1, v0
 v_and_b32 v47, 0x70, v0
 v_mfma_f32_16x16x16_bf16 v[64:67], v[56:57], v[40:41], 0
 v_and_b32 v46, 0x180, v46
 v_mov_b64 v[60:61], 0
 v_mfma_f32_16x16x16_bf16 v[68:71], v[58:59], v[40:41], 0
 v_or_b32 v46, v46, v47
 v_mov_b64 v[62:63], 0
 buffer_store_dwordx4 v[56:59], v0, s[4:7], s33 offen offset:1024 sc1
 s_waitcnt vmcnt(3)
 v_mfma_f32_16x16x32_bf16 v[64:67], v[72:75], v[42:45], v[64:67]
 v_add_f32_dpp v52, v52, v52 row_ror:8 row_mask:0xf bank_mask:0xf
 v_bfe_u32 v47, v0, 7, 1
 s_waitcnt vmcnt(2)
 v_mfma_f32_16x16x32_bf16 v[68:71], v[76:79], v[42:45], v[68:71]
 v_rcp_f32 v52, v52
 v_lshl_add_u32 v47, v47, 9, v46
 v_mov_b64 v[48:49], 0
 v_mov_b64 v[50:51], 0
 v_mov_b64 v[56:57], 0
 v_mov_b64 v[58:59], 0
 v_pk_mul_f32 v[64:65], v[64:65], v[52:53] op_sel_hi:[1,0]
 v_pk_mul_f32 v[66:67], v[66:67], v[52:53] op_sel_hi:[1,0]
 v_pk_mul_f32 v[68:69], v[68:69], v[52:53] op_sel_hi:[1,0]
 v_pk_mul_f32 v[70:71], v[70:71], v[52:53] op_sel_hi:[1,0]
 v_cvt_pk_bf16_f32 v64, v64, v65
 v_cvt_pk_bf16_f32 v65, v66, v67
 v_cvt_pk_bf16_f32 v66, v68, v69
 v_cvt_pk_bf16_f32 v67, v70, v71
 s_mov_b64 exec, s[56:57]
 ds_write_b128 v46, v[64:67] offset:15360
 s_mov_b64 exec, -1
 v_mov_b32_dpp v64, v64 row_ror:8 row_mask:0xf bank_mask:0xc
 v_mov_b32_dpp v65, v65 row_ror:8 row_mask:0xf bank_mask:0xc
 v_mov_b32_dpp v66, v66 row_ror:8 row_mask:0xf bank_mask:0xc
 v_mov_b32_dpp v67, v67 row_ror:8 row_mask:0xf bank_mask:0xc
 s_bfe_u32 s52, s41, 0x10001
 s_sub_u32 s45, 0, s52
 s_waitcnt lgkmcnt(7)
 v_smfmac_f32_16x16x64_bf16 v[48:51], v[64:67], v[24:31], v5
 ds_read_b128 v[24:27], v1 offset:32768
 ds_read_b128 v[28:31], v1 offset:33792
 v_mov_b64 v[52:53], 0
 v_smfmac_f32_16x16x64_bf16 v[56:59], v[64:67], v[192:199], v5
 s_add_u32 s34, s46, s44
 v_mov_b32 v44, -1
 v_smfmac_f32_16x16x64_bf16 v[60:63], v[64:67], v[224:231], v5
 buffer_store_dword v44, v4, s[4:7], s34 offen sc1
 v_mov_b64 v[54:55], 0
 s_add_u32 s33, s48, s47
 s_add_u32 s34, s59, s47
 s_waitcnt lgkmcnt(2)
 s_barrier
 ds_read_b128 v[68:71], v46 offset:14336
 ds_read_b128 v[72:75], v46 offset:14848
 ds_read_b128 v[76:79], v46 offset:15872
 ds_read_b128 v[40:43], v47 offset:14336
 ds_read_b128 v[44:47], v47 offset:15360
 s_waitcnt lgkmcnt(4)
 v_smfmac_f32_16x16x64_bf16 v[48:51], v[68:71], v[8:15], v5
 ds_read_b128 v[8:11], v1 offset:28672
 s_waitcnt lgkmcnt(4)
 v_smfmac_f32_16x16x64_bf16 v[48:51], v[72:75], v[16:23], v5
 ds_read_b128 v[12:15], v1 offset:29696
 s_waitcnt lgkmcnt(4)
 v_smfmac_f32_16x16x64_bf16 v[48:51], v[76:79], v[32:39], v5
 ds_read_b128 v[16:19], v1 offset:30720
 s_waitcnt lgkmcnt(4)
 v_smfmac_f32_16x16x64_bf16 v[52:55], v[40:43], v[240:247], v5
 ds_read_b128 v[20:23], v1 offset:31744
 s_waitcnt lgkmcnt(4)
 v_smfmac_f32_16x16x64_bf16 v[52:55], v[44:47], v[248:255], v5
 ds_read_b128 v[32:35], v1 offset:34816
 v_cvt_pk_bf16_f32 v48, v48, v49
 v_smfmac_f32_16x16x64_bf16 v[56:59], v[68:71], v[176:183], v5
 ds_read_b128 v[36:39], v1 offset:35840
 s_add_u32 s35, s33, 131072
 v_cvt_pk_bf16_f32 v49, v50, v51
 v_smfmac_f32_16x16x64_bf16 v[56:59], v[72:75], v[184:191], v5
 v_and_or_b32 v48, v48, -2, s52
 v_permlane32_swap_b32 v52, v54
 v_smfmac_f32_16x16x64_bf16 v[56:59], v[76:79], v[200:207], v5
 buffer_store_dwordx2 v[48:49], v3, s[4:7], s35 offen sc1
 v_permlane32_swap_b32 v53, v55
 v_smfmac_f32_16x16x64_bf16 v[60:63], v[68:71], v[208:215], v5
 v_mov_b64 v[40:41], 0
 v_add_f32 v52, v52, v54
 v_smfmac_f32_16x16x64_bf16 v[60:63], v[72:75], v[216:223], v5
 v_mov_b64 v[42:43], 0
 v_add_f32 v53, v53, v55
 v_smfmac_f32_16x16x64_bf16 v[60:63], v[76:79], v[232:239], v5
 s_add_u32 s35, s33, 0
 v_cvt_pk_bf16_f32 v56, v56, v57
 v_cvt_pk_bf16_f32 v52, v52, v53
 v_smfmac_f32_16x16x64_bf16 v[40:43], v[64:67], v[24:31], v5
 v_cvt_pk_bf16_f32 v57, v58, v59
 v_and_or_b32 v52, v52, -2, s52
 s_waitcnt lgkmcnt(4)
 v_smfmac_f32_16x16x64_bf16 v[40:43], v[68:71], v[8:15], v5
 buffer_store_dword v52, v2, s[4:7], s34 offen sc1
 v_and_or_b32 v56, v56, -2, s52
 v_cvt_pk_bf16_f32 v60, v60, v61
 s_waitcnt lgkmcnt(2)
 v_smfmac_f32_16x16x64_bf16 v[40:43], v[72:75], v[16:23], v5
 buffer_store_dwordx2 v[56:57], v3, s[4:7], s35 offen sc1
 s_add_u32 s35, s33, 65536
 v_cvt_pk_bf16_f32 v61, v62, v63
 s_waitcnt lgkmcnt(0)
 v_smfmac_f32_16x16x64_bf16 v[40:43], v[76:79], v[32:39], v5
 v_and_or_b32 v60, v60, -2, s52
 buffer_store_dwordx2 v[60:61], v3, s[4:7], s35 offen sc1
 s_add_u32 s35, s33, 196608
 s_mov_b32 s36, s42
 s_mov_b32 s42, s43
 s_mov_b32 s43, s44
 s_mov_b32 s44, s36
 s_xor_b32 s47, s47, 294912
 s_add_u32 s41, s41, 1
 s_add_u32 s58, s58, 262144
 v_cvt_pk_bf16_f32 v40, v40, v41
 v_cvt_pk_bf16_f32 v41, v42, v43
 v_and_or_b32 v40, v40, -2, s52
 buffer_store_dwordx2 v[40:41], v3, s[4:7], s35 offen sc1
 s_branch L_csfr2
L_lastfr2:
 buffer_store_dwordx4 v[56:59], v0, s[4:7], s33 offen offset:1024 sc1
 s_branch L_chx
L_cefn2:
 v_mov_b64 v[40:41], 0
 v_mov_b64 v[42:43], 0
 v_mov_b64 v[44:45], 0
 v_mov_b64 v[46:47], 0
 v_mov_b64 v[48:49], 0
 v_mov_b64 v[50:51], 0
 v_mov_b64 v[52:53], 0
 v_mov_b64 v[54:55], 0
 v_mov_b64 v[56:57], 0
 v_mov_b64 v[58:59], 0
 v_mov_b64 v[60:61], 0
 v_mov_b64 v[62:63], 0
 ds_read_b128 v[24:27], v1 offset:0
 ds_read_b128 v[28:31], v1 offset:1024
 ds_read_b128 v[32:35], v1 offset:2048
 ds_read_b128 v[36:39], v1 offset:3072
 s_barrier
 s_add_u32 s34, s58, 4194304
 s_add_u32 s35, s58, 20971520
 buffer_load_dwordx4 v[64:67], v0, s[4:7], s34 offen offset:0
 buffer_load_dwordx4 v[68:71], v0, s[4:7], s34 offen offset:1024
 buffer_load_dwordx4 v[72:75], v0, s[4:7], s35 offen offset:0
 buffer_load_dwordx4 v[76:79], v0, s[4:7], s35 offen offset:1024
 s_branch L_b1fn2
L_csfn2:
 s_add_u32 s34, s58, 4194304
 s_add_u32 s35, s58, 20971520
 buffer_load_dwordx4 v[64:67], v0, s[4:7], s34 offen offset:0
 buffer_load_dwordx4 v[68:71], v0, s[4:7], s34 offen offset:1024
 buffer_load_dwordx4 v[72:75], v0, s[4:7], s35 offen offset:0
 buffer_load_dwordx4 v[76:79], v0, s[4:7], s35 offen offset:1024
 s_barrier
 s_add_u32 s33, s42, 159389696
 v_mov_b64 v[40:41], 0
 v_mov_b64 v[42:43], 0
 v_mov_b64 v[44:45], 0
 v_mov_b64 v[46:47], 0
 v_mov_b64 v[48:49], 0
 v_mov_b64 v[50:51], 0
 v_mov_b64 v[52:53], 0
 v_mov_b64 v[54:55], 0
 v_mov_b64 v[56:57], 0
 v_mov_b64 v[58:59], 0
 v_mov_b64 v[60:61], 0
 v_mov_b64 v[62:63], 0
 ds_read_b128 v[24:27], v1 offset:0
 ds_read_b128 v[28:31], v1 offset:1024
 ds_read_b128 v[32:35], v1 offset:2048
 ds_read_b128 v[36:39], v1 offset:3072
 buffer_load_dwordx4 v[8:11], v0, s[4:7], s33 offen offset:0 sc1
 buffer_load_dwordx4 v[12:15], v0, s[4:7], s33 offen offset:1024 sc1
L_pmfn2:
 s_waitcnt vmcnt(1)
 ds_write_b128 v0, v[8:11] offset:6144
 v_max3_u32 v16, v8, v9, v10
 s_waitcnt vmcnt(0)
 ds_write_b128 v0, v[12:15] offset:7168
 v_max3_u32 v16, v16, v11, v12
 v_max3_u32 v17, v13, v14, v15
 v_max_u32 v16, v16, v17
 v_cmp_eq_u32 vcc, -1, v16
 s_cmp_eq_u64 vcc, 0
 s_cbranch_scc1 L_b1fn2
 s_cmp_eq_u32 s15, 0
 s_cbranch_scc1 L_b1fn2
 s_sub_u32 s15, s15, 1
 buffer_load_dwordx4 v[8:11], v0, s[4:7], s33 offen offset:0 sc1
 buffer_load_dwordx4 v[12:15], v0, s[4:7], s33 offen offset:1024 sc1
 s_branch L_pmfn2
L_b1fn2:
 s_waitcnt lgkmcnt(2)
 v_smfmac_f32_16x16x64_bf16 v[40:43], v[8:11], v[24:31], v5
 ds_read_b128 v[24:27], v1 offset:4096
 s_waitcnt lgkmcnt(1)
 v_smfmac_f32_16x16x64_bf16 v[44:47], v[8:11], v[32:39], v5
 ds_read_b128 v[28:31], v1 offset:5120
 v_smfmac_f32_16x16x64_bf16 v[40:43], v[12:15], a[32:39], v5
 ds_read_b128 v[32:35], v1 offset:6144
 v_smfmac_f32_16x16x64_bf16 v[44:47], v[12:15], a[40:47], v5
 ds_read_b128 v[36:39], v1 offset:7168
 s_waitcnt lgkmcnt(4)
 s_barrier
 ds_read_b128 v[16:19], v0 offset:8192
 ds_read_b128 v[20:23], v0 offset:0
 v_smfmac_f32_16x16x64_bf16 v[48:51], v[8:11], a[0:7], v5
 v_smfmac_f32_16x16x64_bf16 v[52:55], v[8:11], a[8:15], v5
 ds_read_b128 v[8:11], v0 offset:1024
 v_smfmac_f32_16x16x64_bf16 v[48:51], v[12:15], a[48:55], v5
 v_smfmac_f32_16x16x64_bf16 v[52:55], v[12:15], a[56:63], v5
 ds_read_b128 v[12:15], v0 offset:2048
 s_waitcnt lgkmcnt(3)
 v_smfmac_f32_16x16x64_bf16 v[40:43], v[16:19], a[80:87], v5
 v_smfmac_f32_16x16x64_bf16 v[44:47], v[16:19], a[88:95], v5
 v_smfmac_f32_16x16x64_bf16 v[48:51], v[16:19], v[24:31], v5
 ds_read_b128 v[24:27], v1 offset:12288
 v_smfmac_f32_16x16x64_bf16 v[52:55], v[16:19], v[32:39], v5
 ds_read_b128 v[16:19], v0 offset:3072
 s_waitcnt lgkmcnt(4)
 v_smfmac_f32_16x16x64_bf16 v[40:43], v[20:23], a[112:119], v5
 ds_read_b128 v[28:31], v1 offset:13312
 v_smfmac_f32_16x16x64_bf16 v[44:47], v[20:23], a[120:127], v5
 ds_read_b128 v[20:23], v0 offset:4096
 s_waitcnt lgkmcnt(5)
 v_smfmac_f32_16x16x64_bf16 v[40:43], v[8:11], a[160:167], v5
 ds_read_b128 v[32:35], v1 offset:14336
 v_smfmac_f32_16x16x64_bf16 v[44:47], v[8:11], a[168:175], v5
 ds_read_b128 v[8:11], v0 offset:5120
 s_waitcnt lgkmcnt(6)
 v_smfmac_f32_16x16x64_bf16 v[40:43], v[12:15], a[192:199], v5
 ds_read_b128 v[36:39], v1 offset:15360
 v_smfmac_f32_16x16x64_bf16 v[44:47], v[12:15], a[200:207], v5
 s_waitcnt lgkmcnt(5)
 v_smfmac_f32_16x16x64_bf16 v[40:43], v[16:19], a[208:215], v5
 v_smfmac_f32_16x16x64_bf16 v[44:47], v[16:19], a[216:223], v5
 s_waitcnt lgkmcnt(3)
 v_smfmac_f32_16x16x64_bf16 v[40:43], v[20:23], v[80:87], v5
 s_waitcnt lgkmcnt(1)
 v_smfmac_f32_16x16x64_bf16 v[40:43], v[8:11], v[128:135], v5
 v_smfmac_f32_16x16x64_bf16 v[44:47], v[20:23], v[88:95], v5
 s_waitcnt lgkmcnt(0)
 v_smfmac_f32_16x16x64_bf16 v[44:47], v[8:11], v[136:143], v5
 v_pk_mul_f32 v[40:41], v[40:41], s[54:55]
 v_smfmac_f32_16x16x64_bf16 v[48:51], v[12:15], v[24:31], v5
 ds_read_b128 v[24:27], v1 offset:8192
 v_pk_mul_f32 v[42:43], v[42:43], s[54:55]
 v_smfmac_f32_16x16x64_bf16 v[52:55], v[12:15], v[32:39], v5
 ds_read_b128 v[12:15], v0 offset:0
 v_cvt_pk_bf16_f32 v40, v40, v41
 v_smfmac_f32_16x16x64_bf16 v[48:51], v[16:19], a[224:231], v5
 ds_read_b128 v[28:31], v1 offset:9216
 v_cvt_pk_bf16_f32 v41, v42, v43
 v_smfmac_f32_16x16x64_bf16 v[52:55], v[16:19], a[232:239], v5
 ds_read_b128 v[16:19], v0 offset:1024
 v_pk_mul_f32 v[44:45], v[44:45], s[54:55]
 v_mfma_f32_16x16x16_bf16 v[40:43], v[40:41], v[6:7], 0
 ds_read_b128 v[32:35], v1 offset:10240
 v_pk_mul_f32 v[46:47], v[46:47], s[54:55]
 v_smfmac_f32_16x16x64_bf16 v[48:51], v[20:23], v[96:103], v5
 ds_read_b128 v[36:39], v1 offset:11264
 v_cvt_pk_bf16_f32 v44, v44, v45
 v_smfmac_f32_16x16x64_bf16 v[48:51], v[8:11], v[144:151], v5
 s_waitcnt lgkmcnt(4)
 v_cvt_pk_bf16_f32 v45, v46, v47
 v_smfmac_f32_16x16x64_bf16 v[48:51], v[12:15], a[128:135], v5
 v_cvt_pk_bf16_f32 v40, v40, v41
 v_mfma_f32_16x16x16_bf16 v[44:47], v[44:45], v[6:7], 0
 v_cvt_pk_bf16_f32 v41, v42, v43
 v_smfmac_f32_16x16x64_bf16 v[52:55], v[20:23], v[104:111], v5
 s_waitcnt lgkmcnt(2)
 v_smfmac_f32_16x16x64_bf16 v[48:51], v[16:19], v[24:31], v5
 ds_read_b128 v[24:27], v1 offset:16384
 v_cvt_pk_bf16_f32 v42, v44, v45
 v_smfmac_f32_16x16x64_bf16 v[52:55], v[8:11], v[152:159], v5
 ds_read_b128 v[28:31], v1 offset:17408
 v_cvt_pk_bf16_f32 v43, v46, v47
 v_smfmac_f32_16x16x64_bf16 v[52:55], v[12:15], a[136:143], v5
 s_waitcnt lgkmcnt(2)
 v_cvt_pk_bf16_f32 v48, v48, v49
 v_smfmac_f32_16x16x64_bf16 v[52:55], v[16:19], v[32:39], v5
 ds_read_b128 v[32:35], v1 offset:18432
 s_waitcnt vmcnt(2)
 v_cvt_pk_bf16_f32 v49, v50, v51
 ds_read_b128 v[36:39], v1 offset:19456
 s_add_u32 s33, s58, 37748736
 v_mfma_f32_16x16x16_bf16 v[48:51], v[48:49], v[6:7], 0
 v_mfma_f32_16x16x32_bf16 v[64:67], v[64:67], v[40:43], 0
 v_cvt_pk_bf16_f32 v52, v52, v53
 v_cvt_pk_bf16_f32 v53, v54, v55
 v_mfma_f32_16x16x32_bf16 v[68:71], v[68:71], v[40:43], 0
 v_mfma_f32_16x16x16_bf16 v[52:55], v[52:53], v[6:7], 0
 v_cvt_pk_bf16_f32 v48, v48, v49
 v_cvt_pk_bf16_f32 v49, v50, v51
 v_smfmac_f32_16x16x64_bf16 v[56:59], v[20:23], v[112:119], v5
 v_mov_b32_dpp v64, v68 quad_perm:[0,1,2,3] row_mask:0xf bank_mask:0xc
 v_mov_b32_dpp v65, v69 quad_perm:[0,1,2,3] row_mask:0xf bank_mask:0xc
 v_smfmac_f32_16x16x64_bf16 v[60:63], v[20:23], v[120:127], v5
 ds_read_b128 v[20:23], v0 offset:6144
 v_cvt_pk_bf16_f32 v50, v52, v53
 v_cvt_pk_bf16_f32 v51, v54, v55
 v_mov_b32_dpp v66, v70 quad_perm:[0,1,2,3] row_mask:0xf bank_mask:0xc
 v_mov_b32_dpp v67, v71 quad_perm:[0,1,2,3] row_mask:0xf bank_mask:0xc
 v_mfma_f32_16x16x32_bf16 v[44:47], v[48:51], v[40:43], 0
 ds_write_b128 v0, v[64:67] offset:11264
 v_smfmac_f32_16x16x64_bf16 v[56:59], v[8:11], v[160:167], v5
 buffer_store_dwordx4 v[48:51], v0, s[4:7], s33 offen sc1
 v_smfmac_f32_16x16x64_bf16 v[60:63], v[8:11], v[168:175], v5
 ds_read_b128 v[8:11], v0 offset:7168
 v_cndmask_b32 v52, v45, v44, s[56:57]
 v_cndmask_b32 v53, v47, v46, s[56:57]
 v_cndmask_b32 v52, v52, v53, s[60:61]
 ds_write_b32 v0, v52 offset:13320
 v_smfmac_f32_16x16x64_bf16 v[56:59], v[12:15], a[144:151], v5
 v_smfmac_f32_16x16x64_bf16 v[60:63], v[12:15], a[152:159], v5
 ds_read_b128 v[12:15], v0 offset:8192
 v_smfmac_f32_16x16x64_bf16 v[56:59], v[16:19], a[176:183], v5
 v_smfmac_f32_16x16x64_bf16 v[60:63], v[16:19], a[184:191], v5
 ds_read_b128 v[16:19], v0 offset:2048
 s_waitcnt lgkmcnt(2)
 s_barrier
 ds_read_b128 v[64:67], v0 offset:13312
 ds_read_b128 v[40:43], v0 offset:9216
 ds_read_b128 v[44:47], v0 offset:10240
 ds_read_b128 v[48:51], v0 offset:11264
 ds_read_b128 v[52:55], v0 offset:12288
 v_smfmac_f32_16x16x64_bf16 v[56:59], v[20:23], a[16:23], v5
 v_smfmac_f32_16x16x64_bf16 v[60:63], v[20:23], a[24:31], v5
 ds_read_b128 v[20:23], v0 offset:3072
 v_smfmac_f32_16x16x64_bf16 v[56:59], v[8:11], a[64:71], v5
 v_smfmac_f32_16x16x64_bf16 v[60:63], v[8:11], a[72:79], v5
 s_waitcnt lgkmcnt(7)
 s_waitcnt lgkmcnt(5)
 v_smfmac_f32_16x16x64_bf16 v[56:59], v[12:15], a[96:103], v5
 v_add_f32 v64, v64, v65
 v_smfmac_f32_16x16x64_bf16 v[60:63], v[12:15], a[104:111], v5
 s_waitcnt lgkmcnt(3)
 v_add_f32 v66, v66, v67
 v_smfmac_f32_16x16x64_bf16 v[56:59], v[16:19], v[24:31], v5
 v_pk_add_f32 v[40:41], v[40:41], v[44:45]
 v_smfmac_f32_16x16x64_bf16 v[60:63], v[16:19], v[32:39], v5
 s_waitcnt lgkmcnt(2)
 v_pk_add_f32 v[42:43], v[42:43], v[46:47]
 v_pk_add_f32 v[40:41], v[40:41], v[48:49]
 v_pk_add_f32 v[42:43], v[42:43], v[50:51]
 v_add_f32 v64, v64, v66
 s_waitcnt lgkmcnt(1)
 v_pk_add_f32 v[44:45], v[40:41], v[52:53]
 v_pk_add_f32 v[46:47], v[42:43], v[54:55]
 s_waitcnt lgkmcnt(0)
 v_smfmac_f32_16x16x64_bf16 v[56:59], v[20:23], a[240:247], v5
 v_max3_f32 v68, v44, v45, v46
 v_mov_b64 v[48:49], s[70:71]
 v_smfmac_f32_16x16x64_bf16 v[60:63], v[20:23], a[248:255], v5
 ds_read_b128 v[24:27], v1 offset:24576
 v_max3_f32 v68, v68, v47, v64
 v_mov_b64 v[50:51], s[72:73]
 ds_read_b128 v[28:31], v1 offset:25600
 v_max_f32_dpp v69, v68, v68 row_ror:8 row_mask:0xf bank_mask:0xf
 v_max_f32_dpp v68, v68, v68 row_ror:8 row_mask:0xf bank_mask:0xf
 ds_read_b128 v[32:35], v1 offset:26624
 ds_read_b128 v[36:39], v1 offset:27648
 v_permlane32_swap_b32 v68, v69
 v_max_f32 v70, v68, v69
 v_max_f32 v71, v68, v69
 ds_read_b128 v[8:11], v1 offset:20480
 ds_read_b128 v[12:15], v1 offset:21504
 v_permlane16_swap_b32 v70, v71
 ds_read_b128 v[16:19], v1 offset:22528
 v_max_f32 v68, v70, v71
 v_sub_f32 v64, v64, v68
 v_pk_add_f32 v[44:45], v[44:45], v[68:69] op_sel_hi:[1,0] neg_lo:[0,1] neg_hi:[0,1]
 v_pk_add_f32 v[46:47], v[46:47], v[68:69] op_sel_hi:[1,0] neg_lo:[0,1] neg_hi:[0,1]
 v_exp_f32 v64, v64
 ds_read_b128 v[20:23], v1 offset:23552
 v_exp_f32 v44, v44
 v_mov_b32_dpp v65, v64 row_ror:8 row_mask:0xf bank_mask:0xf
 v_exp_f32 v45, v45
 v_cvt_pk_bf16_f32 v56, v56, v57
 v_exp_f32 v46, v46
 v_cvt_pk_bf16_f32 v40, v64, v65
 v_cvt_pk_bf16_f32 v41, v64, v65
 v_exp_f32 v47, v47
 v_cvt_pk_bf16_f32 v57, v58, v59
 v_cvt_pk_bf16_f32 v42, v44, v45
 v_permlane32_swap_b32 v40, v41
 v_cvt_pk_bf16_f32 v58, v60, v61
 v_cvt_pk_bf16_f32 v43, v46, v47
 v_cvt_pk_bf16_f32 v59, v62, v63
 s_add_u32 s33, s58, 37748736
 v_mov_b32_dpp v44, v42 row_ror:8 row_mask:0xf bank_mask:0xf
 s_cmp_eq_u32 s41, 63
 v_mov_b32_dpp v45, v43 row_ror:8 row_mask:0xf bank_mask:0xf
 s_cbranch_scc1 L_lastfn2
 v_mfma_f32_16x16x32_bf16 v[52:55], v[48:51], v[40:43], 0
 v_lshrrev_b32 v46, 1, v0
 v_and_b32 v47, 0x70, v0
 v_mfma_f32_16x16x16_bf16 v[64:67], v[56:57], v[40:41], 0
 v_and_b32 v46, 0x180, v46
 v_mov_b64 v[60:61], 0
 v_mfma_f32_16x16x16_bf16 v[68:71], v[58:59], v[40:41], 0
 v_or_b32 v46, v46, v47
 v_mov_b64 v[62:63], 0
 buffer_store_dwordx4 v[56:59], v0, s[4:7], s33 offen offset:1024 sc1
 s_waitcnt vmcnt(3)
 v_mfma_f32_16x16x32_bf16 v[64:67], v[72:75], v[42:45], v[64:67]
 v_add_f32_dpp v52, v52, v52 row_ror:8 row_mask:0xf bank_mask:0xf
 v_bfe_u32 v47, v0, 7, 1
 s_waitcnt vmcnt(2)
 v_mfma_f32_16x16x32_bf16 v[68:71], v[76:79], v[42:45], v[68:71]
 v_rcp_f32 v52, v52
 v_lshl_add_u32 v47, v47, 9, v46
 v_mov_b64 v[48:49], 0
 v_mov_b64 v[50:51], 0
 v_mov_b64 v[56:57], 0
 v_mov_b64 v[58:59], 0
 v_pk_mul_f32 v[64:65], v[64:65], v[52:53] op_sel_hi:[1,0]
 v_pk_mul_f32 v[66:67], v[66:67], v[52:53] op_sel_hi:[1,0]
 v_pk_mul_f32 v[68:69], v[68:69], v[52:53] op_sel_hi:[1,0]
 v_pk_mul_f32 v[70:71], v[70:71], v[52:53] op_sel_hi:[1,0]
 v_cvt_pk_bf16_f32 v64, v64, v65
 v_cvt_pk_bf16_f32 v65, v66, v67
 v_cvt_pk_bf16_f32 v66, v68, v69
 v_cvt_pk_bf16_f32 v67, v70, v71
 s_mov_b64 exec, s[56:57]
 ds_write_b128 v46, v[64:67] offset:15360
 s_mov_b64 exec, -1
 v_mov_b32_dpp v64, v64 row_ror:8 row_mask:0xf bank_mask:0xc
 v_mov_b32_dpp v65, v65 row_ror:8 row_mask:0xf bank_mask:0xc
 v_mov_b32_dpp v66, v66 row_ror:8 row_mask:0xf bank_mask:0xc
 v_mov_b32_dpp v67, v67 row_ror:8 row_mask:0xf bank_mask:0xc
 s_bfe_u32 s52, s41, 0x10001
 s_sub_u32 s45, 0, s52
 s_waitcnt lgkmcnt(7)
 v_smfmac_f32_16x16x64_bf16 v[48:51], v[64:67], v[24:31], v5
 ds_read_b128 v[24:27], v1 offset:32768
 ds_read_b128 v[28:31], v1 offset:33792
 v_mov_b64 v[52:53], 0
 v_smfmac_f32_16x16x64_bf16 v[56:59], v[64:67], v[192:199], v5
 v_mov_b64 v[54:55], 0
 v_smfmac_f32_16x16x64_bf16 v[60:63], v[64:67], v[224:231], v5
 s_add_u32 s33, s48, s47
 s_add_u32 s34, s59, s47
 s_waitcnt lgkmcnt(2)
 s_barrier
 ds_read_b128 v[68:71], v46 offset:14336
 ds_read_b128 v[72:75], v46 offset:14848
 ds_read_b128 v[76:79], v46 offset:15872
 ds_read_b128 v[40:43], v47 offset:14336
 ds_read_b128 v[44:47], v47 offset:15360
 s_waitcnt lgkmcnt(4)
 v_smfmac_f32_16x16x64_bf16 v[48:51], v[68:71], v[8:15], v5
 ds_read_b128 v[8:11], v1 offset:28672
 s_waitcnt lgkmcnt(4)
 v_smfmac_f32_16x16x64_bf16 v[48:51], v[72:75], v[16:23], v5
 ds_read_b128 v[12:15], v1 offset:29696
 s_waitcnt lgkmcnt(4)
 v_smfmac_f32_16x16x64_bf16 v[48:51], v[76:79], v[32:39], v5
 ds_read_b128 v[16:19], v1 offset:30720
 s_waitcnt lgkmcnt(4)
 v_smfmac_f32_16x16x64_bf16 v[52:55], v[40:43], v[240:247], v5
 ds_read_b128 v[20:23], v1 offset:31744
 s_waitcnt lgkmcnt(4)
 v_smfmac_f32_16x16x64_bf16 v[52:55], v[44:47], v[248:255], v5
 ds_read_b128 v[32:35], v1 offset:34816
 v_cvt_pk_bf16_f32 v48, v48, v49
 v_smfmac_f32_16x16x64_bf16 v[56:59], v[68:71], v[176:183], v5
 ds_read_b128 v[36:39], v1 offset:35840
 s_add_u32 s35, s33, 131072
 v_cvt_pk_bf16_f32 v49, v50, v51
 v_smfmac_f32_16x16x64_bf16 v[56:59], v[72:75], v[184:191], v5
 v_and_or_b32 v48, v48, -2, s52
 v_permlane32_swap_b32 v52, v54
 v_smfmac_f32_16x16x64_bf16 v[56:59], v[76:79], v[200:207], v5
 buffer_store_dwordx2 v[48:49], v3, s[4:7], s35 offen sc1
 v_permlane32_swap_b32 v53, v55
 v_smfmac_f32_16x16x64_bf16 v[60:63], v[68:71], v[208:215], v5
 v_mov_b64 v[40:41], 0
 v_add_f32 v52, v52, v54
 v_smfmac_f32_16x16x64_bf16 v[60:63], v[72:75], v[216:223], v5
 v_mov_b64 v[42:43], 0
 v_add_f32 v53, v53, v55
 v_smfmac_f32_16x16x64_bf16 v[60:63], v[76:79], v[232:239], v5
 s_add_u32 s35, s33, 0
 v_cvt_pk_bf16_f32 v56, v56, v57
 v_cvt_pk_bf16_f32 v52, v52, v53
 v_smfmac_f32_16x16x64_bf16 v[40:43], v[64:67], v[24:31], v5
 v_cvt_pk_bf16_f32 v57, v58, v59
 v_and_or_b32 v52, v52, -2, s52
 s_waitcnt lgkmcnt(4)
 v_smfmac_f32_16x16x64_bf16 v[40:43], v[68:71], v[8:15], v5
 buffer_store_dword v52, v2, s[4:7], s34 offen sc1
 v_and_or_b32 v56, v56, -2, s52
 v_cvt_pk_bf16_f32 v60, v60, v61
 s_waitcnt lgkmcnt(2)
 v_smfmac_f32_16x16x64_bf16 v[40:43], v[72:75], v[16:23], v5
 buffer_store_dwordx2 v[56:57], v3, s[4:7], s35 offen sc1
 s_add_u32 s35, s33, 65536
 v_cvt_pk_bf16_f32 v61, v62, v63
 s_waitcnt lgkmcnt(0)
 v_smfmac_f32_16x16x64_bf16 v[40:43], v[76:79], v[32:39], v5
 v_and_or_b32 v60, v60, -2, s52
 buffer_store_dwordx2 v[60:61], v3, s[4:7], s35 offen sc1
 s_add_u32 s35, s33, 196608
 s_mov_b32 s36, s42
 s_mov_b32 s42, s43
 s_mov_b32 s43, s44
 s_mov_b32 s44, s36
 s_xor_b32 s47, s47, 294912
 s_add_u32 s41, s41, 1
 s_add_u32 s58, s58, 262144
 v_cvt_pk_bf16_f32 v40, v40, v41
 v_cvt_pk_bf16_f32 v41, v42, v43
 v_and_or_b32 v40, v40, -2, s52
 buffer_store_dwordx2 v[40:41], v3, s[4:7], s35 offen sc1
 s_branch L_csfn2
L_lastfn2:
 buffer_store_dwordx4 v[56:59], v0, s[4:7], s33 offen offset:1024 sc1
 s_branch L_chx
L_cefio:
 v_mov_b64 v[40:41], 0
 v_mov_b64 v[42:43], 0
 v_mov_b64 v[44:45], 0
 v_mov_b64 v[46:47], 0
 v_mov_b64 v[48:49], 0
 v_mov_b64 v[50:51], 0
 v_mov_b64 v[52:53], 0
 v_mov_b64 v[54:55], 0
 v_mov_b64 v[56:57], 0
 v_mov_b64 v[58:59], 0
 v_mov_b64 v[60:61], 0
 v_mov_b64 v[62:63], 0
 ds_read_b128 v[24:27], v1 offset:0
 ds_read_b128 v[28:31], v1 offset:1024
 ds_read_b128 v[32:35], v1 offset:2048
 ds_read_b128 v[36:39], v1 offset:3072
 s_lshr_b32 s34, s41, 1
 s_add_u32 s34, s34, 1
 s_mov_b32 s35, s34
 s_bitcmp1_b32 s41, 0
 s_cselect_b32 s33, s51, s50
 s_cmp_ge_u32 s33, s35
 s_cbranch_scc1 L_okfio99
 v_lshlrev_b32 v21, 3, v0
 s_lshl_b32 s36, s40, 2
 s_add_u32 s36, s36, 0
L_flfio99:
 s_mov_b64 exec, 3
 buffer_load_dword v20, v21, s[4:7], s36 offen sc1
 s_mov_b64 exec, -1
 s_waitcnt vmcnt(0)
 v_readlane_b32 s50, v20, 0
 v_readlane_b32 s51, v20, 1
 s_bitcmp1_b32 s41, 0
 s_cselect_b32 s33, s51, s50
 s_cmp_ge_u32 s33, s34
 s_cbranch_scc1 L_okfio99
 s_cmp_eq_u32 s15, 0
 s_cbranch_scc1 L_okfio99
 s_sub_u32 s15, s15, 1
 s_branch L_flfio99
L_okfio99:
 s_add_u32 s34, s34, 1
 s_cmp_ge_u32 s33, s34
 s_cselect_b32 s33, 2, 0
 s_add_u32 s33, s33, s41
 s_min_u32 s33, s33, 63
 s_lshl_b32 s33, s33, 5
 s_add_u32 s33, s33, s40
 s_lshl_b32 s39, s33, 13
 s_barrier
 s_add_u32 s34, s58, 4194304
 s_add_u32 s35, s58, 20971520
 buffer_load_dwordx4 v[64:67], v0, s[4:7], s34 offen offset:0
 buffer_load_dwordx4 v[68:71], v0, s[4:7], s34 offen offset:1024
 buffer_load_dwordx4 v[72:75], v0, s[4:7], s35 offen offset:0
 buffer_load_dwordx4 v[76:79], v0, s[4:7], s35 offen offset:1024
 v_lshlrev_b32 v20, 3, v0
 s_add_u32 s34, s39, 4194304
 s_add_u32 s35, s39, 20971520
 buffer_load_dword v4, v20, s[4:7], s34 offen
 buffer_load_dword v4, v20, s[4:7], s35 offen
 s_add_u32 s34, s41, 1
 s_lshr_b32 s34, s34, 1
 s_add_u32 s34, s34, 1
 s_min_u32 s34, s34, 32
 s_mov_b32 s35, s34
 s_bitcmp1_b32 s41, 0
 s_cselect_b32 s33, s50, s51
 s_cmp_ge_u32 s33, s35
 s_cbranch_scc1 L_okfio100
 v_lshlrev_b32 v21, 3, v0
 s_lshl_b32 s36, s40, 2
 s_add_u32 s36, s36, 0
L_flfio100:
 s_mov_b64 exec, 3
 buffer_load_dword v20, v21, s[4:7], s36 offen sc1
 s_mov_b64 exec, -1
 s_waitcnt vmcnt(0)
 v_readlane_b32 s50, v20, 0
 v_readlane_b32 s51, v20, 1
 s_bitcmp1_b32 s41, 0
 s_cselect_b32 s33, s50, s51
 s_cmp_ge_u32 s33, s34
 s_cbranch_scc1 L_okfio100
 s_cmp_eq_u32 s15, 0
 s_cbranch_scc1 L_okfio100
 s_sub_u32 s15, s15, 1
 s_branch L_flfio100
L_okfio100:
 s_add_u32 s34, s34, 1
 s_cmp_ge_u32 s33, s34
 s_cselect_b32 s33, 3, 1
 s_add_u32 s33, s33, s41
 s_min_u32 s33, s33, 63
 s_lshl_b32 s33, s33, 5
 s_add_u32 s33, s33, s40
 s_lshl_b32 s39, s33, 13
 s_branch L_b1fio
L_csfio:
 v_mov_b64 v[40:41], 0
 v_mov_b64 v[42:43], 0
 v_mov_b64 v[44:45], 0
 v_mov_b64 v[46:47], 0
 v_mov_b64 v[48:49], 0
 v_mov_b64 v[50:51], 0
 v_mov_b64 v[52:53], 0
 v_mov_b64 v[54:55], 0
 v_mov_b64 v[56:57], 0
 v_mov_b64 v[58:59], 0
 v_mov_b64 v[60:61], 0
 v_mov_b64 v[62:63], 0
 ds_read_b128 v[24:27], v1 offset:0
 ds_read_b128 v[28:31], v1 offset:1024
 ds_read_b128 v[32:35], v1 offset:2048
 ds_read_b128 v[36:39], v1 offset:3072
 s_add_u32 s34, s58, 4194304
 s_add_u32 s35, s58, 20971520
 buffer_load_dwordx4 v[64:67], v0, s[4:7], s34 offen offset:0
 buffer_load_dwordx4 v[68:71], v0, s[4:7], s34 offen offset:1024
 buffer_load_dwordx4 v[72:75], v0, s[4:7], s35 offen offset:0
 buffer_load_dwordx4 v[76:79], v0, s[4:7], s35 offen offset:1024
 s_add_u32 s34, s41, 1
 s_lshr_b32 s34, s34, 1
 s_add_u32 s34, s34, 1
 s_min_u32 s34, s34, 32
 s_add_u32 s35, s34, 1
 s_min_u32 s35, s35, 32
 s_bitcmp1_b32 s41, 0
 s_cselect_b32 s33, s50, s51
 s_cmp_ge_u32 s33, s35
 s_cbranch_scc1 L_okfio101
 v_lshlrev_b32 v9, 3, v0
 s_lshl_b32 s36, s40, 2
 s_add_u32 s36, s36, 0
L_flfio101:
 s_mov_b64 exec, 3
 buffer_load_dword v8, v9, s[4:7], s36 offen sc1
 s_mov_b64 exec, -1
 s_waitcnt vmcnt(0)
 v_readlane_b32 s50, v8, 0
 v_readlane_b32 s51, v8, 1
 s_bitcmp1_b32 s41, 0
 s_cselect_b32 s33, s50, s51
 s_cmp_ge_u32 s33, s34
 s_cbranch_scc1 L_okfio101
 s_cmp_eq_u32 s15, 0
 s_cbranch_scc1 L_okfio101
 s_sub_u32 s15, s15, 1
 s_branch L_flfio101
L_okfio101:
 s_add_u32 s34, s34, 1
 s_cmp_ge_u32 s33, s34
 s_cselect_b32 s33, 3, 1
 s_add_u32 s33, s33, s41
 s_min_u32 s33, s33, 63
 s_lshl_b32 s33, s33, 5
 s_add_u32 s33, s33, s40
 s_lshl_b32 s39, s33, 13
 s_barrier
 s_add_u32 s33, s42, 159387648
 s_add_u32 s34, s42, 159391744
 buffer_load_dwordx4 v[8:11], v0, s[4:7], s33 offen offset:0 sc1
 buffer_load_dwordx4 v[12:15], v0, s[4:7], s33 offen offset:1024 sc1
 buffer_load_dwordx4 v[16:19], v0, s[4:7], s34 offen sc1
L_pmfio:
 s_waitcnt vmcnt(2)
 ds_write_b128 v0, v[8:11] offset:4096
 v_max3_u32 v20, v8, v9, v10
 s_waitcnt vmcnt(1)
 ds_write_b128 v0, v[12:15] offset:5120
 v_max3_u32 v20, v20, v11, v12
 v_max3_u32 v21, v13, v14, v15
 s_waitcnt vmcnt(0)
 ds_write_b128 v0, v[16:19] offset:8192
 v_max3_u32 v20, v20, v16, v17
 v_max3_u32 v21, v21, v18, v19
 v_max_u32 v20, v20, v21
 v_cmp_eq_u32 vcc, -1, v20
 s_cmp_eq_u64 vcc, 0
 s_cbranch_scc1 L_b1fio
 s_cmp_eq_u32 s15, 0
 s_cbranch_scc1 L_b1fio
 s_sub_u32 s15, s15, 1
 buffer_load_dwordx4 v[8:11], v0, s[4:7], s33 offen offset:0 sc1
 buffer_load_dwordx4 v[12:15], v0, s[4:7], s33 offen offset:1024 sc1
 buffer_load_dwordx4 v[16:19], v0, s[4:7], s34 offen sc1
 s_branch L_pmfio
L_b1fio:
 s_waitcnt lgkmcnt(2)
 v_smfmac_f32_16x16x64_bf16 v[40:43], v[8:11], v[24:31], v5
 ds_read_b128 v[24:27], v1 offset:4096
 s_waitcnt lgkmcnt(1)
 v_smfmac_f32_16x16x64_bf16 v[44:47], v[8:11], v[32:39], v5
 ds_read_b128 v[28:31], v1 offset:5120
 v_smfmac_f32_16x16x64_bf16 v[40:43], v[12:15], a[32:39], v5
 ds_read_b128 v[32:35], v1 offset:6144
 v_smfmac_f32_16x16x64_bf16 v[44:47], v[12:15], a[40:47], v5
 ds_read_b128 v[36:39], v1 offset:7168
 v_smfmac_f32_16x16x64_bf16 v[40:43], v[16:19], a[80:87], v5
 v_smfmac_f32_16x16x64_bf16 v[44:47], v[16:19], a[88:95], v5
 s_waitcnt lgkmcnt(4)
 s_barrier
 ds_read_b128 v[20:23], v0 offset:6144
 v_smfmac_f32_16x16x64_bf16 v[48:51], v[8:11], a[0:7], v5
 s_lshl_b32 s36, s40, 7
 s_add_u32 s36, s36, 4096
 v_mov_b32 v62, s41
 v_smfmac_f32_16x16x64_bf16 v[52:55], v[8:11], a[8:15], v5
 ds_read_b128 v[8:11], v0 offset:7168
 v_smfmac_f32_16x16x64_bf16 v[48:51], v[12:15], a[48:55], v5
 s_mov_b64 exec, 1
 buffer_store_dword v62, v0, s[4:7], s36 offen sc1
 s_mov_b64 exec, -1
 v_smfmac_f32_16x16x64_bf16 v[52:55], v[12:15], a[56:63], v5
 ds_read_b128 v[12:15], v0 offset:0
 s_add_u32 s34, s39, 4194304
 s_add_u32 s35, s39, 20971520
 v_lshlrev_b32 v63, 3, v0
 s_waitcnt lgkmcnt(5)
 v_smfmac_f32_16x16x64_bf16 v[48:51], v[16:19], v[24:31], v5
 ds_read_b128 v[24:27], v1 offset:12288
 buffer_load_dword v4, v63, s[4:7], s34 offen
 s_waitcnt lgkmcnt(4)
 v_smfmac_f32_16x16x64_bf16 v[52:55], v[16:19], v[32:39], v5
 ds_read_b128 v[16:19], v0 offset:1024
 s_waitcnt lgkmcnt(4)
 v_smfmac_f32_16x16x64_bf16 v[40:43], v[20:23], a[112:119], v5
 ds_read_b128 v[28:31], v1 offset:13312
 buffer_load_dword v4, v63, s[4:7], s35 offen
 v_smfmac_f32_16x16x64_bf16 v[44:47], v[20:23], a[120:127], v5
 ds_read_b128 v[20:23], v0 offset:2048
 s_waitcnt lgkmcnt(5)
 v_smfmac_f32_16x16x64_bf16 v[40:43], v[8:11], a[160:167], v5
 ds_read_b128 v[32:35], v1 offset:14336
 v_mov_b64 v[62:63], 0
 v_smfmac_f32_16x16x64_bf16 v[44:47], v[8:11], a[168:175], v5
 ds_read_b128 v[8:11], v0 offset:3072
 s_waitcnt lgkmcnt(6)
 v_smfmac_f32_16x16x64_bf16 v[40:43], v[12:15], a[192:199], v5
 ds_read_b128 v[36:39], v1 offset:15360
 v_smfmac_f32_16x16x64_bf16 v[44:47], v[12:15], a[200:207], v5
 s_waitcnt lgkmcnt(5)
 v_smfmac_f32_16x16x64_bf16 v[40:43], v[16:19], a[208:215], v5
 v_smfmac_f32_16x16x64_bf16 v[44:47], v[16:19], a[216:223], v5
 s_waitcnt lgkmcnt(3)
 v_smfmac_f32_16x16x64_bf16 v[40:43], v[20:23], v[80:87], v5
 s_waitcnt lgkmcnt(1)
 v_smfmac_f32_16x16x64_bf16 v[40:43], v[8:11], v[128:135], v5
 v_smfmac_f32_16x16x64_bf16 v[44:47], v[20:23], v[88:95], v5
 s_waitcnt lgkmcnt(0)
 v_smfmac_f32_16x16x64_bf16 v[44:47], v[8:11], v[136:143], v5
 v_pk_mul_f32 v[40:41], v[40:41], s[54:55]
 v_smfmac_f32_16x16x64_bf16 v[48:51], v[12:15], v[24:31], v5
 ds_read_b128 v[24:27], v1 offset:8192
 v_pk_mul_f32 v[42:43], v[42:43], s[54:55]
 v_smfmac_f32_16x16x64_bf16 v[52:55], v[12:15], v[32:39], v5
 ds_read_b128 v[12:15], v0 offset:6144
 v_cvt_pk_bf16_f32 v40, v40, v41
 v_smfmac_f32_16x16x64_bf16 v[48:51], v[16:19], a[224:231], v5
 ds_read_b128 v[28:31], v1 offset:9216
 v_cvt_pk_bf16_f32 v41, v42, v43
 v_smfmac_f32_16x16x64_bf16 v[52:55], v[16:19], a[232:239], v5
 ds_read_b128 v[16:19], v0 offset:7168
 v_pk_mul_f32 v[44:45], v[44:45], s[54:55]
 v_mfma_f32_16x16x16_bf16 v[40:43], v[40:41], v[6:7], 0
 ds_read_b128 v[32:35], v1 offset:10240
 v_pk_mul_f32 v[46:47], v[46:47], s[54:55]
 v_smfmac_f32_16x16x64_bf16 v[48:51], v[20:23], v[96:103], v5
 ds_read_b128 v[36:39], v1 offset:11264
 v_cvt_pk_bf16_f32 v44, v44, v45
 v_smfmac_f32_16x16x64_bf16 v[48:51], v[8:11], v[144:151], v5
 s_waitcnt lgkmcnt(4)
 v_cvt_pk_bf16_f32 v45, v46, v47
 v_smfmac_f32_16x16x64_bf16 v[48:51], v[12:15], a[128:135], v5
 v_cvt_pk_bf16_f32 v40, v40, v41
 v_mfma_f32_16x16x16_bf16 v[44:47], v[44:45], v[6:7], 0
 v_cvt_pk_bf16_f32 v41, v42, v43
 v_smfmac_f32_16x16x64_bf16 v[52:55], v[20:23], v[104:111], v5
 s_waitcnt lgkmcnt(2)
 v_smfmac_f32_16x16x64_bf16 v[48:51], v[16:19], v[24:31], v5
 ds_read_b128 v[24:27], v1 offset:16384
 v_cvt_pk_bf16_f32 v42, v44, v45
 v_smfmac_f32_16x16x64_bf16 v[52:55], v[8:11], v[152:159], v5
 ds_read_b128 v[28:31], v1 offset:17408
 v_cvt_pk_bf16_f32 v43, v46, v47
 v_smfmac_f32_16x16x64_bf16 v[52:55], v[12:15], a[136:143], v5
 s_waitcnt lgkmcnt(2)
 v_cvt_pk_bf16_f32 v48, v48, v49
 v_smfmac_f32_16x16x64_bf16 v[52:55], v[16:19], v[32:39], v5
 ds_read_b128 v[32:35], v1 offset:18432
 s_waitcnt vmcnt(7)
 v_cvt_pk_bf16_f32 v49, v50, v51
 ds_read_b128 v[36:39], v1 offset:19456
 s_add_u32 s33, s58, 37748736
 v_mfma_f32_16x16x16_bf16 v[48:51], v[48:49], v[6:7], 0
 v_mfma_f32_16x16x32_bf16 v[64:67], v[64:67], v[40:43], 0
 v_cvt_pk_bf16_f32 v52, v52, v53
 v_cvt_pk_bf16_f32 v53, v54, v55
 v_mfma_f32_16x16x32_bf16 v[68:71], v[68:71], v[40:43], 0
 v_mfma_f32_16x16x16_bf16 v[52:55], v[52:53], v[6:7], 0
 v_cvt_pk_bf16_f32 v48, v48, v49
 v_cvt_pk_bf16_f32 v49, v50, v51
 v_smfmac_f32_16x16x64_bf16 v[56:59], v[20:23], v[112:119], v5
 v_mov_b32_dpp v64, v68 quad_perm:[0,1,2,3] row_mask:0xf bank_mask:0xc
 v_mov_b32_dpp v65, v69 quad_perm:[0,1,2,3] row_mask:0xf bank_mask:0xc
 v_smfmac_f32_16x16x64_bf16 v[60:63], v[20:23], v[120:127], v5
 ds_read_b128 v[20:23], v0 offset:4096
 v_cvt_pk_bf16_f32 v50, v52, v53
 v_cvt_pk_bf16_f32 v51, v54, v55
 v_mov_b32_dpp v66, v70 quad_perm:[0,1,2,3] row_mask:0xf bank_mask:0xc
 v_mov_b32_dpp v67, v71 quad_perm:[0,1,2,3] row_mask:0xf bank_mask:0xc
 v_mfma_f32_16x16x32_bf16 v[44:47], v[48:51], v[40:43], 0
 ds_write_b128 v0, v[64:67] offset:12288
 v_smfmac_f32_16x16x64_bf16 v[56:59], v[8:11], v[160:167], v5
 buffer_store_dwordx4 v[48:51], v0, s[4:7], s33 offen sc1
 v_smfmac_f32_16x16x64_bf16 v[60:63], v[8:11], v[168:175], v5
 ds_read_b128 v[8:11], v0 offset:5120
 v_cndmask_b32 v52, v45, v44, s[56:57]
 v_cndmask_b32 v53, v47, v46, s[56:57]
 v_cndmask_b32 v52, v52, v53, s[60:61]
 ds_write_b32 v0, v52 offset:13324
 v_smfmac_f32_16x16x64_bf16 v[56:59], v[12:15], a[144:151], v5
 v_smfmac_f32_16x16x64_bf16 v[60:63], v[12:15], a[152:159], v5
 ds_read_b128 v[12:15], v0 offset:8192
 v_smfmac_f32_16x16x64_bf16 v[56:59], v[16:19], a[176:183], v5
 v_smfmac_f32_16x16x64_bf16 v[60:63], v[16:19], a[184:191], v5
 ds_read_b128 v[16:19], v0 offset:0
 s_waitcnt lgkmcnt(2)
 s_barrier
 ds_read_b128 v[64:67], v0 offset:13312
 ds_read_b128 v[40:43], v0 offset:9216
 ds_read_b128 v[44:47], v0 offset:10240
 ds_read_b128 v[48:51], v0 offset:11264
 ds_read_b128 v[52:55], v0 offset:12288
 v_smfmac_f32_16x16x64_bf16 v[56:59], v[20:23], a[16:23], v5
 v_smfmac_f32_16x16x64_bf16 v[60:63], v[20:23], a[24:31], v5
 ds_read_b128 v[20:23], v0 offset:1024
 v_smfmac_f32_16x16x64_bf16 v[56:59], v[8:11], a[64:71], v5
 v_smfmac_f32_16x16x64_bf16 v[60:63], v[8:11], a[72:79], v5
 s_waitcnt lgkmcnt(7)
 s_waitcnt lgkmcnt(5)
 v_smfmac_f32_16x16x64_bf16 v[56:59], v[12:15], a[96:103], v5
 v_add_f32 v64, v64, v65
 v_smfmac_f32_16x16x64_bf16 v[60:63], v[12:15], a[104:111], v5
 s_waitcnt lgkmcnt(3)
 v_add_f32 v66, v66, v67
 v_smfmac_f32_16x16x64_bf16 v[56:59], v[16:19], v[24:31], v5
 v_pk_add_f32 v[40:41], v[40:41], v[44:45]
 v_smfmac_f32_16x16x64_bf16 v[60:63], v[16:19], v[32:39], v5
 s_waitcnt lgkmcnt(2)
 v_pk_add_f32 v[42:43], v[42:43], v[46:47]
 v_pk_add_f32 v[40:41], v[40:41], v[48:49]
 v_pk_add_f32 v[42:43], v[42:43], v[50:51]
 v_add_f32 v64, v64, v66
 s_waitcnt lgkmcnt(1)
 v_pk_add_f32 v[44:45], v[40:41], v[52:53]
 v_pk_add_f32 v[46:47], v[42:43], v[54:55]
 s_waitcnt lgkmcnt(0)
 v_smfmac_f32_16x16x64_bf16 v[56:59], v[20:23], a[240:247], v5
 v_max3_f32 v68, v44, v45, v46
 v_mov_b64 v[48:49], s[70:71]
 v_smfmac_f32_16x16x64_bf16 v[60:63], v[20:23], a[248:255], v5
 ds_read_b128 v[24:27], v1 offset:24576
 v_max3_f32 v68, v68, v47, v64
 v_mov_b64 v[50:51], s[72:73]
 ds_read_b128 v[28:31], v1 offset:25600
 v_max_f32_dpp v69, v68, v68 row_ror:8 row_mask:0xf bank_mask:0xf
 v_max_f32_dpp v68, v68, v68 row_ror:8 row_mask:0xf bank_mask:0xf
 ds_read_b128 v[32:35], v1 offset:26624
 ds_read_b128 v[36:39], v1 offset:27648
 v_permlane32_swap_b32 v68, v69
 v_max_f32 v70, v68, v69
 v_max_f32 v71, v68, v69
 ds_read_b128 v[8:11], v1 offset:20480
 ds_read_b128 v[12:15], v1 offset:21504
 v_permlane16_swap_b32 v70, v71
 ds_read_b128 v[16:19], v1 offset:22528
 v_max_f32 v68, v70, v71
 v_sub_f32 v64, v64, v68
 v_pk_add_f32 v[44:45], v[44:45], v[68:69] op_sel_hi:[1,0] neg_lo:[0,1] neg_hi:[0,1]
 v_pk_add_f32 v[46:47], v[46:47], v[68:69] op_sel_hi:[1,0] neg_lo:[0,1] neg_hi:[0,1]
 v_exp_f32 v64, v64
 ds_read_b128 v[20:23], v1 offset:23552
 v_exp_f32 v44, v44
 v_mov_b32_dpp v65, v64 row_ror:8 row_mask:0xf bank_mask:0xf
 v_exp_f32 v45, v45
 v_cvt_pk_bf16_f32 v56, v56, v57
 v_exp_f32 v46, v46
 v_cvt_pk_bf16_f32 v40, v64, v65
 v_cvt_pk_bf16_f32 v41, v64, v65
 v_exp_f32 v47, v47
 v_cvt_pk_bf16_f32 v57, v58, v59
 v_cvt_pk_bf16_f32 v42, v44, v45
 v_permlane32_swap_b32 v40, v41
 v_cvt_pk_bf16_f32 v58, v60, v61
 v_cvt_pk_bf16_f32 v43, v46, v47
 v_cvt_pk_bf16_f32 v59, v62, v63
 s_add_u32 s33, s58, 37748736
 v_mov_b32_dpp v44, v42 row_ror:8 row_mask:0xf bank_mask:0xf
 s_cmp_eq_u32 s41, 63
 v_mov_b32_dpp v45, v43 row_ror:8 row_mask:0xf bank_mask:0xf
 s_cbranch_scc1 L_lastfio
 v_mfma_f32_16x16x32_bf16 v[52:55], v[48:51], v[40:43], 0
 v_lshrrev_b32 v46, 1, v0
 v_and_b32 v47, 0x70, v0
 v_mfma_f32_16x16x16_bf16 v[64:67], v[56:57], v[40:41], 0
 v_and_b32 v46, 0x180, v46
 v_mov_b64 v[60:61], 0
 v_mfma_f32_16x16x16_bf16 v[68:71], v[58:59], v[40:41], 0
 v_or_b32 v46, v46, v47
 v_mov_b64 v[62:63], 0
 buffer_store_dwordx4 v[56:59], v0, s[4:7], s33 offen offset:1024 sc1
 s_waitcnt vmcnt(8)
 v_mfma_f32_16x16x32_bf16 v[64:67], v[72:75], v[42:45], v[64:67]
 v_add_f32_dpp v52, v52, v52 row_ror:8 row_mask:0xf bank_mask:0xf
 v_bfe_u32 v47, v0, 7, 1
 s_waitcnt vmcnt(7)
 v_mfma_f32_16x16x32_bf16 v[68:71], v[76:79], v[42:45], v[68:71]
 v_rcp_f32 v52, v52
 v_lshl_add_u32 v47, v47, 9, v46
 v_mov_b64 v[48:49], 0
 v_mov_b64 v[50:51], 0
 v_mov_b64 v[56:57], 0
 v_mov_b64 v[58:59], 0
 v_pk_mul_f32 v[64:65], v[64:65], v[52:53] op_sel_hi:[1,0]
 v_pk_mul_f32 v[66:67], v[66:67], v[52:53] op_sel_hi:[1,0]
 v_pk_mul_f32 v[68:69], v[68:69], v[52:53] op_sel_hi:[1,0]
 v_pk_mul_f32 v[70:71], v[70:71], v[52:53] op_sel_hi:[1,0]
 v_cvt_pk_bf16_f32 v64, v64, v65
 v_cvt_pk_bf16_f32 v65, v66, v67
 v_cvt_pk_bf16_f32 v66, v68, v69
 v_cvt_pk_bf16_f32 v67, v70, v71
 s_mov_b64 exec, s[56:57]
 ds_write_b128 v46, v[64:67] offset:15872
 s_mov_b64 exec, -1
 v_mov_b32_dpp v64, v64 row_ror:8 row_mask:0xf bank_mask:0xc
 v_mov_b32_dpp v65, v65 row_ror:8 row_mask:0xf bank_mask:0xc
 v_mov_b32_dpp v66, v66 row_ror:8 row_mask:0xf bank_mask:0xc
 v_mov_b32_dpp v67, v67 row_ror:8 row_mask:0xf bank_mask:0xc
 s_bfe_u32 s52, s41, 0x10001
 s_sub_u32 s45, 0, s52
 s_waitcnt lgkmcnt(5)
 v_smfmac_f32_16x16x64_bf16 v[48:51], v[64:67], v[32:39], v5
 ds_read_b128 v[32:35], v1 offset:34816
 ds_read_b128 v[36:39], v1 offset:35840
 v_mov_b64 v[52:53], 0
 v_smfmac_f32_16x16x64_bf16 v[56:59], v[64:67], v[200:207], v5
 v_mov_b64 v[54:55], 0
 v_smfmac_f32_16x16x64_bf16 v[60:63], v[64:67], v[232:239], v5
 s_add_u32 s33, s48, s47
 s_add_u32 s34, s59, s47
 s_waitcnt lgkmcnt(2)
 s_barrier
 ds_read_b128 v[68:71], v46 offset:14336
 ds_read_b128 v[72:75], v46 offset:14848
 ds_read_b128 v[76:79], v46 offset:15360
 ds_read_b128 v[40:43], v47 offset:14336
 ds_read_b128 v[44:47], v47 offset:15360
 s_waitcnt lgkmcnt(4)
 v_smfmac_f32_16x16x64_bf16 v[48:51], v[68:71], v[8:15], v5
 ds_read_b128 v[8:11], v1 offset:28672
 s_waitcnt lgkmcnt(4)
 v_smfmac_f32_16x16x64_bf16 v[48:51], v[72:75], v[16:23], v5
 ds_read_b128 v[12:15], v1 offset:29696
 s_waitcnt lgkmcnt(4)
 v_smfmac_f32_16x16x64_bf16 v[48:51], v[76:79], v[24:31], v5
 ds_read_b128 v[16:19], v1 offset:30720
 s_waitcnt lgkmcnt(4)
 v_smfmac_f32_16x16x64_bf16 v[52:55], v[40:43], v[240:247], v5
 ds_read_b128 v[20:23], v1 offset:31744
 s_waitcnt lgkmcnt(4)
 v_smfmac_f32_16x16x64_bf16 v[52:55], v[44:47], v[248:255], v5
 ds_read_b128 v[24:27], v1 offset:32768
 v_cvt_pk_bf16_f32 v48, v48, v49
 v_smfmac_f32_16x16x64_bf16 v[56:59], v[68:71], v[176:183], v5
 ds_read_b128 v[28:31], v1 offset:33792
 s_add_u32 s35, s33, 131072
 v_cvt_pk_bf16_f32 v49, v50, v51
 v_smfmac_f32_16x16x64_bf16 v[56:59], v[72:75], v[184:191], v5
 v_and_or_b32 v48, v48, -2, s52
 v_permlane32_swap_b32 v52, v54
 v_smfmac_f32_16x16x64_bf16 v[56:59], v[76:79], v[192:199], v5
 buffer_store_dwordx2 v[48:49], v3, s[4:7], s35 offen sc1
 v_permlane32_swap_b32 v53, v55
 v_smfmac_f32_16x16x64_bf16 v[60:63], v[68:71], v[208:215], v5
 v_mov_b64 v[40:41], 0
 v_add_f32 v52, v52, v54
 v_smfmac_f32_16x16x64_bf16 v[60:63], v[72:75], v[216:223], v5
 v_mov_b64 v[42:43], 0
 v_add_f32 v53, v53, v55
 v_smfmac_f32_16x16x64_bf16 v[60:63], v[76:79], v[224:231], v5
 s_add_u32 s35, s33, 0
 v_cvt_pk_bf16_f32 v56, v56, v57
 v_cvt_pk_bf16_f32 v52, v52, v53
 v_smfmac_f32_16x16x64_bf16 v[40:43], v[64:67], v[32:39], v5
 v_cvt_pk_bf16_f32 v57, v58, v59
 v_and_or_b32 v52, v52, -2, s52
 s_waitcnt lgkmcnt(4)
 v_smfmac_f32_16x16x64_bf16 v[40:43], v[68:71], v[8:15], v5
 buffer_store_dword v52, v2, s[4:7], s34 offen sc1
 v_and_or_b32 v56, v56, -2, s52
 v_cvt_pk_bf16_f32 v60, v60, v61
 s_waitcnt lgkmcnt(2)
 v_smfmac_f32_16x16x64_bf16 v[40:43], v[72:75], v[16:23], v5
 buffer_store_dwordx2 v[56:57], v3, s[4:7], s35 offen sc1
 s_add_u32 s35, s33, 65536
 v_cvt_pk_bf16_f32 v61, v62, v63
 s_waitcnt lgkmcnt(0)
 v_smfmac_f32_16x16x64_bf16 v[40:43], v[76:79], v[24:31], v5
 v_and_or_b32 v60, v60, -2, s52
 buffer_store_dwordx2 v[60:61], v3, s[4:7], s35 offen sc1
 s_add_u32 s35, s33, 196608
 s_mov_b32 s36, s42
 s_mov_b32 s42, s43
 s_mov_b32 s43, s44
 s_mov_b32 s44, s36
 s_xor_b32 s47, s47, 294912
 s_add_u32 s41, s41, 1
 s_add_u32 s58, s58, 262144
 v_cvt_pk_bf16_f32 v40, v40, v41
 v_cvt_pk_bf16_f32 v41, v42, v43
 v_and_or_b32 v40, v40, -2, s52
 buffer_store_dwordx2 v[40:41], v3, s[4:7], s35 offen sc1
 s_branch L_csfio
L_lastfio:
 buffer_store_dwordx4 v[56:59], v0, s[4:7], s33 offen offset:1024 sc1
 s_branch L_chx
L_chx:
 s_waitcnt vmcnt(0)
 s_barrier
 s_cmp_lg_u32 s14, 3
 s_cbranch_scc1 L_x102
 v_lshlrev_b32 v60, 3, v0
 v_mov_b32 v61, 64
 s_lshl_b32 s35, s40, 7
 s_add_u32 s35, s35, 4096
 s_mov_b64 exec, 1
 buffer_store_dword v61, v60, s[4:7], s35 offen sc1
 s_mov_b64 exec, -1
L_x102:
L_exit:
 s_endpgm
.section .rodata,"a"
.p2align 6
.amdhsa_kernel parallel_sum__memory_aug_recurrent_mem_tr__dense_activation_relu__prompt_kernel
  .amdhsa_next_free_vgpr 512
  .amdhsa_next_free_sgpr 102
  .amdhsa_accum_offset 256
  .amdhsa_group_segment_fixed_size 0
  .amdhsa_kernarg_size 104
  .amdhsa_user_sgpr_count 2
  .amdhsa_user_sgpr_kernarg_segment_ptr 1
  .amdhsa_system_sgpr_workgroup_id_x 1
.end_amdhsa_kernel
```
